```python
import torch

def _softmax(x, axis=-1):
    return torch.softmax(x, dim=axis)
def _gelu(x):
    return torch.nn.functional.gelu(x, approximate="tanh")
def _silu(x):
    return torch.nn.functional.silu(x)
def _sigmoid(x):
    return torch.sigmoid(x)
def _layernorm(x, axis=-1, eps=1e-5):
    m = x.mean(dim=axis, keepdim=True)
    v = x.var(dim=axis, keepdim=True, unbiased=False)
    return (x - m) / torch.sqrt(v + eps)
def _scatter_add(tgt, idx, src, axis=0):
    return tgt.clone().index_add_(axis, idx, src)
def _segment_sum(src, seg, n):
    out = torch.zeros((n,) + src.shape[1:], dtype=src.dtype)
    return out.index_add_(0, seg, src)
def _pad(x, pw):
    flat = tuple(v for pair in reversed(pw) for v in pair)
    return torch.nn.functional.pad(x, flat)

kernel_name = 'concat_heads__mha_block_cached__mha_block_cached__near_ridge'

def setup_inputs():

    _w = (lambda a: (lambda t: t.to(torch.bfloat16) if t.is_floating_point() else t)(torch.as_tensor(a)))
    def _A_setup():
        B, Sq, D = 16, 192, 576
        H, Sk, Dh = 32, 512, 128
        return {
            "x": _w((lambda *s: torch.randn(*s, dtype=torch.bfloat16) * 0.8)(B, Sq, D)),
            "k_cache": _w((lambda *s: torch.randn(*s, dtype=torch.bfloat16) * 0.8)(B, H, Sk, Dh)),
            "v_cache": _w((lambda *s: torch.randn(*s, dtype=torch.bfloat16) * 0.05)(B, H, Sk, Dh)),
            "wq": _w((lambda *s: torch.randn(*s, dtype=torch.bfloat16) * 0.8)(D, H * Dh) * (D ** -0.5)),
            "wo": _w((lambda *s: torch.randn(*s, dtype=torch.bfloat16) * 0.05)(H * Dh, D) * ((H * Dh) ** -0.5)),
        }
    _A_in = _A_setup()

    def _B_setup():
        B, Sq, D = 16, 192, 576
        H, Sk, Dh = 32, 512, 128
        return {
            "x": _w((lambda *s: torch.randn(*s, dtype=torch.bfloat16) * 0.8)(B, Sq, D)),
            "k_cache": _w((lambda *s: torch.randn(*s, dtype=torch.bfloat16) * 0.8)(B, H, Sk, Dh)),
            "v_cache": _w((lambda *s: torch.randn(*s, dtype=torch.bfloat16) * 0.05)(B, H, Sk, Dh)),
            "wq": _w((lambda *s: torch.randn(*s, dtype=torch.bfloat16) * 0.8)(D, H * Dh) * (D ** -0.5)),
            "wo": _w((lambda *s: torch.randn(*s, dtype=torch.bfloat16) * 0.05)(H * Dh, D) * ((H * Dh) ** -0.5)),
        }
    _B_in = _B_setup()

    return {
        "A_x": _A_in["x"],
        "A_k_cache": _A_in["k_cache"],
        "A_v_cache": _A_in["v_cache"],
        "A_wq": _A_in["wq"],
        "A_wo": _A_in["wo"],
        "B_x": _B_in["x"],
        "B_k_cache": _B_in["k_cache"],
        "B_v_cache": _B_in["v_cache"],
        "B_wq": _B_in["wq"],
        "B_wo": _B_in["wo"],
    }

def reference(A_x, A_k_cache, A_v_cache, A_wq, A_wo, B_x, B_k_cache, B_v_cache, B_wq, B_wo):
    def _A_ref(x, k_cache, v_cache, wq, wo):
        B, Sq, D = x.shape
        H, Dh = 32, 128
        q = (lambda x, *d: x.permute(*d))((x @ wq).reshape(B, Sq, H, Dh), 0, 2, 1, 3)
        scores = torch.einsum("bhqd,bhkd->bhqk", q, k_cache) * (Dh ** -0.5)
        p = _softmax(scores, axis=-1)
        o = torch.einsum("bhqk,bhkd->bhqd", p, v_cache)
        return (lambda x, *d: x.permute(*d))(o, 0, 2, 1, 3).reshape(B, Sq, H * Dh) @ wo

    def _B_ref(x, k_cache, v_cache, wq, wo):
        B, Sq, D = x.shape
        H, Dh = 32, 128
        q = (lambda x, *d: x.permute(*d))((x @ wq).reshape(B, Sq, H, Dh), 0, 2, 1, 3)
        scores = torch.einsum("bhqd,bhkd->bhqk", q, k_cache) * (Dh ** -0.5)
        p = _softmax(scores, axis=-1)
        o = torch.einsum("bhqk,bhkd->bhqd", p, v_cache)
        return (lambda x, *d: x.permute(*d))(o, 0, 2, 1, 3).reshape(B, Sq, H * Dh) @ wo

    a = _A_ref(A_x, A_k_cache, A_v_cache, A_wq, A_wo)
    b = _B_ref(B_x, B_k_cache, B_v_cache, B_wq, B_wo)
    return torch.concatenate([a, b], axis=-1)
```

```asm
; @launch kernel=k1_kernel grid=(256,1,1) block=(512,1,1) lds=163840
; @launch kernel=k3_kernel grid=(1728,1,1) block=(256,1,1) lds=0
.amdgcn_target "amdgcn-amd-amdhsa--gfx950"
.text
.globl k1_kernel
.p2align 8
.type k1_kernel,@function
k1_kernel:
s_cmp_ge_u32 s2, 256
s_cbranch_scc0 L_go
s_endpgm
L_go:
s_load_dwordx2 s[4:5], s[0:1], 80
s_load_dwordx2 s[6:7], s[0:1], 96
s_load_dwordx2 s[72:73], s[0:1], 88
s_and_b32 s32, s2, 7
s_lshr_b32 s33, s2, 3
s_lshl_b32 s34, s32, 2
s_lshr_b32 s35, s33, 3
s_add_u32 s34, s34, s35
s_and_b32 s35, s33, 7
s_lshr_b32 s36, s34, 4
s_and_b32 s37, s34, 15
s_lshl_b32 s51, s34, 3
s_add_u32 s51, s51, s35
s_mul_i32 s38, s36, 40
s_add_u32 s52, s0, s38
s_addc_u32 s53, s1, 0
s_load_dwordx4 s[40:43], s[52:53], 0
s_load_dwordx4 s[44:47], s[52:53], 16
s_load_dwordx2 s[48:49], s[52:53], 32
v_lshrrev_b32 v1, 6, v0
s_nop 0
v_readfirstlane_b32 s39, v1
v_and_b32 v0, 63, v0
s_and_b32 s50, s39, 3
s_lshr_b32 s3, s39, 2
s_lshl_b32 s58, s3, 9
s_add_u32 s58, s58, 0x10000
s_lshl_b32 s62, s50, 11
s_lshl_b32 s63, s3, 10
s_add_u32 s63, s63, s62
s_add_u32 s62, s62, s58
s_and_b32 s54, s50, 1
v_and_b32 v1, 3, v0
v_xor_b32 v1, s54, v1
v_lshrrev_b32 v7, 4, v0
v_lshl_add_u32 v1, v7, 2, v1
v_lshlrev_b32 v1, 4, v1
v_bfe_u32 v7, v0, 2, 2
v_lshl_add_u32 v1, v7, 13, v1
s_lshl_b32 s54, s50, 16
s_lshl_b32 s55, s3, 15
s_add_u32 s54, s54, s55
v_add_u32 v8, s54, v1
s_lshl_b32 s54, s3, 2
v_lshrrev_b32 v7, 4, v0
v_add_u32 v7, s54, v7
v_and_b32 v1, 7, v0
v_xor_b32 v1, v1, v7
v_lshrrev_b32 v7, 3, v0
v_mul_u32_u24 v7, 0x480, v7
v_lshl_add_u32 v1, v1, 4, v7
s_mul_i32 s54, s50, 0xd800
s_mul_i32 s55, s3, 0x2400
s_add_u32 s54, s54, s55
v_add_u32 v9, s54, v1
s_waitcnt lgkmcnt(0)
s_lshl_b32 s54, s35, 10
s_add_u32 s16, s46, s54
s_addc_u32 s17, s47, 0
s_sub_u32 s18, 0x480000, s54
s_mov_b32 s19, 0x20000
s_mul_i32 s54, s37, 0x36000
s_add_u32 s20, s40, s54
s_addc_u32 s21, s41, 0
s_mov_b32 s22, 0x36000
s_mov_b32 s23, 0x20000
s_add_u32 m0, s63, 0x10000
s_mov_b32 s66, 0
buffer_load_dwordx4 v8, s[16:19], s66 offen lds
s_add_u32 m0, s63, 0x8000
s_mov_b32 s66, 0
buffer_load_dwordx4 v9, s[20:23], s66 offen lds
s_add_u32 m0, s63, 0xa000
s_mov_b32 s66, 0x4800
buffer_load_dwordx4 v9, s[20:23], s66 offen lds
s_add_u32 m0, s63, 0xc000
s_mov_b32 s66, 0x9000
buffer_load_dwordx4 v9, s[20:23], s66 offen lds
s_add_u32 m0, s63, 0x12000
s_mov_b32 s66, 0x40000
buffer_load_dwordx4 v8, s[16:19], s66 offen lds
s_add_u32 m0, s63, 0x14000
s_mov_b32 s66, 0x80000
buffer_load_dwordx4 v8, s[16:19], s66 offen lds
s_add_u32 m0, s63, 0x20000
s_mov_b32 s66, 0x80
buffer_load_dwordx4 v9, s[20:23], s66 offen lds
s_add_u32 m0, s63, 0x22000
s_mov_b32 s66, 0x4880
buffer_load_dwordx4 v9, s[20:23], s66 offen lds
s_add_u32 m0, s63, 0x24000
s_mov_b32 s66, 0x9080
buffer_load_dwordx4 v9, s[20:23], s66 offen lds
s_add_u32 m0, s63, 0x16000
s_mov_b32 s66, 0xc0000
buffer_load_dwordx4 v8, s[16:19], s66 offen lds
s_add_u32 m0, s63, 0x18000
s_mov_b32 s66, 0x100000
buffer_load_dwordx4 v8, s[16:19], s66 offen lds
s_add_u32 m0, s63, 0x26000
s_mov_b32 s66, 0x100
buffer_load_dwordx4 v9, s[20:23], s66 offen lds
s_add_u32 m0, s63, 0x1c000
s_mov_b32 s66, 0x4900
buffer_load_dwordx4 v9, s[20:23], s66 offen lds
s_add_u32 m0, s63, 0x1e000
s_mov_b32 s66, 0x9100
buffer_load_dwordx4 v9, s[20:23], s66 offen lds
s_add_u32 m0, s63, 0x1a000
s_mov_b32 s66, 0x140000
buffer_load_dwordx4 v8, s[16:19], s66 offen lds
s_lshl_b32 s54, s37, 3
s_add_u32 s54, s54, s35
s_lshl_b32 s54, s54, 19
s_add_u32 s8, s42, s54
s_addc_u32 s9, s43, 0
s_mov_b32 s10, 0x80000
s_mov_b32 s11, 0x20000
s_add_u32 s12, s44, s54
s_addc_u32 s13, s45, 0
s_mov_b32 s14, 0x80000
s_mov_b32 s15, 0x20000
s_mov_b32 s24, s6
s_mov_b32 s25, s7
s_mov_b32 s26, 0x3600000
s_mov_b32 s27, 0x20000
s_mul_i32 s54, s35, 0x90000
s_add_u32 s28, s48, s54
s_addc_u32 s29, s49, 0
s_mov_b32 s30, 0x90000
s_mov_b32 s31, 0x20000
s_getpc_b64 s[52:53]
L_cpf:
s_lshr_b32 s54, s2, 3
s_lshl_b32 s54, s54, 3
s_add_u32 s54, s54, s39
s_lshl_b32 s54, s54, 9
v_and_b32 v20, 3, v0
v_lshlrev_b32 v20, 7, v20
v_add_u32 v20, s54, v20
v_min_u32 v20, L_k1_end-L_cpf-8, v20
global_load_dword v21, v20, s[52:53]
v_and_b32 v1, 3, v0
v_bfe_u32 v7, v0, 4, 1
v_xor_b32 v1, v1, v7
v_bfe_u32 v7, v0, 2, 2
v_lshl_add_u32 v1, v7, 2, v1
v_lshrrev_b32 v7, 4, v0
v_lshl_add_u32 v1, v7, 7, v1
v_lshlrev_b32 v1, 4, v1
v_and_b32 v7, 1, v0
v_lshl_add_u32 v1, v7, 3, v1
v_add_u32 v10, s58, v1
v_xor_b32 v11, 8, v10
v_lshrrev_b32 v1, 4, v0
v_bfe_u32 v7, v0, 1, 3
v_xor_b32 v1, v1, v7
v_lshlrev_b32 v1, 4, v1
v_and_b32 v7, 15, v0
v_lshl_add_u32 v1, v7, 7, v1
s_lshl_b32 s54, s50, 11
s_add_u32 s54, s54, 0x1c000
v_add_u32 v12, s54, v1
v_xor_b32 v13, 64, v12
v_subrev_u32 v16, 0x1c000, v12
v_subrev_u32 v17, 0x1c000, v13
s_and_b32 s54, s50, 1
s_lshl_b32 s55, s54, 1
v_and_b32 v1, 3, v0
v_xor_b32 v1, s55, v1
v_lshrrev_b32 v7, 4, v0
v_lshl_add_u32 v1, v7, 2, v1
v_lshlrev_b32 v1, 4, v1
v_bfe_u32 v7, v0, 2, 2
v_lshl_add_u32 v1, v7, 8, v1
s_lshl_b32 s56, s50, 11
s_lshr_b32 s57, s50, 1
s_lshl_b32 s57, s57, 2
s_add_u32 s57, s57, s54
s_lshl_b32 s57, s57, 10
v_add_u32 v14, s56, v1
v_add_u32 v15, s57, v1
s_lshl_b32 s70, s3, 13
s_add_u32 s68, s56, s70
s_add_u32 s69, s57, s70
s_mov_b32 s59, 0x3e0293ee
s_mov_b32 s64, 0xffff0000
s_mov_b32 s65, 0xffff0000
s_waitcnt vmcnt(12)
s_barrier
ds_read_b64_tr_b16 v[40:41], v10
ds_read_b64_tr_b16 v[42:43], v10 offset:1024
ds_read_b64_tr_b16 v[44:45], v11
ds_read_b64_tr_b16 v[46:47], v11 offset:1024
ds_read_b64_tr_b16 v[48:49], v10 offset:256
ds_read_b64_tr_b16 v[50:51], v10 offset:1280
ds_read_b128 v[56:59], v16 offset:32768
ds_read_b128 v[60:63], v16 offset:40960
ds_read_b128 v[64:67], v16 offset:49152
s_waitcnt lgkmcnt(0)
v_mfma_f32_16x16x32_bf16 v[152:155], v[40:43], v[56:59], 0
ds_read_b64_tr_b16 v[52:53], v11 offset:256
v_mfma_f32_16x16x32_bf16 v[184:187], v[40:43], v[60:63], 0
ds_read_b64_tr_b16 v[54:55], v11 offset:1280
v_mfma_f32_16x16x32_bf16 v[216:219], v[40:43], v[64:67], 0
s_waitcnt vmcnt(11)
s_barrier
v_mfma_f32_16x16x32_bf16 v[156:159], v[44:47], v[56:59], 0
ds_read_b64_tr_b16 v[40:41], v10 offset:8192
ds_read_b128 v[68:71], v17 offset:32768
v_mfma_f32_16x16x32_bf16 v[188:191], v[44:47], v[60:63], 0
ds_read_b64_tr_b16 v[42:43], v10 offset:9216
v_mfma_f32_16x16x32_bf16 v[220:223], v[44:47], v[64:67], 0
ds_read_b128 v[72:75], v17 offset:40960
v_mfma_f32_16x16x32_bf16 v[160:163], v[48:51], v[56:59], 0
ds_read_b64_tr_b16 v[44:45], v11 offset:8192
v_mfma_f32_16x16x32_bf16 v[192:195], v[48:51], v[60:63], 0
ds_read_b64_tr_b16 v[46:47], v11 offset:9216
ds_read_b128 v[76:79], v17 offset:49152
v_mfma_f32_16x16x32_bf16 v[224:227], v[48:51], v[64:67], 0
s_waitcnt lgkmcnt(7)
v_mfma_f32_16x16x32_bf16 v[164:167], v[52:55], v[56:59], 0
ds_read_b64_tr_b16 v[48:49], v10 offset:8448
v_mfma_f32_16x16x32_bf16 v[196:199], v[52:55], v[60:63], 0
ds_read_b64_tr_b16 v[50:51], v10 offset:9472
v_mfma_f32_16x16x32_bf16 v[228:231], v[52:55], v[64:67], 0
s_waitcnt lgkmcnt(2)
v_mfma_f32_16x16x32_bf16 v[152:155], v[40:43], v[68:71], v[152:155]
ds_read_b64_tr_b16 v[52:53], v11 offset:8448
v_mfma_f32_16x16x32_bf16 v[184:187], v[40:43], v[72:75], v[184:187]
ds_read_b64_tr_b16 v[54:55], v11 offset:9472
v_mfma_f32_16x16x32_bf16 v[216:219], v[40:43], v[76:79], v[216:219]
s_waitcnt vmcnt(7)
s_barrier
v_mfma_f32_16x16x32_bf16 v[156:159], v[44:47], v[68:71], v[156:159]
ds_read_b64_tr_b16 v[40:41], v10 offset:16384
ds_read_b128 v[56:59], v12 offset:16384
s_add_u32 m0, s63, 0x10000
s_mov_b32 s66, 0x180000
v_mfma_f32_16x16x32_bf16 v[188:191], v[44:47], v[72:75], v[188:191]
ds_read_b64_tr_b16 v[42:43], v10 offset:17408
buffer_load_dwordx4 v8, s[16:19], s66 offen lds
v_mfma_f32_16x16x32_bf16 v[220:223], v[44:47], v[76:79], v[220:223]
ds_read_b128 v[60:63], v12 offset:24576
s_add_u32 m0, s63, 0x8000
s_waitcnt lgkmcnt(6)
v_mfma_f32_16x16x32_bf16 v[160:163], v[48:51], v[68:71], v[160:163]
ds_read_b64_tr_b16 v[44:45], v11 offset:16384
s_mov_b32 s66, 0x180
v_mfma_f32_16x16x32_bf16 v[192:195], v[48:51], v[72:75], v[192:195]
ds_read_b64_tr_b16 v[46:47], v11 offset:17408
ds_read_b128 v[64:67], v12 offset:32768
buffer_load_dwordx4 v9, s[20:23], s66 offen lds
v_mfma_f32_16x16x32_bf16 v[224:227], v[48:51], v[76:79], v[224:227]
s_add_u32 m0, s63, 0xa000
s_waitcnt lgkmcnt(7)
v_mfma_f32_16x16x32_bf16 v[164:167], v[52:55], v[68:71], v[164:167]
ds_read_b64_tr_b16 v[48:49], v10 offset:16640
s_mov_b32 s66, 0x4980
v_mfma_f32_16x16x32_bf16 v[196:199], v[52:55], v[72:75], v[196:199]
ds_read_b64_tr_b16 v[50:51], v10 offset:17664
buffer_load_dwordx4 v9, s[20:23], s66 offen lds
v_mfma_f32_16x16x32_bf16 v[228:231], v[52:55], v[76:79], v[228:231]
s_add_u32 m0, s63, 0xc000
s_waitcnt lgkmcnt(2)
v_mfma_f32_16x16x32_bf16 v[152:155], v[40:43], v[56:59], v[152:155]
ds_read_b64_tr_b16 v[52:53], v11 offset:16640
s_mov_b32 s66, 0x9180
v_mfma_f32_16x16x32_bf16 v[184:187], v[40:43], v[60:63], v[184:187]
ds_read_b64_tr_b16 v[54:55], v11 offset:17664
buffer_load_dwordx4 v9, s[20:23], s66 offen lds
v_mfma_f32_16x16x32_bf16 v[216:219], v[40:43], v[64:67], v[216:219]
s_waitcnt vmcnt(10)
s_barrier
v_mfma_f32_16x16x32_bf16 v[156:159], v[44:47], v[56:59], v[156:159]
ds_read_b64_tr_b16 v[40:41], v10 offset:24576
ds_read_b128 v[68:71], v13 offset:16384
s_add_u32 m0, s63, 0x12000
v_mfma_f32_16x16x32_bf16 v[188:191], v[44:47], v[60:63], v[188:191]
ds_read_b64_tr_b16 v[42:43], v10 offset:25600
v_mfma_f32_16x16x32_bf16 v[220:223], v[44:47], v[64:67], v[220:223]
ds_read_b128 v[72:75], v13 offset:24576
s_waitcnt lgkmcnt(6)
v_mfma_f32_16x16x32_bf16 v[160:163], v[48:51], v[56:59], v[160:163]
ds_read_b64_tr_b16 v[44:45], v11 offset:24576
s_mov_b32 s66, 0x1c0000
v_mfma_f32_16x16x32_bf16 v[192:195], v[48:51], v[60:63], v[192:195]
ds_read_b64_tr_b16 v[46:47], v11 offset:25600
ds_read_b128 v[76:79], v13 offset:32768
v_mfma_f32_16x16x32_bf16 v[224:227], v[48:51], v[64:67], v[224:227]
s_waitcnt lgkmcnt(7)
v_mfma_f32_16x16x32_bf16 v[164:167], v[52:55], v[56:59], v[164:167]
ds_read_b64_tr_b16 v[48:49], v10 offset:24832
v_mfma_f32_16x16x32_bf16 v[196:199], v[52:55], v[60:63], v[196:199]
ds_read_b64_tr_b16 v[50:51], v10 offset:25856
buffer_load_dwordx4 v8, s[16:19], s66 offen lds
v_mfma_f32_16x16x32_bf16 v[228:231], v[52:55], v[64:67], v[228:231]
s_waitcnt lgkmcnt(2)
v_mfma_f32_16x16x32_bf16 v[152:155], v[40:43], v[68:71], v[152:155]
ds_read_b64_tr_b16 v[52:53], v11 offset:24832
v_mfma_f32_16x16x32_bf16 v[184:187], v[40:43], v[72:75], v[184:187]
ds_read_b64_tr_b16 v[54:55], v11 offset:25856
v_mfma_f32_16x16x32_bf16 v[216:219], v[40:43], v[76:79], v[216:219]
s_waitcnt vmcnt(7)
s_barrier
v_mfma_f32_16x16x32_bf16 v[156:159], v[44:47], v[68:71], v[156:159]
ds_read_b64_tr_b16 v[40:41], v10 offset:32768
ds_read_b128 v[56:59], v12 offset:40960
s_add_u32 m0, s63, 0x14000
s_mov_b32 s66, 0x200000
v_mfma_f32_16x16x32_bf16 v[188:191], v[44:47], v[72:75], v[188:191]
ds_read_b64_tr_b16 v[42:43], v10 offset:33792
buffer_load_dwordx4 v8, s[16:19], s66 offen lds
v_mfma_f32_16x16x32_bf16 v[220:223], v[44:47], v[76:79], v[220:223]
ds_read_b128 v[60:63], v12
s_add_u32 m0, s63, 0x20000
s_waitcnt lgkmcnt(6)
v_mfma_f32_16x16x32_bf16 v[160:163], v[48:51], v[68:71], v[160:163]
ds_read_b64_tr_b16 v[44:45], v11 offset:32768
s_mov_b32 s66, 0x200
v_mfma_f32_16x16x32_bf16 v[192:195], v[48:51], v[72:75], v[192:195]
ds_read_b64_tr_b16 v[46:47], v11 offset:33792
ds_read_b128 v[64:67], v12 offset:8192
buffer_load_dwordx4 v9, s[20:23], s66 offen lds
v_mfma_f32_16x16x32_bf16 v[224:227], v[48:51], v[76:79], v[224:227]
s_add_u32 m0, s63, 0x22000
s_waitcnt lgkmcnt(7)
v_mfma_f32_16x16x32_bf16 v[164:167], v[52:55], v[68:71], v[164:167]
ds_read_b64_tr_b16 v[48:49], v10 offset:33024
s_mov_b32 s66, 0x4a00
v_mfma_f32_16x16x32_bf16 v[196:199], v[52:55], v[72:75], v[196:199]
ds_read_b64_tr_b16 v[50:51], v10 offset:34048
buffer_load_dwordx4 v9, s[20:23], s66 offen lds
v_mfma_f32_16x16x32_bf16 v[228:231], v[52:55], v[76:79], v[228:231]
s_add_u32 m0, s63, 0x24000
s_waitcnt lgkmcnt(2)
v_mfma_f32_16x16x32_bf16 v[152:155], v[40:43], v[56:59], v[152:155]
ds_read_b64_tr_b16 v[52:53], v11 offset:33024
s_mov_b32 s66, 0x9200
v_mfma_f32_16x16x32_bf16 v[184:187], v[40:43], v[60:63], v[184:187]
ds_read_b64_tr_b16 v[54:55], v11 offset:34048
buffer_load_dwordx4 v9, s[20:23], s66 offen lds
v_mfma_f32_16x16x32_bf16 v[216:219], v[40:43], v[64:67], v[216:219]
s_waitcnt vmcnt(10)
s_barrier
v_mfma_f32_16x16x32_bf16 v[156:159], v[44:47], v[56:59], v[156:159]
ds_read_b64_tr_b16 v[40:41], v10 offset:40960
ds_read_b128 v[68:71], v13 offset:40960
s_add_u32 m0, s63, 0x16000
v_mfma_f32_16x16x32_bf16 v[188:191], v[44:47], v[60:63], v[188:191]
ds_read_b64_tr_b16 v[42:43], v10 offset:41984
v_mfma_f32_16x16x32_bf16 v[220:223], v[44:47], v[64:67], v[220:223]
ds_read_b128 v[72:75], v13
s_waitcnt lgkmcnt(6)
v_mfma_f32_16x16x32_bf16 v[160:163], v[48:51], v[56:59], v[160:163]
ds_read_b64_tr_b16 v[44:45], v11 offset:40960
s_mov_b32 s66, 0x240000
v_mfma_f32_16x16x32_bf16 v[192:195], v[48:51], v[60:63], v[192:195]
ds_read_b64_tr_b16 v[46:47], v11 offset:41984
ds_read_b128 v[76:79], v13 offset:8192
v_mfma_f32_16x16x32_bf16 v[224:227], v[48:51], v[64:67], v[224:227]
s_waitcnt lgkmcnt(7)
v_mfma_f32_16x16x32_bf16 v[164:167], v[52:55], v[56:59], v[164:167]
ds_read_b64_tr_b16 v[48:49], v10 offset:41216
v_mfma_f32_16x16x32_bf16 v[196:199], v[52:55], v[60:63], v[196:199]
ds_read_b64_tr_b16 v[50:51], v10 offset:42240
buffer_load_dwordx4 v8, s[16:19], s66 offen lds
v_mfma_f32_16x16x32_bf16 v[228:231], v[52:55], v[64:67], v[228:231]
s_waitcnt lgkmcnt(2)
v_mfma_f32_16x16x32_bf16 v[152:155], v[40:43], v[68:71], v[152:155]
ds_read_b64_tr_b16 v[52:53], v11 offset:41216
v_mfma_f32_16x16x32_bf16 v[184:187], v[40:43], v[72:75], v[184:187]
ds_read_b64_tr_b16 v[54:55], v11 offset:42240
v_mfma_f32_16x16x32_bf16 v[216:219], v[40:43], v[76:79], v[216:219]
s_waitcnt vmcnt(6)
s_barrier
v_mfma_f32_16x16x32_bf16 v[156:159], v[44:47], v[68:71], v[156:159]
ds_read_b64_tr_b16 v[40:41], v10
ds_read_b128 v[56:59], v16 offset:32768
s_add_u32 m0, s63, 0x18000
s_mov_b32 s66, 0x280000
v_mfma_f32_16x16x32_bf16 v[188:191], v[44:47], v[72:75], v[188:191]
ds_read_b64_tr_b16 v[42:43], v10 offset:1024
buffer_load_dwordx4 v8, s[16:19], s66 offen lds
v_mfma_f32_16x16x32_bf16 v[220:223], v[44:47], v[76:79], v[220:223]
ds_read_b128 v[60:63], v16 offset:40960
s_add_u32 m0, s63, 0x26000
s_waitcnt lgkmcnt(6)
v_mfma_f32_16x16x32_bf16 v[160:163], v[48:51], v[68:71], v[160:163]
ds_read_b64_tr_b16 v[44:45], v11
s_mov_b32 s66, 0x280
v_mfma_f32_16x16x32_bf16 v[192:195], v[48:51], v[72:75], v[192:195]
ds_read_b64_tr_b16 v[46:47], v11 offset:1024
ds_read_b128 v[64:67], v16 offset:49152
buffer_load_dwordx4 v9, s[20:23], s66 offen lds
v_mfma_f32_16x16x32_bf16 v[224:227], v[48:51], v[76:79], v[224:227]
s_add_u32 m0, s63, 0x1c000
s_waitcnt lgkmcnt(7)
v_mfma_f32_16x16x32_bf16 v[164:167], v[52:55], v[68:71], v[164:167]
ds_read_b64_tr_b16 v[48:49], v10 offset:256
s_mov_b32 s66, 0x4a80
v_mfma_f32_16x16x32_bf16 v[196:199], v[52:55], v[72:75], v[196:199]
ds_read_b64_tr_b16 v[50:51], v10 offset:1280
buffer_load_dwordx4 v9, s[20:23], s66 offen lds
v_mfma_f32_16x16x32_bf16 v[228:231], v[52:55], v[76:79], v[228:231]
s_add_u32 m0, s63, 0x1e000
s_waitcnt lgkmcnt(2)
v_mfma_f32_16x16x32_bf16 v[152:155], v[40:43], v[56:59], v[152:155]
ds_read_b64_tr_b16 v[52:53], v11 offset:256
s_mov_b32 s66, 0x9280
v_mfma_f32_16x16x32_bf16 v[184:187], v[40:43], v[60:63], v[184:187]
ds_read_b64_tr_b16 v[54:55], v11 offset:1280
buffer_load_dwordx4 v9, s[20:23], s66 offen lds
v_mfma_f32_16x16x32_bf16 v[216:219], v[40:43], v[64:67], v[216:219]
s_waitcnt vmcnt(9)
s_barrier
v_mfma_f32_16x16x32_bf16 v[156:159], v[44:47], v[56:59], v[156:159]
ds_read_b64_tr_b16 v[40:41], v10 offset:8192
ds_read_b128 v[68:71], v17 offset:32768
s_add_u32 m0, s63, 0x1a000
v_mfma_f32_16x16x32_bf16 v[188:191], v[44:47], v[60:63], v[188:191]
ds_read_b64_tr_b16 v[42:43], v10 offset:9216
v_mfma_f32_16x16x32_bf16 v[220:223], v[44:47], v[64:67], v[220:223]
ds_read_b128 v[72:75], v17 offset:40960
s_waitcnt lgkmcnt(6)
v_mfma_f32_16x16x32_bf16 v[160:163], v[48:51], v[56:59], v[160:163]
ds_read_b64_tr_b16 v[44:45], v11 offset:8192
s_mov_b32 s66, 0x2c0000
v_mfma_f32_16x16x32_bf16 v[192:195], v[48:51], v[60:63], v[192:195]
ds_read_b64_tr_b16 v[46:47], v11 offset:9216
ds_read_b128 v[76:79], v17 offset:49152
v_mfma_f32_16x16x32_bf16 v[224:227], v[48:51], v[64:67], v[224:227]
s_waitcnt lgkmcnt(7)
v_mfma_f32_16x16x32_bf16 v[164:167], v[52:55], v[56:59], v[164:167]
ds_read_b64_tr_b16 v[48:49], v10 offset:8448
v_mfma_f32_16x16x32_bf16 v[196:199], v[52:55], v[60:63], v[196:199]
ds_read_b64_tr_b16 v[50:51], v10 offset:9472
buffer_load_dwordx4 v8, s[16:19], s66 offen lds
v_mfma_f32_16x16x32_bf16 v[228:231], v[52:55], v[64:67], v[228:231]
s_waitcnt lgkmcnt(2)
v_mfma_f32_16x16x32_bf16 v[152:155], v[40:43], v[68:71], v[152:155]
ds_read_b64_tr_b16 v[52:53], v11 offset:8448
v_mfma_f32_16x16x32_bf16 v[184:187], v[40:43], v[72:75], v[184:187]
ds_read_b64_tr_b16 v[54:55], v11 offset:9472
v_mfma_f32_16x16x32_bf16 v[216:219], v[40:43], v[76:79], v[216:219]
s_waitcnt vmcnt(6)
s_barrier
v_mfma_f32_16x16x32_bf16 v[156:159], v[44:47], v[68:71], v[156:159]
ds_read_b64_tr_b16 v[40:41], v10 offset:16384
ds_read_b128 v[56:59], v12 offset:16384
s_add_u32 m0, s63, 0x10000
s_mov_b32 s66, 0x300000
v_mfma_f32_16x16x32_bf16 v[188:191], v[44:47], v[72:75], v[188:191]
ds_read_b64_tr_b16 v[42:43], v10 offset:17408
buffer_load_dwordx4 v8, s[16:19], s66 offen lds
v_mfma_f32_16x16x32_bf16 v[220:223], v[44:47], v[76:79], v[220:223]
ds_read_b128 v[60:63], v12 offset:24576
s_add_u32 m0, s63, 0x8000
s_waitcnt lgkmcnt(6)
v_mfma_f32_16x16x32_bf16 v[160:163], v[48:51], v[68:71], v[160:163]
ds_read_b64_tr_b16 v[44:45], v11 offset:16384
s_mov_b32 s66, 0x300
v_mfma_f32_16x16x32_bf16 v[192:195], v[48:51], v[72:75], v[192:195]
ds_read_b64_tr_b16 v[46:47], v11 offset:17408
ds_read_b128 v[64:67], v12 offset:32768
buffer_load_dwordx4 v9, s[20:23], s66 offen lds
v_mfma_f32_16x16x32_bf16 v[224:227], v[48:51], v[76:79], v[224:227]
s_add_u32 m0, s63, 0xa000
s_waitcnt lgkmcnt(7)
v_mfma_f32_16x16x32_bf16 v[164:167], v[52:55], v[68:71], v[164:167]
ds_read_b64_tr_b16 v[48:49], v10 offset:16640
s_mov_b32 s66, 0x4b00
v_mfma_f32_16x16x32_bf16 v[196:199], v[52:55], v[72:75], v[196:199]
ds_read_b64_tr_b16 v[50:51], v10 offset:17664
buffer_load_dwordx4 v9, s[20:23], s66 offen lds
v_mfma_f32_16x16x32_bf16 v[228:231], v[52:55], v[76:79], v[228:231]
s_add_u32 m0, s63, 0xc000
s_waitcnt lgkmcnt(2)
v_mfma_f32_16x16x32_bf16 v[152:155], v[40:43], v[56:59], v[152:155]
ds_read_b64_tr_b16 v[52:53], v11 offset:16640
s_mov_b32 s66, 0x9300
v_mfma_f32_16x16x32_bf16 v[184:187], v[40:43], v[60:63], v[184:187]
ds_read_b64_tr_b16 v[54:55], v11 offset:17664
buffer_load_dwordx4 v9, s[20:23], s66 offen lds
v_mfma_f32_16x16x32_bf16 v[216:219], v[40:43], v[64:67], v[216:219]
s_waitcnt vmcnt(9)
s_barrier
v_mfma_f32_16x16x32_bf16 v[156:159], v[44:47], v[56:59], v[156:159]
ds_read_b64_tr_b16 v[40:41], v10 offset:24576
ds_read_b128 v[68:71], v13 offset:16384
s_add_u32 m0, s63, 0x12000
v_mfma_f32_16x16x32_bf16 v[188:191], v[44:47], v[60:63], v[188:191]
ds_read_b64_tr_b16 v[42:43], v10 offset:25600
s_mov_b32 s66, 0x340000
v_mfma_f32_16x16x32_bf16 v[220:223], v[44:47], v[64:67], v[220:223]
ds_read_b128 v[72:75], v13 offset:24576
s_waitcnt lgkmcnt(6)
v_mfma_f32_16x16x32_bf16 v[160:163], v[48:51], v[56:59], v[160:163]
ds_read_b64_tr_b16 v[44:45], v11 offset:24576
buffer_load_dwordx4 v8, s[16:19], s66 offen lds
v_mfma_f32_16x16x32_bf16 v[192:195], v[48:51], v[60:63], v[192:195]
ds_read_b64_tr_b16 v[46:47], v11 offset:25600
ds_read_b128 v[76:79], v13 offset:32768
s_add_u32 m0, s68, 0
v_mfma_f32_16x16x32_bf16 v[224:227], v[48:51], v[64:67], v[224:227]
s_waitcnt lgkmcnt(7)
v_mfma_f32_16x16x32_bf16 v[164:167], v[52:55], v[56:59], v[164:167]
ds_read_b64_tr_b16 v[48:49], v10 offset:24832
s_add_u32 s66, s70, 0
v_mfma_f32_16x16x32_bf16 v[196:199], v[52:55], v[60:63], v[196:199]
ds_read_b64_tr_b16 v[50:51], v10 offset:25856
buffer_load_dwordx4 v14, s[8:11], s66 offen nt lds
v_mfma_f32_16x16x32_bf16 v[228:231], v[52:55], v[64:67], v[228:231]
s_waitcnt lgkmcnt(2)
v_mfma_f32_16x16x32_bf16 v[152:155], v[40:43], v[68:71], v[152:155]
ds_read_b64_tr_b16 v[52:53], v11 offset:24832
buffer_load_dwordx4 v14, s[8:11], s66 offen offset:1024 nt lds
v_mfma_f32_16x16x32_bf16 v[184:187], v[40:43], v[72:75], v[184:187]
ds_read_b64_tr_b16 v[54:55], v11 offset:25856
v_mfma_f32_16x16x32_bf16 v[216:219], v[40:43], v[76:79], v[216:219]
s_waitcnt vmcnt(8)
s_barrier
v_mfma_f32_16x16x32_bf16 v[156:159], v[44:47], v[68:71], v[156:159]
ds_read_b64_tr_b16 v[40:41], v10 offset:32768
ds_read_b128 v[56:59], v12 offset:40960
s_add_u32 m0, s63, 0x14000
s_mov_b32 s66, 0x380000
v_mfma_f32_16x16x32_bf16 v[188:191], v[44:47], v[72:75], v[188:191]
ds_read_b64_tr_b16 v[42:43], v10 offset:33792
buffer_load_dwordx4 v8, s[16:19], s66 offen lds
v_mfma_f32_16x16x32_bf16 v[220:223], v[44:47], v[76:79], v[220:223]
ds_read_b128 v[60:63], v12
s_add_u32 m0, s63, 0x20000
s_waitcnt lgkmcnt(6)
v_mfma_f32_16x16x32_bf16 v[160:163], v[48:51], v[68:71], v[160:163]
ds_read_b64_tr_b16 v[44:45], v11 offset:32768
s_mov_b32 s66, 0x380
v_mfma_f32_16x16x32_bf16 v[192:195], v[48:51], v[72:75], v[192:195]
ds_read_b64_tr_b16 v[46:47], v11 offset:33792
ds_read_b128 v[64:67], v12 offset:8192
buffer_load_dwordx4 v9, s[20:23], s66 offen lds
v_mfma_f32_16x16x32_bf16 v[224:227], v[48:51], v[76:79], v[224:227]
s_add_u32 m0, s63, 0x22000
s_waitcnt lgkmcnt(7)
v_mfma_f32_16x16x32_bf16 v[164:167], v[52:55], v[68:71], v[164:167]
ds_read_b64_tr_b16 v[48:49], v10 offset:33024
s_mov_b32 s66, 0x4b80
v_mfma_f32_16x16x32_bf16 v[196:199], v[52:55], v[72:75], v[196:199]
ds_read_b64_tr_b16 v[50:51], v10 offset:34048
buffer_load_dwordx4 v9, s[20:23], s66 offen lds
v_mfma_f32_16x16x32_bf16 v[228:231], v[52:55], v[76:79], v[228:231]
s_add_u32 m0, s63, 0x24000
s_waitcnt lgkmcnt(2)
v_mfma_f32_16x16x32_bf16 v[152:155], v[40:43], v[56:59], v[152:155]
ds_read_b64_tr_b16 v[52:53], v11 offset:33024
s_mov_b32 s66, 0x9380
v_mfma_f32_16x16x32_bf16 v[184:187], v[40:43], v[60:63], v[184:187]
ds_read_b64_tr_b16 v[54:55], v11 offset:34048
buffer_load_dwordx4 v9, s[20:23], s66 offen lds
v_mfma_f32_16x16x32_bf16 v[216:219], v[40:43], v[64:67], v[216:219]
s_waitcnt vmcnt(11)
s_barrier
v_mfma_f32_16x16x32_bf16 v[156:159], v[44:47], v[56:59], v[156:159]
ds_read_b64_tr_b16 v[40:41], v10 offset:40960
ds_read_b128 v[68:71], v13 offset:40960
s_add_u32 m0, s63, 0x16000
v_mfma_f32_16x16x32_bf16 v[188:191], v[44:47], v[60:63], v[188:191]
ds_read_b64_tr_b16 v[42:43], v10 offset:41984
v_mfma_f32_16x16x32_bf16 v[220:223], v[44:47], v[64:67], v[220:223]
ds_read_b128 v[72:75], v13
s_waitcnt lgkmcnt(6)
v_mfma_f32_16x16x32_bf16 v[160:163], v[48:51], v[56:59], v[160:163]
ds_read_b64_tr_b16 v[44:45], v11 offset:40960
s_mov_b32 s66, 0x3c0000
v_mfma_f32_16x16x32_bf16 v[192:195], v[48:51], v[60:63], v[192:195]
ds_read_b64_tr_b16 v[46:47], v11 offset:41984
ds_read_b128 v[76:79], v13 offset:8192
v_mfma_f32_16x16x32_bf16 v[224:227], v[48:51], v[64:67], v[224:227]
s_waitcnt lgkmcnt(7)
v_mfma_f32_16x16x32_bf16 v[164:167], v[52:55], v[56:59], v[164:167]
ds_read_b64_tr_b16 v[48:49], v10 offset:41216
v_mfma_f32_16x16x32_bf16 v[196:199], v[52:55], v[60:63], v[196:199]
ds_read_b64_tr_b16 v[50:51], v10 offset:42240
buffer_load_dwordx4 v8, s[16:19], s66 offen lds
v_mfma_f32_16x16x32_bf16 v[228:231], v[52:55], v[64:67], v[228:231]
s_waitcnt lgkmcnt(2)
v_mfma_f32_16x16x32_bf16 v[152:155], v[40:43], v[68:71], v[152:155]
ds_read_b64_tr_b16 v[52:53], v11 offset:41216
v_mfma_f32_16x16x32_bf16 v[184:187], v[40:43], v[72:75], v[184:187]
ds_read_b64_tr_b16 v[54:55], v11 offset:42240
v_mfma_f32_16x16x32_bf16 v[216:219], v[40:43], v[76:79], v[216:219]
s_waitcnt vmcnt(8)
s_barrier
v_mfma_f32_16x16x32_bf16 v[156:159], v[44:47], v[68:71], v[156:159]
ds_read_b64_tr_b16 v[40:41], v10
ds_read_b128 v[56:59], v16 offset:32768
s_add_u32 m0, s63, 0x18000
s_mov_b32 s66, 0x400000
v_mfma_f32_16x16x32_bf16 v[188:191], v[44:47], v[72:75], v[188:191]
ds_read_b64_tr_b16 v[42:43], v10 offset:1024
buffer_load_dwordx4 v8, s[16:19], s66 offen lds
v_mfma_f32_16x16x32_bf16 v[220:223], v[44:47], v[76:79], v[220:223]
ds_read_b128 v[60:63], v16 offset:40960
s_add_u32 m0, s63, 0x26000
s_waitcnt lgkmcnt(6)
v_mfma_f32_16x16x32_bf16 v[160:163], v[48:51], v[68:71], v[160:163]
ds_read_b64_tr_b16 v[44:45], v11
s_mov_b32 s66, 0x400
v_mfma_f32_16x16x32_bf16 v[192:195], v[48:51], v[72:75], v[192:195]
ds_read_b64_tr_b16 v[46:47], v11 offset:1024
ds_read_b128 v[64:67], v16 offset:49152
buffer_load_dwordx4 v9, s[20:23], s66 offen lds
v_mfma_f32_16x16x32_bf16 v[224:227], v[48:51], v[76:79], v[224:227]
s_add_u32 m0, s63, 0x1c000
s_waitcnt lgkmcnt(7)
v_mfma_f32_16x16x32_bf16 v[164:167], v[52:55], v[68:71], v[164:167]
ds_read_b64_tr_b16 v[48:49], v10 offset:256
s_mov_b32 s66, 0x4c00
v_mfma_f32_16x16x32_bf16 v[196:199], v[52:55], v[72:75], v[196:199]
ds_read_b64_tr_b16 v[50:51], v10 offset:1280
buffer_load_dwordx4 v9, s[20:23], s66 offen lds
v_mfma_f32_16x16x32_bf16 v[228:231], v[52:55], v[76:79], v[228:231]
s_add_u32 m0, s63, 0x1e000
s_waitcnt lgkmcnt(2)
v_mfma_f32_16x16x32_bf16 v[152:155], v[40:43], v[56:59], v[152:155]
ds_read_b64_tr_b16 v[52:53], v11 offset:256
s_mov_b32 s66, 0x9400
v_mfma_f32_16x16x32_bf16 v[184:187], v[40:43], v[60:63], v[184:187]
ds_read_b64_tr_b16 v[54:55], v11 offset:1280
buffer_load_dwordx4 v9, s[20:23], s66 offen lds
v_mfma_f32_16x16x32_bf16 v[216:219], v[40:43], v[64:67], v[216:219]
s_waitcnt vmcnt(11)
s_barrier
v_mfma_f32_16x16x32_bf16 v[156:159], v[44:47], v[56:59], v[156:159]
ds_read_b64_tr_b16 v[40:41], v10 offset:8192
ds_read_b128 v[68:71], v17 offset:32768
s_add_u32 m0, s63, 0x1a000
v_mfma_f32_16x16x32_bf16 v[188:191], v[44:47], v[60:63], v[188:191]
ds_read_b64_tr_b16 v[42:43], v10 offset:9216
s_mov_b32 s66, 0x440000
v_mfma_f32_16x16x32_bf16 v[220:223], v[44:47], v[64:67], v[220:223]
ds_read_b128 v[72:75], v17 offset:40960
s_waitcnt lgkmcnt(6)
v_mfma_f32_16x16x32_bf16 v[160:163], v[48:51], v[56:59], v[160:163]
ds_read_b64_tr_b16 v[44:45], v11 offset:8192
buffer_load_dwordx4 v8, s[16:19], s66 offen lds
v_mfma_f32_16x16x32_bf16 v[192:195], v[48:51], v[60:63], v[192:195]
ds_read_b64_tr_b16 v[46:47], v11 offset:9216
ds_read_b128 v[76:79], v17 offset:49152
s_add_u32 m0, s68, 0x4000
v_mfma_f32_16x16x32_bf16 v[224:227], v[48:51], v[64:67], v[224:227]
s_waitcnt lgkmcnt(7)
v_mfma_f32_16x16x32_bf16 v[164:167], v[52:55], v[56:59], v[164:167]
ds_read_b64_tr_b16 v[48:49], v10 offset:8448
s_add_u32 s66, s70, 0x4000
v_mfma_f32_16x16x32_bf16 v[196:199], v[52:55], v[60:63], v[196:199]
ds_read_b64_tr_b16 v[50:51], v10 offset:9472
buffer_load_dwordx4 v14, s[8:11], s66 offen nt lds
v_mfma_f32_16x16x32_bf16 v[228:231], v[52:55], v[64:67], v[228:231]
s_waitcnt lgkmcnt(2)
v_mfma_f32_16x16x32_bf16 v[152:155], v[40:43], v[68:71], v[152:155]
ds_read_b64_tr_b16 v[52:53], v11 offset:8448
buffer_load_dwordx4 v14, s[8:11], s66 offen offset:1024 nt lds
v_mfma_f32_16x16x32_bf16 v[184:187], v[40:43], v[72:75], v[184:187]
ds_read_b64_tr_b16 v[54:55], v11 offset:9472
v_mfma_f32_16x16x32_bf16 v[216:219], v[40:43], v[76:79], v[216:219]
s_waitcnt vmcnt(8)
s_barrier
v_mfma_f32_16x16x32_bf16 v[156:159], v[44:47], v[68:71], v[156:159]
ds_read_b64_tr_b16 v[40:41], v10 offset:16384
ds_read_b128 v[56:59], v12 offset:16384
v_mfma_f32_16x16x32_bf16 v[188:191], v[44:47], v[72:75], v[188:191]
ds_read_b64_tr_b16 v[42:43], v10 offset:17408
v_mfma_f32_16x16x32_bf16 v[220:223], v[44:47], v[76:79], v[220:223]
ds_read_b128 v[60:63], v12 offset:24576
s_waitcnt lgkmcnt(6)
v_mfma_f32_16x16x32_bf16 v[160:163], v[48:51], v[68:71], v[160:163]
ds_read_b64_tr_b16 v[44:45], v11 offset:16384
v_mfma_f32_16x16x32_bf16 v[192:195], v[48:51], v[72:75], v[192:195]
ds_read_b64_tr_b16 v[46:47], v11 offset:17408
ds_read_b128 v[64:67], v12 offset:32768
v_mfma_f32_16x16x32_bf16 v[224:227], v[48:51], v[76:79], v[224:227]
s_waitcnt lgkmcnt(7)
v_mfma_f32_16x16x32_bf16 v[164:167], v[52:55], v[68:71], v[164:167]
ds_read_b64_tr_b16 v[48:49], v10 offset:16640
v_mfma_f32_16x16x32_bf16 v[196:199], v[52:55], v[72:75], v[196:199]
ds_read_b64_tr_b16 v[50:51], v10 offset:17664
v_mfma_f32_16x16x32_bf16 v[228:231], v[52:55], v[76:79], v[228:231]
s_waitcnt lgkmcnt(2)
v_mfma_f32_16x16x32_bf16 v[152:155], v[40:43], v[56:59], v[152:155]
ds_read_b64_tr_b16 v[52:53], v11 offset:16640
v_mfma_f32_16x16x32_bf16 v[184:187], v[40:43], v[60:63], v[184:187]
ds_read_b64_tr_b16 v[54:55], v11 offset:17664
v_mfma_f32_16x16x32_bf16 v[216:219], v[40:43], v[64:67], v[216:219]
s_waitcnt vmcnt(7)
s_barrier
v_mfma_f32_16x16x32_bf16 v[156:159], v[44:47], v[56:59], v[156:159]
ds_read_b64_tr_b16 v[40:41], v10 offset:24576
ds_read_b128 v[68:71], v13 offset:16384
s_add_u32 m0, s69, 0x8000
v_mfma_f32_16x16x32_bf16 v[188:191], v[44:47], v[60:63], v[188:191]
ds_read_b64_tr_b16 v[42:43], v10 offset:25600
v_mfma_f32_16x16x32_bf16 v[220:223], v[44:47], v[64:67], v[220:223]
ds_read_b128 v[72:75], v13 offset:24576
s_add_u32 s66, s70, 0
s_waitcnt lgkmcnt(6)
v_mfma_f32_16x16x32_bf16 v[160:163], v[48:51], v[56:59], v[160:163]
ds_read_b64_tr_b16 v[44:45], v11 offset:24576
v_mfma_f32_16x16x32_bf16 v[192:195], v[48:51], v[60:63], v[192:195]
ds_read_b64_tr_b16 v[46:47], v11 offset:25600
ds_read_b128 v[76:79], v13 offset:32768
v_mfma_f32_16x16x32_bf16 v[224:227], v[48:51], v[64:67], v[224:227]
buffer_load_dwordx4 v15, s[12:15], s66 offen nt lds
s_waitcnt lgkmcnt(7)
v_mfma_f32_16x16x32_bf16 v[164:167], v[52:55], v[56:59], v[164:167]
ds_read_b64_tr_b16 v[48:49], v10 offset:24832
v_mfma_f32_16x16x32_bf16 v[196:199], v[52:55], v[60:63], v[196:199]
ds_read_b64_tr_b16 v[50:51], v10 offset:25856
v_mfma_f32_16x16x32_bf16 v[228:231], v[52:55], v[64:67], v[228:231]
buffer_load_dwordx4 v15, s[12:15], s66 offen offset:2048 nt lds
s_waitcnt lgkmcnt(2)
v_mfma_f32_16x16x32_bf16 v[152:155], v[40:43], v[68:71], v[152:155]
ds_read_b64_tr_b16 v[52:53], v11 offset:24832
v_mfma_f32_16x16x32_bf16 v[184:187], v[40:43], v[72:75], v[184:187]
ds_read_b64_tr_b16 v[54:55], v11 offset:25856
v_mfma_f32_16x16x32_bf16 v[216:219], v[40:43], v[76:79], v[216:219]
s_waitcnt vmcnt(5)
s_barrier
v_mfma_f32_16x16x32_bf16 v[156:159], v[44:47], v[68:71], v[156:159]
ds_read_b64_tr_b16 v[40:41], v10 offset:32768
ds_read_b128 v[56:59], v12 offset:40960
v_mfma_f32_16x16x32_bf16 v[188:191], v[44:47], v[72:75], v[188:191]
ds_read_b64_tr_b16 v[42:43], v10 offset:33792
v_mfma_f32_16x16x32_bf16 v[220:223], v[44:47], v[76:79], v[220:223]
ds_read_b128 v[60:63], v12
s_waitcnt lgkmcnt(6)
v_mfma_f32_16x16x32_bf16 v[160:163], v[48:51], v[68:71], v[160:163]
ds_read_b64_tr_b16 v[44:45], v11 offset:32768
v_mfma_f32_16x16x32_bf16 v[192:195], v[48:51], v[72:75], v[192:195]
ds_read_b64_tr_b16 v[46:47], v11 offset:33792
ds_read_b128 v[64:67], v12 offset:8192
v_mfma_f32_16x16x32_bf16 v[224:227], v[48:51], v[76:79], v[224:227]
s_waitcnt lgkmcnt(7)
v_mfma_f32_16x16x32_bf16 v[164:167], v[52:55], v[68:71], v[164:167]
ds_read_b64_tr_b16 v[48:49], v10 offset:33024
v_mfma_f32_16x16x32_bf16 v[196:199], v[52:55], v[72:75], v[196:199]
ds_read_b64_tr_b16 v[50:51], v10 offset:34048
v_mfma_f32_16x16x32_bf16 v[228:231], v[52:55], v[76:79], v[228:231]
s_waitcnt lgkmcnt(2)
v_mfma_f32_16x16x32_bf16 v[152:155], v[40:43], v[56:59], v[152:155]
ds_read_b64_tr_b16 v[52:53], v11 offset:33024
v_mfma_f32_16x16x32_bf16 v[184:187], v[40:43], v[60:63], v[184:187]
ds_read_b64_tr_b16 v[54:55], v11 offset:34048
v_mfma_f32_16x16x32_bf16 v[216:219], v[40:43], v[64:67], v[216:219]
s_waitcnt vmcnt(4)
s_barrier
v_mfma_f32_16x16x32_bf16 v[156:159], v[44:47], v[56:59], v[156:159]
ds_read_b64_tr_b16 v[40:41], v10 offset:40960
ds_read_b128 v[68:71], v13 offset:40960
s_add_u32 m0, s69, 0xc000
v_mfma_f32_16x16x32_bf16 v[188:191], v[44:47], v[60:63], v[188:191]
ds_read_b64_tr_b16 v[42:43], v10 offset:41984
v_mfma_f32_16x16x32_bf16 v[220:223], v[44:47], v[64:67], v[220:223]
ds_read_b128 v[72:75], v13
s_add_u32 s66, s70, 0x4000
s_waitcnt lgkmcnt(6)
v_mfma_f32_16x16x32_bf16 v[160:163], v[48:51], v[56:59], v[160:163]
ds_read_b64_tr_b16 v[44:45], v11 offset:40960
v_mfma_f32_16x16x32_bf16 v[192:195], v[48:51], v[60:63], v[192:195]
ds_read_b64_tr_b16 v[46:47], v11 offset:41984
ds_read_b128 v[76:79], v13 offset:8192
v_mfma_f32_16x16x32_bf16 v[224:227], v[48:51], v[64:67], v[224:227]
buffer_load_dwordx4 v15, s[12:15], s66 offen nt lds
s_waitcnt lgkmcnt(7)
v_mfma_f32_16x16x32_bf16 v[164:167], v[52:55], v[56:59], v[164:167]
ds_read_b64_tr_b16 v[48:49], v10 offset:41216
v_mfma_f32_16x16x32_bf16 v[196:199], v[52:55], v[60:63], v[196:199]
ds_read_b64_tr_b16 v[50:51], v10 offset:42240
v_mfma_f32_16x16x32_bf16 v[228:231], v[52:55], v[64:67], v[228:231]
buffer_load_dwordx4 v15, s[12:15], s66 offen offset:2048 nt lds
s_waitcnt lgkmcnt(2)
v_mfma_f32_16x16x32_bf16 v[152:155], v[40:43], v[68:71], v[152:155]
ds_read_b64_tr_b16 v[52:53], v11 offset:41216
v_mfma_f32_16x16x32_bf16 v[184:187], v[40:43], v[72:75], v[184:187]
ds_read_b64_tr_b16 v[54:55], v11 offset:42240
v_mfma_f32_16x16x32_bf16 v[216:219], v[40:43], v[76:79], v[216:219]
v_mfma_f32_16x16x32_bf16 v[156:159], v[44:47], v[68:71], v[156:159]
v_mfma_f32_16x16x32_bf16 v[188:191], v[44:47], v[72:75], v[188:191]
v_mfma_f32_16x16x32_bf16 v[220:223], v[44:47], v[76:79], v[220:223]
s_waitcnt lgkmcnt(2)
v_mfma_f32_16x16x32_bf16 v[160:163], v[48:51], v[68:71], v[160:163]
v_mfma_f32_16x16x32_bf16 v[192:195], v[48:51], v[72:75], v[192:195]
v_mfma_f32_16x16x32_bf16 v[224:227], v[48:51], v[76:79], v[224:227]
s_waitcnt lgkmcnt(0)
v_mfma_f32_16x16x32_bf16 v[164:167], v[52:55], v[68:71], v[164:167]
v_mfma_f32_16x16x32_bf16 v[196:199], v[52:55], v[72:75], v[196:199]
v_mfma_f32_16x16x32_bf16 v[228:231], v[52:55], v[76:79], v[228:231]
v_mul_f32 v152, s59, v152
v_mul_f32 v153, s59, v153
v_mul_f32 v154, s59, v154
v_mul_f32 v155, s59, v155
v_cvt_pk_bf16_f32 v80, v152, v153
v_cvt_pk_bf16_f32 v81, v154, v155
v_mul_f32 v156, s59, v156
v_mul_f32 v157, s59, v157
v_mul_f32 v158, s59, v158
v_mul_f32 v159, s59, v159
v_cvt_pk_bf16_f32 v82, v156, v157
v_cvt_pk_bf16_f32 v83, v158, v159
v_cndmask_b32 v104, v80, v82, s[64:65]
v_cndmask_b32 v106, v82, v80, s[64:65]
v_cndmask_b32 v105, v81, v83, s[64:65]
v_cndmask_b32 v107, v83, v81, s[64:65]
v_mul_f32 v184, s59, v184
v_mul_f32 v185, s59, v185
v_mul_f32 v186, s59, v186
v_mul_f32 v187, s59, v187
v_cvt_pk_bf16_f32 v84, v184, v185
v_cvt_pk_bf16_f32 v85, v186, v187
v_mul_f32 v188, s59, v188
v_mul_f32 v189, s59, v189
v_mul_f32 v190, s59, v190
v_mul_f32 v191, s59, v191
v_cvt_pk_bf16_f32 v86, v188, v189
v_cvt_pk_bf16_f32 v87, v190, v191
v_cndmask_b32 v120, v84, v86, s[64:65]
v_cndmask_b32 v122, v86, v84, s[64:65]
v_cndmask_b32 v121, v85, v87, s[64:65]
v_cndmask_b32 v123, v87, v85, s[64:65]
v_mul_f32 v216, s59, v216
v_mul_f32 v217, s59, v217
v_mul_f32 v218, s59, v218
v_mul_f32 v219, s59, v219
v_cvt_pk_bf16_f32 v88, v216, v217
v_cvt_pk_bf16_f32 v89, v218, v219
v_mul_f32 v220, s59, v220
v_mul_f32 v221, s59, v221
v_mul_f32 v222, s59, v222
v_mul_f32 v223, s59, v223
v_cvt_pk_bf16_f32 v90, v220, v221
v_cvt_pk_bf16_f32 v91, v222, v223
v_cndmask_b32 v136, v88, v90, s[64:65]
v_cndmask_b32 v138, v90, v88, s[64:65]
v_cndmask_b32 v137, v89, v91, s[64:65]
v_cndmask_b32 v139, v91, v89, s[64:65]
v_mul_f32 v160, s59, v160
v_mul_f32 v161, s59, v161
v_mul_f32 v162, s59, v162
v_mul_f32 v163, s59, v163
v_cvt_pk_bf16_f32 v80, v160, v161
v_cvt_pk_bf16_f32 v81, v162, v163
v_mul_f32 v164, s59, v164
v_mul_f32 v165, s59, v165
v_mul_f32 v166, s59, v166
v_mul_f32 v167, s59, v167
v_cvt_pk_bf16_f32 v82, v164, v165
v_cvt_pk_bf16_f32 v83, v166, v167
v_cndmask_b32 v108, v80, v82, s[64:65]
v_cndmask_b32 v110, v82, v80, s[64:65]
v_cndmask_b32 v109, v81, v83, s[64:65]
v_cndmask_b32 v111, v83, v81, s[64:65]
v_mul_f32 v192, s59, v192
v_mul_f32 v193, s59, v193
v_mul_f32 v194, s59, v194
v_mul_f32 v195, s59, v195
v_cvt_pk_bf16_f32 v84, v192, v193
v_cvt_pk_bf16_f32 v85, v194, v195
v_mul_f32 v196, s59, v196
v_mul_f32 v197, s59, v197
v_mul_f32 v198, s59, v198
v_mul_f32 v199, s59, v199
v_cvt_pk_bf16_f32 v86, v196, v197
v_cvt_pk_bf16_f32 v87, v198, v199
v_cndmask_b32 v124, v84, v86, s[64:65]
v_cndmask_b32 v126, v86, v84, s[64:65]
v_cndmask_b32 v125, v85, v87, s[64:65]
v_cndmask_b32 v127, v87, v85, s[64:65]
v_mul_f32 v224, s59, v224
v_mul_f32 v225, s59, v225
v_mul_f32 v226, s59, v226
v_mul_f32 v227, s59, v227
v_cvt_pk_bf16_f32 v88, v224, v225
v_cvt_pk_bf16_f32 v89, v226, v227
v_mul_f32 v228, s59, v228
v_mul_f32 v229, s59, v229
v_mul_f32 v230, s59, v230
v_mul_f32 v231, s59, v231
v_cvt_pk_bf16_f32 v90, v228, v229
v_cvt_pk_bf16_f32 v91, v230, v231
v_cndmask_b32 v140, v88, v90, s[64:65]
v_cndmask_b32 v142, v90, v88, s[64:65]
v_cndmask_b32 v141, v89, v91, s[64:65]
v_cndmask_b32 v143, v91, v89, s[64:65]
s_cmp_ge_u32 s39, 4
s_cbranch_scc0 L_A
s_branch L_P
L_A:
s_setprio 1
v_lshrrev_b32 v1, 4, v0
v_bfe_u32 v7, v0, 3, 1
v_lshlrev_b32 v7, 1, v7
v_xor_b32 v1, v1, v7
v_and_b32 v7, 3, v0
v_lshl_add_u32 v1, v7, 2, v1
v_bfe_u32 v7, v0, 2, 2
v_lshl_add_u32 v1, v7, 6, v1
v_lshlrev_b32 v2, 4, v1
v_bfe_u32 v1, v0, 1, 1
v_bfe_u32 v7, v0, 4, 1
v_lshl_add_u32 v1, v7, 1, v1
v_bfe_u32 v7, v0, 2, 2
v_lshl_add_u32 v1, v7, 2, v1
v_lshrrev_b32 v7, 4, v0
v_lshl_add_u32 v1, v7, 6, v1
v_lshlrev_b32 v1, 4, v1
v_and_b32 v7, 1, v0
v_lshl_add_u32 v3, v7, 3, v1
v_xor_b32 v4, 32, v3
s_mul_i32 s54, s50, 0x3000
s_add_u32 s54, s54, 0x1c000
v_lshlrev_b32 v1, 4, v0
v_add_u32 v5, s54, v1
v_mov_b32 v6, v1
s_mov_b32 s60, 0x44800000
s_mov_b32 s71, 0
s_mul_i32 s54, s50, 0x1800
s_add_u32 s54, s54, 0x10000
v_add_u32 v1, s54, v6
s_barrier
ds_read_b128 v[40:43], v2
ds_read_b128 v[48:51], v2 offset:256
ds_read_b128 v[112:115], v1
ds_read_b128 v[128:131], v1 offset:2048
ds_read_b128 v[144:147], v1 offset:4096
ds_read_b128 v[116:119], v1 offset:1024
ds_read_b128 v[132:135], v1 offset:3072
ds_read_b128 v[148:151], v1 offset:5120
s_waitcnt lgkmcnt(0)
v_mfma_f32_16x16x32_bf16 v[56:59], v[40:43], v[104:107], 0
v_mfma_f32_16x16x32_bf16 v[60:63], v[40:43], v[120:123], 0
v_mfma_f32_16x16x32_bf16 v[64:67], v[40:43], v[136:139], 0
ds_read_b128 v[40:43], v2 offset:512
v_mfma_f32_16x16x32_bf16 v[56:59], v[48:51], v[108:111], v[56:59]
v_mfma_f32_16x16x32_bf16 v[60:63], v[48:51], v[124:127], v[60:63]
v_mfma_f32_16x16x32_bf16 v[64:67], v[48:51], v[140:143], v[64:67]
ds_read_b128 v[48:51], v2 offset:768
s_waitcnt lgkmcnt(1)
v_mfma_f32_16x16x32_bf16 v[56:59], v[40:43], v[112:115], v[56:59]
v_mfma_f32_16x16x32_bf16 v[60:63], v[40:43], v[128:131], v[60:63]
v_mfma_f32_16x16x32_bf16 v[64:67], v[40:43], v[144:147], v[64:67]
ds_read_b128 v[40:43], v2 offset:4096
s_waitcnt lgkmcnt(1)
v_mfma_f32_16x16x32_bf16 v[56:59], v[48:51], v[116:119], v[56:59]
v_mfma_f32_16x16x32_bf16 v[60:63], v[48:51], v[132:135], v[60:63]
v_mfma_f32_16x16x32_bf16 v[64:67], v[48:51], v[148:151], v[64:67]
ds_read_b128 v[48:51], v2 offset:4352
s_waitcnt lgkmcnt(1)
v_mfma_f32_16x16x32_bf16 v[68:71], v[40:43], v[104:107], 0
s_nop 2
v_max3_f32 v28, v56, v57, v58
v_max_f32 v28, v28, v59
v_max3_f32 v32, v60, v61, v62
v_max_f32 v32, v32, v63
v_max3_f32 v36, v64, v65, v66
v_mfma_f32_16x16x32_bf16 v[72:75], v[40:43], v[120:123], 0
v_max_f32 v36, v36, v67
v_mov_b32 v29, v28
v_mov_b32 v33, v32
v_mov_b32 v37, v36
v_mfma_f32_16x16x32_bf16 v[76:79], v[40:43], v[136:139], 0
v_permlane32_swap_b32 v28, v29
v_permlane32_swap_b32 v32, v33
v_permlane32_swap_b32 v36, v37
v_max_f32 v28, v28, v29
ds_read_b128 v[40:43], v2 offset:4608
v_max_f32 v32, v32, v33
v_max_f32 v36, v36, v37
v_mov_b32 v29, v28
v_mov_b32 v33, v32
v_mov_b32 v37, v36
v_permlane16_swap_b32 v28, v29
v_permlane16_swap_b32 v32, v33
v_permlane16_swap_b32 v36, v37
v_max_f32 v28, v28, v29
v_max_f32 v32, v32, v33
v_max_f32 v36, v36, v37
v_ceil_f32 v28, v28
v_ceil_f32 v32, v32
s_waitcnt lgkmcnt(1)
v_mfma_f32_16x16x32_bf16 v[68:71], v[48:51], v[108:111], v[68:71]
v_ceil_f32 v36, v36
v_sub_f32 v28, 0, v28
v_sub_f32 v32, 0, v32
v_sub_f32 v36, 0, v36
v_mfma_f32_16x16x32_bf16 v[72:75], v[48:51], v[124:127], v[72:75]
v_add_f32 v56, v28, v56
v_add_f32 v57, v28, v57
v_add_f32 v58, v28, v58
v_add_f32 v59, v28, v59
v_mfma_f32_16x16x32_bf16 v[76:79], v[48:51], v[140:143], v[76:79]
v_add_f32 v60, v32, v60
v_add_f32 v61, v32, v61
v_add_f32 v62, v32, v62
v_add_f32 v63, v32, v63
v_add_f32 v64, v36, v64
ds_read_b128 v[48:51], v2 offset:4864
v_add_f32 v65, v36, v65
v_add_f32 v66, v36, v66
v_add_f32 v67, v36, v67
v_mov_b32 v29, v28
v_mov_b32 v30, v28
v_mov_b32 v31, v28
v_mov_b32 v33, v32
v_mov_b32 v34, v32
v_mov_b32 v35, v32
v_mov_b32 v37, v36
v_mov_b32 v38, v36
v_mov_b32 v39, v36
s_waitcnt lgkmcnt(1)
v_mfma_f32_16x16x32_bf16 v[68:71], v[40:43], v[112:115], v[68:71]
v_exp_f32 v8, v56
v_exp_f32 v9, v57
v_mfma_f32_16x16x32_bf16 v[72:75], v[40:43], v[128:131], v[72:75]
v_exp_f32 v10, v58
v_mfma_f32_16x16x32_bf16 v[76:79], v[40:43], v[144:147], v[76:79]
v_exp_f32 v11, v59
v_add_f32 v16, v8, v9
v_cvt_pk_bf16_f32 v80, v8, v9
ds_read_b128 v[40:43], v2 offset:8192
v_exp_f32 v12, v60
v_add_f32 v17, v10, v11
v_cvt_pk_bf16_f32 v81, v10, v11
v_exp_f32 v13, v61
v_add_f32 v18, v16, v17
v_exp_f32 v14, v62
v_add_f32 v16, v12, v13
s_waitcnt lgkmcnt(1)
v_mfma_f32_16x16x32_bf16 v[68:71], v[48:51], v[116:119], v[68:71]
v_exp_f32 v15, v63
v_cvt_pk_bf16_f32 v84, v12, v13
v_mfma_f32_16x16x32_bf16 v[72:75], v[48:51], v[132:135], v[72:75]
v_exp_f32 v8, v64
v_add_f32 v17, v14, v15
v_cvt_pk_bf16_f32 v85, v14, v15
v_mfma_f32_16x16x32_bf16 v[76:79], v[48:51], v[148:151], v[76:79]
v_exp_f32 v9, v65
v_add_f32 v19, v16, v17
ds_read_b128 v[48:51], v2 offset:8448
v_exp_f32 v10, v66
v_add_f32 v16, v8, v9
v_cvt_pk_bf16_f32 v88, v8, v9
v_exp_f32 v11, v67
s_nop 0
v_add_f32 v17, v10, v11
v_add_f32 v20, v16, v17
v_cvt_pk_bf16_f32 v89, v10, v11
v_add_f32 v68, v28, v68
v_add_f32 v69, v28, v69
v_add_f32 v70, v28, v70
v_add_f32 v71, v28, v71
v_add_f32 v72, v32, v72
v_add_f32 v73, v32, v73
v_add_f32 v74, v32, v74
v_add_f32 v75, v32, v75
v_add_f32 v76, v36, v76
v_add_f32 v77, v36, v77
v_add_f32 v78, v36, v78
v_add_f32 v79, v36, v79
v_exp_f32 v8, v68
v_exp_f32 v9, v69
s_waitcnt lgkmcnt(1)
v_mfma_f32_16x16x32_bf16 v[56:59], v[40:43], v[104:107], v[28:31]
v_exp_f32 v10, v70
v_mfma_f32_16x16x32_bf16 v[60:63], v[40:43], v[120:123], v[32:35]
v_mov_b32 v21, v18
v_mov_b32 v22, v19
v_mfma_f32_16x16x32_bf16 v[64:67], v[40:43], v[136:139], v[36:39]
v_exp_f32 v11, v71
ds_read_b128 v[40:43], v2 offset:8704
v_add_f32 v16, v8, v9
v_cvt_pk_bf16_f32 v82, v8, v9
v_exp_f32 v12, v72
v_add_f32 v17, v10, v11
v_cvt_pk_bf16_f32 v83, v10, v11
s_waitcnt lgkmcnt(1)
v_mfma_f32_16x16x32_bf16 v[56:59], v[48:51], v[108:111], v[56:59]
s_waitcnt vmcnt(0)
s_barrier
v_exp_f32 v13, v73
v_mfma_f32_16x16x32_bf16 v[60:63], v[48:51], v[124:127], v[60:63]
v_mov_b32 v23, v20
v_add_f32 v18, v16, v17
v_mfma_f32_16x16x32_bf16 v[64:67], v[48:51], v[140:143], v[64:67]
v_exp_f32 v14, v74
ds_read_b128 v[48:51], v2 offset:8960
v_add_f32 v16, v12, v13
v_exp_f32 v15, v75
v_cvt_pk_bf16_f32 v86, v12, v13
s_waitcnt lgkmcnt(1)
v_mfma_f32_16x16x32_bf16 v[56:59], v[40:43], v[112:115], v[56:59]
v_exp_f32 v8, v76
v_mfma_f32_16x16x32_bf16 v[60:63], v[40:43], v[128:131], v[60:63]
v_add_f32 v17, v14, v15
v_cvt_pk_bf16_f32 v87, v14, v15
v_mfma_f32_16x16x32_bf16 v[64:67], v[40:43], v[144:147], v[64:67]
v_exp_f32 v9, v77
ds_read_b128 v[40:43], v2 offset:12288
v_add_f32 v19, v16, v17
v_exp_f32 v10, v78
ds_read_b64_tr_b16 v[44:45], v3 offset:32768
v_add_f32 v16, v8, v9
v_cvt_pk_bf16_f32 v90, v8, v9
s_waitcnt lgkmcnt(2)
v_mfma_f32_16x16x32_bf16 v[56:59], v[48:51], v[116:119], v[56:59]
v_exp_f32 v11, v79
v_mfma_f32_16x16x32_bf16 v[60:63], v[48:51], v[132:135], v[60:63]
ds_read_b64_tr_b16 v[46:47], v3 offset:36864
v_add_f32 v17, v10, v11
v_add_f32 v20, v16, v17
v_mfma_f32_16x16x32_bf16 v[64:67], v[48:51], v[148:151], v[64:67]
v_max3_f32 v27, v18, v19, v20
v_cmp_lt_f32 vcc, s60, v27
ds_read_b128 v[48:51], v2 offset:12544
v_cvt_pk_bf16_f32 v91, v10, v11
v_exp_f32 v8, v56
ds_read_b64_tr_b16 v[52:53], v4 offset:32768
s_cbranch_vccnz TR_Yp1
RET_Yp1:
v_exp_f32 v9, v57
s_waitcnt lgkmcnt(4)
v_mfma_f32_16x16x32_bf16 v[68:71], v[40:43], v[104:107], v[28:31]
v_exp_f32 v10, v58
v_mfma_f32_16x16x32_bf16 v[72:75], v[40:43], v[120:123], v[32:35]
ds_read_b64_tr_b16 v[54:55], v4 offset:36864
v_add_f32 v21, v21, v18
v_add_f32 v22, v22, v19
v_mfma_f32_16x16x32_bf16 v[76:79], v[40:43], v[136:139], v[36:39]
s_waitcnt lgkmcnt(3)
v_exp_f32 v11, v59
v_mfma_f32_16x16x32_bf16 v[152:155], v[44:47], v[80:83], 0
ds_read_b128 v[40:43], v2 offset:12800
v_add_f32 v16, v8, v9
v_cvt_pk_bf16_f32 v92, v8, v9
v_mfma_f32_16x16x32_bf16 v[184:187], v[44:47], v[84:87], 0
v_exp_f32 v12, v60
v_mfma_f32_16x16x32_bf16 v[216:219], v[44:47], v[88:91], 0
s_waitcnt lgkmcnt(3)
ds_read_b64_tr_b16 v[44:45], v3 offset:33024
v_add_f32 v17, v10, v11
v_cvt_pk_bf16_f32 v93, v10, v11
v_mfma_f32_16x16x32_bf16 v[68:71], v[48:51], v[108:111], v[68:71]
v_exp_f32 v13, v61
v_mfma_f32_16x16x32_bf16 v[72:75], v[48:51], v[124:127], v[72:75]
ds_read_b64_tr_b16 v[46:47], v3 offset:37120
v_add_f32 v23, v23, v20
v_add_f32 v18, v16, v17
v_mfma_f32_16x16x32_bf16 v[76:79], v[48:51], v[140:143], v[76:79]
s_waitcnt lgkmcnt(3)
v_exp_f32 v14, v62
v_mfma_f32_16x16x32_bf16 v[156:159], v[52:55], v[80:83], 0
ds_read_b128 v[48:51], v2 offset:13056
v_add_f32 v16, v12, v13
v_mfma_f32_16x16x32_bf16 v[188:191], v[52:55], v[84:87], 0
v_exp_f32 v15, v63
v_mfma_f32_16x16x32_bf16 v[220:223], v[52:55], v[88:91], 0
s_waitcnt lgkmcnt(3)
ds_read_b64_tr_b16 v[52:53], v4 offset:33024
v_cvt_pk_bf16_f32 v96, v12, v13
v_mfma_f32_16x16x32_bf16 v[68:71], v[40:43], v[112:115], v[68:71]
v_exp_f32 v8, v64
v_mfma_f32_16x16x32_bf16 v[72:75], v[40:43], v[128:131], v[72:75]
ds_read_b64_tr_b16 v[54:55], v4 offset:37120
v_add_f32 v17, v14, v15
v_cvt_pk_bf16_f32 v97, v14, v15
v_mfma_f32_16x16x32_bf16 v[76:79], v[40:43], v[144:147], v[76:79]
s_waitcnt lgkmcnt(3)
v_exp_f32 v9, v65
v_mfma_f32_16x16x32_bf16 v[160:163], v[44:47], v[80:83], 0
ds_read_b128 v[40:43], v2 offset:16384
v_add_f32 v19, v16, v17
v_mfma_f32_16x16x32_bf16 v[192:195], v[44:47], v[84:87], 0
v_exp_f32 v10, v66
v_mfma_f32_16x16x32_bf16 v[224:227], v[44:47], v[88:91], 0
s_waitcnt lgkmcnt(3)
ds_read_b64_tr_b16 v[44:45], v3 offset:33280
v_add_f32 v16, v8, v9
v_cvt_pk_bf16_f32 v100, v8, v9
v_mfma_f32_16x16x32_bf16 v[68:71], v[48:51], v[116:119], v[68:71]
v_exp_f32 v11, v67
v_mfma_f32_16x16x32_bf16 v[72:75], v[48:51], v[132:135], v[72:75]
ds_read_b64_tr_b16 v[46:47], v3 offset:37376
v_add_f32 v17, v10, v11
v_add_f32 v20, v16, v17
v_mfma_f32_16x16x32_bf16 v[76:79], v[48:51], v[148:151], v[76:79]
s_waitcnt lgkmcnt(3)
v_max3_f32 v27, v18, v19, v20
v_cmp_lt_f32 vcc, s60, v27
v_mfma_f32_16x16x32_bf16 v[164:167], v[52:55], v[80:83], 0
ds_read_b128 v[48:51], v2 offset:16640
v_cvt_pk_bf16_f32 v101, v10, v11
v_mfma_f32_16x16x32_bf16 v[196:199], v[52:55], v[84:87], 0
v_exp_f32 v8, v68
v_mfma_f32_16x16x32_bf16 v[228:231], v[52:55], v[88:91], 0
ds_read_b64_tr_b16 v[52:53], v4 offset:33280
s_cbranch_vccnz TR_Xp1
RET_Xp1:
v_exp_f32 v9, v69
.p2align 6
L_A_loop:
s_waitcnt lgkmcnt(4)
v_mfma_f32_16x16x32_bf16 v[56:59], v[40:43], v[104:107], v[28:31]
v_exp_f32 v10, v70
v_mfma_f32_16x16x32_bf16 v[60:63], v[40:43], v[120:123], v[32:35]
ds_read_b64_tr_b16 v[54:55], v4 offset:37376
v_add_f32 v21, v21, v18
v_add_f32 v22, v22, v19
v_mfma_f32_16x16x32_bf16 v[64:67], v[40:43], v[136:139], v[36:39]
s_waitcnt lgkmcnt(3)
v_exp_f32 v11, v71
v_mfma_f32_16x16x32_bf16 v[168:171], v[44:47], v[80:83], 0
ds_read_b128 v[40:43], v2 offset:16896
v_add_f32 v16, v8, v9
v_cvt_pk_bf16_f32 v94, v8, v9
v_mfma_f32_16x16x32_bf16 v[200:203], v[44:47], v[84:87], 0
v_exp_f32 v12, v72
v_mfma_f32_16x16x32_bf16 v[232:235], v[44:47], v[88:91], 0
s_waitcnt lgkmcnt(3)
ds_read_b64_tr_b16 v[44:45], v3 offset:33536
v_add_f32 v17, v10, v11
v_cvt_pk_bf16_f32 v95, v10, v11
v_mfma_f32_16x16x32_bf16 v[56:59], v[48:51], v[108:111], v[56:59]
s_waitcnt lgkmcnt(4)
s_barrier
v_exp_f32 v13, v73
v_mfma_f32_16x16x32_bf16 v[60:63], v[48:51], v[124:127], v[60:63]
ds_read_b64_tr_b16 v[46:47], v3 offset:37632
v_add_f32 v23, v23, v20
v_add_f32 v18, v16, v17
v_mfma_f32_16x16x32_bf16 v[64:67], v[48:51], v[140:143], v[64:67]
s_waitcnt lgkmcnt(3)
v_exp_f32 v14, v74
v_mfma_f32_16x16x32_bf16 v[172:175], v[52:55], v[80:83], 0
ds_read_b128 v[48:51], v2 offset:17152
v_add_f32 v16, v12, v13
v_mfma_f32_16x16x32_bf16 v[204:207], v[52:55], v[84:87], 0
v_exp_f32 v15, v75
v_mfma_f32_16x16x32_bf16 v[236:239], v[52:55], v[88:91], 0
s_waitcnt lgkmcnt(3)
ds_read_b64_tr_b16 v[52:53], v4 offset:33536
v_cvt_pk_bf16_f32 v98, v12, v13
v_mfma_f32_16x16x32_bf16 v[56:59], v[40:43], v[112:115], v[56:59]
v_exp_f32 v8, v76
v_mfma_f32_16x16x32_bf16 v[60:63], v[40:43], v[128:131], v[60:63]
ds_read_b64_tr_b16 v[54:55], v4 offset:37632
v_add_f32 v17, v14, v15
v_cvt_pk_bf16_f32 v99, v14, v15
v_mfma_f32_16x16x32_bf16 v[64:67], v[40:43], v[144:147], v[64:67]
s_waitcnt lgkmcnt(3)
v_exp_f32 v9, v77
v_mfma_f32_16x16x32_bf16 v[176:179], v[44:47], v[80:83], 0
ds_read_b128 v[40:43], v2 offset:20480
v_add_f32 v19, v16, v17
v_mfma_f32_16x16x32_bf16 v[208:211], v[44:47], v[84:87], 0
v_exp_f32 v10, v78
v_mfma_f32_16x16x32_bf16 v[240:243], v[44:47], v[88:91], 0
s_waitcnt lgkmcnt(3)
ds_read_b64_tr_b16 v[44:45], v3 offset:40960
v_add_f32 v16, v8, v9
v_cvt_pk_bf16_f32 v102, v8, v9
v_mfma_f32_16x16x32_bf16 v[56:59], v[48:51], v[116:119], v[56:59]
v_exp_f32 v11, v79
v_mfma_f32_16x16x32_bf16 v[60:63], v[48:51], v[132:135], v[60:63]
ds_read_b64_tr_b16 v[46:47], v3 offset:45056
v_add_f32 v17, v10, v11
v_add_f32 v20, v16, v17
v_mfma_f32_16x16x32_bf16 v[64:67], v[48:51], v[148:151], v[64:67]
s_waitcnt lgkmcnt(3)
v_max3_f32 v27, v18, v19, v20
v_cmp_lt_f32 vcc, s60, v27
v_mfma_f32_16x16x32_bf16 v[180:183], v[52:55], v[80:83], 0
ds_read_b128 v[48:51], v2 offset:20736
v_cvt_pk_bf16_f32 v103, v10, v11
v_mfma_f32_16x16x32_bf16 v[212:215], v[52:55], v[84:87], 0
v_exp_f32 v8, v56
v_mfma_f32_16x16x32_bf16 v[244:247], v[52:55], v[88:91], 0
s_waitcnt lgkmcnt(3)
ds_read_b64_tr_b16 v[52:53], v4 offset:40960
s_cbranch_vccnz TR_Y1
RET_Y1:
v_exp_f32 v9, v57
v_mfma_f32_16x16x32_bf16 v[68:71], v[40:43], v[104:107], v[28:31]
v_exp_f32 v10, v58
v_mfma_f32_16x16x32_bf16 v[72:75], v[40:43], v[120:123], v[32:35]
ds_read_b64_tr_b16 v[54:55], v4 offset:45056
v_add_f32 v21, v21, v18
v_add_f32 v22, v22, v19
v_mfma_f32_16x16x32_bf16 v[76:79], v[40:43], v[136:139], v[36:39]
s_waitcnt lgkmcnt(3)
v_exp_f32 v11, v59
v_mfma_f32_16x16x32_bf16 v[152:155], v[44:47], v[92:95], v[152:155]
ds_read_b128 v[40:43], v2 offset:20992
v_add_f32 v16, v8, v9
v_cvt_pk_bf16_f32 v80, v8, v9
v_mfma_f32_16x16x32_bf16 v[184:187], v[44:47], v[96:99], v[184:187]
v_exp_f32 v12, v60
v_mfma_f32_16x16x32_bf16 v[216:219], v[44:47], v[100:103], v[216:219]
s_waitcnt lgkmcnt(3)
ds_read_b64_tr_b16 v[44:45], v3 offset:41216
v_add_f32 v17, v10, v11
v_cvt_pk_bf16_f32 v81, v10, v11
v_mfma_f32_16x16x32_bf16 v[68:71], v[48:51], v[108:111], v[68:71]
v_exp_f32 v13, v61
v_mfma_f32_16x16x32_bf16 v[72:75], v[48:51], v[124:127], v[72:75]
ds_read_b64_tr_b16 v[46:47], v3 offset:45312
v_add_f32 v23, v23, v20
v_add_f32 v18, v16, v17
v_mfma_f32_16x16x32_bf16 v[76:79], v[48:51], v[140:143], v[76:79]
s_waitcnt lgkmcnt(3)
v_exp_f32 v14, v62
v_mfma_f32_16x16x32_bf16 v[156:159], v[52:55], v[92:95], v[156:159]
ds_read_b128 v[48:51], v2 offset:21248
v_add_f32 v16, v12, v13
v_mfma_f32_16x16x32_bf16 v[188:191], v[52:55], v[96:99], v[188:191]
v_exp_f32 v15, v63
v_mfma_f32_16x16x32_bf16 v[220:223], v[52:55], v[100:103], v[220:223]
s_waitcnt lgkmcnt(3)
ds_read_b64_tr_b16 v[52:53], v4 offset:41216
v_cvt_pk_bf16_f32 v84, v12, v13
v_mfma_f32_16x16x32_bf16 v[68:71], v[40:43], v[112:115], v[68:71]
v_exp_f32 v8, v64
v_mfma_f32_16x16x32_bf16 v[72:75], v[40:43], v[128:131], v[72:75]
ds_read_b64_tr_b16 v[54:55], v4 offset:45312
v_add_f32 v17, v14, v15
v_cvt_pk_bf16_f32 v85, v14, v15
v_mfma_f32_16x16x32_bf16 v[76:79], v[40:43], v[144:147], v[76:79]
s_waitcnt lgkmcnt(3)
v_exp_f32 v9, v65
v_mfma_f32_16x16x32_bf16 v[160:163], v[44:47], v[92:95], v[160:163]
ds_read_b128 v[40:43], v2 offset:24576
v_add_f32 v19, v16, v17
v_mfma_f32_16x16x32_bf16 v[192:195], v[44:47], v[96:99], v[192:195]
v_exp_f32 v10, v66
v_mfma_f32_16x16x32_bf16 v[224:227], v[44:47], v[100:103], v[224:227]
s_waitcnt lgkmcnt(3)
ds_read_b64_tr_b16 v[44:45], v3 offset:41472
v_add_f32 v16, v8, v9
v_cvt_pk_bf16_f32 v88, v8, v9
v_mfma_f32_16x16x32_bf16 v[68:71], v[48:51], v[116:119], v[68:71]
v_exp_f32 v11, v67
v_mfma_f32_16x16x32_bf16 v[72:75], v[48:51], v[132:135], v[72:75]
ds_read_b64_tr_b16 v[46:47], v3 offset:45568
v_add_f32 v17, v10, v11
v_add_f32 v20, v16, v17
v_mfma_f32_16x16x32_bf16 v[76:79], v[48:51], v[148:151], v[76:79]
s_waitcnt lgkmcnt(3)
v_max3_f32 v27, v18, v19, v20
v_cmp_lt_f32 vcc, s60, v27
v_mfma_f32_16x16x32_bf16 v[164:167], v[52:55], v[92:95], v[164:167]
ds_read_b128 v[48:51], v2 offset:24832
v_cvt_pk_bf16_f32 v89, v10, v11
v_mfma_f32_16x16x32_bf16 v[196:199], v[52:55], v[96:99], v[196:199]
v_exp_f32 v8, v68
v_mfma_f32_16x16x32_bf16 v[228:231], v[52:55], v[100:103], v[228:231]
ds_read_b64_tr_b16 v[52:53], v4 offset:41472
s_cbranch_vccnz TR_X1
RET_X1:
v_exp_f32 v9, v69
s_waitcnt lgkmcnt(4)
v_mfma_f32_16x16x32_bf16 v[56:59], v[40:43], v[104:107], v[28:31]
v_exp_f32 v10, v70
v_mfma_f32_16x16x32_bf16 v[60:63], v[40:43], v[120:123], v[32:35]
ds_read_b64_tr_b16 v[54:55], v4 offset:45568
v_add_f32 v21, v21, v18
v_add_f32 v22, v22, v19
v_mfma_f32_16x16x32_bf16 v[64:67], v[40:43], v[136:139], v[36:39]
s_waitcnt lgkmcnt(3)
v_exp_f32 v11, v71
v_mfma_f32_16x16x32_bf16 v[168:171], v[44:47], v[92:95], v[168:171]
ds_read_b128 v[40:43], v2 offset:25088
v_add_f32 v16, v8, v9
v_cvt_pk_bf16_f32 v82, v8, v9
v_mfma_f32_16x16x32_bf16 v[200:203], v[44:47], v[96:99], v[200:203]
v_exp_f32 v12, v72
v_mfma_f32_16x16x32_bf16 v[232:235], v[44:47], v[100:103], v[232:235]
s_waitcnt lgkmcnt(3)
ds_read_b64_tr_b16 v[44:45], v3 offset:41728
v_add_f32 v17, v10, v11
v_cvt_pk_bf16_f32 v83, v10, v11
v_mfma_f32_16x16x32_bf16 v[56:59], v[48:51], v[108:111], v[56:59]
s_barrier
v_exp_f32 v13, v73
v_mfma_f32_16x16x32_bf16 v[60:63], v[48:51], v[124:127], v[60:63]
ds_read_b64_tr_b16 v[46:47], v3 offset:45824
v_add_f32 v23, v23, v20
v_add_f32 v18, v16, v17
v_mfma_f32_16x16x32_bf16 v[64:67], v[48:51], v[140:143], v[64:67]
s_waitcnt lgkmcnt(3)
v_exp_f32 v14, v74
v_mfma_f32_16x16x32_bf16 v[172:175], v[52:55], v[92:95], v[172:175]
ds_read_b128 v[48:51], v2 offset:25344
v_add_f32 v16, v12, v13
v_mfma_f32_16x16x32_bf16 v[204:207], v[52:55], v[96:99], v[204:207]
v_exp_f32 v15, v75
v_mfma_f32_16x16x32_bf16 v[236:239], v[52:55], v[100:103], v[236:239]
s_waitcnt lgkmcnt(3)
ds_read_b64_tr_b16 v[52:53], v4 offset:41728
v_cvt_pk_bf16_f32 v86, v12, v13
v_mfma_f32_16x16x32_bf16 v[56:59], v[40:43], v[112:115], v[56:59]
v_exp_f32 v8, v76
v_mfma_f32_16x16x32_bf16 v[60:63], v[40:43], v[128:131], v[60:63]
ds_read_b64_tr_b16 v[54:55], v4 offset:45824
v_add_f32 v17, v14, v15
v_cvt_pk_bf16_f32 v87, v14, v15
v_mfma_f32_16x16x32_bf16 v[64:67], v[40:43], v[144:147], v[64:67]
s_waitcnt lgkmcnt(3)
v_exp_f32 v9, v77
v_mfma_f32_16x16x32_bf16 v[176:179], v[44:47], v[92:95], v[176:179]
ds_read_b128 v[40:43], v2 offset:28672
v_add_f32 v19, v16, v17
v_mfma_f32_16x16x32_bf16 v[208:211], v[44:47], v[96:99], v[208:211]
v_exp_f32 v10, v78
v_mfma_f32_16x16x32_bf16 v[240:243], v[44:47], v[100:103], v[240:243]
s_waitcnt lgkmcnt(3)
ds_read_b64_tr_b16 v[44:45], v3 offset:49152
v_add_f32 v16, v8, v9
v_cvt_pk_bf16_f32 v90, v8, v9
v_mfma_f32_16x16x32_bf16 v[56:59], v[48:51], v[116:119], v[56:59]
v_exp_f32 v11, v79
v_mfma_f32_16x16x32_bf16 v[60:63], v[48:51], v[132:135], v[60:63]
ds_read_b64_tr_b16 v[46:47], v3 offset:53248
v_add_f32 v17, v10, v11
v_add_f32 v20, v16, v17
v_mfma_f32_16x16x32_bf16 v[64:67], v[48:51], v[148:151], v[64:67]
s_waitcnt lgkmcnt(3)
v_max3_f32 v27, v18, v19, v20
v_cmp_lt_f32 vcc, s60, v27
v_mfma_f32_16x16x32_bf16 v[180:183], v[52:55], v[92:95], v[180:183]
ds_read_b128 v[48:51], v2 offset:28928
v_cvt_pk_bf16_f32 v91, v10, v11
v_mfma_f32_16x16x32_bf16 v[212:215], v[52:55], v[96:99], v[212:215]
v_exp_f32 v8, v56
v_mfma_f32_16x16x32_bf16 v[244:247], v[52:55], v[100:103], v[244:247]
s_waitcnt lgkmcnt(3)
ds_read_b64_tr_b16 v[52:53], v4 offset:49152
s_cbranch_vccnz TR_Y2
RET_Y2:
v_exp_f32 v9, v57
v_mfma_f32_16x16x32_bf16 v[68:71], v[40:43], v[104:107], v[28:31]
v_exp_f32 v10, v58
v_mfma_f32_16x16x32_bf16 v[72:75], v[40:43], v[120:123], v[32:35]
ds_read_b64_tr_b16 v[54:55], v4 offset:53248
v_add_f32 v21, v21, v18
v_add_f32 v22, v22, v19
v_mfma_f32_16x16x32_bf16 v[76:79], v[40:43], v[136:139], v[36:39]
s_waitcnt lgkmcnt(3)
v_exp_f32 v11, v59
v_mfma_f32_16x16x32_bf16 v[152:155], v[44:47], v[80:83], v[152:155]
ds_read_b128 v[40:43], v2 offset:29184
v_add_f32 v16, v8, v9
v_cvt_pk_bf16_f32 v92, v8, v9
v_mfma_f32_16x16x32_bf16 v[184:187], v[44:47], v[84:87], v[184:187]
v_exp_f32 v12, v60
v_mfma_f32_16x16x32_bf16 v[216:219], v[44:47], v[88:91], v[216:219]
s_waitcnt lgkmcnt(3)
ds_read_b64_tr_b16 v[44:45], v3 offset:49408
v_add_f32 v17, v10, v11
v_cvt_pk_bf16_f32 v93, v10, v11
v_mfma_f32_16x16x32_bf16 v[68:71], v[48:51], v[108:111], v[68:71]
v_exp_f32 v13, v61
v_mfma_f32_16x16x32_bf16 v[72:75], v[48:51], v[124:127], v[72:75]
ds_read_b64_tr_b16 v[46:47], v3 offset:53504
v_add_f32 v23, v23, v20
v_add_f32 v18, v16, v17
v_mfma_f32_16x16x32_bf16 v[76:79], v[48:51], v[140:143], v[76:79]
s_waitcnt lgkmcnt(3)
v_exp_f32 v14, v62
v_mfma_f32_16x16x32_bf16 v[156:159], v[52:55], v[80:83], v[156:159]
ds_read_b128 v[48:51], v2 offset:29440
v_add_f32 v16, v12, v13
v_mfma_f32_16x16x32_bf16 v[188:191], v[52:55], v[84:87], v[188:191]
v_exp_f32 v15, v63
v_mfma_f32_16x16x32_bf16 v[220:223], v[52:55], v[88:91], v[220:223]
s_waitcnt lgkmcnt(3)
ds_read_b64_tr_b16 v[52:53], v4 offset:49408
v_cvt_pk_bf16_f32 v96, v12, v13
v_mfma_f32_16x16x32_bf16 v[68:71], v[40:43], v[112:115], v[68:71]
v_exp_f32 v8, v64
v_mfma_f32_16x16x32_bf16 v[72:75], v[40:43], v[128:131], v[72:75]
ds_read_b64_tr_b16 v[54:55], v4 offset:53504
v_add_f32 v17, v14, v15
v_cvt_pk_bf16_f32 v97, v14, v15
v_mfma_f32_16x16x32_bf16 v[76:79], v[40:43], v[144:147], v[76:79]
s_waitcnt lgkmcnt(3)
v_exp_f32 v9, v65
v_mfma_f32_16x16x32_bf16 v[160:163], v[44:47], v[80:83], v[160:163]
ds_read_b128 v[40:43], v2
v_add_f32 v19, v16, v17
v_mfma_f32_16x16x32_bf16 v[192:195], v[44:47], v[84:87], v[192:195]
v_exp_f32 v10, v66
v_mfma_f32_16x16x32_bf16 v[224:227], v[44:47], v[88:91], v[224:227]
s_waitcnt lgkmcnt(3)
ds_read_b64_tr_b16 v[44:45], v3 offset:49664
v_add_f32 v16, v8, v9
v_cvt_pk_bf16_f32 v100, v8, v9
v_mfma_f32_16x16x32_bf16 v[68:71], v[48:51], v[116:119], v[68:71]
v_exp_f32 v11, v67
v_mfma_f32_16x16x32_bf16 v[72:75], v[48:51], v[132:135], v[72:75]
ds_read_b64_tr_b16 v[46:47], v3 offset:53760
v_add_f32 v17, v10, v11
v_add_f32 v20, v16, v17
v_mfma_f32_16x16x32_bf16 v[76:79], v[48:51], v[148:151], v[76:79]
s_waitcnt lgkmcnt(3)
v_max3_f32 v27, v18, v19, v20
v_cmp_lt_f32 vcc, s60, v27
v_mfma_f32_16x16x32_bf16 v[164:167], v[52:55], v[80:83], v[164:167]
ds_read_b128 v[48:51], v2 offset:256
v_cvt_pk_bf16_f32 v101, v10, v11
v_mfma_f32_16x16x32_bf16 v[196:199], v[52:55], v[84:87], v[196:199]
v_exp_f32 v8, v68
v_mfma_f32_16x16x32_bf16 v[228:231], v[52:55], v[88:91], v[228:231]
ds_read_b64_tr_b16 v[52:53], v4 offset:49664
s_cbranch_vccnz TR_X2
RET_X2:
v_exp_f32 v9, v69
s_waitcnt lgkmcnt(4)
v_mfma_f32_16x16x32_bf16 v[56:59], v[40:43], v[104:107], v[28:31]
v_exp_f32 v10, v70
v_mfma_f32_16x16x32_bf16 v[60:63], v[40:43], v[120:123], v[32:35]
ds_read_b64_tr_b16 v[54:55], v4 offset:53760
v_add_f32 v21, v21, v18
v_add_f32 v22, v22, v19
v_mfma_f32_16x16x32_bf16 v[64:67], v[40:43], v[136:139], v[36:39]
s_waitcnt lgkmcnt(3)
v_exp_f32 v11, v71
v_mfma_f32_16x16x32_bf16 v[168:171], v[44:47], v[80:83], v[168:171]
ds_read_b128 v[40:43], v2 offset:512
v_add_f32 v16, v8, v9
v_cvt_pk_bf16_f32 v94, v8, v9
v_mfma_f32_16x16x32_bf16 v[200:203], v[44:47], v[84:87], v[200:203]
v_exp_f32 v12, v72
v_mfma_f32_16x16x32_bf16 v[232:235], v[44:47], v[88:91], v[232:235]
s_waitcnt lgkmcnt(3)
ds_read_b64_tr_b16 v[44:45], v3 offset:49920
v_add_f32 v17, v10, v11
v_cvt_pk_bf16_f32 v95, v10, v11
v_mfma_f32_16x16x32_bf16 v[56:59], v[48:51], v[108:111], v[56:59]
s_barrier
v_exp_f32 v13, v73
v_mfma_f32_16x16x32_bf16 v[60:63], v[48:51], v[124:127], v[60:63]
ds_read_b64_tr_b16 v[46:47], v3 offset:54016
v_add_f32 v23, v23, v20
v_add_f32 v18, v16, v17
v_mfma_f32_16x16x32_bf16 v[64:67], v[48:51], v[140:143], v[64:67]
s_waitcnt lgkmcnt(3)
v_exp_f32 v14, v74
v_mfma_f32_16x16x32_bf16 v[172:175], v[52:55], v[80:83], v[172:175]
ds_read_b128 v[48:51], v2 offset:768
v_add_f32 v16, v12, v13
v_mfma_f32_16x16x32_bf16 v[204:207], v[52:55], v[84:87], v[204:207]
v_exp_f32 v15, v75
v_mfma_f32_16x16x32_bf16 v[236:239], v[52:55], v[88:91], v[236:239]
s_waitcnt lgkmcnt(3)
ds_read_b64_tr_b16 v[52:53], v4 offset:49920
v_cvt_pk_bf16_f32 v98, v12, v13
v_mfma_f32_16x16x32_bf16 v[56:59], v[40:43], v[112:115], v[56:59]
v_exp_f32 v8, v76
v_mfma_f32_16x16x32_bf16 v[60:63], v[40:43], v[128:131], v[60:63]
ds_read_b64_tr_b16 v[54:55], v4 offset:54016
v_add_f32 v17, v14, v15
v_cvt_pk_bf16_f32 v99, v14, v15
v_mfma_f32_16x16x32_bf16 v[64:67], v[40:43], v[144:147], v[64:67]
s_waitcnt lgkmcnt(3)
v_exp_f32 v9, v77
v_mfma_f32_16x16x32_bf16 v[176:179], v[44:47], v[80:83], v[176:179]
ds_read_b128 v[40:43], v2 offset:4096
v_add_f32 v19, v16, v17
v_mfma_f32_16x16x32_bf16 v[208:211], v[44:47], v[84:87], v[208:211]
v_exp_f32 v10, v78
v_mfma_f32_16x16x32_bf16 v[240:243], v[44:47], v[88:91], v[240:243]
s_waitcnt lgkmcnt(3)
ds_read_b64_tr_b16 v[44:45], v3 offset:57344
v_add_f32 v16, v8, v9
v_cvt_pk_bf16_f32 v102, v8, v9
v_mfma_f32_16x16x32_bf16 v[56:59], v[48:51], v[116:119], v[56:59]
v_exp_f32 v11, v79
v_mfma_f32_16x16x32_bf16 v[60:63], v[48:51], v[132:135], v[60:63]
ds_read_b64_tr_b16 v[46:47], v3 offset:61440
v_add_f32 v17, v10, v11
v_add_f32 v20, v16, v17
v_mfma_f32_16x16x32_bf16 v[64:67], v[48:51], v[148:151], v[64:67]
s_waitcnt lgkmcnt(3)
v_max3_f32 v27, v18, v19, v20
v_cmp_lt_f32 vcc, s60, v27
v_mfma_f32_16x16x32_bf16 v[180:183], v[52:55], v[80:83], v[180:183]
ds_read_b128 v[48:51], v2 offset:4352
v_cvt_pk_bf16_f32 v103, v10, v11
v_mfma_f32_16x16x32_bf16 v[212:215], v[52:55], v[84:87], v[212:215]
v_exp_f32 v8, v56
v_mfma_f32_16x16x32_bf16 v[244:247], v[52:55], v[88:91], v[244:247]
s_waitcnt lgkmcnt(3)
ds_read_b64_tr_b16 v[52:53], v4 offset:57344
s_cbranch_vccnz TR_Y3
RET_Y3:
v_exp_f32 v9, v57
v_mfma_f32_16x16x32_bf16 v[68:71], v[40:43], v[104:107], v[28:31]
v_exp_f32 v10, v58
v_mfma_f32_16x16x32_bf16 v[72:75], v[40:43], v[120:123], v[32:35]
ds_read_b64_tr_b16 v[54:55], v4 offset:61440
v_add_f32 v21, v21, v18
v_add_f32 v22, v22, v19
v_mfma_f32_16x16x32_bf16 v[76:79], v[40:43], v[136:139], v[36:39]
s_waitcnt lgkmcnt(3)
v_exp_f32 v11, v59
v_mfma_f32_16x16x32_bf16 v[152:155], v[44:47], v[92:95], v[152:155]
ds_read_b128 v[40:43], v2 offset:4608
v_add_f32 v16, v8, v9
v_cvt_pk_bf16_f32 v80, v8, v9
v_mfma_f32_16x16x32_bf16 v[184:187], v[44:47], v[96:99], v[184:187]
v_exp_f32 v12, v60
v_mfma_f32_16x16x32_bf16 v[216:219], v[44:47], v[100:103], v[216:219]
s_waitcnt lgkmcnt(3)
ds_read_b64_tr_b16 v[44:45], v3 offset:57600
v_add_f32 v17, v10, v11
v_cvt_pk_bf16_f32 v81, v10, v11
v_mfma_f32_16x16x32_bf16 v[68:71], v[48:51], v[108:111], v[68:71]
v_exp_f32 v13, v61
v_mfma_f32_16x16x32_bf16 v[72:75], v[48:51], v[124:127], v[72:75]
ds_read_b64_tr_b16 v[46:47], v3 offset:61696
v_add_f32 v23, v23, v20
v_add_f32 v18, v16, v17
v_mfma_f32_16x16x32_bf16 v[76:79], v[48:51], v[140:143], v[76:79]
s_waitcnt lgkmcnt(3)
v_exp_f32 v14, v62
v_mfma_f32_16x16x32_bf16 v[156:159], v[52:55], v[92:95], v[156:159]
ds_read_b128 v[48:51], v2 offset:4864
v_add_f32 v16, v12, v13
v_mfma_f32_16x16x32_bf16 v[188:191], v[52:55], v[96:99], v[188:191]
v_exp_f32 v15, v63
v_mfma_f32_16x16x32_bf16 v[220:223], v[52:55], v[100:103], v[220:223]
s_waitcnt lgkmcnt(3)
ds_read_b64_tr_b16 v[52:53], v4 offset:57600
v_cvt_pk_bf16_f32 v84, v12, v13
v_mfma_f32_16x16x32_bf16 v[68:71], v[40:43], v[112:115], v[68:71]
v_exp_f32 v8, v64
v_mfma_f32_16x16x32_bf16 v[72:75], v[40:43], v[128:131], v[72:75]
ds_read_b64_tr_b16 v[54:55], v4 offset:61696
v_add_f32 v17, v14, v15
v_cvt_pk_bf16_f32 v85, v14, v15
v_mfma_f32_16x16x32_bf16 v[76:79], v[40:43], v[144:147], v[76:79]
s_waitcnt lgkmcnt(3)
v_exp_f32 v9, v65
v_mfma_f32_16x16x32_bf16 v[160:163], v[44:47], v[92:95], v[160:163]
ds_read_b128 v[40:43], v2 offset:8192
v_add_f32 v19, v16, v17
v_mfma_f32_16x16x32_bf16 v[192:195], v[44:47], v[96:99], v[192:195]
v_exp_f32 v10, v66
v_mfma_f32_16x16x32_bf16 v[224:227], v[44:47], v[100:103], v[224:227]
s_waitcnt lgkmcnt(3)
ds_read_b64_tr_b16 v[44:45], v3 offset:57856
v_add_f32 v16, v8, v9
v_cvt_pk_bf16_f32 v88, v8, v9
v_mfma_f32_16x16x32_bf16 v[68:71], v[48:51], v[116:119], v[68:71]
v_exp_f32 v11, v67
v_mfma_f32_16x16x32_bf16 v[72:75], v[48:51], v[132:135], v[72:75]
ds_read_b64_tr_b16 v[46:47], v3 offset:61952
v_add_f32 v17, v10, v11
v_add_f32 v20, v16, v17
v_mfma_f32_16x16x32_bf16 v[76:79], v[48:51], v[148:151], v[76:79]
s_waitcnt lgkmcnt(3)
v_max3_f32 v27, v18, v19, v20
v_cmp_lt_f32 vcc, s60, v27
v_mfma_f32_16x16x32_bf16 v[164:167], v[52:55], v[92:95], v[164:167]
ds_read_b128 v[48:51], v2 offset:8448
v_cvt_pk_bf16_f32 v89, v10, v11
v_mfma_f32_16x16x32_bf16 v[196:199], v[52:55], v[96:99], v[196:199]
v_exp_f32 v8, v68
v_mfma_f32_16x16x32_bf16 v[228:231], v[52:55], v[100:103], v[228:231]
ds_read_b64_tr_b16 v[52:53], v4 offset:57856
s_cbranch_vccnz TR_X3
RET_X3:
v_exp_f32 v9, v69
s_waitcnt lgkmcnt(4)
v_mfma_f32_16x16x32_bf16 v[56:59], v[40:43], v[104:107], v[28:31]
v_exp_f32 v10, v70
v_mfma_f32_16x16x32_bf16 v[60:63], v[40:43], v[120:123], v[32:35]
ds_read_b64_tr_b16 v[54:55], v4 offset:61952
v_add_f32 v21, v21, v18
v_add_f32 v22, v22, v19
v_mfma_f32_16x16x32_bf16 v[64:67], v[40:43], v[136:139], v[36:39]
s_waitcnt lgkmcnt(3)
v_exp_f32 v11, v71
v_mfma_f32_16x16x32_bf16 v[168:171], v[44:47], v[92:95], v[168:171]
ds_read_b128 v[40:43], v2 offset:8704
v_add_f32 v16, v8, v9
v_cvt_pk_bf16_f32 v82, v8, v9
v_mfma_f32_16x16x32_bf16 v[200:203], v[44:47], v[96:99], v[200:203]
v_exp_f32 v12, v72
v_mfma_f32_16x16x32_bf16 v[232:235], v[44:47], v[100:103], v[232:235]
s_waitcnt lgkmcnt(3)
ds_read_b64_tr_b16 v[44:45], v3 offset:58112
v_add_f32 v17, v10, v11
v_cvt_pk_bf16_f32 v83, v10, v11
v_mfma_f32_16x16x32_bf16 v[56:59], v[48:51], v[108:111], v[56:59]
s_barrier
v_exp_f32 v13, v73
v_mfma_f32_16x16x32_bf16 v[60:63], v[48:51], v[124:127], v[60:63]
ds_read_b64_tr_b16 v[46:47], v3 offset:62208
v_add_f32 v23, v23, v20
v_add_f32 v18, v16, v17
v_mfma_f32_16x16x32_bf16 v[64:67], v[48:51], v[140:143], v[64:67]
s_waitcnt lgkmcnt(3)
v_exp_f32 v14, v74
v_mfma_f32_16x16x32_bf16 v[172:175], v[52:55], v[92:95], v[172:175]
ds_read_b128 v[48:51], v2 offset:8960
v_add_f32 v16, v12, v13
v_mfma_f32_16x16x32_bf16 v[204:207], v[52:55], v[96:99], v[204:207]
v_exp_f32 v15, v75
v_mfma_f32_16x16x32_bf16 v[236:239], v[52:55], v[100:103], v[236:239]
s_waitcnt lgkmcnt(3)
ds_read_b64_tr_b16 v[52:53], v4 offset:58112
v_cvt_pk_bf16_f32 v86, v12, v13
v_mfma_f32_16x16x32_bf16 v[56:59], v[40:43], v[112:115], v[56:59]
v_exp_f32 v8, v76
v_mfma_f32_16x16x32_bf16 v[60:63], v[40:43], v[128:131], v[60:63]
ds_read_b64_tr_b16 v[54:55], v4 offset:62208
v_add_f32 v17, v14, v15
v_cvt_pk_bf16_f32 v87, v14, v15
v_mfma_f32_16x16x32_bf16 v[64:67], v[40:43], v[144:147], v[64:67]
s_waitcnt lgkmcnt(3)
v_exp_f32 v9, v77
v_mfma_f32_16x16x32_bf16 v[176:179], v[44:47], v[92:95], v[176:179]
ds_read_b128 v[40:43], v2 offset:12288
v_add_f32 v19, v16, v17
v_mfma_f32_16x16x32_bf16 v[208:211], v[44:47], v[96:99], v[208:211]
v_exp_f32 v10, v78
v_mfma_f32_16x16x32_bf16 v[240:243], v[44:47], v[100:103], v[240:243]
s_waitcnt lgkmcnt(3)
ds_read_b64_tr_b16 v[44:45], v3 offset:32768
v_add_f32 v16, v8, v9
v_cvt_pk_bf16_f32 v90, v8, v9
v_mfma_f32_16x16x32_bf16 v[56:59], v[48:51], v[116:119], v[56:59]
v_exp_f32 v11, v79
v_mfma_f32_16x16x32_bf16 v[60:63], v[48:51], v[132:135], v[60:63]
ds_read_b64_tr_b16 v[46:47], v3 offset:36864
v_add_f32 v17, v10, v11
v_add_f32 v20, v16, v17
v_mfma_f32_16x16x32_bf16 v[64:67], v[48:51], v[148:151], v[64:67]
s_waitcnt lgkmcnt(3)
v_max3_f32 v27, v18, v19, v20
v_cmp_lt_f32 vcc, s60, v27
v_mfma_f32_16x16x32_bf16 v[180:183], v[52:55], v[92:95], v[180:183]
ds_read_b128 v[48:51], v2 offset:12544
v_cvt_pk_bf16_f32 v91, v10, v11
v_mfma_f32_16x16x32_bf16 v[212:215], v[52:55], v[96:99], v[212:215]
v_exp_f32 v8, v56
v_mfma_f32_16x16x32_bf16 v[244:247], v[52:55], v[100:103], v[244:247]
s_waitcnt lgkmcnt(3)
ds_read_b64_tr_b16 v[52:53], v4 offset:32768
s_cbranch_vccnz TR_Y4
RET_Y4:
v_exp_f32 v9, v57
v_mfma_f32_16x16x32_bf16 v[68:71], v[40:43], v[104:107], v[28:31]
v_exp_f32 v10, v58
v_mfma_f32_16x16x32_bf16 v[72:75], v[40:43], v[120:123], v[32:35]
ds_read_b64_tr_b16 v[54:55], v4 offset:36864
v_add_f32 v21, v21, v18
v_add_f32 v22, v22, v19
v_mfma_f32_16x16x32_bf16 v[76:79], v[40:43], v[136:139], v[36:39]
s_waitcnt lgkmcnt(3)
v_exp_f32 v11, v59
v_mfma_f32_16x16x32_bf16 v[152:155], v[44:47], v[80:83], v[152:155]
ds_read_b128 v[40:43], v2 offset:12800
v_add_f32 v16, v8, v9
v_cvt_pk_bf16_f32 v92, v8, v9
v_mfma_f32_16x16x32_bf16 v[184:187], v[44:47], v[84:87], v[184:187]
v_exp_f32 v12, v60
v_mfma_f32_16x16x32_bf16 v[216:219], v[44:47], v[88:91], v[216:219]
s_waitcnt lgkmcnt(3)
ds_read_b64_tr_b16 v[44:45], v3 offset:33024
v_add_f32 v17, v10, v11
v_cvt_pk_bf16_f32 v93, v10, v11
v_mfma_f32_16x16x32_bf16 v[68:71], v[48:51], v[108:111], v[68:71]
v_exp_f32 v13, v61
v_mfma_f32_16x16x32_bf16 v[72:75], v[48:51], v[124:127], v[72:75]
ds_read_b64_tr_b16 v[46:47], v3 offset:37120
v_add_f32 v23, v23, v20
v_add_f32 v18, v16, v17
v_mfma_f32_16x16x32_bf16 v[76:79], v[48:51], v[140:143], v[76:79]
s_waitcnt lgkmcnt(3)
v_exp_f32 v14, v62
v_mfma_f32_16x16x32_bf16 v[156:159], v[52:55], v[80:83], v[156:159]
ds_read_b128 v[48:51], v2 offset:13056
v_add_f32 v16, v12, v13
v_mfma_f32_16x16x32_bf16 v[188:191], v[52:55], v[84:87], v[188:191]
v_exp_f32 v15, v63
v_mfma_f32_16x16x32_bf16 v[220:223], v[52:55], v[88:91], v[220:223]
s_waitcnt lgkmcnt(3)
ds_read_b64_tr_b16 v[52:53], v4 offset:33024
v_cvt_pk_bf16_f32 v96, v12, v13
v_mfma_f32_16x16x32_bf16 v[68:71], v[40:43], v[112:115], v[68:71]
v_exp_f32 v8, v64
v_mfma_f32_16x16x32_bf16 v[72:75], v[40:43], v[128:131], v[72:75]
ds_read_b64_tr_b16 v[54:55], v4 offset:37120
v_add_f32 v17, v14, v15
v_cvt_pk_bf16_f32 v97, v14, v15
v_mfma_f32_16x16x32_bf16 v[76:79], v[40:43], v[144:147], v[76:79]
s_waitcnt lgkmcnt(3)
v_exp_f32 v9, v65
v_mfma_f32_16x16x32_bf16 v[160:163], v[44:47], v[80:83], v[160:163]
ds_read_b128 v[40:43], v2 offset:16384
v_add_f32 v19, v16, v17
v_mfma_f32_16x16x32_bf16 v[192:195], v[44:47], v[84:87], v[192:195]
v_exp_f32 v10, v66
v_mfma_f32_16x16x32_bf16 v[224:227], v[44:47], v[88:91], v[224:227]
s_waitcnt lgkmcnt(3)
ds_read_b64_tr_b16 v[44:45], v3 offset:33280
v_add_f32 v16, v8, v9
v_cvt_pk_bf16_f32 v100, v8, v9
v_mfma_f32_16x16x32_bf16 v[68:71], v[48:51], v[116:119], v[68:71]
v_exp_f32 v11, v67
v_mfma_f32_16x16x32_bf16 v[72:75], v[48:51], v[132:135], v[72:75]
ds_read_b64_tr_b16 v[46:47], v3 offset:37376
v_add_f32 v17, v10, v11
v_add_f32 v20, v16, v17
v_mfma_f32_16x16x32_bf16 v[76:79], v[48:51], v[148:151], v[76:79]
s_waitcnt lgkmcnt(3)
v_max3_f32 v27, v18, v19, v20
v_cmp_lt_f32 vcc, s60, v27
v_mfma_f32_16x16x32_bf16 v[164:167], v[52:55], v[80:83], v[164:167]
ds_read_b128 v[48:51], v2 offset:16640
v_cvt_pk_bf16_f32 v101, v10, v11
v_mfma_f32_16x16x32_bf16 v[196:199], v[52:55], v[84:87], v[196:199]
v_exp_f32 v8, v68
v_mfma_f32_16x16x32_bf16 v[228:231], v[52:55], v[88:91], v[228:231]
ds_read_b64_tr_b16 v[52:53], v4 offset:33280
s_cbranch_vccnz TR_X4
RET_X4:
v_exp_f32 v9, v69
s_waitcnt lgkmcnt(4)
v_mfma_f32_16x16x32_bf16 v[56:59], v[40:43], v[104:107], v[28:31]
v_exp_f32 v10, v70
v_mfma_f32_16x16x32_bf16 v[60:63], v[40:43], v[120:123], v[32:35]
ds_read_b64_tr_b16 v[54:55], v4 offset:37376
v_add_f32 v21, v21, v18
v_add_f32 v22, v22, v19
v_mfma_f32_16x16x32_bf16 v[64:67], v[40:43], v[136:139], v[36:39]
s_waitcnt lgkmcnt(3)
v_exp_f32 v11, v71
v_mfma_f32_16x16x32_bf16 v[168:171], v[44:47], v[80:83], v[168:171]
ds_read_b128 v[40:43], v2 offset:16896
v_add_f32 v16, v8, v9
v_cvt_pk_bf16_f32 v94, v8, v9
v_mfma_f32_16x16x32_bf16 v[200:203], v[44:47], v[84:87], v[200:203]
v_exp_f32 v12, v72
v_mfma_f32_16x16x32_bf16 v[232:235], v[44:47], v[88:91], v[232:235]
s_waitcnt lgkmcnt(3)
ds_read_b64_tr_b16 v[44:45], v3 offset:33536
v_add_f32 v17, v10, v11
v_cvt_pk_bf16_f32 v95, v10, v11
v_mfma_f32_16x16x32_bf16 v[56:59], v[48:51], v[108:111], v[56:59]
s_barrier
v_exp_f32 v13, v73
v_mfma_f32_16x16x32_bf16 v[60:63], v[48:51], v[124:127], v[60:63]
ds_read_b64_tr_b16 v[46:47], v3 offset:37632
v_add_f32 v23, v23, v20
v_add_f32 v18, v16, v17
v_mfma_f32_16x16x32_bf16 v[64:67], v[48:51], v[140:143], v[64:67]
s_waitcnt lgkmcnt(3)
v_exp_f32 v14, v74
v_mfma_f32_16x16x32_bf16 v[172:175], v[52:55], v[80:83], v[172:175]
ds_read_b128 v[48:51], v2 offset:17152
v_add_f32 v16, v12, v13
v_mfma_f32_16x16x32_bf16 v[204:207], v[52:55], v[84:87], v[204:207]
v_exp_f32 v15, v75
v_mfma_f32_16x16x32_bf16 v[236:239], v[52:55], v[88:91], v[236:239]
s_waitcnt lgkmcnt(3)
ds_read_b64_tr_b16 v[52:53], v4 offset:33536
v_cvt_pk_bf16_f32 v98, v12, v13
v_mfma_f32_16x16x32_bf16 v[56:59], v[40:43], v[112:115], v[56:59]
v_exp_f32 v8, v76
v_mfma_f32_16x16x32_bf16 v[60:63], v[40:43], v[128:131], v[60:63]
ds_read_b64_tr_b16 v[54:55], v4 offset:37632
v_add_f32 v17, v14, v15
v_cvt_pk_bf16_f32 v99, v14, v15
v_mfma_f32_16x16x32_bf16 v[64:67], v[40:43], v[144:147], v[64:67]
s_waitcnt lgkmcnt(3)
v_exp_f32 v9, v77
v_mfma_f32_16x16x32_bf16 v[176:179], v[44:47], v[80:83], v[176:179]
ds_read_b128 v[40:43], v2 offset:20480
v_add_f32 v19, v16, v17
v_mfma_f32_16x16x32_bf16 v[208:211], v[44:47], v[84:87], v[208:211]
v_exp_f32 v10, v78
v_mfma_f32_16x16x32_bf16 v[240:243], v[44:47], v[88:91], v[240:243]
s_waitcnt lgkmcnt(3)
ds_read_b64_tr_b16 v[44:45], v3 offset:40960
v_add_f32 v16, v8, v9
v_cvt_pk_bf16_f32 v102, v8, v9
v_mfma_f32_16x16x32_bf16 v[56:59], v[48:51], v[116:119], v[56:59]
v_exp_f32 v11, v79
v_mfma_f32_16x16x32_bf16 v[60:63], v[48:51], v[132:135], v[60:63]
ds_read_b64_tr_b16 v[46:47], v3 offset:45056
v_add_f32 v17, v10, v11
v_add_f32 v20, v16, v17
v_mfma_f32_16x16x32_bf16 v[64:67], v[48:51], v[148:151], v[64:67]
s_waitcnt lgkmcnt(3)
v_max3_f32 v27, v18, v19, v20
v_cmp_lt_f32 vcc, s60, v27
v_mfma_f32_16x16x32_bf16 v[180:183], v[52:55], v[80:83], v[180:183]
ds_read_b128 v[48:51], v2 offset:20736
v_cvt_pk_bf16_f32 v103, v10, v11
v_mfma_f32_16x16x32_bf16 v[212:215], v[52:55], v[84:87], v[212:215]
v_exp_f32 v8, v56
v_mfma_f32_16x16x32_bf16 v[244:247], v[52:55], v[88:91], v[244:247]
s_waitcnt lgkmcnt(3)
ds_read_b64_tr_b16 v[52:53], v4 offset:40960
s_cbranch_vccnz TR_Y5
RET_Y5:
v_exp_f32 v9, v57
v_mfma_f32_16x16x32_bf16 v[68:71], v[40:43], v[104:107], v[28:31]
v_exp_f32 v10, v58
v_mfma_f32_16x16x32_bf16 v[72:75], v[40:43], v[120:123], v[32:35]
ds_read_b64_tr_b16 v[54:55], v4 offset:45056
v_add_f32 v21, v21, v18
v_add_f32 v22, v22, v19
v_mfma_f32_16x16x32_bf16 v[76:79], v[40:43], v[136:139], v[36:39]
s_waitcnt lgkmcnt(3)
v_exp_f32 v11, v59
v_mfma_f32_16x16x32_bf16 v[152:155], v[44:47], v[92:95], v[152:155]
ds_read_b128 v[40:43], v2 offset:20992
v_add_f32 v16, v8, v9
v_cvt_pk_bf16_f32 v80, v8, v9
v_mfma_f32_16x16x32_bf16 v[184:187], v[44:47], v[96:99], v[184:187]
v_exp_f32 v12, v60
v_mfma_f32_16x16x32_bf16 v[216:219], v[44:47], v[100:103], v[216:219]
s_waitcnt lgkmcnt(3)
ds_read_b64_tr_b16 v[44:45], v3 offset:41216
v_add_f32 v17, v10, v11
v_cvt_pk_bf16_f32 v81, v10, v11
v_mfma_f32_16x16x32_bf16 v[68:71], v[48:51], v[108:111], v[68:71]
v_exp_f32 v13, v61
v_mfma_f32_16x16x32_bf16 v[72:75], v[48:51], v[124:127], v[72:75]
ds_read_b64_tr_b16 v[46:47], v3 offset:45312
v_add_f32 v23, v23, v20
v_add_f32 v18, v16, v17
v_mfma_f32_16x16x32_bf16 v[76:79], v[48:51], v[140:143], v[76:79]
s_waitcnt lgkmcnt(3)
v_exp_f32 v14, v62
v_mfma_f32_16x16x32_bf16 v[156:159], v[52:55], v[92:95], v[156:159]
ds_read_b128 v[48:51], v2 offset:21248
v_add_f32 v16, v12, v13
v_mfma_f32_16x16x32_bf16 v[188:191], v[52:55], v[96:99], v[188:191]
v_exp_f32 v15, v63
v_mfma_f32_16x16x32_bf16 v[220:223], v[52:55], v[100:103], v[220:223]
s_waitcnt lgkmcnt(3)
ds_read_b64_tr_b16 v[52:53], v4 offset:41216
v_cvt_pk_bf16_f32 v84, v12, v13
v_mfma_f32_16x16x32_bf16 v[68:71], v[40:43], v[112:115], v[68:71]
v_exp_f32 v8, v64
v_mfma_f32_16x16x32_bf16 v[72:75], v[40:43], v[128:131], v[72:75]
ds_read_b64_tr_b16 v[54:55], v4 offset:45312
v_add_f32 v17, v14, v15
v_cvt_pk_bf16_f32 v85, v14, v15
v_mfma_f32_16x16x32_bf16 v[76:79], v[40:43], v[144:147], v[76:79]
s_waitcnt lgkmcnt(3)
v_exp_f32 v9, v65
v_mfma_f32_16x16x32_bf16 v[160:163], v[44:47], v[92:95], v[160:163]
ds_read_b128 v[40:43], v2 offset:24576
v_add_f32 v19, v16, v17
v_mfma_f32_16x16x32_bf16 v[192:195], v[44:47], v[96:99], v[192:195]
v_exp_f32 v10, v66
v_mfma_f32_16x16x32_bf16 v[224:227], v[44:47], v[100:103], v[224:227]
s_waitcnt lgkmcnt(3)
ds_read_b64_tr_b16 v[44:45], v3 offset:41472
v_add_f32 v16, v8, v9
v_cvt_pk_bf16_f32 v88, v8, v9
v_mfma_f32_16x16x32_bf16 v[68:71], v[48:51], v[116:119], v[68:71]
v_exp_f32 v11, v67
v_mfma_f32_16x16x32_bf16 v[72:75], v[48:51], v[132:135], v[72:75]
ds_read_b64_tr_b16 v[46:47], v3 offset:45568
v_add_f32 v17, v10, v11
v_add_f32 v20, v16, v17
v_mfma_f32_16x16x32_bf16 v[76:79], v[48:51], v[148:151], v[76:79]
s_waitcnt lgkmcnt(3)
v_max3_f32 v27, v18, v19, v20
v_cmp_lt_f32 vcc, s60, v27
v_mfma_f32_16x16x32_bf16 v[164:167], v[52:55], v[92:95], v[164:167]
ds_read_b128 v[48:51], v2 offset:24832
v_cvt_pk_bf16_f32 v89, v10, v11
v_mfma_f32_16x16x32_bf16 v[196:199], v[52:55], v[96:99], v[196:199]
v_exp_f32 v8, v68
v_mfma_f32_16x16x32_bf16 v[228:231], v[52:55], v[100:103], v[228:231]
ds_read_b64_tr_b16 v[52:53], v4 offset:41472
s_cbranch_vccnz TR_X5
RET_X5:
v_exp_f32 v9, v69
s_waitcnt lgkmcnt(4)
v_mfma_f32_16x16x32_bf16 v[56:59], v[40:43], v[104:107], v[28:31]
v_exp_f32 v10, v70
v_mfma_f32_16x16x32_bf16 v[60:63], v[40:43], v[120:123], v[32:35]
ds_read_b64_tr_b16 v[54:55], v4 offset:45568
v_add_f32 v21, v21, v18
v_add_f32 v22, v22, v19
v_mfma_f32_16x16x32_bf16 v[64:67], v[40:43], v[136:139], v[36:39]
s_waitcnt lgkmcnt(3)
v_exp_f32 v11, v71
v_mfma_f32_16x16x32_bf16 v[168:171], v[44:47], v[92:95], v[168:171]
ds_read_b128 v[40:43], v2 offset:25088
v_add_f32 v16, v8, v9
v_cvt_pk_bf16_f32 v82, v8, v9
v_mfma_f32_16x16x32_bf16 v[200:203], v[44:47], v[96:99], v[200:203]
v_exp_f32 v12, v72
v_mfma_f32_16x16x32_bf16 v[232:235], v[44:47], v[100:103], v[232:235]
s_waitcnt lgkmcnt(3)
ds_read_b64_tr_b16 v[44:45], v3 offset:41728
v_add_f32 v17, v10, v11
v_cvt_pk_bf16_f32 v83, v10, v11
v_mfma_f32_16x16x32_bf16 v[56:59], v[48:51], v[108:111], v[56:59]
s_barrier
v_exp_f32 v13, v73
v_mfma_f32_16x16x32_bf16 v[60:63], v[48:51], v[124:127], v[60:63]
ds_read_b64_tr_b16 v[46:47], v3 offset:45824
v_add_f32 v23, v23, v20
v_add_f32 v18, v16, v17
v_mfma_f32_16x16x32_bf16 v[64:67], v[48:51], v[140:143], v[64:67]
s_waitcnt lgkmcnt(3)
v_exp_f32 v14, v74
v_mfma_f32_16x16x32_bf16 v[172:175], v[52:55], v[92:95], v[172:175]
ds_read_b128 v[48:51], v2 offset:25344
v_add_f32 v16, v12, v13
v_mfma_f32_16x16x32_bf16 v[204:207], v[52:55], v[96:99], v[204:207]
v_exp_f32 v15, v75
v_mfma_f32_16x16x32_bf16 v[236:239], v[52:55], v[100:103], v[236:239]
s_waitcnt lgkmcnt(3)
ds_read_b64_tr_b16 v[52:53], v4 offset:41728
v_cvt_pk_bf16_f32 v86, v12, v13
v_mfma_f32_16x16x32_bf16 v[56:59], v[40:43], v[112:115], v[56:59]
v_exp_f32 v8, v76
v_mfma_f32_16x16x32_bf16 v[60:63], v[40:43], v[128:131], v[60:63]
ds_read_b64_tr_b16 v[54:55], v4 offset:45824
v_add_f32 v17, v14, v15
v_cvt_pk_bf16_f32 v87, v14, v15
v_mfma_f32_16x16x32_bf16 v[64:67], v[40:43], v[144:147], v[64:67]
s_waitcnt lgkmcnt(3)
v_exp_f32 v9, v77
v_mfma_f32_16x16x32_bf16 v[176:179], v[44:47], v[92:95], v[176:179]
ds_read_b128 v[40:43], v2 offset:28672
v_add_f32 v19, v16, v17
v_mfma_f32_16x16x32_bf16 v[208:211], v[44:47], v[96:99], v[208:211]
v_exp_f32 v10, v78
v_mfma_f32_16x16x32_bf16 v[240:243], v[44:47], v[100:103], v[240:243]
s_waitcnt lgkmcnt(3)
ds_read_b64_tr_b16 v[44:45], v3 offset:49152
v_add_f32 v16, v8, v9
v_cvt_pk_bf16_f32 v90, v8, v9
v_mfma_f32_16x16x32_bf16 v[56:59], v[48:51], v[116:119], v[56:59]
v_exp_f32 v11, v79
v_mfma_f32_16x16x32_bf16 v[60:63], v[48:51], v[132:135], v[60:63]
ds_read_b64_tr_b16 v[46:47], v3 offset:53248
v_add_f32 v17, v10, v11
v_add_f32 v20, v16, v17
v_mfma_f32_16x16x32_bf16 v[64:67], v[48:51], v[148:151], v[64:67]
s_waitcnt lgkmcnt(3)
v_max3_f32 v27, v18, v19, v20
v_cmp_lt_f32 vcc, s60, v27
v_mfma_f32_16x16x32_bf16 v[180:183], v[52:55], v[92:95], v[180:183]
ds_read_b128 v[48:51], v2 offset:28928
v_cvt_pk_bf16_f32 v91, v10, v11
v_mfma_f32_16x16x32_bf16 v[212:215], v[52:55], v[96:99], v[212:215]
v_exp_f32 v8, v56
v_mfma_f32_16x16x32_bf16 v[244:247], v[52:55], v[100:103], v[244:247]
s_waitcnt lgkmcnt(3)
ds_read_b64_tr_b16 v[52:53], v4 offset:49152
s_cbranch_vccnz TR_Y6
RET_Y6:
v_exp_f32 v9, v57
v_mfma_f32_16x16x32_bf16 v[68:71], v[40:43], v[104:107], v[28:31]
v_exp_f32 v10, v58
v_mfma_f32_16x16x32_bf16 v[72:75], v[40:43], v[120:123], v[32:35]
ds_read_b64_tr_b16 v[54:55], v4 offset:53248
v_add_f32 v21, v21, v18
v_add_f32 v22, v22, v19
v_mfma_f32_16x16x32_bf16 v[76:79], v[40:43], v[136:139], v[36:39]
s_waitcnt lgkmcnt(3)
v_exp_f32 v11, v59
v_mfma_f32_16x16x32_bf16 v[152:155], v[44:47], v[80:83], v[152:155]
ds_read_b128 v[40:43], v2 offset:29184
v_add_f32 v16, v8, v9
v_cvt_pk_bf16_f32 v92, v8, v9
v_mfma_f32_16x16x32_bf16 v[184:187], v[44:47], v[84:87], v[184:187]
v_exp_f32 v12, v60
v_mfma_f32_16x16x32_bf16 v[216:219], v[44:47], v[88:91], v[216:219]
s_waitcnt lgkmcnt(3)
ds_read_b64_tr_b16 v[44:45], v3 offset:49408
v_add_f32 v17, v10, v11
v_cvt_pk_bf16_f32 v93, v10, v11
v_mfma_f32_16x16x32_bf16 v[68:71], v[48:51], v[108:111], v[68:71]
v_exp_f32 v13, v61
v_mfma_f32_16x16x32_bf16 v[72:75], v[48:51], v[124:127], v[72:75]
ds_read_b64_tr_b16 v[46:47], v3 offset:53504
v_add_f32 v23, v23, v20
v_add_f32 v18, v16, v17
v_mfma_f32_16x16x32_bf16 v[76:79], v[48:51], v[140:143], v[76:79]
s_waitcnt lgkmcnt(3)
v_exp_f32 v14, v62
v_mfma_f32_16x16x32_bf16 v[156:159], v[52:55], v[80:83], v[156:159]
ds_read_b128 v[48:51], v2 offset:29440
v_add_f32 v16, v12, v13
v_mfma_f32_16x16x32_bf16 v[188:191], v[52:55], v[84:87], v[188:191]
v_exp_f32 v15, v63
v_mfma_f32_16x16x32_bf16 v[220:223], v[52:55], v[88:91], v[220:223]
s_waitcnt lgkmcnt(3)
ds_read_b64_tr_b16 v[52:53], v4 offset:49408
v_cvt_pk_bf16_f32 v96, v12, v13
v_mfma_f32_16x16x32_bf16 v[68:71], v[40:43], v[112:115], v[68:71]
v_exp_f32 v8, v64
v_mfma_f32_16x16x32_bf16 v[72:75], v[40:43], v[128:131], v[72:75]
ds_read_b64_tr_b16 v[54:55], v4 offset:53504
v_add_f32 v17, v14, v15
v_cvt_pk_bf16_f32 v97, v14, v15
v_mfma_f32_16x16x32_bf16 v[76:79], v[40:43], v[144:147], v[76:79]
s_waitcnt lgkmcnt(3)
v_exp_f32 v9, v65
v_mfma_f32_16x16x32_bf16 v[160:163], v[44:47], v[80:83], v[160:163]
ds_read_b128 v[40:43], v2
v_add_f32 v19, v16, v17
v_mfma_f32_16x16x32_bf16 v[192:195], v[44:47], v[84:87], v[192:195]
v_exp_f32 v10, v66
v_mfma_f32_16x16x32_bf16 v[224:227], v[44:47], v[88:91], v[224:227]
s_waitcnt lgkmcnt(3)
ds_read_b64_tr_b16 v[44:45], v3 offset:49664
v_add_f32 v16, v8, v9
v_cvt_pk_bf16_f32 v100, v8, v9
v_mfma_f32_16x16x32_bf16 v[68:71], v[48:51], v[116:119], v[68:71]
v_exp_f32 v11, v67
v_mfma_f32_16x16x32_bf16 v[72:75], v[48:51], v[132:135], v[72:75]
ds_read_b64_tr_b16 v[46:47], v3 offset:53760
v_add_f32 v17, v10, v11
v_add_f32 v20, v16, v17
v_mfma_f32_16x16x32_bf16 v[76:79], v[48:51], v[148:151], v[76:79]
s_waitcnt lgkmcnt(3)
v_max3_f32 v27, v18, v19, v20
v_cmp_lt_f32 vcc, s60, v27
v_mfma_f32_16x16x32_bf16 v[164:167], v[52:55], v[80:83], v[164:167]
ds_read_b128 v[48:51], v2 offset:256
v_cvt_pk_bf16_f32 v101, v10, v11
v_mfma_f32_16x16x32_bf16 v[196:199], v[52:55], v[84:87], v[196:199]
v_exp_f32 v8, v68
v_mfma_f32_16x16x32_bf16 v[228:231], v[52:55], v[88:91], v[228:231]
ds_read_b64_tr_b16 v[52:53], v4 offset:49664
s_cbranch_vccnz TR_X6
RET_X6:
v_exp_f32 v9, v69
s_waitcnt lgkmcnt(4)
v_mfma_f32_16x16x32_bf16 v[56:59], v[40:43], v[104:107], v[28:31]
v_exp_f32 v10, v70
v_mfma_f32_16x16x32_bf16 v[60:63], v[40:43], v[120:123], v[32:35]
ds_read_b64_tr_b16 v[54:55], v4 offset:53760
v_add_f32 v21, v21, v18
v_add_f32 v22, v22, v19
v_mfma_f32_16x16x32_bf16 v[64:67], v[40:43], v[136:139], v[36:39]
s_waitcnt lgkmcnt(3)
v_exp_f32 v11, v71
v_mfma_f32_16x16x32_bf16 v[168:171], v[44:47], v[80:83], v[168:171]
ds_read_b128 v[40:43], v2 offset:512
v_add_f32 v16, v8, v9
v_cvt_pk_bf16_f32 v94, v8, v9
v_mfma_f32_16x16x32_bf16 v[200:203], v[44:47], v[84:87], v[200:203]
v_exp_f32 v12, v72
v_mfma_f32_16x16x32_bf16 v[232:235], v[44:47], v[88:91], v[232:235]
s_waitcnt lgkmcnt(3)
ds_read_b64_tr_b16 v[44:45], v3 offset:49920
v_add_f32 v17, v10, v11
v_cvt_pk_bf16_f32 v95, v10, v11
v_mfma_f32_16x16x32_bf16 v[56:59], v[48:51], v[108:111], v[56:59]
s_barrier
v_exp_f32 v13, v73
v_mfma_f32_16x16x32_bf16 v[60:63], v[48:51], v[124:127], v[60:63]
ds_read_b64_tr_b16 v[46:47], v3 offset:54016
v_add_f32 v23, v23, v20
v_add_f32 v18, v16, v17
v_mfma_f32_16x16x32_bf16 v[64:67], v[48:51], v[140:143], v[64:67]
s_waitcnt lgkmcnt(3)
v_exp_f32 v14, v74
v_mfma_f32_16x16x32_bf16 v[172:175], v[52:55], v[80:83], v[172:175]
ds_read_b128 v[48:51], v2 offset:768
v_add_f32 v16, v12, v13
v_mfma_f32_16x16x32_bf16 v[204:207], v[52:55], v[84:87], v[204:207]
v_exp_f32 v15, v75
v_mfma_f32_16x16x32_bf16 v[236:239], v[52:55], v[88:91], v[236:239]
s_waitcnt lgkmcnt(3)
ds_read_b64_tr_b16 v[52:53], v4 offset:49920
v_cvt_pk_bf16_f32 v98, v12, v13
v_mfma_f32_16x16x32_bf16 v[56:59], v[40:43], v[112:115], v[56:59]
v_exp_f32 v8, v76
v_mfma_f32_16x16x32_bf16 v[60:63], v[40:43], v[128:131], v[60:63]
ds_read_b64_tr_b16 v[54:55], v4 offset:54016
v_add_f32 v17, v14, v15
v_cvt_pk_bf16_f32 v99, v14, v15
v_mfma_f32_16x16x32_bf16 v[64:67], v[40:43], v[144:147], v[64:67]
s_waitcnt lgkmcnt(3)
v_exp_f32 v9, v77
v_mfma_f32_16x16x32_bf16 v[176:179], v[44:47], v[80:83], v[176:179]
ds_read_b128 v[40:43], v2 offset:4096
v_add_f32 v19, v16, v17
v_mfma_f32_16x16x32_bf16 v[208:211], v[44:47], v[84:87], v[208:211]
v_exp_f32 v10, v78
v_mfma_f32_16x16x32_bf16 v[240:243], v[44:47], v[88:91], v[240:243]
s_waitcnt lgkmcnt(3)
ds_read_b64_tr_b16 v[44:45], v3 offset:57344
v_add_f32 v16, v8, v9
v_cvt_pk_bf16_f32 v102, v8, v9
v_mfma_f32_16x16x32_bf16 v[56:59], v[48:51], v[116:119], v[56:59]
v_exp_f32 v11, v79
v_mfma_f32_16x16x32_bf16 v[60:63], v[48:51], v[132:135], v[60:63]
ds_read_b64_tr_b16 v[46:47], v3 offset:61440
v_add_f32 v17, v10, v11
v_add_f32 v20, v16, v17
v_mfma_f32_16x16x32_bf16 v[64:67], v[48:51], v[148:151], v[64:67]
s_waitcnt lgkmcnt(3)
v_max3_f32 v27, v18, v19, v20
v_cmp_lt_f32 vcc, s60, v27
v_mfma_f32_16x16x32_bf16 v[180:183], v[52:55], v[80:83], v[180:183]
ds_read_b128 v[48:51], v2 offset:4352
v_cvt_pk_bf16_f32 v103, v10, v11
v_mfma_f32_16x16x32_bf16 v[212:215], v[52:55], v[84:87], v[212:215]
v_exp_f32 v8, v56
v_mfma_f32_16x16x32_bf16 v[244:247], v[52:55], v[88:91], v[244:247]
s_waitcnt lgkmcnt(3)
ds_read_b64_tr_b16 v[52:53], v4 offset:57344
s_cbranch_vccnz TR_Y7
RET_Y7:
v_exp_f32 v9, v57
v_mfma_f32_16x16x32_bf16 v[68:71], v[40:43], v[104:107], v[28:31]
v_exp_f32 v10, v58
v_mfma_f32_16x16x32_bf16 v[72:75], v[40:43], v[120:123], v[32:35]
ds_read_b64_tr_b16 v[54:55], v4 offset:61440
v_add_f32 v21, v21, v18
v_add_f32 v22, v22, v19
v_mfma_f32_16x16x32_bf16 v[76:79], v[40:43], v[136:139], v[36:39]
s_waitcnt lgkmcnt(3)
v_exp_f32 v11, v59
v_mfma_f32_16x16x32_bf16 v[152:155], v[44:47], v[92:95], v[152:155]
ds_read_b128 v[40:43], v2 offset:4608
v_add_f32 v16, v8, v9
v_cvt_pk_bf16_f32 v80, v8, v9
v_mfma_f32_16x16x32_bf16 v[184:187], v[44:47], v[96:99], v[184:187]
v_exp_f32 v12, v60
v_mfma_f32_16x16x32_bf16 v[216:219], v[44:47], v[100:103], v[216:219]
s_waitcnt lgkmcnt(3)
ds_read_b64_tr_b16 v[44:45], v3 offset:57600
v_add_f32 v17, v10, v11
v_cvt_pk_bf16_f32 v81, v10, v11
v_mfma_f32_16x16x32_bf16 v[68:71], v[48:51], v[108:111], v[68:71]
v_exp_f32 v13, v61
v_mfma_f32_16x16x32_bf16 v[72:75], v[48:51], v[124:127], v[72:75]
ds_read_b64_tr_b16 v[46:47], v3 offset:61696
v_add_f32 v23, v23, v20
v_add_f32 v18, v16, v17
v_mfma_f32_16x16x32_bf16 v[76:79], v[48:51], v[140:143], v[76:79]
s_waitcnt lgkmcnt(3)
v_exp_f32 v14, v62
v_mfma_f32_16x16x32_bf16 v[156:159], v[52:55], v[92:95], v[156:159]
ds_read_b128 v[48:51], v2 offset:4864
v_add_f32 v16, v12, v13
v_mfma_f32_16x16x32_bf16 v[188:191], v[52:55], v[96:99], v[188:191]
v_exp_f32 v15, v63
v_mfma_f32_16x16x32_bf16 v[220:223], v[52:55], v[100:103], v[220:223]
s_waitcnt lgkmcnt(3)
ds_read_b64_tr_b16 v[52:53], v4 offset:57600
v_cvt_pk_bf16_f32 v84, v12, v13
v_mfma_f32_16x16x32_bf16 v[68:71], v[40:43], v[112:115], v[68:71]
v_exp_f32 v8, v64
v_mfma_f32_16x16x32_bf16 v[72:75], v[40:43], v[128:131], v[72:75]
ds_read_b64_tr_b16 v[54:55], v4 offset:61696
v_add_f32 v17, v14, v15
v_cvt_pk_bf16_f32 v85, v14, v15
v_mfma_f32_16x16x32_bf16 v[76:79], v[40:43], v[144:147], v[76:79]
s_waitcnt lgkmcnt(3)
v_exp_f32 v9, v65
v_mfma_f32_16x16x32_bf16 v[160:163], v[44:47], v[92:95], v[160:163]
ds_read_b128 v[40:43], v2 offset:8192
v_add_f32 v19, v16, v17
v_mfma_f32_16x16x32_bf16 v[192:195], v[44:47], v[96:99], v[192:195]
v_exp_f32 v10, v66
v_mfma_f32_16x16x32_bf16 v[224:227], v[44:47], v[100:103], v[224:227]
s_waitcnt lgkmcnt(3)
ds_read_b64_tr_b16 v[44:45], v3 offset:57856
v_add_f32 v16, v8, v9
v_cvt_pk_bf16_f32 v88, v8, v9
v_mfma_f32_16x16x32_bf16 v[68:71], v[48:51], v[116:119], v[68:71]
v_exp_f32 v11, v67
v_mfma_f32_16x16x32_bf16 v[72:75], v[48:51], v[132:135], v[72:75]
ds_read_b64_tr_b16 v[46:47], v3 offset:61952
v_add_f32 v17, v10, v11
v_add_f32 v20, v16, v17
v_mfma_f32_16x16x32_bf16 v[76:79], v[48:51], v[148:151], v[76:79]
s_waitcnt lgkmcnt(3)
v_max3_f32 v27, v18, v19, v20
v_cmp_lt_f32 vcc, s60, v27
v_mfma_f32_16x16x32_bf16 v[164:167], v[52:55], v[92:95], v[164:167]
ds_read_b128 v[48:51], v2 offset:8448
v_cvt_pk_bf16_f32 v89, v10, v11
v_mfma_f32_16x16x32_bf16 v[196:199], v[52:55], v[96:99], v[196:199]
v_exp_f32 v8, v68
v_mfma_f32_16x16x32_bf16 v[228:231], v[52:55], v[100:103], v[228:231]
ds_read_b64_tr_b16 v[52:53], v4 offset:57856
s_cbranch_vccnz TR_X7
RET_X7:
v_exp_f32 v9, v69
s_waitcnt lgkmcnt(4)
v_mfma_f32_16x16x32_bf16 v[56:59], v[40:43], v[104:107], v[28:31]
v_exp_f32 v10, v70
v_mfma_f32_16x16x32_bf16 v[60:63], v[40:43], v[120:123], v[32:35]
ds_read_b64_tr_b16 v[54:55], v4 offset:61952
v_add_f32 v21, v21, v18
v_add_f32 v22, v22, v19
v_mfma_f32_16x16x32_bf16 v[64:67], v[40:43], v[136:139], v[36:39]
s_waitcnt lgkmcnt(3)
v_exp_f32 v11, v71
v_mfma_f32_16x16x32_bf16 v[168:171], v[44:47], v[92:95], v[168:171]
ds_read_b128 v[40:43], v2 offset:8704
v_add_f32 v16, v8, v9
v_cvt_pk_bf16_f32 v82, v8, v9
v_mfma_f32_16x16x32_bf16 v[200:203], v[44:47], v[96:99], v[200:203]
v_exp_f32 v12, v72
v_mfma_f32_16x16x32_bf16 v[232:235], v[44:47], v[100:103], v[232:235]
s_waitcnt lgkmcnt(3)
ds_read_b64_tr_b16 v[44:45], v3 offset:58112
v_add_f32 v17, v10, v11
v_cvt_pk_bf16_f32 v83, v10, v11
v_mfma_f32_16x16x32_bf16 v[56:59], v[48:51], v[108:111], v[56:59]
s_barrier
v_exp_f32 v13, v73
v_mfma_f32_16x16x32_bf16 v[60:63], v[48:51], v[124:127], v[60:63]
ds_read_b64_tr_b16 v[46:47], v3 offset:62208
v_add_f32 v23, v23, v20
v_add_f32 v18, v16, v17
v_mfma_f32_16x16x32_bf16 v[64:67], v[48:51], v[140:143], v[64:67]
s_waitcnt lgkmcnt(3)
v_exp_f32 v14, v74
v_mfma_f32_16x16x32_bf16 v[172:175], v[52:55], v[92:95], v[172:175]
ds_read_b128 v[48:51], v2 offset:8960
v_add_f32 v16, v12, v13
v_mfma_f32_16x16x32_bf16 v[204:207], v[52:55], v[96:99], v[204:207]
v_exp_f32 v15, v75
v_mfma_f32_16x16x32_bf16 v[236:239], v[52:55], v[100:103], v[236:239]
s_waitcnt lgkmcnt(3)
ds_read_b64_tr_b16 v[52:53], v4 offset:58112
v_cvt_pk_bf16_f32 v86, v12, v13
v_mfma_f32_16x16x32_bf16 v[56:59], v[40:43], v[112:115], v[56:59]
v_exp_f32 v8, v76
v_mfma_f32_16x16x32_bf16 v[60:63], v[40:43], v[128:131], v[60:63]
ds_read_b64_tr_b16 v[54:55], v4 offset:62208
v_add_f32 v17, v14, v15
v_cvt_pk_bf16_f32 v87, v14, v15
v_mfma_f32_16x16x32_bf16 v[64:67], v[40:43], v[144:147], v[64:67]
s_waitcnt lgkmcnt(3)
v_exp_f32 v9, v77
v_mfma_f32_16x16x32_bf16 v[176:179], v[44:47], v[92:95], v[176:179]
ds_read_b128 v[40:43], v2 offset:12288
v_add_f32 v19, v16, v17
v_mfma_f32_16x16x32_bf16 v[208:211], v[44:47], v[96:99], v[208:211]
v_exp_f32 v10, v78
v_mfma_f32_16x16x32_bf16 v[240:243], v[44:47], v[100:103], v[240:243]
s_waitcnt lgkmcnt(3)
ds_read_b64_tr_b16 v[44:45], v3 offset:32768
v_add_f32 v16, v8, v9
v_cvt_pk_bf16_f32 v90, v8, v9
v_mfma_f32_16x16x32_bf16 v[56:59], v[48:51], v[116:119], v[56:59]
v_exp_f32 v11, v79
v_mfma_f32_16x16x32_bf16 v[60:63], v[48:51], v[132:135], v[60:63]
ds_read_b64_tr_b16 v[46:47], v3 offset:36864
v_add_f32 v17, v10, v11
v_add_f32 v20, v16, v17
v_mfma_f32_16x16x32_bf16 v[64:67], v[48:51], v[148:151], v[64:67]
s_waitcnt lgkmcnt(3)
v_max3_f32 v27, v18, v19, v20
v_cmp_lt_f32 vcc, s60, v27
v_mfma_f32_16x16x32_bf16 v[180:183], v[52:55], v[92:95], v[180:183]
ds_read_b128 v[48:51], v2 offset:12544
v_cvt_pk_bf16_f32 v91, v10, v11
v_mfma_f32_16x16x32_bf16 v[212:215], v[52:55], v[96:99], v[212:215]
v_exp_f32 v8, v56
v_mfma_f32_16x16x32_bf16 v[244:247], v[52:55], v[100:103], v[244:247]
s_waitcnt lgkmcnt(3)
ds_read_b64_tr_b16 v[52:53], v4 offset:32768
s_cbranch_vccnz TR_Y8
RET_Y8:
v_exp_f32 v9, v57
v_mfma_f32_16x16x32_bf16 v[68:71], v[40:43], v[104:107], v[28:31]
v_exp_f32 v10, v58
v_mfma_f32_16x16x32_bf16 v[72:75], v[40:43], v[120:123], v[32:35]
ds_read_b64_tr_b16 v[54:55], v4 offset:36864
v_add_f32 v21, v21, v18
v_add_f32 v22, v22, v19
v_mfma_f32_16x16x32_bf16 v[76:79], v[40:43], v[136:139], v[36:39]
s_waitcnt lgkmcnt(3)
v_exp_f32 v11, v59
v_mfma_f32_16x16x32_bf16 v[152:155], v[44:47], v[80:83], v[152:155]
ds_read_b128 v[40:43], v2 offset:12800
v_add_f32 v16, v8, v9
v_cvt_pk_bf16_f32 v92, v8, v9
v_mfma_f32_16x16x32_bf16 v[184:187], v[44:47], v[84:87], v[184:187]
v_exp_f32 v12, v60
v_mfma_f32_16x16x32_bf16 v[216:219], v[44:47], v[88:91], v[216:219]
s_waitcnt lgkmcnt(3)
ds_read_b64_tr_b16 v[44:45], v3 offset:33024
v_add_f32 v17, v10, v11
v_cvt_pk_bf16_f32 v93, v10, v11
v_mfma_f32_16x16x32_bf16 v[68:71], v[48:51], v[108:111], v[68:71]
v_exp_f32 v13, v61
v_mfma_f32_16x16x32_bf16 v[72:75], v[48:51], v[124:127], v[72:75]
ds_read_b64_tr_b16 v[46:47], v3 offset:37120
v_add_f32 v23, v23, v20
v_add_f32 v18, v16, v17
v_mfma_f32_16x16x32_bf16 v[76:79], v[48:51], v[140:143], v[76:79]
s_waitcnt lgkmcnt(3)
v_exp_f32 v14, v62
v_mfma_f32_16x16x32_bf16 v[156:159], v[52:55], v[80:83], v[156:159]
ds_read_b128 v[48:51], v2 offset:13056
v_add_f32 v16, v12, v13
v_mfma_f32_16x16x32_bf16 v[188:191], v[52:55], v[84:87], v[188:191]
v_exp_f32 v15, v63
v_mfma_f32_16x16x32_bf16 v[220:223], v[52:55], v[88:91], v[220:223]
s_waitcnt lgkmcnt(3)
ds_read_b64_tr_b16 v[52:53], v4 offset:33024
v_cvt_pk_bf16_f32 v96, v12, v13
v_mfma_f32_16x16x32_bf16 v[68:71], v[40:43], v[112:115], v[68:71]
v_exp_f32 v8, v64
v_mfma_f32_16x16x32_bf16 v[72:75], v[40:43], v[128:131], v[72:75]
ds_read_b64_tr_b16 v[54:55], v4 offset:37120
v_add_f32 v17, v14, v15
v_cvt_pk_bf16_f32 v97, v14, v15
v_mfma_f32_16x16x32_bf16 v[76:79], v[40:43], v[144:147], v[76:79]
s_waitcnt lgkmcnt(3)
v_exp_f32 v9, v65
v_mfma_f32_16x16x32_bf16 v[160:163], v[44:47], v[80:83], v[160:163]
ds_read_b128 v[40:43], v2 offset:16384
v_add_f32 v19, v16, v17
v_mfma_f32_16x16x32_bf16 v[192:195], v[44:47], v[84:87], v[192:195]
v_exp_f32 v10, v66
v_mfma_f32_16x16x32_bf16 v[224:227], v[44:47], v[88:91], v[224:227]
s_waitcnt lgkmcnt(3)
ds_read_b64_tr_b16 v[44:45], v3 offset:33280
v_add_f32 v16, v8, v9
v_cvt_pk_bf16_f32 v100, v8, v9
v_mfma_f32_16x16x32_bf16 v[68:71], v[48:51], v[116:119], v[68:71]
v_exp_f32 v11, v67
v_mfma_f32_16x16x32_bf16 v[72:75], v[48:51], v[132:135], v[72:75]
ds_read_b64_tr_b16 v[46:47], v3 offset:37376
v_add_f32 v17, v10, v11
v_add_f32 v20, v16, v17
v_mfma_f32_16x16x32_bf16 v[76:79], v[48:51], v[148:151], v[76:79]
s_waitcnt lgkmcnt(3)
v_max3_f32 v27, v18, v19, v20
v_cmp_lt_f32 vcc, s60, v27
v_mfma_f32_16x16x32_bf16 v[164:167], v[52:55], v[80:83], v[164:167]
ds_read_b128 v[48:51], v2 offset:16640
v_cvt_pk_bf16_f32 v101, v10, v11
v_mfma_f32_16x16x32_bf16 v[196:199], v[52:55], v[84:87], v[196:199]
v_exp_f32 v8, v68
v_mfma_f32_16x16x32_bf16 v[228:231], v[52:55], v[88:91], v[228:231]
ds_read_b64_tr_b16 v[52:53], v4 offset:33280
s_cbranch_vccnz TR_X8
RET_X8:
v_exp_f32 v9, v69
s_waitcnt lgkmcnt(4)
v_mfma_f32_16x16x32_bf16 v[56:59], v[40:43], v[104:107], v[28:31]
v_exp_f32 v10, v70
v_mfma_f32_16x16x32_bf16 v[60:63], v[40:43], v[120:123], v[32:35]
ds_read_b64_tr_b16 v[54:55], v4 offset:37376
v_add_f32 v21, v21, v18
v_add_f32 v22, v22, v19
v_mfma_f32_16x16x32_bf16 v[64:67], v[40:43], v[136:139], v[36:39]
s_waitcnt lgkmcnt(3)
v_exp_f32 v11, v71
v_mfma_f32_16x16x32_bf16 v[168:171], v[44:47], v[80:83], v[168:171]
ds_read_b128 v[40:43], v2 offset:16896
v_add_f32 v16, v8, v9
v_cvt_pk_bf16_f32 v94, v8, v9
v_mfma_f32_16x16x32_bf16 v[200:203], v[44:47], v[84:87], v[200:203]
v_exp_f32 v12, v72
v_mfma_f32_16x16x32_bf16 v[232:235], v[44:47], v[88:91], v[232:235]
s_waitcnt lgkmcnt(3)
ds_read_b64_tr_b16 v[44:45], v3 offset:33536
v_add_f32 v17, v10, v11
v_cvt_pk_bf16_f32 v95, v10, v11
v_mfma_f32_16x16x32_bf16 v[56:59], v[48:51], v[108:111], v[56:59]
s_barrier
v_exp_f32 v13, v73
v_mfma_f32_16x16x32_bf16 v[60:63], v[48:51], v[124:127], v[60:63]
ds_read_b64_tr_b16 v[46:47], v3 offset:37632
v_add_f32 v23, v23, v20
v_add_f32 v18, v16, v17
v_mfma_f32_16x16x32_bf16 v[64:67], v[48:51], v[140:143], v[64:67]
s_waitcnt lgkmcnt(3)
v_exp_f32 v14, v74
v_mfma_f32_16x16x32_bf16 v[172:175], v[52:55], v[80:83], v[172:175]
ds_read_b128 v[48:51], v2 offset:17152
v_add_f32 v16, v12, v13
v_mfma_f32_16x16x32_bf16 v[204:207], v[52:55], v[84:87], v[204:207]
v_exp_f32 v15, v75
v_mfma_f32_16x16x32_bf16 v[236:239], v[52:55], v[88:91], v[236:239]
s_waitcnt lgkmcnt(3)
ds_read_b64_tr_b16 v[52:53], v4 offset:33536
v_cvt_pk_bf16_f32 v98, v12, v13
v_mfma_f32_16x16x32_bf16 v[56:59], v[40:43], v[112:115], v[56:59]
v_exp_f32 v8, v76
v_mfma_f32_16x16x32_bf16 v[60:63], v[40:43], v[128:131], v[60:63]
ds_read_b64_tr_b16 v[54:55], v4 offset:37632
v_add_f32 v17, v14, v15
v_cvt_pk_bf16_f32 v99, v14, v15
v_mfma_f32_16x16x32_bf16 v[64:67], v[40:43], v[144:147], v[64:67]
s_waitcnt lgkmcnt(3)
v_exp_f32 v9, v77
v_mfma_f32_16x16x32_bf16 v[176:179], v[44:47], v[80:83], v[176:179]
ds_read_b128 v[40:43], v2 offset:20480
v_add_f32 v19, v16, v17
v_mfma_f32_16x16x32_bf16 v[208:211], v[44:47], v[84:87], v[208:211]
v_exp_f32 v10, v78
v_mfma_f32_16x16x32_bf16 v[240:243], v[44:47], v[88:91], v[240:243]
s_waitcnt lgkmcnt(3)
ds_read_b64_tr_b16 v[44:45], v3 offset:40960
v_add_f32 v16, v8, v9
v_cvt_pk_bf16_f32 v102, v8, v9
v_mfma_f32_16x16x32_bf16 v[56:59], v[48:51], v[116:119], v[56:59]
v_exp_f32 v11, v79
v_mfma_f32_16x16x32_bf16 v[60:63], v[48:51], v[132:135], v[60:63]
ds_read_b64_tr_b16 v[46:47], v3 offset:45056
v_add_f32 v17, v10, v11
v_add_f32 v20, v16, v17
v_mfma_f32_16x16x32_bf16 v[64:67], v[48:51], v[148:151], v[64:67]
s_waitcnt lgkmcnt(3)
v_max3_f32 v27, v18, v19, v20
v_cmp_lt_f32 vcc, s60, v27
v_mfma_f32_16x16x32_bf16 v[180:183], v[52:55], v[80:83], v[180:183]
ds_read_b128 v[48:51], v2 offset:20736
v_cvt_pk_bf16_f32 v103, v10, v11
v_mfma_f32_16x16x32_bf16 v[212:215], v[52:55], v[84:87], v[212:215]
v_exp_f32 v8, v56
v_mfma_f32_16x16x32_bf16 v[244:247], v[52:55], v[88:91], v[244:247]
s_waitcnt lgkmcnt(3)
ds_read_b64_tr_b16 v[52:53], v4 offset:40960
s_cbranch_vccnz TR_Y9
RET_Y9:
v_exp_f32 v9, v57
v_mfma_f32_16x16x32_bf16 v[68:71], v[40:43], v[104:107], v[28:31]
v_exp_f32 v10, v58
v_mfma_f32_16x16x32_bf16 v[72:75], v[40:43], v[120:123], v[32:35]
ds_read_b64_tr_b16 v[54:55], v4 offset:45056
v_add_f32 v21, v21, v18
v_add_f32 v22, v22, v19
v_mfma_f32_16x16x32_bf16 v[76:79], v[40:43], v[136:139], v[36:39]
s_waitcnt lgkmcnt(3)
v_exp_f32 v11, v59
v_mfma_f32_16x16x32_bf16 v[152:155], v[44:47], v[92:95], v[152:155]
ds_read_b128 v[40:43], v2 offset:20992
v_add_f32 v16, v8, v9
v_cvt_pk_bf16_f32 v80, v8, v9
v_mfma_f32_16x16x32_bf16 v[184:187], v[44:47], v[96:99], v[184:187]
v_exp_f32 v12, v60
v_mfma_f32_16x16x32_bf16 v[216:219], v[44:47], v[100:103], v[216:219]
s_waitcnt lgkmcnt(3)
ds_read_b64_tr_b16 v[44:45], v3 offset:41216
v_add_f32 v17, v10, v11
v_cvt_pk_bf16_f32 v81, v10, v11
v_mfma_f32_16x16x32_bf16 v[68:71], v[48:51], v[108:111], v[68:71]
v_exp_f32 v13, v61
v_mfma_f32_16x16x32_bf16 v[72:75], v[48:51], v[124:127], v[72:75]
ds_read_b64_tr_b16 v[46:47], v3 offset:45312
v_add_f32 v23, v23, v20
v_add_f32 v18, v16, v17
v_mfma_f32_16x16x32_bf16 v[76:79], v[48:51], v[140:143], v[76:79]
s_waitcnt lgkmcnt(3)
v_exp_f32 v14, v62
v_mfma_f32_16x16x32_bf16 v[156:159], v[52:55], v[92:95], v[156:159]
ds_read_b128 v[48:51], v2 offset:21248
v_add_f32 v16, v12, v13
v_mfma_f32_16x16x32_bf16 v[188:191], v[52:55], v[96:99], v[188:191]
v_exp_f32 v15, v63
v_mfma_f32_16x16x32_bf16 v[220:223], v[52:55], v[100:103], v[220:223]
s_waitcnt lgkmcnt(3)
ds_read_b64_tr_b16 v[52:53], v4 offset:41216
v_cvt_pk_bf16_f32 v84, v12, v13
v_mfma_f32_16x16x32_bf16 v[68:71], v[40:43], v[112:115], v[68:71]
v_exp_f32 v8, v64
v_mfma_f32_16x16x32_bf16 v[72:75], v[40:43], v[128:131], v[72:75]
ds_read_b64_tr_b16 v[54:55], v4 offset:45312
v_add_f32 v17, v14, v15
v_cvt_pk_bf16_f32 v85, v14, v15
v_mfma_f32_16x16x32_bf16 v[76:79], v[40:43], v[144:147], v[76:79]
s_waitcnt lgkmcnt(3)
v_exp_f32 v9, v65
v_mfma_f32_16x16x32_bf16 v[160:163], v[44:47], v[92:95], v[160:163]
ds_read_b128 v[40:43], v2 offset:24576
v_add_f32 v19, v16, v17
v_mfma_f32_16x16x32_bf16 v[192:195], v[44:47], v[96:99], v[192:195]
v_exp_f32 v10, v66
v_mfma_f32_16x16x32_bf16 v[224:227], v[44:47], v[100:103], v[224:227]
s_waitcnt lgkmcnt(3)
ds_read_b64_tr_b16 v[44:45], v3 offset:41472
v_add_f32 v16, v8, v9
v_cvt_pk_bf16_f32 v88, v8, v9
v_mfma_f32_16x16x32_bf16 v[68:71], v[48:51], v[116:119], v[68:71]
v_exp_f32 v11, v67
v_mfma_f32_16x16x32_bf16 v[72:75], v[48:51], v[132:135], v[72:75]
ds_read_b64_tr_b16 v[46:47], v3 offset:45568
v_add_f32 v17, v10, v11
v_add_f32 v20, v16, v17
v_mfma_f32_16x16x32_bf16 v[76:79], v[48:51], v[148:151], v[76:79]
s_waitcnt lgkmcnt(3)
v_max3_f32 v27, v18, v19, v20
v_cmp_lt_f32 vcc, s60, v27
v_mfma_f32_16x16x32_bf16 v[164:167], v[52:55], v[92:95], v[164:167]
ds_read_b128 v[48:51], v2 offset:24832
v_cvt_pk_bf16_f32 v89, v10, v11
v_mfma_f32_16x16x32_bf16 v[196:199], v[52:55], v[96:99], v[196:199]
v_exp_f32 v8, v68
v_mfma_f32_16x16x32_bf16 v[228:231], v[52:55], v[100:103], v[228:231]
ds_read_b64_tr_b16 v[52:53], v4 offset:41472
s_cbranch_vccnz TR_X9
RET_X9:
v_exp_f32 v9, v69
s_waitcnt lgkmcnt(4)
v_mfma_f32_16x16x32_bf16 v[56:59], v[40:43], v[104:107], v[28:31]
v_exp_f32 v10, v70
v_mfma_f32_16x16x32_bf16 v[60:63], v[40:43], v[120:123], v[32:35]
ds_read_b64_tr_b16 v[54:55], v4 offset:45568
v_add_f32 v21, v21, v18
v_add_f32 v22, v22, v19
v_mfma_f32_16x16x32_bf16 v[64:67], v[40:43], v[136:139], v[36:39]
s_waitcnt lgkmcnt(3)
v_exp_f32 v11, v71
v_mfma_f32_16x16x32_bf16 v[168:171], v[44:47], v[92:95], v[168:171]
ds_read_b128 v[40:43], v2 offset:25088
v_add_f32 v16, v8, v9
v_cvt_pk_bf16_f32 v82, v8, v9
v_mfma_f32_16x16x32_bf16 v[200:203], v[44:47], v[96:99], v[200:203]
v_exp_f32 v12, v72
v_mfma_f32_16x16x32_bf16 v[232:235], v[44:47], v[100:103], v[232:235]
s_waitcnt lgkmcnt(3)
ds_read_b64_tr_b16 v[44:45], v3 offset:41728
v_add_f32 v17, v10, v11
v_cvt_pk_bf16_f32 v83, v10, v11
v_mfma_f32_16x16x32_bf16 v[56:59], v[48:51], v[108:111], v[56:59]
s_barrier
v_exp_f32 v13, v73
v_mfma_f32_16x16x32_bf16 v[60:63], v[48:51], v[124:127], v[60:63]
ds_read_b64_tr_b16 v[46:47], v3 offset:45824
v_add_f32 v23, v23, v20
v_add_f32 v18, v16, v17
v_mfma_f32_16x16x32_bf16 v[64:67], v[48:51], v[140:143], v[64:67]
s_waitcnt lgkmcnt(3)
v_exp_f32 v14, v74
v_mfma_f32_16x16x32_bf16 v[172:175], v[52:55], v[92:95], v[172:175]
ds_read_b128 v[48:51], v2 offset:25344
v_add_f32 v16, v12, v13
v_mfma_f32_16x16x32_bf16 v[204:207], v[52:55], v[96:99], v[204:207]
v_exp_f32 v15, v75
v_mfma_f32_16x16x32_bf16 v[236:239], v[52:55], v[100:103], v[236:239]
s_waitcnt lgkmcnt(3)
ds_read_b64_tr_b16 v[52:53], v4 offset:41728
v_cvt_pk_bf16_f32 v86, v12, v13
v_mfma_f32_16x16x32_bf16 v[56:59], v[40:43], v[112:115], v[56:59]
v_exp_f32 v8, v76
v_mfma_f32_16x16x32_bf16 v[60:63], v[40:43], v[128:131], v[60:63]
ds_read_b64_tr_b16 v[54:55], v4 offset:45824
v_add_f32 v17, v14, v15
v_cvt_pk_bf16_f32 v87, v14, v15
v_mfma_f32_16x16x32_bf16 v[64:67], v[40:43], v[144:147], v[64:67]
s_waitcnt lgkmcnt(3)
v_exp_f32 v9, v77
v_mfma_f32_16x16x32_bf16 v[176:179], v[44:47], v[92:95], v[176:179]
ds_read_b128 v[40:43], v2 offset:28672
v_add_f32 v19, v16, v17
v_mfma_f32_16x16x32_bf16 v[208:211], v[44:47], v[96:99], v[208:211]
v_exp_f32 v10, v78
v_mfma_f32_16x16x32_bf16 v[240:243], v[44:47], v[100:103], v[240:243]
s_waitcnt lgkmcnt(3)
ds_read_b64_tr_b16 v[44:45], v3 offset:49152
v_add_f32 v16, v8, v9
v_cvt_pk_bf16_f32 v90, v8, v9
v_mfma_f32_16x16x32_bf16 v[56:59], v[48:51], v[116:119], v[56:59]
v_exp_f32 v11, v79
v_mfma_f32_16x16x32_bf16 v[60:63], v[48:51], v[132:135], v[60:63]
ds_read_b64_tr_b16 v[46:47], v3 offset:53248
v_add_f32 v17, v10, v11
v_add_f32 v20, v16, v17
v_mfma_f32_16x16x32_bf16 v[64:67], v[48:51], v[148:151], v[64:67]
s_waitcnt lgkmcnt(3)
v_max3_f32 v27, v18, v19, v20
v_cmp_lt_f32 vcc, s60, v27
v_mfma_f32_16x16x32_bf16 v[180:183], v[52:55], v[92:95], v[180:183]
ds_read_b128 v[48:51], v2 offset:28928
v_cvt_pk_bf16_f32 v91, v10, v11
v_mfma_f32_16x16x32_bf16 v[212:215], v[52:55], v[96:99], v[212:215]
v_exp_f32 v8, v56
v_mfma_f32_16x16x32_bf16 v[244:247], v[52:55], v[100:103], v[244:247]
s_waitcnt lgkmcnt(3)
ds_read_b64_tr_b16 v[52:53], v4 offset:49152
s_cbranch_vccnz TR_Y10
RET_Y10:
v_exp_f32 v9, v57
v_mfma_f32_16x16x32_bf16 v[68:71], v[40:43], v[104:107], v[28:31]
v_exp_f32 v10, v58
v_mfma_f32_16x16x32_bf16 v[72:75], v[40:43], v[120:123], v[32:35]
ds_read_b64_tr_b16 v[54:55], v4 offset:53248
v_add_f32 v21, v21, v18
v_add_f32 v22, v22, v19
v_mfma_f32_16x16x32_bf16 v[76:79], v[40:43], v[136:139], v[36:39]
s_waitcnt lgkmcnt(3)
v_exp_f32 v11, v59
v_mfma_f32_16x16x32_bf16 v[152:155], v[44:47], v[80:83], v[152:155]
ds_read_b128 v[40:43], v2 offset:29184
v_add_f32 v16, v8, v9
v_cvt_pk_bf16_f32 v92, v8, v9
v_mfma_f32_16x16x32_bf16 v[184:187], v[44:47], v[84:87], v[184:187]
v_exp_f32 v12, v60
v_mfma_f32_16x16x32_bf16 v[216:219], v[44:47], v[88:91], v[216:219]
s_waitcnt lgkmcnt(3)
ds_read_b64_tr_b16 v[44:45], v3 offset:49408
v_add_f32 v17, v10, v11
v_cvt_pk_bf16_f32 v93, v10, v11
v_mfma_f32_16x16x32_bf16 v[68:71], v[48:51], v[108:111], v[68:71]
v_exp_f32 v13, v61
v_mfma_f32_16x16x32_bf16 v[72:75], v[48:51], v[124:127], v[72:75]
ds_read_b64_tr_b16 v[46:47], v3 offset:53504
v_add_f32 v23, v23, v20
v_add_f32 v18, v16, v17
v_mfma_f32_16x16x32_bf16 v[76:79], v[48:51], v[140:143], v[76:79]
s_waitcnt lgkmcnt(3)
v_exp_f32 v14, v62
v_mfma_f32_16x16x32_bf16 v[156:159], v[52:55], v[80:83], v[156:159]
ds_read_b128 v[48:51], v2 offset:29440
v_add_f32 v16, v12, v13
v_mfma_f32_16x16x32_bf16 v[188:191], v[52:55], v[84:87], v[188:191]
v_exp_f32 v15, v63
v_mfma_f32_16x16x32_bf16 v[220:223], v[52:55], v[88:91], v[220:223]
s_waitcnt lgkmcnt(3)
ds_read_b64_tr_b16 v[52:53], v4 offset:49408
v_cvt_pk_bf16_f32 v96, v12, v13
v_mfma_f32_16x16x32_bf16 v[68:71], v[40:43], v[112:115], v[68:71]
v_exp_f32 v8, v64
v_mfma_f32_16x16x32_bf16 v[72:75], v[40:43], v[128:131], v[72:75]
ds_read_b64_tr_b16 v[54:55], v4 offset:53504
v_add_f32 v17, v14, v15
v_cvt_pk_bf16_f32 v97, v14, v15
v_mfma_f32_16x16x32_bf16 v[76:79], v[40:43], v[144:147], v[76:79]
s_waitcnt lgkmcnt(3)
v_exp_f32 v9, v65
v_mfma_f32_16x16x32_bf16 v[160:163], v[44:47], v[80:83], v[160:163]
ds_read_b128 v[40:43], v2
v_add_f32 v19, v16, v17
v_mfma_f32_16x16x32_bf16 v[192:195], v[44:47], v[84:87], v[192:195]
v_exp_f32 v10, v66
v_mfma_f32_16x16x32_bf16 v[224:227], v[44:47], v[88:91], v[224:227]
s_waitcnt lgkmcnt(3)
ds_read_b64_tr_b16 v[44:45], v3 offset:49664
v_add_f32 v16, v8, v9
v_cvt_pk_bf16_f32 v100, v8, v9
v_mfma_f32_16x16x32_bf16 v[68:71], v[48:51], v[116:119], v[68:71]
v_exp_f32 v11, v67
v_mfma_f32_16x16x32_bf16 v[72:75], v[48:51], v[132:135], v[72:75]
ds_read_b64_tr_b16 v[46:47], v3 offset:53760
v_add_f32 v17, v10, v11
v_add_f32 v20, v16, v17
v_mfma_f32_16x16x32_bf16 v[76:79], v[48:51], v[148:151], v[76:79]
s_waitcnt lgkmcnt(3)
v_max3_f32 v27, v18, v19, v20
v_cmp_lt_f32 vcc, s60, v27
v_mfma_f32_16x16x32_bf16 v[164:167], v[52:55], v[80:83], v[164:167]
ds_read_b128 v[48:51], v2 offset:256
v_cvt_pk_bf16_f32 v101, v10, v11
v_mfma_f32_16x16x32_bf16 v[196:199], v[52:55], v[84:87], v[196:199]
v_exp_f32 v8, v68
v_mfma_f32_16x16x32_bf16 v[228:231], v[52:55], v[88:91], v[228:231]
ds_read_b64_tr_b16 v[52:53], v4 offset:49664
s_cbranch_vccnz TR_X10
RET_X10:
v_exp_f32 v9, v69
s_waitcnt lgkmcnt(4)
v_mfma_f32_16x16x32_bf16 v[56:59], v[40:43], v[104:107], v[28:31]
v_exp_f32 v10, v70
v_mfma_f32_16x16x32_bf16 v[60:63], v[40:43], v[120:123], v[32:35]
ds_read_b64_tr_b16 v[54:55], v4 offset:53760
v_add_f32 v21, v21, v18
v_add_f32 v22, v22, v19
v_mfma_f32_16x16x32_bf16 v[64:67], v[40:43], v[136:139], v[36:39]
s_waitcnt lgkmcnt(3)
v_exp_f32 v11, v71
v_mfma_f32_16x16x32_bf16 v[168:171], v[44:47], v[80:83], v[168:171]
ds_read_b128 v[40:43], v2 offset:512
v_add_f32 v16, v8, v9
v_cvt_pk_bf16_f32 v94, v8, v9
v_mfma_f32_16x16x32_bf16 v[200:203], v[44:47], v[84:87], v[200:203]
v_exp_f32 v12, v72
v_mfma_f32_16x16x32_bf16 v[232:235], v[44:47], v[88:91], v[232:235]
s_waitcnt lgkmcnt(3)
ds_read_b64_tr_b16 v[44:45], v3 offset:49920
v_add_f32 v17, v10, v11
v_cvt_pk_bf16_f32 v95, v10, v11
v_mfma_f32_16x16x32_bf16 v[56:59], v[48:51], v[108:111], v[56:59]
s_barrier
v_exp_f32 v13, v73
v_mfma_f32_16x16x32_bf16 v[60:63], v[48:51], v[124:127], v[60:63]
ds_read_b64_tr_b16 v[46:47], v3 offset:54016
v_add_f32 v23, v23, v20
v_add_f32 v18, v16, v17
v_mfma_f32_16x16x32_bf16 v[64:67], v[48:51], v[140:143], v[64:67]
s_waitcnt lgkmcnt(3)
v_exp_f32 v14, v74
v_mfma_f32_16x16x32_bf16 v[172:175], v[52:55], v[80:83], v[172:175]
ds_read_b128 v[48:51], v2 offset:768
v_add_f32 v16, v12, v13
v_mfma_f32_16x16x32_bf16 v[204:207], v[52:55], v[84:87], v[204:207]
v_exp_f32 v15, v75
v_mfma_f32_16x16x32_bf16 v[236:239], v[52:55], v[88:91], v[236:239]
s_waitcnt lgkmcnt(3)
ds_read_b64_tr_b16 v[52:53], v4 offset:49920
v_cvt_pk_bf16_f32 v98, v12, v13
v_mfma_f32_16x16x32_bf16 v[56:59], v[40:43], v[112:115], v[56:59]
v_exp_f32 v8, v76
v_mfma_f32_16x16x32_bf16 v[60:63], v[40:43], v[128:131], v[60:63]
ds_read_b64_tr_b16 v[54:55], v4 offset:54016
v_add_f32 v17, v14, v15
v_cvt_pk_bf16_f32 v99, v14, v15
v_mfma_f32_16x16x32_bf16 v[64:67], v[40:43], v[144:147], v[64:67]
s_waitcnt lgkmcnt(3)
v_exp_f32 v9, v77
v_mfma_f32_16x16x32_bf16 v[176:179], v[44:47], v[80:83], v[176:179]
ds_read_b128 v[40:43], v2 offset:4096
v_add_f32 v19, v16, v17
v_mfma_f32_16x16x32_bf16 v[208:211], v[44:47], v[84:87], v[208:211]
v_exp_f32 v10, v78
v_mfma_f32_16x16x32_bf16 v[240:243], v[44:47], v[88:91], v[240:243]
s_waitcnt lgkmcnt(3)
ds_read_b64_tr_b16 v[44:45], v3 offset:57344
v_add_f32 v16, v8, v9
v_cvt_pk_bf16_f32 v102, v8, v9
v_mfma_f32_16x16x32_bf16 v[56:59], v[48:51], v[116:119], v[56:59]
v_exp_f32 v11, v79
v_mfma_f32_16x16x32_bf16 v[60:63], v[48:51], v[132:135], v[60:63]
ds_read_b64_tr_b16 v[46:47], v3 offset:61440
v_add_f32 v17, v10, v11
v_add_f32 v20, v16, v17
v_mfma_f32_16x16x32_bf16 v[64:67], v[48:51], v[148:151], v[64:67]
s_waitcnt lgkmcnt(3)
v_max3_f32 v27, v18, v19, v20
v_cmp_lt_f32 vcc, s60, v27
v_mfma_f32_16x16x32_bf16 v[180:183], v[52:55], v[80:83], v[180:183]
ds_read_b128 v[48:51], v2 offset:4352
v_cvt_pk_bf16_f32 v103, v10, v11
v_mfma_f32_16x16x32_bf16 v[212:215], v[52:55], v[84:87], v[212:215]
v_exp_f32 v8, v56
v_mfma_f32_16x16x32_bf16 v[244:247], v[52:55], v[88:91], v[244:247]
s_waitcnt lgkmcnt(3)
ds_read_b64_tr_b16 v[52:53], v4 offset:57344
s_cbranch_vccnz TR_Y11
RET_Y11:
v_exp_f32 v9, v57
v_mfma_f32_16x16x32_bf16 v[68:71], v[40:43], v[104:107], v[28:31]
v_exp_f32 v10, v58
v_mfma_f32_16x16x32_bf16 v[72:75], v[40:43], v[120:123], v[32:35]
ds_read_b64_tr_b16 v[54:55], v4 offset:61440
v_add_f32 v21, v21, v18
v_add_f32 v22, v22, v19
v_mfma_f32_16x16x32_bf16 v[76:79], v[40:43], v[136:139], v[36:39]
s_waitcnt lgkmcnt(3)
v_exp_f32 v11, v59
v_mfma_f32_16x16x32_bf16 v[152:155], v[44:47], v[92:95], v[152:155]
ds_read_b128 v[40:43], v2 offset:4608
v_add_f32 v16, v8, v9
v_cvt_pk_bf16_f32 v80, v8, v9
v_mfma_f32_16x16x32_bf16 v[184:187], v[44:47], v[96:99], v[184:187]
v_exp_f32 v12, v60
v_mfma_f32_16x16x32_bf16 v[216:219], v[44:47], v[100:103], v[216:219]
s_waitcnt lgkmcnt(3)
ds_read_b64_tr_b16 v[44:45], v3 offset:57600
v_add_f32 v17, v10, v11
v_cvt_pk_bf16_f32 v81, v10, v11
v_mfma_f32_16x16x32_bf16 v[68:71], v[48:51], v[108:111], v[68:71]
v_exp_f32 v13, v61
v_mfma_f32_16x16x32_bf16 v[72:75], v[48:51], v[124:127], v[72:75]
ds_read_b64_tr_b16 v[46:47], v3 offset:61696
v_add_f32 v23, v23, v20
v_add_f32 v18, v16, v17
v_mfma_f32_16x16x32_bf16 v[76:79], v[48:51], v[140:143], v[76:79]
s_waitcnt lgkmcnt(3)
v_exp_f32 v14, v62
v_mfma_f32_16x16x32_bf16 v[156:159], v[52:55], v[92:95], v[156:159]
ds_read_b128 v[48:51], v2 offset:4864
v_add_f32 v16, v12, v13
v_mfma_f32_16x16x32_bf16 v[188:191], v[52:55], v[96:99], v[188:191]
v_exp_f32 v15, v63
v_mfma_f32_16x16x32_bf16 v[220:223], v[52:55], v[100:103], v[220:223]
s_waitcnt lgkmcnt(3)
ds_read_b64_tr_b16 v[52:53], v4 offset:57600
v_cvt_pk_bf16_f32 v84, v12, v13
v_mfma_f32_16x16x32_bf16 v[68:71], v[40:43], v[112:115], v[68:71]
v_exp_f32 v8, v64
v_mfma_f32_16x16x32_bf16 v[72:75], v[40:43], v[128:131], v[72:75]
ds_read_b64_tr_b16 v[54:55], v4 offset:61696
v_add_f32 v17, v14, v15
v_cvt_pk_bf16_f32 v85, v14, v15
v_mfma_f32_16x16x32_bf16 v[76:79], v[40:43], v[144:147], v[76:79]
s_waitcnt lgkmcnt(3)
v_exp_f32 v9, v65
v_mfma_f32_16x16x32_bf16 v[160:163], v[44:47], v[92:95], v[160:163]
ds_read_b128 v[40:43], v2 offset:8192
v_add_f32 v19, v16, v17
v_mfma_f32_16x16x32_bf16 v[192:195], v[44:47], v[96:99], v[192:195]
v_exp_f32 v10, v66
v_mfma_f32_16x16x32_bf16 v[224:227], v[44:47], v[100:103], v[224:227]
s_waitcnt lgkmcnt(3)
ds_read_b64_tr_b16 v[44:45], v3 offset:57856
v_add_f32 v16, v8, v9
v_cvt_pk_bf16_f32 v88, v8, v9
v_mfma_f32_16x16x32_bf16 v[68:71], v[48:51], v[116:119], v[68:71]
v_exp_f32 v11, v67
v_mfma_f32_16x16x32_bf16 v[72:75], v[48:51], v[132:135], v[72:75]
ds_read_b64_tr_b16 v[46:47], v3 offset:61952
v_add_f32 v17, v10, v11
v_add_f32 v20, v16, v17
v_mfma_f32_16x16x32_bf16 v[76:79], v[48:51], v[148:151], v[76:79]
s_waitcnt lgkmcnt(3)
v_max3_f32 v27, v18, v19, v20
v_cmp_lt_f32 vcc, s60, v27
v_mfma_f32_16x16x32_bf16 v[164:167], v[52:55], v[92:95], v[164:167]
ds_read_b128 v[48:51], v2 offset:8448
v_cvt_pk_bf16_f32 v89, v10, v11
v_mfma_f32_16x16x32_bf16 v[196:199], v[52:55], v[96:99], v[196:199]
v_exp_f32 v8, v68
v_mfma_f32_16x16x32_bf16 v[228:231], v[52:55], v[100:103], v[228:231]
ds_read_b64_tr_b16 v[52:53], v4 offset:57856
s_cbranch_vccnz TR_X11
RET_X11:
v_exp_f32 v9, v69
s_waitcnt lgkmcnt(4)
v_mfma_f32_16x16x32_bf16 v[56:59], v[40:43], v[104:107], v[28:31]
v_exp_f32 v10, v70
v_mfma_f32_16x16x32_bf16 v[60:63], v[40:43], v[120:123], v[32:35]
ds_read_b64_tr_b16 v[54:55], v4 offset:61952
v_add_f32 v21, v21, v18
v_add_f32 v22, v22, v19
v_mfma_f32_16x16x32_bf16 v[64:67], v[40:43], v[136:139], v[36:39]
s_waitcnt lgkmcnt(3)
v_exp_f32 v11, v71
v_mfma_f32_16x16x32_bf16 v[168:171], v[44:47], v[92:95], v[168:171]
ds_read_b128 v[40:43], v2 offset:8704
v_add_f32 v16, v8, v9
v_cvt_pk_bf16_f32 v82, v8, v9
v_mfma_f32_16x16x32_bf16 v[200:203], v[44:47], v[96:99], v[200:203]
v_exp_f32 v12, v72
v_mfma_f32_16x16x32_bf16 v[232:235], v[44:47], v[100:103], v[232:235]
s_waitcnt lgkmcnt(3)
ds_read_b64_tr_b16 v[44:45], v3 offset:58112
v_add_f32 v17, v10, v11
v_cvt_pk_bf16_f32 v83, v10, v11
v_mfma_f32_16x16x32_bf16 v[56:59], v[48:51], v[108:111], v[56:59]
s_barrier
v_exp_f32 v13, v73
v_mfma_f32_16x16x32_bf16 v[60:63], v[48:51], v[124:127], v[60:63]
ds_read_b64_tr_b16 v[46:47], v3 offset:62208
v_add_f32 v23, v23, v20
v_add_f32 v18, v16, v17
v_mfma_f32_16x16x32_bf16 v[64:67], v[48:51], v[140:143], v[64:67]
s_waitcnt lgkmcnt(3)
v_exp_f32 v14, v74
v_mfma_f32_16x16x32_bf16 v[172:175], v[52:55], v[92:95], v[172:175]
ds_read_b128 v[48:51], v2 offset:8960
v_add_f32 v16, v12, v13
v_mfma_f32_16x16x32_bf16 v[204:207], v[52:55], v[96:99], v[204:207]
v_exp_f32 v15, v75
v_mfma_f32_16x16x32_bf16 v[236:239], v[52:55], v[100:103], v[236:239]
s_waitcnt lgkmcnt(3)
ds_read_b64_tr_b16 v[52:53], v4 offset:58112
v_cvt_pk_bf16_f32 v86, v12, v13
v_mfma_f32_16x16x32_bf16 v[56:59], v[40:43], v[112:115], v[56:59]
v_exp_f32 v8, v76
v_mfma_f32_16x16x32_bf16 v[60:63], v[40:43], v[128:131], v[60:63]
ds_read_b64_tr_b16 v[54:55], v4 offset:62208
v_add_f32 v17, v14, v15
v_cvt_pk_bf16_f32 v87, v14, v15
v_mfma_f32_16x16x32_bf16 v[64:67], v[40:43], v[144:147], v[64:67]
s_waitcnt lgkmcnt(3)
v_exp_f32 v9, v77
v_mfma_f32_16x16x32_bf16 v[176:179], v[44:47], v[92:95], v[176:179]
ds_read_b128 v[40:43], v2 offset:12288
v_add_f32 v19, v16, v17
v_mfma_f32_16x16x32_bf16 v[208:211], v[44:47], v[96:99], v[208:211]
v_exp_f32 v10, v78
v_mfma_f32_16x16x32_bf16 v[240:243], v[44:47], v[100:103], v[240:243]
s_waitcnt lgkmcnt(3)
ds_read_b64_tr_b16 v[44:45], v3 offset:32768
v_add_f32 v16, v8, v9
v_cvt_pk_bf16_f32 v90, v8, v9
v_mfma_f32_16x16x32_bf16 v[56:59], v[48:51], v[116:119], v[56:59]
v_exp_f32 v11, v79
v_mfma_f32_16x16x32_bf16 v[60:63], v[48:51], v[132:135], v[60:63]
ds_read_b64_tr_b16 v[46:47], v3 offset:36864
v_add_f32 v17, v10, v11
v_add_f32 v20, v16, v17
v_mfma_f32_16x16x32_bf16 v[64:67], v[48:51], v[148:151], v[64:67]
s_waitcnt lgkmcnt(3)
v_max3_f32 v27, v18, v19, v20
v_cmp_lt_f32 vcc, s60, v27
v_mfma_f32_16x16x32_bf16 v[180:183], v[52:55], v[92:95], v[180:183]
ds_read_b128 v[48:51], v2 offset:12544
v_cvt_pk_bf16_f32 v91, v10, v11
v_mfma_f32_16x16x32_bf16 v[212:215], v[52:55], v[96:99], v[212:215]
v_exp_f32 v8, v56
v_mfma_f32_16x16x32_bf16 v[244:247], v[52:55], v[100:103], v[244:247]
s_waitcnt lgkmcnt(3)
ds_read_b64_tr_b16 v[52:53], v4 offset:32768
s_cbranch_vccnz TR_Y12
RET_Y12:
v_exp_f32 v9, v57
v_mfma_f32_16x16x32_bf16 v[68:71], v[40:43], v[104:107], v[28:31]
v_exp_f32 v10, v58
v_mfma_f32_16x16x32_bf16 v[72:75], v[40:43], v[120:123], v[32:35]
ds_read_b64_tr_b16 v[54:55], v4 offset:36864
v_add_f32 v21, v21, v18
v_add_f32 v22, v22, v19
v_mfma_f32_16x16x32_bf16 v[76:79], v[40:43], v[136:139], v[36:39]
s_waitcnt lgkmcnt(3)
v_exp_f32 v11, v59
v_mfma_f32_16x16x32_bf16 v[152:155], v[44:47], v[80:83], v[152:155]
ds_read_b128 v[40:43], v2 offset:12800
v_add_f32 v16, v8, v9
v_cvt_pk_bf16_f32 v92, v8, v9
v_mfma_f32_16x16x32_bf16 v[184:187], v[44:47], v[84:87], v[184:187]
v_exp_f32 v12, v60
v_mfma_f32_16x16x32_bf16 v[216:219], v[44:47], v[88:91], v[216:219]
s_waitcnt lgkmcnt(3)
ds_read_b64_tr_b16 v[44:45], v3 offset:33024
v_add_f32 v17, v10, v11
v_cvt_pk_bf16_f32 v93, v10, v11
v_mfma_f32_16x16x32_bf16 v[68:71], v[48:51], v[108:111], v[68:71]
v_exp_f32 v13, v61
v_mfma_f32_16x16x32_bf16 v[72:75], v[48:51], v[124:127], v[72:75]
ds_read_b64_tr_b16 v[46:47], v3 offset:37120
v_add_f32 v23, v23, v20
v_add_f32 v18, v16, v17
v_mfma_f32_16x16x32_bf16 v[76:79], v[48:51], v[140:143], v[76:79]
s_waitcnt lgkmcnt(3)
v_exp_f32 v14, v62
v_mfma_f32_16x16x32_bf16 v[156:159], v[52:55], v[80:83], v[156:159]
ds_read_b128 v[48:51], v2 offset:13056
v_add_f32 v16, v12, v13
v_mfma_f32_16x16x32_bf16 v[188:191], v[52:55], v[84:87], v[188:191]
v_exp_f32 v15, v63
v_mfma_f32_16x16x32_bf16 v[220:223], v[52:55], v[88:91], v[220:223]
s_waitcnt lgkmcnt(3)
ds_read_b64_tr_b16 v[52:53], v4 offset:33024
v_cvt_pk_bf16_f32 v96, v12, v13
v_mfma_f32_16x16x32_bf16 v[68:71], v[40:43], v[112:115], v[68:71]
v_exp_f32 v8, v64
v_mfma_f32_16x16x32_bf16 v[72:75], v[40:43], v[128:131], v[72:75]
ds_read_b64_tr_b16 v[54:55], v4 offset:37120
v_add_f32 v17, v14, v15
v_cvt_pk_bf16_f32 v97, v14, v15
v_mfma_f32_16x16x32_bf16 v[76:79], v[40:43], v[144:147], v[76:79]
s_waitcnt lgkmcnt(3)
v_exp_f32 v9, v65
v_mfma_f32_16x16x32_bf16 v[160:163], v[44:47], v[80:83], v[160:163]
ds_read_b128 v[40:43], v2 offset:16384
v_add_f32 v19, v16, v17
v_mfma_f32_16x16x32_bf16 v[192:195], v[44:47], v[84:87], v[192:195]
v_exp_f32 v10, v66
v_mfma_f32_16x16x32_bf16 v[224:227], v[44:47], v[88:91], v[224:227]
s_waitcnt lgkmcnt(3)
ds_read_b64_tr_b16 v[44:45], v3 offset:33280
v_add_f32 v16, v8, v9
v_cvt_pk_bf16_f32 v100, v8, v9
v_mfma_f32_16x16x32_bf16 v[68:71], v[48:51], v[116:119], v[68:71]
v_exp_f32 v11, v67
v_mfma_f32_16x16x32_bf16 v[72:75], v[48:51], v[132:135], v[72:75]
ds_read_b64_tr_b16 v[46:47], v3 offset:37376
v_add_f32 v17, v10, v11
v_add_f32 v20, v16, v17
v_mfma_f32_16x16x32_bf16 v[76:79], v[48:51], v[148:151], v[76:79]
s_waitcnt lgkmcnt(3)
v_max3_f32 v27, v18, v19, v20
v_cmp_lt_f32 vcc, s60, v27
v_mfma_f32_16x16x32_bf16 v[164:167], v[52:55], v[80:83], v[164:167]
ds_read_b128 v[48:51], v2 offset:16640
v_cvt_pk_bf16_f32 v101, v10, v11
v_mfma_f32_16x16x32_bf16 v[196:199], v[52:55], v[84:87], v[196:199]
v_exp_f32 v8, v68
v_mfma_f32_16x16x32_bf16 v[228:231], v[52:55], v[88:91], v[228:231]
ds_read_b64_tr_b16 v[52:53], v4 offset:33280
s_cbranch_vccnz TR_X12
RET_X12:
v_exp_f32 v9, v69
s_waitcnt lgkmcnt(4)
v_mfma_f32_16x16x32_bf16 v[56:59], v[40:43], v[104:107], v[28:31]
v_exp_f32 v10, v70
v_mfma_f32_16x16x32_bf16 v[60:63], v[40:43], v[120:123], v[32:35]
ds_read_b64_tr_b16 v[54:55], v4 offset:37376
v_add_f32 v21, v21, v18
v_add_f32 v22, v22, v19
v_mfma_f32_16x16x32_bf16 v[64:67], v[40:43], v[136:139], v[36:39]
s_waitcnt lgkmcnt(3)
v_exp_f32 v11, v71
v_mfma_f32_16x16x32_bf16 v[168:171], v[44:47], v[80:83], v[168:171]
ds_read_b128 v[40:43], v2 offset:16896
v_add_f32 v16, v8, v9
v_cvt_pk_bf16_f32 v94, v8, v9
v_mfma_f32_16x16x32_bf16 v[200:203], v[44:47], v[84:87], v[200:203]
v_exp_f32 v12, v72
v_mfma_f32_16x16x32_bf16 v[232:235], v[44:47], v[88:91], v[232:235]
s_waitcnt lgkmcnt(3)
ds_read_b64_tr_b16 v[44:45], v3 offset:33536
v_add_f32 v17, v10, v11
v_cvt_pk_bf16_f32 v95, v10, v11
v_mfma_f32_16x16x32_bf16 v[56:59], v[48:51], v[108:111], v[56:59]
s_barrier
v_exp_f32 v13, v73
v_mfma_f32_16x16x32_bf16 v[60:63], v[48:51], v[124:127], v[60:63]
ds_read_b64_tr_b16 v[46:47], v3 offset:37632
v_add_f32 v23, v23, v20
v_add_f32 v18, v16, v17
v_mfma_f32_16x16x32_bf16 v[64:67], v[48:51], v[140:143], v[64:67]
s_waitcnt lgkmcnt(3)
v_exp_f32 v14, v74
v_mfma_f32_16x16x32_bf16 v[172:175], v[52:55], v[80:83], v[172:175]
ds_read_b128 v[48:51], v2 offset:17152
v_add_f32 v16, v12, v13
v_mfma_f32_16x16x32_bf16 v[204:207], v[52:55], v[84:87], v[204:207]
v_exp_f32 v15, v75
v_mfma_f32_16x16x32_bf16 v[236:239], v[52:55], v[88:91], v[236:239]
s_waitcnt lgkmcnt(3)
ds_read_b64_tr_b16 v[52:53], v4 offset:33536
v_cvt_pk_bf16_f32 v98, v12, v13
v_mfma_f32_16x16x32_bf16 v[56:59], v[40:43], v[112:115], v[56:59]
v_exp_f32 v8, v76
v_mfma_f32_16x16x32_bf16 v[60:63], v[40:43], v[128:131], v[60:63]
ds_read_b64_tr_b16 v[54:55], v4 offset:37632
v_add_f32 v17, v14, v15
v_cvt_pk_bf16_f32 v99, v14, v15
v_mfma_f32_16x16x32_bf16 v[64:67], v[40:43], v[144:147], v[64:67]
s_waitcnt lgkmcnt(3)
v_exp_f32 v9, v77
v_mfma_f32_16x16x32_bf16 v[176:179], v[44:47], v[80:83], v[176:179]
ds_read_b128 v[40:43], v2 offset:20480
v_add_f32 v19, v16, v17
v_mfma_f32_16x16x32_bf16 v[208:211], v[44:47], v[84:87], v[208:211]
v_exp_f32 v10, v78
v_mfma_f32_16x16x32_bf16 v[240:243], v[44:47], v[88:91], v[240:243]
s_waitcnt lgkmcnt(3)
ds_read_b64_tr_b16 v[44:45], v3 offset:40960
v_add_f32 v16, v8, v9
v_cvt_pk_bf16_f32 v102, v8, v9
v_mfma_f32_16x16x32_bf16 v[56:59], v[48:51], v[116:119], v[56:59]
v_exp_f32 v11, v79
v_mfma_f32_16x16x32_bf16 v[60:63], v[48:51], v[132:135], v[60:63]
ds_read_b64_tr_b16 v[46:47], v3 offset:45056
v_add_f32 v17, v10, v11
v_add_f32 v20, v16, v17
v_mfma_f32_16x16x32_bf16 v[64:67], v[48:51], v[148:151], v[64:67]
s_waitcnt lgkmcnt(3)
v_max3_f32 v27, v18, v19, v20
v_cmp_lt_f32 vcc, s60, v27
v_mfma_f32_16x16x32_bf16 v[180:183], v[52:55], v[80:83], v[180:183]
ds_read_b128 v[48:51], v2 offset:20736
v_cvt_pk_bf16_f32 v103, v10, v11
v_mfma_f32_16x16x32_bf16 v[212:215], v[52:55], v[84:87], v[212:215]
v_exp_f32 v8, v56
v_mfma_f32_16x16x32_bf16 v[244:247], v[52:55], v[88:91], v[244:247]
s_waitcnt lgkmcnt(3)
ds_read_b64_tr_b16 v[52:53], v4 offset:40960
s_cbranch_vccnz TR_Y13
RET_Y13:
v_exp_f32 v9, v57
v_mfma_f32_16x16x32_bf16 v[68:71], v[40:43], v[104:107], v[28:31]
v_exp_f32 v10, v58
v_mfma_f32_16x16x32_bf16 v[72:75], v[40:43], v[120:123], v[32:35]
ds_read_b64_tr_b16 v[54:55], v4 offset:45056
v_add_f32 v21, v21, v18
v_add_f32 v22, v22, v19
v_mfma_f32_16x16x32_bf16 v[76:79], v[40:43], v[136:139], v[36:39]
s_waitcnt lgkmcnt(3)
v_exp_f32 v11, v59
v_mfma_f32_16x16x32_bf16 v[152:155], v[44:47], v[92:95], v[152:155]
ds_read_b128 v[40:43], v2 offset:20992
v_add_f32 v16, v8, v9
v_cvt_pk_bf16_f32 v80, v8, v9
v_mfma_f32_16x16x32_bf16 v[184:187], v[44:47], v[96:99], v[184:187]
v_exp_f32 v12, v60
v_mfma_f32_16x16x32_bf16 v[216:219], v[44:47], v[100:103], v[216:219]
s_waitcnt lgkmcnt(3)
ds_read_b64_tr_b16 v[44:45], v3 offset:41216
v_add_f32 v17, v10, v11
v_cvt_pk_bf16_f32 v81, v10, v11
v_mfma_f32_16x16x32_bf16 v[68:71], v[48:51], v[108:111], v[68:71]
v_exp_f32 v13, v61
v_mfma_f32_16x16x32_bf16 v[72:75], v[48:51], v[124:127], v[72:75]
ds_read_b64_tr_b16 v[46:47], v3 offset:45312
v_add_f32 v23, v23, v20
v_add_f32 v18, v16, v17
v_mfma_f32_16x16x32_bf16 v[76:79], v[48:51], v[140:143], v[76:79]
s_waitcnt lgkmcnt(3)
v_exp_f32 v14, v62
v_mfma_f32_16x16x32_bf16 v[156:159], v[52:55], v[92:95], v[156:159]
ds_read_b128 v[48:51], v2 offset:21248
v_add_f32 v16, v12, v13
v_mfma_f32_16x16x32_bf16 v[188:191], v[52:55], v[96:99], v[188:191]
v_exp_f32 v15, v63
v_mfma_f32_16x16x32_bf16 v[220:223], v[52:55], v[100:103], v[220:223]
s_waitcnt lgkmcnt(3)
ds_read_b64_tr_b16 v[52:53], v4 offset:41216
v_cvt_pk_bf16_f32 v84, v12, v13
v_mfma_f32_16x16x32_bf16 v[68:71], v[40:43], v[112:115], v[68:71]
v_exp_f32 v8, v64
v_mfma_f32_16x16x32_bf16 v[72:75], v[40:43], v[128:131], v[72:75]
ds_read_b64_tr_b16 v[54:55], v4 offset:45312
v_add_f32 v17, v14, v15
v_cvt_pk_bf16_f32 v85, v14, v15
v_mfma_f32_16x16x32_bf16 v[76:79], v[40:43], v[144:147], v[76:79]
s_waitcnt lgkmcnt(3)
v_exp_f32 v9, v65
v_mfma_f32_16x16x32_bf16 v[160:163], v[44:47], v[92:95], v[160:163]
ds_read_b128 v[40:43], v2 offset:24576
v_add_f32 v19, v16, v17
v_mfma_f32_16x16x32_bf16 v[192:195], v[44:47], v[96:99], v[192:195]
v_exp_f32 v10, v66
v_mfma_f32_16x16x32_bf16 v[224:227], v[44:47], v[100:103], v[224:227]
s_waitcnt lgkmcnt(3)
ds_read_b64_tr_b16 v[44:45], v3 offset:41472
v_add_f32 v16, v8, v9
v_cvt_pk_bf16_f32 v88, v8, v9
v_mfma_f32_16x16x32_bf16 v[68:71], v[48:51], v[116:119], v[68:71]
v_exp_f32 v11, v67
v_mfma_f32_16x16x32_bf16 v[72:75], v[48:51], v[132:135], v[72:75]
ds_read_b64_tr_b16 v[46:47], v3 offset:45568
v_add_f32 v17, v10, v11
v_add_f32 v20, v16, v17
v_mfma_f32_16x16x32_bf16 v[76:79], v[48:51], v[148:151], v[76:79]
s_waitcnt lgkmcnt(3)
v_max3_f32 v27, v18, v19, v20
v_cmp_lt_f32 vcc, s60, v27
v_mfma_f32_16x16x32_bf16 v[164:167], v[52:55], v[92:95], v[164:167]
ds_read_b128 v[48:51], v2 offset:24832
v_cvt_pk_bf16_f32 v89, v10, v11
v_mfma_f32_16x16x32_bf16 v[196:199], v[52:55], v[96:99], v[196:199]
v_exp_f32 v8, v68
v_mfma_f32_16x16x32_bf16 v[228:231], v[52:55], v[100:103], v[228:231]
ds_read_b64_tr_b16 v[52:53], v4 offset:41472
s_cbranch_vccnz TR_X13
RET_X13:
v_exp_f32 v9, v69
s_cmp_eq_u32 s71, 3
s_cbranch_scc1 L_A_tail
s_waitcnt lgkmcnt(4)
v_mfma_f32_16x16x32_bf16 v[56:59], v[40:43], v[104:107], v[28:31]
v_exp_f32 v10, v70
v_mfma_f32_16x16x32_bf16 v[60:63], v[40:43], v[120:123], v[32:35]
ds_read_b64_tr_b16 v[54:55], v4 offset:45568
v_add_f32 v21, v21, v18
v_add_f32 v22, v22, v19
v_mfma_f32_16x16x32_bf16 v[64:67], v[40:43], v[136:139], v[36:39]
s_waitcnt lgkmcnt(3)
v_exp_f32 v11, v71
v_mfma_f32_16x16x32_bf16 v[168:171], v[44:47], v[92:95], v[168:171]
ds_read_b128 v[40:43], v2 offset:25088
v_add_f32 v16, v8, v9
v_cvt_pk_bf16_f32 v82, v8, v9
v_mfma_f32_16x16x32_bf16 v[200:203], v[44:47], v[96:99], v[200:203]
v_exp_f32 v12, v72
v_mfma_f32_16x16x32_bf16 v[232:235], v[44:47], v[100:103], v[232:235]
s_waitcnt lgkmcnt(3)
ds_read_b64_tr_b16 v[44:45], v3 offset:41728
v_add_f32 v17, v10, v11
v_cvt_pk_bf16_f32 v83, v10, v11
v_mfma_f32_16x16x32_bf16 v[56:59], v[48:51], v[108:111], v[56:59]
s_barrier
v_exp_f32 v13, v73
v_mfma_f32_16x16x32_bf16 v[60:63], v[48:51], v[124:127], v[60:63]
ds_read_b64_tr_b16 v[46:47], v3 offset:45824
v_add_f32 v23, v23, v20
v_add_f32 v18, v16, v17
v_mfma_f32_16x16x32_bf16 v[64:67], v[48:51], v[140:143], v[64:67]
s_waitcnt lgkmcnt(3)
v_exp_f32 v14, v74
v_mfma_f32_16x16x32_bf16 v[172:175], v[52:55], v[92:95], v[172:175]
ds_read_b128 v[48:51], v2 offset:25344
v_add_f32 v16, v12, v13
v_mfma_f32_16x16x32_bf16 v[204:207], v[52:55], v[96:99], v[204:207]
v_exp_f32 v15, v75
v_mfma_f32_16x16x32_bf16 v[236:239], v[52:55], v[100:103], v[236:239]
s_waitcnt lgkmcnt(3)
ds_read_b64_tr_b16 v[52:53], v4 offset:41728
v_cvt_pk_bf16_f32 v86, v12, v13
v_mfma_f32_16x16x32_bf16 v[56:59], v[40:43], v[112:115], v[56:59]
v_exp_f32 v8, v76
v_mfma_f32_16x16x32_bf16 v[60:63], v[40:43], v[128:131], v[60:63]
ds_read_b64_tr_b16 v[54:55], v4 offset:45824
v_add_f32 v17, v14, v15
v_cvt_pk_bf16_f32 v87, v14, v15
v_mfma_f32_16x16x32_bf16 v[64:67], v[40:43], v[144:147], v[64:67]
s_waitcnt lgkmcnt(3)
v_exp_f32 v9, v77
v_mfma_f32_16x16x32_bf16 v[176:179], v[44:47], v[92:95], v[176:179]
ds_read_b128 v[40:43], v2 offset:28672
v_add_f32 v19, v16, v17
v_mfma_f32_16x16x32_bf16 v[208:211], v[44:47], v[96:99], v[208:211]
v_exp_f32 v10, v78
v_mfma_f32_16x16x32_bf16 v[240:243], v[44:47], v[100:103], v[240:243]
s_waitcnt lgkmcnt(3)
ds_read_b64_tr_b16 v[44:45], v3 offset:49152
v_add_f32 v16, v8, v9
v_cvt_pk_bf16_f32 v90, v8, v9
v_mfma_f32_16x16x32_bf16 v[56:59], v[48:51], v[116:119], v[56:59]
v_exp_f32 v11, v79
v_mfma_f32_16x16x32_bf16 v[60:63], v[48:51], v[132:135], v[60:63]
ds_read_b64_tr_b16 v[46:47], v3 offset:53248
v_add_f32 v17, v10, v11
v_add_f32 v20, v16, v17
v_mfma_f32_16x16x32_bf16 v[64:67], v[48:51], v[148:151], v[64:67]
s_waitcnt lgkmcnt(3)
v_max3_f32 v27, v18, v19, v20
v_cmp_lt_f32 vcc, s60, v27
v_mfma_f32_16x16x32_bf16 v[180:183], v[52:55], v[92:95], v[180:183]
ds_read_b128 v[48:51], v2 offset:28928
v_cvt_pk_bf16_f32 v91, v10, v11
v_mfma_f32_16x16x32_bf16 v[212:215], v[52:55], v[96:99], v[212:215]
v_exp_f32 v8, v56
v_mfma_f32_16x16x32_bf16 v[244:247], v[52:55], v[100:103], v[244:247]
s_waitcnt lgkmcnt(3)
ds_read_b64_tr_b16 v[52:53], v4 offset:49152
s_cbranch_vccnz TR_Y14
RET_Y14:
v_exp_f32 v9, v57
v_mfma_f32_16x16x32_bf16 v[68:71], v[40:43], v[104:107], v[28:31]
v_exp_f32 v10, v58
v_mfma_f32_16x16x32_bf16 v[72:75], v[40:43], v[120:123], v[32:35]
ds_read_b64_tr_b16 v[54:55], v4 offset:53248
v_add_f32 v21, v21, v18
v_add_f32 v22, v22, v19
v_mfma_f32_16x16x32_bf16 v[76:79], v[40:43], v[136:139], v[36:39]
s_waitcnt lgkmcnt(3)
v_exp_f32 v11, v59
v_mfma_f32_16x16x32_bf16 v[152:155], v[44:47], v[80:83], v[152:155]
ds_read_b128 v[40:43], v2 offset:29184
ds_read_b128 v[104:107], v5
v_add_f32 v16, v8, v9
v_cvt_pk_bf16_f32 v92, v8, v9
v_mfma_f32_16x16x32_bf16 v[184:187], v[44:47], v[84:87], v[184:187]
ds_read_b128 v[120:123], v5 offset:4096
v_exp_f32 v12, v60
v_mfma_f32_16x16x32_bf16 v[216:219], v[44:47], v[88:91], v[216:219]
s_waitcnt lgkmcnt(5)
ds_read_b64_tr_b16 v[44:45], v3 offset:49408
ds_read_b128 v[136:139], v5 offset:8192
v_add_f32 v17, v10, v11
v_cvt_pk_bf16_f32 v93, v10, v11
v_mfma_f32_16x16x32_bf16 v[68:71], v[48:51], v[108:111], v[68:71]
v_exp_f32 v13, v61
v_mfma_f32_16x16x32_bf16 v[72:75], v[48:51], v[124:127], v[72:75]
ds_read_b64_tr_b16 v[46:47], v3 offset:53504
v_add_f32 v23, v23, v20
v_add_f32 v18, v16, v17
v_mfma_f32_16x16x32_bf16 v[76:79], v[48:51], v[140:143], v[76:79]
s_waitcnt lgkmcnt(6)
v_exp_f32 v14, v62
v_mfma_f32_16x16x32_bf16 v[156:159], v[52:55], v[80:83], v[156:159]
ds_read_b128 v[48:51], v2 offset:29440
ds_read_b128 v[108:111], v5 offset:1024
v_add_f32 v16, v12, v13
v_mfma_f32_16x16x32_bf16 v[188:191], v[52:55], v[84:87], v[188:191]
ds_read_b128 v[124:127], v5 offset:5120
v_exp_f32 v15, v63
v_mfma_f32_16x16x32_bf16 v[220:223], v[52:55], v[88:91], v[220:223]
s_waitcnt lgkmcnt(8)
ds_read_b64_tr_b16 v[52:53], v4 offset:49408
ds_read_b128 v[140:143], v5 offset:9216
v_cvt_pk_bf16_f32 v96, v12, v13
v_mfma_f32_16x16x32_bf16 v[68:71], v[40:43], v[112:115], v[68:71]
v_exp_f32 v8, v64
v_mfma_f32_16x16x32_bf16 v[72:75], v[40:43], v[128:131], v[72:75]
ds_read_b64_tr_b16 v[54:55], v4 offset:53504
v_add_f32 v17, v14, v15
v_cvt_pk_bf16_f32 v97, v14, v15
v_mfma_f32_16x16x32_bf16 v[76:79], v[40:43], v[144:147], v[76:79]
s_waitcnt lgkmcnt(6)
v_exp_f32 v9, v65
v_mfma_f32_16x16x32_bf16 v[160:163], v[44:47], v[80:83], v[160:163]
ds_read_b128 v[40:43], v2
ds_read_b128 v[112:115], v5 offset:2048
v_add_f32 v19, v16, v17
v_mfma_f32_16x16x32_bf16 v[192:195], v[44:47], v[84:87], v[192:195]
ds_read_b128 v[128:131], v5 offset:6144
v_exp_f32 v10, v66
v_mfma_f32_16x16x32_bf16 v[224:227], v[44:47], v[88:91], v[224:227]
s_waitcnt lgkmcnt(8)
ds_read_b64_tr_b16 v[44:45], v3 offset:49664
ds_read_b128 v[144:147], v5 offset:10240
v_add_f32 v16, v8, v9
v_cvt_pk_bf16_f32 v100, v8, v9
v_mfma_f32_16x16x32_bf16 v[68:71], v[48:51], v[116:119], v[68:71]
v_exp_f32 v11, v67
v_mfma_f32_16x16x32_bf16 v[72:75], v[48:51], v[132:135], v[72:75]
ds_read_b64_tr_b16 v[46:47], v3 offset:53760
v_add_f32 v17, v10, v11
v_add_f32 v20, v16, v17
v_mfma_f32_16x16x32_bf16 v[76:79], v[48:51], v[148:151], v[76:79]
s_waitcnt lgkmcnt(6)
v_max3_f32 v27, v18, v19, v20
v_cmp_lt_f32 vcc, s60, v27
v_mfma_f32_16x16x32_bf16 v[164:167], v[52:55], v[80:83], v[164:167]
ds_read_b128 v[48:51], v2 offset:256
ds_read_b128 v[116:119], v5 offset:3072
v_cvt_pk_bf16_f32 v101, v10, v11
v_mfma_f32_16x16x32_bf16 v[196:199], v[52:55], v[84:87], v[196:199]
ds_read_b128 v[132:135], v5 offset:7168
v_exp_f32 v8, v68
v_mfma_f32_16x16x32_bf16 v[228:231], v[52:55], v[88:91], v[228:231]
ds_read_b64_tr_b16 v[52:53], v4 offset:49664
ds_read_b128 v[148:151], v5 offset:11264
s_cbranch_vccnz TR_X14
RET_X14:
v_exp_f32 v9, v69
s_waitcnt lgkmcnt(10)
v_mfma_f32_16x16x32_bf16 v[56:59], v[40:43], v[104:107], 0
v_exp_f32 v10, v70
v_mfma_f32_16x16x32_bf16 v[60:63], v[40:43], v[120:123], 0
ds_read_b64_tr_b16 v[54:55], v4 offset:53760
v_add_f32 v21, v21, v18
v_add_f32 v22, v22, v19
v_mfma_f32_16x16x32_bf16 v[64:67], v[40:43], v[136:139], 0
s_waitcnt lgkmcnt(6)
v_exp_f32 v11, v71
v_mfma_f32_16x16x32_bf16 v[168:171], v[44:47], v[80:83], v[168:171]
ds_read_b128 v[40:43], v2 offset:512
v_add_f32 v16, v8, v9
v_cvt_pk_bf16_f32 v94, v8, v9
v_mfma_f32_16x16x32_bf16 v[200:203], v[44:47], v[84:87], v[200:203]
v_exp_f32 v12, v72
v_mfma_f32_16x16x32_bf16 v[232:235], v[44:47], v[88:91], v[232:235]
s_waitcnt lgkmcnt(6)
ds_read_b64_tr_b16 v[44:45], v3 offset:49920
v_add_f32 v17, v10, v11
v_cvt_pk_bf16_f32 v95, v10, v11
v_mfma_f32_16x16x32_bf16 v[56:59], v[48:51], v[108:111], v[56:59]
s_barrier
v_exp_f32 v13, v73
v_mfma_f32_16x16x32_bf16 v[60:63], v[48:51], v[124:127], v[60:63]
ds_read_b64_tr_b16 v[46:47], v3 offset:54016
v_add_f32 v23, v23, v20
v_add_f32 v18, v16, v17
v_mfma_f32_16x16x32_bf16 v[64:67], v[48:51], v[140:143], v[64:67]
s_waitcnt lgkmcnt(3)
v_exp_f32 v14, v74
v_mfma_f32_16x16x32_bf16 v[172:175], v[52:55], v[80:83], v[172:175]
ds_read_b128 v[48:51], v2 offset:768
v_add_f32 v16, v12, v13
v_mfma_f32_16x16x32_bf16 v[204:207], v[52:55], v[84:87], v[204:207]
v_exp_f32 v15, v75
v_mfma_f32_16x16x32_bf16 v[236:239], v[52:55], v[88:91], v[236:239]
s_waitcnt lgkmcnt(3)
ds_read_b64_tr_b16 v[52:53], v4 offset:49920
v_cvt_pk_bf16_f32 v98, v12, v13
v_mfma_f32_16x16x32_bf16 v[56:59], v[40:43], v[112:115], v[56:59]
v_exp_f32 v8, v76
v_mfma_f32_16x16x32_bf16 v[60:63], v[40:43], v[128:131], v[60:63]
ds_read_b64_tr_b16 v[54:55], v4 offset:54016
v_add_f32 v17, v14, v15
v_cvt_pk_bf16_f32 v99, v14, v15
v_mfma_f32_16x16x32_bf16 v[64:67], v[40:43], v[144:147], v[64:67]
s_waitcnt lgkmcnt(3)
v_exp_f32 v9, v77
v_mfma_f32_16x16x32_bf16 v[176:179], v[44:47], v[80:83], v[176:179]
ds_read_b128 v[40:43], v2 offset:4096
v_add_f32 v19, v16, v17
v_mfma_f32_16x16x32_bf16 v[208:211], v[44:47], v[84:87], v[208:211]
v_exp_f32 v10, v78
v_mfma_f32_16x16x32_bf16 v[240:243], v[44:47], v[88:91], v[240:243]
s_waitcnt lgkmcnt(3)
ds_read_b64_tr_b16 v[44:45], v3 offset:57344
v_add_f32 v16, v8, v9
v_cvt_pk_bf16_f32 v102, v8, v9
v_mfma_f32_16x16x32_bf16 v[56:59], v[48:51], v[116:119], v[56:59]
v_exp_f32 v11, v79
v_mfma_f32_16x16x32_bf16 v[60:63], v[48:51], v[132:135], v[60:63]
ds_read_b64_tr_b16 v[46:47], v3 offset:61440
v_add_f32 v17, v10, v11
v_add_f32 v20, v16, v17
v_mfma_f32_16x16x32_bf16 v[64:67], v[48:51], v[148:151], v[64:67]
s_waitcnt lgkmcnt(3)
v_max3_f32 v27, v18, v19, v20
v_cmp_lt_f32 vcc, s60, v27
v_mfma_f32_16x16x32_bf16 v[180:183], v[52:55], v[80:83], v[180:183]
ds_read_b128 v[48:51], v2 offset:4352
v_cvt_pk_bf16_f32 v103, v10, v11
v_mfma_f32_16x16x32_bf16 v[212:215], v[52:55], v[84:87], v[212:215]
v_mfma_f32_16x16x32_bf16 v[244:247], v[52:55], v[88:91], v[244:247]
s_waitcnt lgkmcnt(3)
ds_read_b64_tr_b16 v[52:53], v4 offset:57344
s_cbranch_vccnz TR_Y15
RET_Y15:
v_mfma_f32_16x16x32_bf16 v[68:71], v[40:43], v[104:107], 0
v_add_f32 v21, v21, v18
v_add_f32 v22, v22, v19
v_add_f32 v23, v23, v20
v_mov_b32 v24, v21
v_mov_b32 v25, v22
v_mov_b32 v26, v23
v_mov_b32 v248, v24
v_mfma_f32_16x16x32_bf16 v[72:75], v[40:43], v[120:123], 0
ds_read_b64_tr_b16 v[54:55], v4 offset:61440
v_mov_b32 v249, v25
v_mov_b32 v250, v26
v_permlane32_swap_b32 v24, v248
v_permlane32_swap_b32 v25, v249
v_permlane32_swap_b32 v26, v250
v_add_f32 v24, v24, v248
v_mfma_f32_16x16x32_bf16 v[76:79], v[40:43], v[136:139], 0
s_waitcnt lgkmcnt(3)
v_add_f32 v25, v25, v249
v_add_f32 v26, v26, v250
v_mov_b32 v248, v24
v_mov_b32 v249, v25
v_mov_b32 v250, v26
v_permlane16_swap_b32 v24, v248
v_permlane16_swap_b32 v25, v249
v_mfma_f32_16x16x32_bf16 v[152:155], v[44:47], v[92:95], v[152:155]
ds_read_b128 v[40:43], v2 offset:4608
v_permlane16_swap_b32 v26, v250
v_add_f32 v24, v24, v248
v_add_f32 v25, v25, v249
v_add_f32 v26, v26, v250
v_rcp_f32 v24, v24
v_rcp_f32 v25, v25
v_mfma_f32_16x16x32_bf16 v[184:187], v[44:47], v[96:99], v[184:187]
v_rcp_f32 v26, v26
v_max3_f32 v28, v56, v57, v58
v_max_f32 v28, v28, v59
v_max3_f32 v32, v60, v61, v62
v_max_f32 v32, v32, v63
v_max3_f32 v36, v64, v65, v66
v_max_f32 v36, v36, v67
v_mfma_f32_16x16x32_bf16 v[216:219], v[44:47], v[100:103], v[216:219]
s_waitcnt lgkmcnt(3)
ds_read_b64_tr_b16 v[44:45], v3 offset:57600
v_mov_b32 v29, v28
v_mov_b32 v33, v32
v_mov_b32 v37, v36
v_permlane32_swap_b32 v28, v29
v_permlane32_swap_b32 v32, v33
v_permlane32_swap_b32 v36, v37
v_mfma_f32_16x16x32_bf16 v[68:71], v[48:51], v[108:111], v[68:71]
v_max_f32 v28, v28, v29
v_max_f32 v32, v32, v33
v_max_f32 v36, v36, v37
v_mov_b32 v29, v28
v_mov_b32 v33, v32
v_mov_b32 v37, v36
v_permlane16_swap_b32 v28, v29
v_mfma_f32_16x16x32_bf16 v[72:75], v[48:51], v[124:127], v[72:75]
ds_read_b64_tr_b16 v[46:47], v3 offset:61696
v_permlane16_swap_b32 v32, v33
v_permlane16_swap_b32 v36, v37
v_max_f32 v28, v28, v29
v_max_f32 v32, v32, v33
v_max_f32 v36, v36, v37
v_ceil_f32 v28, v28
v_mfma_f32_16x16x32_bf16 v[76:79], v[48:51], v[140:143], v[76:79]
s_waitcnt lgkmcnt(3)
v_ceil_f32 v32, v32
v_ceil_f32 v36, v36
v_sub_f32 v28, 0, v28
v_sub_f32 v32, 0, v32
v_sub_f32 v36, 0, v36
v_add_f32 v56, v28, v56
v_add_f32 v57, v28, v57
v_mfma_f32_16x16x32_bf16 v[156:159], v[52:55], v[92:95], v[156:159]
ds_read_b128 v[48:51], v2 offset:4864
v_add_f32 v58, v28, v58
v_add_f32 v59, v28, v59
v_add_f32 v60, v32, v60
v_add_f32 v61, v32, v61
v_add_f32 v62, v32, v62
v_add_f32 v63, v32, v63
v_mfma_f32_16x16x32_bf16 v[188:191], v[52:55], v[96:99], v[188:191]
v_add_f32 v64, v36, v64
v_add_f32 v65, v36, v65
v_add_f32 v66, v36, v66
v_add_f32 v67, v36, v67
v_mov_b32 v29, v28
v_mov_b32 v30, v28
v_mov_b32 v31, v28
v_mfma_f32_16x16x32_bf16 v[220:223], v[52:55], v[100:103], v[220:223]
s_waitcnt lgkmcnt(3)
ds_read_b64_tr_b16 v[52:53], v4 offset:57600
v_mov_b32 v33, v32
v_mov_b32 v34, v32
v_mov_b32 v35, v32
v_mov_b32 v37, v36
v_mov_b32 v38, v36
v_mov_b32 v39, v36
v_mfma_f32_16x16x32_bf16 v[68:71], v[40:43], v[112:115], v[68:71]
v_exp_f32 v8, v56
v_exp_f32 v9, v57
v_mfma_f32_16x16x32_bf16 v[72:75], v[40:43], v[128:131], v[72:75]
ds_read_b64_tr_b16 v[54:55], v4 offset:61696
v_exp_f32 v10, v58
v_mfma_f32_16x16x32_bf16 v[76:79], v[40:43], v[144:147], v[76:79]
s_waitcnt lgkmcnt(3)
v_exp_f32 v11, v59
v_add_f32 v16, v8, v9
v_cvt_pk_bf16_f32 v80, v8, v9
v_mfma_f32_16x16x32_bf16 v[160:163], v[44:47], v[92:95], v[160:163]
ds_read_b128 v[40:43], v2 offset:8192
v_exp_f32 v12, v60
v_add_f32 v17, v10, v11
v_cvt_pk_bf16_f32 v81, v10, v11
v_mfma_f32_16x16x32_bf16 v[192:195], v[44:47], v[96:99], v[192:195]
v_exp_f32 v13, v61
v_add_f32 v18, v16, v17
v_mfma_f32_16x16x32_bf16 v[224:227], v[44:47], v[100:103], v[224:227]
s_waitcnt lgkmcnt(3)
ds_read_b64_tr_b16 v[44:45], v3 offset:57856
v_exp_f32 v14, v62
v_add_f32 v16, v12, v13
v_mfma_f32_16x16x32_bf16 v[68:71], v[48:51], v[116:119], v[68:71]
v_exp_f32 v15, v63
v_cvt_pk_bf16_f32 v84, v12, v13
v_mfma_f32_16x16x32_bf16 v[72:75], v[48:51], v[132:135], v[72:75]
ds_read_b64_tr_b16 v[46:47], v3 offset:61952
v_exp_f32 v8, v64
v_add_f32 v17, v14, v15
v_cvt_pk_bf16_f32 v85, v14, v15
v_mfma_f32_16x16x32_bf16 v[76:79], v[48:51], v[148:151], v[76:79]
s_waitcnt lgkmcnt(3)
v_exp_f32 v9, v65
v_add_f32 v19, v16, v17
v_mfma_f32_16x16x32_bf16 v[164:167], v[52:55], v[92:95], v[164:167]
ds_read_b128 v[48:51], v2 offset:8448
v_exp_f32 v10, v66
v_add_f32 v16, v8, v9
v_cvt_pk_bf16_f32 v88, v8, v9
v_mfma_f32_16x16x32_bf16 v[196:199], v[52:55], v[96:99], v[196:199]
v_exp_f32 v11, v67
s_nop 0
v_add_f32 v17, v10, v11
v_add_f32 v20, v16, v17
v_mfma_f32_16x16x32_bf16 v[228:231], v[52:55], v[100:103], v[228:231]
ds_read_b64_tr_b16 v[52:53], v4 offset:57856
v_cvt_pk_bf16_f32 v89, v10, v11
v_add_f32 v68, v28, v68
v_add_f32 v69, v28, v69
v_add_f32 v70, v28, v70
v_add_f32 v71, v28, v71
v_add_f32 v72, v32, v72
v_add_f32 v73, v32, v73
v_add_f32 v74, v32, v74
v_add_f32 v75, v32, v75
v_add_f32 v76, v36, v76
v_add_f32 v77, v36, v77
v_add_f32 v78, v36, v78
v_add_f32 v79, v36, v79
v_exp_f32 v8, v68
v_exp_f32 v9, v69
s_waitcnt lgkmcnt(4)
v_mfma_f32_16x16x32_bf16 v[56:59], v[40:43], v[104:107], v[28:31]
v_exp_f32 v10, v70
v_mul_f32 v152, v24, v152
v_mul_f32 v153, v24, v153
v_mul_f32 v154, v24, v154
v_mfma_f32_16x16x32_bf16 v[60:63], v[40:43], v[120:123], v[32:35]
ds_read_b64_tr_b16 v[54:55], v4 offset:61952
v_mov_b32 v21, v18
v_mov_b32 v22, v19
v_mul_f32 v155, v24, v155
v_cvt_pk_bf16_f32 v248, v152, v153
v_cvt_pk_bf16_f32 v249, v154, v155
v_mfma_f32_16x16x32_bf16 v[64:67], v[40:43], v[136:139], v[36:39]
s_waitcnt lgkmcnt(3)
v_exp_f32 v11, v71
v_mul_f32 v156, v24, v156
v_mul_f32 v157, v24, v157
v_mul_f32 v158, v24, v158
v_mfma_f32_16x16x32_bf16 v[168:171], v[44:47], v[92:95], v[168:171]
ds_read_b128 v[40:43], v2 offset:8704
v_add_f32 v16, v8, v9
v_cvt_pk_bf16_f32 v82, v8, v9
v_mul_f32 v159, v24, v159
v_cvt_pk_bf16_f32 v250, v156, v157
v_cvt_pk_bf16_f32 v251, v158, v159
v_mfma_f32_16x16x32_bf16 v[200:203], v[44:47], v[96:99], v[200:203]
v_exp_f32 v12, v72
ds_write_b128 v5, v[248:251]
v_mul_f32 v184, v25, v184
v_mul_f32 v185, v25, v185
v_mfma_f32_16x16x32_bf16 v[232:235], v[44:47], v[100:103], v[232:235]
s_waitcnt lgkmcnt(4)
ds_read_b64_tr_b16 v[44:45], v3 offset:58112
v_add_f32 v17, v10, v11
v_cvt_pk_bf16_f32 v83, v10, v11
v_mul_f32 v186, v25, v186
v_mul_f32 v187, v25, v187
v_cvt_pk_bf16_f32 v252, v184, v185
v_mfma_f32_16x16x32_bf16 v[56:59], v[48:51], v[108:111], v[56:59]
s_barrier
v_exp_f32 v13, v73
v_cvt_pk_bf16_f32 v253, v186, v187
v_mul_f32 v188, v25, v188
v_mul_f32 v189, v25, v189
v_mfma_f32_16x16x32_bf16 v[60:63], v[48:51], v[124:127], v[60:63]
ds_read_b64_tr_b16 v[46:47], v3 offset:62208
v_mov_b32 v23, v20
v_add_f32 v18, v16, v17
v_mul_f32 v190, v25, v190
v_mul_f32 v191, v25, v191
v_cvt_pk_bf16_f32 v254, v188, v189
v_mfma_f32_16x16x32_bf16 v[64:67], v[48:51], v[140:143], v[64:67]
s_waitcnt lgkmcnt(4)
v_exp_f32 v14, v74
v_cvt_pk_bf16_f32 v255, v190, v191
ds_write_b128 v5, v[252:255] offset:4096
v_mul_f32 v216, v26, v216
v_mfma_f32_16x16x32_bf16 v[172:175], v[52:55], v[92:95], v[172:175]
ds_read_b128 v[48:51], v2 offset:8960
v_add_f32 v16, v12, v13
v_mul_f32 v217, v26, v217
v_mul_f32 v218, v26, v218
v_mul_f32 v219, v26, v219
v_mfma_f32_16x16x32_bf16 v[204:207], v[52:55], v[96:99], v[204:207]
v_exp_f32 v15, v75
v_cvt_pk_bf16_f32 v248, v216, v217
v_cvt_pk_bf16_f32 v249, v218, v219
v_mul_f32 v220, v26, v220
v_mfma_f32_16x16x32_bf16 v[236:239], v[52:55], v[100:103], v[236:239]
s_waitcnt lgkmcnt(5)
ds_read_b64_tr_b16 v[52:53], v4 offset:58112
v_cvt_pk_bf16_f32 v86, v12, v13
v_mul_f32 v221, v26, v221
v_mul_f32 v222, v26, v222
v_mul_f32 v223, v26, v223
v_mfma_f32_16x16x32_bf16 v[56:59], v[40:43], v[112:115], v[56:59]
v_exp_f32 v8, v76
v_cvt_pk_bf16_f32 v250, v220, v221
v_cvt_pk_bf16_f32 v251, v222, v223
ds_write_b128 v5, v[248:251] offset:8192
v_mfma_f32_16x16x32_bf16 v[60:63], v[40:43], v[128:131], v[60:63]
ds_read_b64_tr_b16 v[54:55], v4 offset:62208
v_add_f32 v17, v14, v15
v_cvt_pk_bf16_f32 v87, v14, v15
v_mul_f32 v160, v24, v160
v_mul_f32 v161, v24, v161
v_mul_f32 v162, v24, v162
v_mfma_f32_16x16x32_bf16 v[64:67], v[40:43], v[144:147], v[64:67]
s_waitcnt lgkmcnt(5)
v_exp_f32 v9, v77
v_mul_f32 v163, v24, v163
v_cvt_pk_bf16_f32 v252, v160, v161
v_cvt_pk_bf16_f32 v253, v162, v163
v_mfma_f32_16x16x32_bf16 v[176:179], v[44:47], v[92:95], v[176:179]
ds_read_b128 v[40:43], v2 offset:12288
v_add_f32 v19, v16, v17
v_mul_f32 v164, v24, v164
v_mul_f32 v165, v24, v165
v_mul_f32 v166, v24, v166
v_mfma_f32_16x16x32_bf16 v[208:211], v[44:47], v[96:99], v[208:211]
v_exp_f32 v10, v78
v_mul_f32 v167, v24, v167
v_cvt_pk_bf16_f32 v254, v164, v165
v_cvt_pk_bf16_f32 v255, v166, v167
v_mfma_f32_16x16x32_bf16 v[240:243], v[44:47], v[100:103], v[240:243]
s_waitcnt lgkmcnt(4)
ds_read_b64_tr_b16 v[44:45], v3 offset:32768
v_add_f32 v16, v8, v9
v_cvt_pk_bf16_f32 v90, v8, v9
ds_write_b128 v5, v[252:255] offset:1024
v_mul_f32 v192, v25, v192
v_mul_f32 v193, v25, v193
v_mfma_f32_16x16x32_bf16 v[56:59], v[48:51], v[116:119], v[56:59]
v_exp_f32 v11, v79
v_mul_f32 v194, v25, v194
v_mul_f32 v195, v25, v195
v_cvt_pk_bf16_f32 v248, v192, v193
v_mfma_f32_16x16x32_bf16 v[60:63], v[48:51], v[132:135], v[60:63]
ds_read_b64_tr_b16 v[46:47], v3 offset:36864
v_add_f32 v17, v10, v11
v_add_f32 v20, v16, v17
v_cvt_pk_bf16_f32 v249, v194, v195
v_mul_f32 v196, v25, v196
v_mul_f32 v197, v25, v197
v_mfma_f32_16x16x32_bf16 v[64:67], v[48:51], v[148:151], v[64:67]
s_waitcnt lgkmcnt(4)
v_max3_f32 v27, v18, v19, v20
v_cmp_lt_f32 vcc, s60, v27
v_mul_f32 v198, v25, v198
v_mul_f32 v199, v25, v199
v_cvt_pk_bf16_f32 v250, v196, v197
v_mfma_f32_16x16x32_bf16 v[180:183], v[52:55], v[92:95], v[180:183]
ds_read_b128 v[48:51], v2 offset:12544
v_cvt_pk_bf16_f32 v91, v10, v11
v_cvt_pk_bf16_f32 v251, v198, v199
ds_write_b128 v5, v[248:251] offset:5120
v_mul_f32 v224, v26, v224
v_mfma_f32_16x16x32_bf16 v[212:215], v[52:55], v[96:99], v[212:215]
v_exp_f32 v8, v56
v_mul_f32 v225, v26, v225
v_mul_f32 v226, v26, v226
v_mul_f32 v227, v26, v227
v_mfma_f32_16x16x32_bf16 v[244:247], v[52:55], v[100:103], v[244:247]
s_waitcnt lgkmcnt(5)
ds_read_b64_tr_b16 v[52:53], v4 offset:32768
v_cvt_pk_bf16_f32 v252, v224, v225
v_cvt_pk_bf16_f32 v253, v226, v227
v_mul_f32 v228, v26, v228
s_cbranch_vccnz TR_Y0
RET_Y0:
v_exp_f32 v9, v57
v_mfma_f32_16x16x32_bf16 v[68:71], v[40:43], v[104:107], v[28:31]
v_exp_f32 v10, v58
v_mul_f32 v229, v26, v229
v_mul_f32 v230, v26, v230
v_mul_f32 v231, v26, v231
v_mfma_f32_16x16x32_bf16 v[72:75], v[40:43], v[120:123], v[32:35]
ds_read_b64_tr_b16 v[54:55], v4 offset:36864
v_add_f32 v21, v21, v18
v_add_f32 v22, v22, v19
v_cvt_pk_bf16_f32 v254, v228, v229
v_cvt_pk_bf16_f32 v255, v230, v231
ds_write_b128 v5, v[252:255] offset:9216
v_mfma_f32_16x16x32_bf16 v[76:79], v[40:43], v[136:139], v[36:39]
s_waitcnt lgkmcnt(5)
v_exp_f32 v11, v59
v_mfma_f32_16x16x32_bf16 v[152:155], v[44:47], v[80:83], 0
ds_read_b128 v[40:43], v2 offset:12800
v_add_f32 v16, v8, v9
v_cvt_pk_bf16_f32 v92, v8, v9
v_mul_f32 v168, v24, v168
v_mul_f32 v169, v24, v169
v_mul_f32 v170, v24, v170
v_mul_f32 v171, v24, v171
v_cvt_pk_bf16_f32 v248, v168, v169
v_mfma_f32_16x16x32_bf16 v[184:187], v[44:47], v[84:87], 0
v_exp_f32 v12, v60
v_cvt_pk_bf16_f32 v249, v170, v171
v_mul_f32 v172, v24, v172
v_mul_f32 v173, v24, v173
v_mul_f32 v174, v24, v174
v_mfma_f32_16x16x32_bf16 v[216:219], v[44:47], v[88:91], 0
s_waitcnt lgkmcnt(5)
ds_read_b64_tr_b16 v[44:45], v3 offset:33024
v_add_f32 v17, v10, v11
v_cvt_pk_bf16_f32 v93, v10, v11
v_mul_f32 v175, v24, v175
v_cvt_pk_bf16_f32 v250, v172, v173
v_cvt_pk_bf16_f32 v251, v174, v175
ds_write_b128 v5, v[248:251] offset:2048
v_mfma_f32_16x16x32_bf16 v[68:71], v[48:51], v[108:111], v[68:71]
v_exp_f32 v13, v61
v_mul_f32 v200, v25, v200
v_mul_f32 v201, v25, v201
v_mul_f32 v202, v25, v202
v_mul_f32 v203, v25, v203
v_mfma_f32_16x16x32_bf16 v[72:75], v[48:51], v[124:127], v[72:75]
ds_read_b64_tr_b16 v[46:47], v3 offset:37120
v_add_f32 v23, v23, v20
v_add_f32 v18, v16, v17
v_cvt_pk_bf16_f32 v252, v200, v201
v_cvt_pk_bf16_f32 v253, v202, v203
v_mul_f32 v204, v25, v204
v_mul_f32 v205, v25, v205
v_mfma_f32_16x16x32_bf16 v[76:79], v[48:51], v[140:143], v[76:79]
s_waitcnt lgkmcnt(5)
v_exp_f32 v14, v62
v_mul_f32 v206, v25, v206
v_mul_f32 v207, v25, v207
v_cvt_pk_bf16_f32 v254, v204, v205
v_cvt_pk_bf16_f32 v255, v206, v207
v_mfma_f32_16x16x32_bf16 v[156:159], v[52:55], v[80:83], 0
ds_read_b128 v[48:51], v2 offset:13056
v_add_f32 v16, v12, v13
ds_write_b128 v5, v[252:255] offset:6144
v_mul_f32 v232, v26, v232
v_mul_f32 v233, v26, v233
v_mul_f32 v234, v26, v234
v_mfma_f32_16x16x32_bf16 v[188:191], v[52:55], v[84:87], 0
v_exp_f32 v15, v63
v_mul_f32 v235, v26, v235
v_cvt_pk_bf16_f32 v248, v232, v233
v_cvt_pk_bf16_f32 v249, v234, v235
v_mul_f32 v236, v26, v236
v_mfma_f32_16x16x32_bf16 v[220:223], v[52:55], v[88:91], 0
s_waitcnt lgkmcnt(5)
ds_read_b64_tr_b16 v[52:53], v4 offset:33024
v_cvt_pk_bf16_f32 v96, v12, v13
v_mul_f32 v237, v26, v237
v_mul_f32 v238, v26, v238
v_mul_f32 v239, v26, v239
v_cvt_pk_bf16_f32 v250, v236, v237
v_mfma_f32_16x16x32_bf16 v[68:71], v[40:43], v[112:115], v[68:71]
v_exp_f32 v8, v64
v_cvt_pk_bf16_f32 v251, v238, v239
ds_write_b128 v5, v[248:251] offset:10240
v_mul_f32 v176, v24, v176
v_mul_f32 v177, v24, v177
v_mul_f32 v178, v24, v178
v_mfma_f32_16x16x32_bf16 v[72:75], v[40:43], v[128:131], v[72:75]
ds_read_b64_tr_b16 v[54:55], v4 offset:37120
v_add_f32 v17, v14, v15
v_cvt_pk_bf16_f32 v97, v14, v15
v_mul_f32 v179, v24, v179
v_cvt_pk_bf16_f32 v252, v176, v177
v_cvt_pk_bf16_f32 v253, v178, v179
v_mul_f32 v180, v24, v180
v_mfma_f32_16x16x32_bf16 v[76:79], v[40:43], v[144:147], v[76:79]
s_waitcnt lgkmcnt(5)
v_exp_f32 v9, v65
v_mul_f32 v181, v24, v181
v_mul_f32 v182, v24, v182
v_mul_f32 v183, v24, v183
v_cvt_pk_bf16_f32 v254, v180, v181
v_mfma_f32_16x16x32_bf16 v[160:163], v[44:47], v[80:83], 0
ds_read_b128 v[40:43], v2 offset:16384
v_add_f32 v19, v16, v17
v_cvt_pk_bf16_f32 v255, v182, v183
ds_write_b128 v5, v[252:255] offset:3072
v_mul_f32 v208, v25, v208
v_mul_f32 v209, v25, v209
v_mfma_f32_16x16x32_bf16 v[192:195], v[44:47], v[84:87], 0
v_exp_f32 v10, v66
v_mul_f32 v210, v25, v210
v_mul_f32 v211, v25, v211
v_cvt_pk_bf16_f32 v248, v208, v209
v_cvt_pk_bf16_f32 v249, v210, v211
v_mfma_f32_16x16x32_bf16 v[224:227], v[44:47], v[88:91], 0
s_waitcnt lgkmcnt(6)
ds_read_b64_tr_b16 v[44:45], v3 offset:33280
v_add_f32 v16, v8, v9
v_cvt_pk_bf16_f32 v100, v8, v9
v_mul_f32 v212, v25, v212
v_mul_f32 v213, v25, v213
v_mul_f32 v214, v25, v214
v_mul_f32 v215, v25, v215
v_mfma_f32_16x16x32_bf16 v[68:71], v[48:51], v[116:119], v[68:71]
v_exp_f32 v11, v67
v_cvt_pk_bf16_f32 v250, v212, v213
v_cvt_pk_bf16_f32 v251, v214, v215
ds_write_b128 v5, v[248:251] offset:7168
v_mul_f32 v240, v26, v240
v_mfma_f32_16x16x32_bf16 v[72:75], v[48:51], v[132:135], v[72:75]
ds_read_b64_tr_b16 v[46:47], v3 offset:37376
v_add_f32 v17, v10, v11
v_add_f32 v20, v16, v17
v_mul_f32 v241, v26, v241
v_mul_f32 v242, v26, v242
v_mul_f32 v243, v26, v243
v_cvt_pk_bf16_f32 v252, v240, v241
v_mfma_f32_16x16x32_bf16 v[76:79], v[48:51], v[148:151], v[76:79]
s_waitcnt lgkmcnt(5)
v_max3_f32 v27, v18, v19, v20
v_cmp_lt_f32 vcc, s60, v27
v_cvt_pk_bf16_f32 v253, v242, v243
v_mul_f32 v244, v26, v244
v_mul_f32 v245, v26, v245
v_mul_f32 v246, v26, v246
v_mfma_f32_16x16x32_bf16 v[164:167], v[52:55], v[80:83], 0
ds_read_b128 v[48:51], v2 offset:16640
v_cvt_pk_bf16_f32 v101, v10, v11
v_mul_f32 v247, v26, v247
v_cvt_pk_bf16_f32 v254, v244, v245
v_cvt_pk_bf16_f32 v255, v246, v247
ds_write_b128 v5, v[252:255] offset:11264
v_mfma_f32_16x16x32_bf16 v[196:199], v[52:55], v[84:87], 0
v_exp_f32 v8, v68
v_mfma_f32_16x16x32_bf16 v[228:231], v[52:55], v[88:91], 0
ds_read_b64_tr_b16 v[52:53], v4 offset:33280
s_cbranch_vccnz TR_X0
RET_X0:
v_exp_f32 v9, v69
s_add_u32 s71, s71, 1
s_branch L_A_loop
TR_Yp1:
s_call_b64 s[62:63], RARE_0
s_branch RET_Yp1
TR_Xp1:
s_call_b64 s[62:63], RARE_1
s_branch RET_Xp1
TR_Y1:
s_call_b64 s[62:63], RARE_2
s_branch RET_Y1
TR_X1:
s_call_b64 s[62:63], RARE_3
s_branch RET_X1
TR_Y2:
s_call_b64 s[62:63], RARE_4
s_branch RET_Y2
TR_X2:
s_call_b64 s[62:63], RARE_1
s_branch RET_X2
TR_Y3:
s_call_b64 s[62:63], RARE_2
s_branch RET_Y3
TR_X3:
s_call_b64 s[62:63], RARE_3
s_branch RET_X3
TR_Y4:
s_call_b64 s[62:63], RARE_4
s_branch RET_Y4
TR_X4:
s_call_b64 s[62:63], RARE_1
s_branch RET_X4
TR_Y5:
s_call_b64 s[62:63], RARE_2
s_branch RET_Y5
TR_X5:
s_call_b64 s[62:63], RARE_3
s_branch RET_X5
TR_Y6:
s_call_b64 s[62:63], RARE_4
s_branch RET_Y6
TR_X6:
s_call_b64 s[62:63], RARE_1
s_branch RET_X6
TR_Y7:
s_call_b64 s[62:63], RARE_2
s_branch RET_Y7
TR_X7:
s_call_b64 s[62:63], RARE_3
s_branch RET_X7
TR_Y8:
s_call_b64 s[62:63], RARE_4
s_branch RET_Y8
TR_X8:
s_call_b64 s[62:63], RARE_1
s_branch RET_X8
TR_Y9:
s_call_b64 s[62:63], RARE_2
s_branch RET_Y9
TR_X9:
s_call_b64 s[62:63], RARE_3
s_branch RET_X9
TR_Y10:
s_call_b64 s[62:63], RARE_4
s_branch RET_Y10
TR_X10:
s_call_b64 s[62:63], RARE_1
s_branch RET_X10
TR_Y11:
s_call_b64 s[62:63], RARE_2
s_branch RET_Y11
TR_X11:
s_call_b64 s[62:63], RARE_3
s_branch RET_X11
TR_Y12:
s_call_b64 s[62:63], RARE_4
s_branch RET_Y12
TR_X12:
s_call_b64 s[62:63], RARE_1
s_branch RET_X12
TR_Y13:
s_call_b64 s[62:63], RARE_2
s_branch RET_Y13
TR_X13:
s_call_b64 s[62:63], RARE_3
s_branch RET_X13
TR_Y14:
s_call_b64 s[62:63], RARE_4
s_branch RET_Y14
TR_X14:
s_call_b64 s[62:63], RARE_1
s_branch RET_X14
TR_Y15:
s_call_b64 s[62:63], RARE_5
s_branch RET_Y15
TR_Y0:
s_call_b64 s[62:63], RARE_0
s_branch RET_Y0
TR_X0:
s_call_b64 s[62:63], RARE_1
s_branch RET_X0
TR_Yt62:
s_call_b64 s[62:63], RARE_4
s_branch RET_Yt62
TR_Xt62:
s_call_b64 s[62:63], RARE_1
s_branch RET_Xt62
TR_Yt63:
s_call_b64 s[62:63], RARE_5
s_branch RET_Yt63
RARE_0:
s_nop 15
v_max3_f32 v16, v68, v69, v70
v_max_f32 v16, v16, v71
v_mov_b32 v27, v16
s_nop 1
v_permlane32_swap_b32 v16, v27
v_max_f32 v16, v16, v27
v_mov_b32 v27, v16
s_nop 1
v_permlane16_swap_b32 v16, v27
v_max_f32 v16, v16, v27
v_ceil_f32 v16, v16
v_max_f32 v16, 0, v16
v_sub_f32 v17, 0, v16
v_exp_f32 v17, v17
v_sub_f32 v68, v68, v16
v_sub_f32 v56, v56, v16
v_sub_f32 v28, v28, v16
v_sub_f32 v69, v69, v16
v_sub_f32 v57, v57, v16
v_sub_f32 v29, v29, v16
v_sub_f32 v70, v70, v16
v_sub_f32 v58, v58, v16
v_sub_f32 v30, v30, v16
v_sub_f32 v71, v71, v16
v_sub_f32 v59, v59, v16
v_sub_f32 v31, v31, v16
v_mul_f32 v21, v17, v21
v_lshlrev_b32 v8, 16, v80
v_and_b32 v9, 0xffff0000, v80
v_mul_f32 v8, v17, v8
v_mul_f32 v9, v17, v9
v_cvt_pk_bf16_f32 v80, v8, v9
v_lshlrev_b32 v8, 16, v81
v_and_b32 v9, 0xffff0000, v81
v_mul_f32 v8, v17, v8
v_mul_f32 v9, v17, v9
v_cvt_pk_bf16_f32 v81, v8, v9
v_exp_f32 v8, v68
v_exp_f32 v9, v69
v_exp_f32 v10, v70
v_exp_f32 v11, v71
v_cvt_pk_bf16_f32 v82, v8, v9
v_cvt_pk_bf16_f32 v83, v10, v11
v_add_f32 v8, v8, v9
v_add_f32 v10, v10, v11
v_add_f32 v18, v8, v10
v_max3_f32 v16, v72, v73, v74
v_max_f32 v16, v16, v75
v_mov_b32 v27, v16
s_nop 1
v_permlane32_swap_b32 v16, v27
v_max_f32 v16, v16, v27
v_mov_b32 v27, v16
s_nop 1
v_permlane16_swap_b32 v16, v27
v_max_f32 v16, v16, v27
v_ceil_f32 v16, v16
v_max_f32 v16, 0, v16
v_sub_f32 v17, 0, v16
v_exp_f32 v17, v17
v_sub_f32 v72, v72, v16
v_sub_f32 v60, v60, v16
v_sub_f32 v32, v32, v16
v_sub_f32 v73, v73, v16
v_sub_f32 v61, v61, v16
v_sub_f32 v33, v33, v16
v_sub_f32 v74, v74, v16
v_sub_f32 v62, v62, v16
v_sub_f32 v34, v34, v16
v_sub_f32 v75, v75, v16
v_sub_f32 v63, v63, v16
v_sub_f32 v35, v35, v16
v_mul_f32 v22, v17, v22
v_lshlrev_b32 v8, 16, v84
v_and_b32 v9, 0xffff0000, v84
v_mul_f32 v8, v17, v8
v_mul_f32 v9, v17, v9
v_cvt_pk_bf16_f32 v84, v8, v9
v_lshlrev_b32 v8, 16, v85
v_and_b32 v9, 0xffff0000, v85
v_mul_f32 v8, v17, v8
v_mul_f32 v9, v17, v9
v_cvt_pk_bf16_f32 v85, v8, v9
v_exp_f32 v8, v72
v_exp_f32 v9, v73
v_exp_f32 v10, v74
v_exp_f32 v11, v75
v_cvt_pk_bf16_f32 v86, v8, v9
v_cvt_pk_bf16_f32 v87, v10, v11
v_add_f32 v8, v8, v9
v_add_f32 v10, v10, v11
v_add_f32 v19, v8, v10
v_max3_f32 v16, v76, v77, v78
v_max_f32 v16, v16, v79
v_mov_b32 v27, v16
s_nop 1
v_permlane32_swap_b32 v16, v27
v_max_f32 v16, v16, v27
v_mov_b32 v27, v16
s_nop 1
v_permlane16_swap_b32 v16, v27
v_max_f32 v16, v16, v27
v_ceil_f32 v16, v16
v_max_f32 v16, 0, v16
v_sub_f32 v17, 0, v16
v_exp_f32 v17, v17
v_sub_f32 v76, v76, v16
v_sub_f32 v64, v64, v16
v_sub_f32 v36, v36, v16
v_sub_f32 v77, v77, v16
v_sub_f32 v65, v65, v16
v_sub_f32 v37, v37, v16
v_sub_f32 v78, v78, v16
v_sub_f32 v66, v66, v16
v_sub_f32 v38, v38, v16
v_sub_f32 v79, v79, v16
v_sub_f32 v67, v67, v16
v_sub_f32 v39, v39, v16
v_mul_f32 v23, v17, v23
v_lshlrev_b32 v8, 16, v88
v_and_b32 v9, 0xffff0000, v88
v_mul_f32 v8, v17, v8
v_mul_f32 v9, v17, v9
v_cvt_pk_bf16_f32 v88, v8, v9
v_lshlrev_b32 v8, 16, v89
v_and_b32 v9, 0xffff0000, v89
v_mul_f32 v8, v17, v8
v_mul_f32 v9, v17, v9
v_cvt_pk_bf16_f32 v89, v8, v9
v_exp_f32 v8, v76
v_exp_f32 v9, v77
v_exp_f32 v10, v78
v_exp_f32 v11, v79
v_cvt_pk_bf16_f32 v90, v8, v9
v_cvt_pk_bf16_f32 v91, v10, v11
v_add_f32 v8, v8, v9
v_add_f32 v10, v10, v11
v_add_f32 v20, v8, v10
v_exp_f32 v8, v56
s_nop 3
s_setpc_b64 s[62:63]
RARE_1:
s_nop 15
v_max3_f32 v16, v56, v57, v58
v_max_f32 v16, v16, v59
v_mov_b32 v27, v16
s_nop 1
v_permlane32_swap_b32 v16, v27
v_max_f32 v16, v16, v27
v_mov_b32 v27, v16
s_nop 1
v_permlane16_swap_b32 v16, v27
v_max_f32 v16, v16, v27
v_ceil_f32 v16, v16
v_max_f32 v16, 0, v16
v_sub_f32 v17, 0, v16
v_exp_f32 v17, v17
v_sub_f32 v56, v56, v16
v_sub_f32 v68, v68, v16
v_sub_f32 v28, v28, v16
v_sub_f32 v57, v57, v16
v_sub_f32 v69, v69, v16
v_sub_f32 v29, v29, v16
v_sub_f32 v58, v58, v16
v_sub_f32 v70, v70, v16
v_sub_f32 v30, v30, v16
v_sub_f32 v59, v59, v16
v_sub_f32 v71, v71, v16
v_sub_f32 v31, v31, v16
v_mul_f32 v21, v17, v21
v_mul_f32 v152, v17, v152
v_mul_f32 v153, v17, v153
v_mul_f32 v154, v17, v154
v_mul_f32 v155, v17, v155
v_mul_f32 v156, v17, v156
v_mul_f32 v157, v17, v157
v_mul_f32 v158, v17, v158
v_mul_f32 v159, v17, v159
v_mul_f32 v160, v17, v160
v_mul_f32 v161, v17, v161
v_mul_f32 v162, v17, v162
v_mul_f32 v163, v17, v163
v_mul_f32 v164, v17, v164
v_mul_f32 v165, v17, v165
v_mul_f32 v166, v17, v166
v_mul_f32 v167, v17, v167
v_mul_f32 v168, v17, v168
v_mul_f32 v169, v17, v169
v_mul_f32 v170, v17, v170
v_mul_f32 v171, v17, v171
v_mul_f32 v172, v17, v172
v_mul_f32 v173, v17, v173
v_mul_f32 v174, v17, v174
v_mul_f32 v175, v17, v175
v_mul_f32 v176, v17, v176
v_mul_f32 v177, v17, v177
v_mul_f32 v178, v17, v178
v_mul_f32 v179, v17, v179
v_mul_f32 v180, v17, v180
v_mul_f32 v181, v17, v181
v_mul_f32 v182, v17, v182
v_mul_f32 v183, v17, v183
v_lshlrev_b32 v8, 16, v80
v_and_b32 v9, 0xffff0000, v80
v_mul_f32 v8, v17, v8
v_mul_f32 v9, v17, v9
v_cvt_pk_bf16_f32 v80, v8, v9
v_lshlrev_b32 v8, 16, v81
v_and_b32 v9, 0xffff0000, v81
v_mul_f32 v8, v17, v8
v_mul_f32 v9, v17, v9
v_cvt_pk_bf16_f32 v81, v8, v9
v_lshlrev_b32 v8, 16, v82
v_and_b32 v9, 0xffff0000, v82
v_mul_f32 v8, v17, v8
v_mul_f32 v9, v17, v9
v_cvt_pk_bf16_f32 v82, v8, v9
v_lshlrev_b32 v8, 16, v83
v_and_b32 v9, 0xffff0000, v83
v_mul_f32 v8, v17, v8
v_mul_f32 v9, v17, v9
v_cvt_pk_bf16_f32 v83, v8, v9
v_exp_f32 v8, v56
v_exp_f32 v9, v57
v_exp_f32 v10, v58
v_exp_f32 v11, v59
v_cvt_pk_bf16_f32 v92, v8, v9
v_cvt_pk_bf16_f32 v93, v10, v11
v_add_f32 v8, v8, v9
v_add_f32 v10, v10, v11
v_add_f32 v18, v8, v10
v_max3_f32 v16, v60, v61, v62
v_max_f32 v16, v16, v63
v_mov_b32 v27, v16
s_nop 1
v_permlane32_swap_b32 v16, v27
v_max_f32 v16, v16, v27
v_mov_b32 v27, v16
s_nop 1
v_permlane16_swap_b32 v16, v27
v_max_f32 v16, v16, v27
v_ceil_f32 v16, v16
v_max_f32 v16, 0, v16
v_sub_f32 v17, 0, v16
v_exp_f32 v17, v17
v_sub_f32 v60, v60, v16
v_sub_f32 v72, v72, v16
v_sub_f32 v32, v32, v16
v_sub_f32 v61, v61, v16
v_sub_f32 v73, v73, v16
v_sub_f32 v33, v33, v16
v_sub_f32 v62, v62, v16
v_sub_f32 v74, v74, v16
v_sub_f32 v34, v34, v16
v_sub_f32 v63, v63, v16
v_sub_f32 v75, v75, v16
v_sub_f32 v35, v35, v16
v_mul_f32 v22, v17, v22
v_mul_f32 v184, v17, v184
v_mul_f32 v185, v17, v185
v_mul_f32 v186, v17, v186
v_mul_f32 v187, v17, v187
v_mul_f32 v188, v17, v188
v_mul_f32 v189, v17, v189
v_mul_f32 v190, v17, v190
v_mul_f32 v191, v17, v191
v_mul_f32 v192, v17, v192
v_mul_f32 v193, v17, v193
v_mul_f32 v194, v17, v194
v_mul_f32 v195, v17, v195
v_mul_f32 v196, v17, v196
v_mul_f32 v197, v17, v197
v_mul_f32 v198, v17, v198
v_mul_f32 v199, v17, v199
v_mul_f32 v200, v17, v200
v_mul_f32 v201, v17, v201
v_mul_f32 v202, v17, v202
v_mul_f32 v203, v17, v203
v_mul_f32 v204, v17, v204
v_mul_f32 v205, v17, v205
v_mul_f32 v206, v17, v206
v_mul_f32 v207, v17, v207
v_mul_f32 v208, v17, v208
v_mul_f32 v209, v17, v209
v_mul_f32 v210, v17, v210
v_mul_f32 v211, v17, v211
v_mul_f32 v212, v17, v212
v_mul_f32 v213, v17, v213
v_mul_f32 v214, v17, v214
v_mul_f32 v215, v17, v215
v_lshlrev_b32 v8, 16, v84
v_and_b32 v9, 0xffff0000, v84
v_mul_f32 v8, v17, v8
v_mul_f32 v9, v17, v9
v_cvt_pk_bf16_f32 v84, v8, v9
v_lshlrev_b32 v8, 16, v85
v_and_b32 v9, 0xffff0000, v85
v_mul_f32 v8, v17, v8
v_mul_f32 v9, v17, v9
v_cvt_pk_bf16_f32 v85, v8, v9
v_lshlrev_b32 v8, 16, v86
v_and_b32 v9, 0xffff0000, v86
v_mul_f32 v8, v17, v8
v_mul_f32 v9, v17, v9
v_cvt_pk_bf16_f32 v86, v8, v9
v_lshlrev_b32 v8, 16, v87
v_and_b32 v9, 0xffff0000, v87
v_mul_f32 v8, v17, v8
v_mul_f32 v9, v17, v9
v_cvt_pk_bf16_f32 v87, v8, v9
v_exp_f32 v8, v60
v_exp_f32 v9, v61
v_exp_f32 v10, v62
v_exp_f32 v11, v63
v_cvt_pk_bf16_f32 v96, v8, v9
v_cvt_pk_bf16_f32 v97, v10, v11
v_add_f32 v8, v8, v9
v_add_f32 v10, v10, v11
v_add_f32 v19, v8, v10
v_max3_f32 v16, v64, v65, v66
v_max_f32 v16, v16, v67
v_mov_b32 v27, v16
s_nop 1
v_permlane32_swap_b32 v16, v27
v_max_f32 v16, v16, v27
v_mov_b32 v27, v16
s_nop 1
v_permlane16_swap_b32 v16, v27
v_max_f32 v16, v16, v27
v_ceil_f32 v16, v16
v_max_f32 v16, 0, v16
v_sub_f32 v17, 0, v16
v_exp_f32 v17, v17
v_sub_f32 v64, v64, v16
v_sub_f32 v76, v76, v16
v_sub_f32 v36, v36, v16
v_sub_f32 v65, v65, v16
v_sub_f32 v77, v77, v16
v_sub_f32 v37, v37, v16
v_sub_f32 v66, v66, v16
v_sub_f32 v78, v78, v16
v_sub_f32 v38, v38, v16
v_sub_f32 v67, v67, v16
v_sub_f32 v79, v79, v16
v_sub_f32 v39, v39, v16
v_mul_f32 v23, v17, v23
v_mul_f32 v216, v17, v216
v_mul_f32 v217, v17, v217
v_mul_f32 v218, v17, v218
v_mul_f32 v219, v17, v219
v_mul_f32 v220, v17, v220
v_mul_f32 v221, v17, v221
v_mul_f32 v222, v17, v222
v_mul_f32 v223, v17, v223
v_mul_f32 v224, v17, v224
v_mul_f32 v225, v17, v225
v_mul_f32 v226, v17, v226
v_mul_f32 v227, v17, v227
v_mul_f32 v228, v17, v228
v_mul_f32 v229, v17, v229
v_mul_f32 v230, v17, v230
v_mul_f32 v231, v17, v231
v_mul_f32 v232, v17, v232
v_mul_f32 v233, v17, v233
v_mul_f32 v234, v17, v234
v_mul_f32 v235, v17, v235
v_mul_f32 v236, v17, v236
v_mul_f32 v237, v17, v237
v_mul_f32 v238, v17, v238
v_mul_f32 v239, v17, v239
v_mul_f32 v240, v17, v240
v_mul_f32 v241, v17, v241
v_mul_f32 v242, v17, v242
v_mul_f32 v243, v17, v243
v_mul_f32 v244, v17, v244
v_mul_f32 v245, v17, v245
v_mul_f32 v246, v17, v246
v_mul_f32 v247, v17, v247
v_lshlrev_b32 v8, 16, v88
v_and_b32 v9, 0xffff0000, v88
v_mul_f32 v8, v17, v8
v_mul_f32 v9, v17, v9
v_cvt_pk_bf16_f32 v88, v8, v9
v_lshlrev_b32 v8, 16, v89
v_and_b32 v9, 0xffff0000, v89
v_mul_f32 v8, v17, v8
v_mul_f32 v9, v17, v9
v_cvt_pk_bf16_f32 v89, v8, v9
v_lshlrev_b32 v8, 16, v90
v_and_b32 v9, 0xffff0000, v90
v_mul_f32 v8, v17, v8
v_mul_f32 v9, v17, v9
v_cvt_pk_bf16_f32 v90, v8, v9
v_lshlrev_b32 v8, 16, v91
v_and_b32 v9, 0xffff0000, v91
v_mul_f32 v8, v17, v8
v_mul_f32 v9, v17, v9
v_cvt_pk_bf16_f32 v91, v8, v9
v_exp_f32 v8, v64
v_exp_f32 v9, v65
v_exp_f32 v10, v66
v_exp_f32 v11, v67
v_cvt_pk_bf16_f32 v100, v8, v9
v_cvt_pk_bf16_f32 v101, v10, v11
v_add_f32 v8, v8, v9
v_add_f32 v10, v10, v11
v_add_f32 v20, v8, v10
v_exp_f32 v8, v68
s_nop 3
s_setpc_b64 s[62:63]
RARE_2:
s_nop 15
v_max3_f32 v16, v68, v69, v70
v_max_f32 v16, v16, v71
v_mov_b32 v27, v16
s_nop 1
v_permlane32_swap_b32 v16, v27
v_max_f32 v16, v16, v27
v_mov_b32 v27, v16
s_nop 1
v_permlane16_swap_b32 v16, v27
v_max_f32 v16, v16, v27
v_ceil_f32 v16, v16
v_max_f32 v16, 0, v16
v_sub_f32 v17, 0, v16
v_exp_f32 v17, v17
v_sub_f32 v68, v68, v16
v_sub_f32 v56, v56, v16
v_sub_f32 v28, v28, v16
v_sub_f32 v69, v69, v16
v_sub_f32 v57, v57, v16
v_sub_f32 v29, v29, v16
v_sub_f32 v70, v70, v16
v_sub_f32 v58, v58, v16
v_sub_f32 v30, v30, v16
v_sub_f32 v71, v71, v16
v_sub_f32 v59, v59, v16
v_sub_f32 v31, v31, v16
v_mul_f32 v21, v17, v21
v_mul_f32 v152, v17, v152
v_mul_f32 v153, v17, v153
v_mul_f32 v154, v17, v154
v_mul_f32 v155, v17, v155
v_mul_f32 v156, v17, v156
v_mul_f32 v157, v17, v157
v_mul_f32 v158, v17, v158
v_mul_f32 v159, v17, v159
v_mul_f32 v160, v17, v160
v_mul_f32 v161, v17, v161
v_mul_f32 v162, v17, v162
v_mul_f32 v163, v17, v163
v_mul_f32 v164, v17, v164
v_mul_f32 v165, v17, v165
v_mul_f32 v166, v17, v166
v_mul_f32 v167, v17, v167
v_mul_f32 v168, v17, v168
v_mul_f32 v169, v17, v169
v_mul_f32 v170, v17, v170
v_mul_f32 v171, v17, v171
v_mul_f32 v172, v17, v172
v_mul_f32 v173, v17, v173
v_mul_f32 v174, v17, v174
v_mul_f32 v175, v17, v175
v_mul_f32 v176, v17, v176
v_mul_f32 v177, v17, v177
v_mul_f32 v178, v17, v178
v_mul_f32 v179, v17, v179
v_mul_f32 v180, v17, v180
v_mul_f32 v181, v17, v181
v_mul_f32 v182, v17, v182
v_mul_f32 v183, v17, v183
v_lshlrev_b32 v8, 16, v92
v_and_b32 v9, 0xffff0000, v92
v_mul_f32 v8, v17, v8
v_mul_f32 v9, v17, v9
v_cvt_pk_bf16_f32 v92, v8, v9
v_lshlrev_b32 v8, 16, v93
v_and_b32 v9, 0xffff0000, v93
v_mul_f32 v8, v17, v8
v_mul_f32 v9, v17, v9
v_cvt_pk_bf16_f32 v93, v8, v9
v_exp_f32 v8, v68
v_exp_f32 v9, v69
v_exp_f32 v10, v70
v_exp_f32 v11, v71
v_cvt_pk_bf16_f32 v94, v8, v9
v_cvt_pk_bf16_f32 v95, v10, v11
v_add_f32 v8, v8, v9
v_add_f32 v10, v10, v11
v_add_f32 v18, v8, v10
v_max3_f32 v16, v72, v73, v74
v_max_f32 v16, v16, v75
v_mov_b32 v27, v16
s_nop 1
v_permlane32_swap_b32 v16, v27
v_max_f32 v16, v16, v27
v_mov_b32 v27, v16
s_nop 1
v_permlane16_swap_b32 v16, v27
v_max_f32 v16, v16, v27
v_ceil_f32 v16, v16
v_max_f32 v16, 0, v16
v_sub_f32 v17, 0, v16
v_exp_f32 v17, v17
v_sub_f32 v72, v72, v16
v_sub_f32 v60, v60, v16
v_sub_f32 v32, v32, v16
v_sub_f32 v73, v73, v16
v_sub_f32 v61, v61, v16
v_sub_f32 v33, v33, v16
v_sub_f32 v74, v74, v16
v_sub_f32 v62, v62, v16
v_sub_f32 v34, v34, v16
v_sub_f32 v75, v75, v16
v_sub_f32 v63, v63, v16
v_sub_f32 v35, v35, v16
v_mul_f32 v22, v17, v22
v_mul_f32 v184, v17, v184
v_mul_f32 v185, v17, v185
v_mul_f32 v186, v17, v186
v_mul_f32 v187, v17, v187
v_mul_f32 v188, v17, v188
v_mul_f32 v189, v17, v189
v_mul_f32 v190, v17, v190
v_mul_f32 v191, v17, v191
v_mul_f32 v192, v17, v192
v_mul_f32 v193, v17, v193
v_mul_f32 v194, v17, v194
v_mul_f32 v195, v17, v195
v_mul_f32 v196, v17, v196
v_mul_f32 v197, v17, v197
v_mul_f32 v198, v17, v198
v_mul_f32 v199, v17, v199
v_mul_f32 v200, v17, v200
v_mul_f32 v201, v17, v201
v_mul_f32 v202, v17, v202
v_mul_f32 v203, v17, v203
v_mul_f32 v204, v17, v204
v_mul_f32 v205, v17, v205
v_mul_f32 v206, v17, v206
v_mul_f32 v207, v17, v207
v_mul_f32 v208, v17, v208
v_mul_f32 v209, v17, v209
v_mul_f32 v210, v17, v210
v_mul_f32 v211, v17, v211
v_mul_f32 v212, v17, v212
v_mul_f32 v213, v17, v213
v_mul_f32 v214, v17, v214
v_mul_f32 v215, v17, v215
v_lshlrev_b32 v8, 16, v96
v_and_b32 v9, 0xffff0000, v96
v_mul_f32 v8, v17, v8
v_mul_f32 v9, v17, v9
v_cvt_pk_bf16_f32 v96, v8, v9
v_lshlrev_b32 v8, 16, v97
v_and_b32 v9, 0xffff0000, v97
v_mul_f32 v8, v17, v8
v_mul_f32 v9, v17, v9
v_cvt_pk_bf16_f32 v97, v8, v9
v_exp_f32 v8, v72
v_exp_f32 v9, v73
v_exp_f32 v10, v74
v_exp_f32 v11, v75
v_cvt_pk_bf16_f32 v98, v8, v9
v_cvt_pk_bf16_f32 v99, v10, v11
v_add_f32 v8, v8, v9
v_add_f32 v10, v10, v11
v_add_f32 v19, v8, v10
v_max3_f32 v16, v76, v77, v78
v_max_f32 v16, v16, v79
v_mov_b32 v27, v16
s_nop 1
v_permlane32_swap_b32 v16, v27
v_max_f32 v16, v16, v27
v_mov_b32 v27, v16
s_nop 1
v_permlane16_swap_b32 v16, v27
v_max_f32 v16, v16, v27
v_ceil_f32 v16, v16
v_max_f32 v16, 0, v16
v_sub_f32 v17, 0, v16
v_exp_f32 v17, v17
v_sub_f32 v76, v76, v16
v_sub_f32 v64, v64, v16
v_sub_f32 v36, v36, v16
v_sub_f32 v77, v77, v16
v_sub_f32 v65, v65, v16
v_sub_f32 v37, v37, v16
v_sub_f32 v78, v78, v16
v_sub_f32 v66, v66, v16
v_sub_f32 v38, v38, v16
v_sub_f32 v79, v79, v16
v_sub_f32 v67, v67, v16
v_sub_f32 v39, v39, v16
v_mul_f32 v23, v17, v23
v_mul_f32 v216, v17, v216
v_mul_f32 v217, v17, v217
v_mul_f32 v218, v17, v218
v_mul_f32 v219, v17, v219
v_mul_f32 v220, v17, v220
v_mul_f32 v221, v17, v221
v_mul_f32 v222, v17, v222
v_mul_f32 v223, v17, v223
v_mul_f32 v224, v17, v224
v_mul_f32 v225, v17, v225
v_mul_f32 v226, v17, v226
v_mul_f32 v227, v17, v227
v_mul_f32 v228, v17, v228
v_mul_f32 v229, v17, v229
v_mul_f32 v230, v17, v230
v_mul_f32 v231, v17, v231
v_mul_f32 v232, v17, v232
v_mul_f32 v233, v17, v233
v_mul_f32 v234, v17, v234
v_mul_f32 v235, v17, v235
v_mul_f32 v236, v17, v236
v_mul_f32 v237, v17, v237
v_mul_f32 v238, v17, v238
v_mul_f32 v239, v17, v239
v_mul_f32 v240, v17, v240
v_mul_f32 v241, v17, v241
v_mul_f32 v242, v17, v242
v_mul_f32 v243, v17, v243
v_mul_f32 v244, v17, v244
v_mul_f32 v245, v17, v245
v_mul_f32 v246, v17, v246
v_mul_f32 v247, v17, v247
v_lshlrev_b32 v8, 16, v100
v_and_b32 v9, 0xffff0000, v100
v_mul_f32 v8, v17, v8
v_mul_f32 v9, v17, v9
v_cvt_pk_bf16_f32 v100, v8, v9
v_lshlrev_b32 v8, 16, v101
v_and_b32 v9, 0xffff0000, v101
v_mul_f32 v8, v17, v8
v_mul_f32 v9, v17, v9
v_cvt_pk_bf16_f32 v101, v8, v9
v_exp_f32 v8, v76
v_exp_f32 v9, v77
v_exp_f32 v10, v78
v_exp_f32 v11, v79
v_cvt_pk_bf16_f32 v102, v8, v9
v_cvt_pk_bf16_f32 v103, v10, v11
v_add_f32 v8, v8, v9
v_add_f32 v10, v10, v11
v_add_f32 v20, v8, v10
v_exp_f32 v8, v56
s_nop 3
s_setpc_b64 s[62:63]
RARE_3:
s_nop 15
v_max3_f32 v16, v56, v57, v58
v_max_f32 v16, v16, v59
v_mov_b32 v27, v16
s_nop 1
v_permlane32_swap_b32 v16, v27
v_max_f32 v16, v16, v27
v_mov_b32 v27, v16
s_nop 1
v_permlane16_swap_b32 v16, v27
v_max_f32 v16, v16, v27
v_ceil_f32 v16, v16
v_max_f32 v16, 0, v16
v_sub_f32 v17, 0, v16
v_exp_f32 v17, v17
v_sub_f32 v56, v56, v16
v_sub_f32 v68, v68, v16
v_sub_f32 v28, v28, v16
v_sub_f32 v57, v57, v16
v_sub_f32 v69, v69, v16
v_sub_f32 v29, v29, v16
v_sub_f32 v58, v58, v16
v_sub_f32 v70, v70, v16
v_sub_f32 v30, v30, v16
v_sub_f32 v59, v59, v16
v_sub_f32 v71, v71, v16
v_sub_f32 v31, v31, v16
v_mul_f32 v21, v17, v21
v_mul_f32 v152, v17, v152
v_mul_f32 v153, v17, v153
v_mul_f32 v154, v17, v154
v_mul_f32 v155, v17, v155
v_mul_f32 v156, v17, v156
v_mul_f32 v157, v17, v157
v_mul_f32 v158, v17, v158
v_mul_f32 v159, v17, v159
v_mul_f32 v160, v17, v160
v_mul_f32 v161, v17, v161
v_mul_f32 v162, v17, v162
v_mul_f32 v163, v17, v163
v_mul_f32 v164, v17, v164
v_mul_f32 v165, v17, v165
v_mul_f32 v166, v17, v166
v_mul_f32 v167, v17, v167
v_mul_f32 v168, v17, v168
v_mul_f32 v169, v17, v169
v_mul_f32 v170, v17, v170
v_mul_f32 v171, v17, v171
v_mul_f32 v172, v17, v172
v_mul_f32 v173, v17, v173
v_mul_f32 v174, v17, v174
v_mul_f32 v175, v17, v175
v_mul_f32 v176, v17, v176
v_mul_f32 v177, v17, v177
v_mul_f32 v178, v17, v178
v_mul_f32 v179, v17, v179
v_mul_f32 v180, v17, v180
v_mul_f32 v181, v17, v181
v_mul_f32 v182, v17, v182
v_mul_f32 v183, v17, v183
v_lshlrev_b32 v8, 16, v92
v_and_b32 v9, 0xffff0000, v92
v_mul_f32 v8, v17, v8
v_mul_f32 v9, v17, v9
v_cvt_pk_bf16_f32 v92, v8, v9
v_lshlrev_b32 v8, 16, v93
v_and_b32 v9, 0xffff0000, v93
v_mul_f32 v8, v17, v8
v_mul_f32 v9, v17, v9
v_cvt_pk_bf16_f32 v93, v8, v9
v_lshlrev_b32 v8, 16, v94
v_and_b32 v9, 0xffff0000, v94
v_mul_f32 v8, v17, v8
v_mul_f32 v9, v17, v9
v_cvt_pk_bf16_f32 v94, v8, v9
v_lshlrev_b32 v8, 16, v95
v_and_b32 v9, 0xffff0000, v95
v_mul_f32 v8, v17, v8
v_mul_f32 v9, v17, v9
v_cvt_pk_bf16_f32 v95, v8, v9
v_exp_f32 v8, v56
v_exp_f32 v9, v57
v_exp_f32 v10, v58
v_exp_f32 v11, v59
v_cvt_pk_bf16_f32 v80, v8, v9
v_cvt_pk_bf16_f32 v81, v10, v11
v_add_f32 v8, v8, v9
v_add_f32 v10, v10, v11
v_add_f32 v18, v8, v10
v_max3_f32 v16, v60, v61, v62
v_max_f32 v16, v16, v63
v_mov_b32 v27, v16
s_nop 1
v_permlane32_swap_b32 v16, v27
v_max_f32 v16, v16, v27
v_mov_b32 v27, v16
s_nop 1
v_permlane16_swap_b32 v16, v27
v_max_f32 v16, v16, v27
v_ceil_f32 v16, v16
v_max_f32 v16, 0, v16
v_sub_f32 v17, 0, v16
v_exp_f32 v17, v17
v_sub_f32 v60, v60, v16
v_sub_f32 v72, v72, v16
v_sub_f32 v32, v32, v16
v_sub_f32 v61, v61, v16
v_sub_f32 v73, v73, v16
v_sub_f32 v33, v33, v16
v_sub_f32 v62, v62, v16
v_sub_f32 v74, v74, v16
v_sub_f32 v34, v34, v16
v_sub_f32 v63, v63, v16
v_sub_f32 v75, v75, v16
v_sub_f32 v35, v35, v16
v_mul_f32 v22, v17, v22
v_mul_f32 v184, v17, v184
v_mul_f32 v185, v17, v185
v_mul_f32 v186, v17, v186
v_mul_f32 v187, v17, v187
v_mul_f32 v188, v17, v188
v_mul_f32 v189, v17, v189
v_mul_f32 v190, v17, v190
v_mul_f32 v191, v17, v191
v_mul_f32 v192, v17, v192
v_mul_f32 v193, v17, v193
v_mul_f32 v194, v17, v194
v_mul_f32 v195, v17, v195
v_mul_f32 v196, v17, v196
v_mul_f32 v197, v17, v197
v_mul_f32 v198, v17, v198
v_mul_f32 v199, v17, v199
v_mul_f32 v200, v17, v200
v_mul_f32 v201, v17, v201
v_mul_f32 v202, v17, v202
v_mul_f32 v203, v17, v203
v_mul_f32 v204, v17, v204
v_mul_f32 v205, v17, v205
v_mul_f32 v206, v17, v206
v_mul_f32 v207, v17, v207
v_mul_f32 v208, v17, v208
v_mul_f32 v209, v17, v209
v_mul_f32 v210, v17, v210
v_mul_f32 v211, v17, v211
v_mul_f32 v212, v17, v212
v_mul_f32 v213, v17, v213
v_mul_f32 v214, v17, v214
v_mul_f32 v215, v17, v215
v_lshlrev_b32 v8, 16, v96
v_and_b32 v9, 0xffff0000, v96
v_mul_f32 v8, v17, v8
v_mul_f32 v9, v17, v9
v_cvt_pk_bf16_f32 v96, v8, v9
v_lshlrev_b32 v8, 16, v97
v_and_b32 v9, 0xffff0000, v97
v_mul_f32 v8, v17, v8
v_mul_f32 v9, v17, v9
v_cvt_pk_bf16_f32 v97, v8, v9
v_lshlrev_b32 v8, 16, v98
v_and_b32 v9, 0xffff0000, v98
v_mul_f32 v8, v17, v8
v_mul_f32 v9, v17, v9
v_cvt_pk_bf16_f32 v98, v8, v9
v_lshlrev_b32 v8, 16, v99
v_and_b32 v9, 0xffff0000, v99
v_mul_f32 v8, v17, v8
v_mul_f32 v9, v17, v9
v_cvt_pk_bf16_f32 v99, v8, v9
v_exp_f32 v8, v60
v_exp_f32 v9, v61
v_exp_f32 v10, v62
v_exp_f32 v11, v63
v_cvt_pk_bf16_f32 v84, v8, v9
v_cvt_pk_bf16_f32 v85, v10, v11
v_add_f32 v8, v8, v9
v_add_f32 v10, v10, v11
v_add_f32 v19, v8, v10
v_max3_f32 v16, v64, v65, v66
v_max_f32 v16, v16, v67
v_mov_b32 v27, v16
s_nop 1
v_permlane32_swap_b32 v16, v27
v_max_f32 v16, v16, v27
v_mov_b32 v27, v16
s_nop 1
v_permlane16_swap_b32 v16, v27
v_max_f32 v16, v16, v27
v_ceil_f32 v16, v16
v_max_f32 v16, 0, v16
v_sub_f32 v17, 0, v16
v_exp_f32 v17, v17
v_sub_f32 v64, v64, v16
v_sub_f32 v76, v76, v16
v_sub_f32 v36, v36, v16
v_sub_f32 v65, v65, v16
v_sub_f32 v77, v77, v16
v_sub_f32 v37, v37, v16
v_sub_f32 v66, v66, v16
v_sub_f32 v78, v78, v16
v_sub_f32 v38, v38, v16
v_sub_f32 v67, v67, v16
v_sub_f32 v79, v79, v16
v_sub_f32 v39, v39, v16
v_mul_f32 v23, v17, v23
v_mul_f32 v216, v17, v216
v_mul_f32 v217, v17, v217
v_mul_f32 v218, v17, v218
v_mul_f32 v219, v17, v219
v_mul_f32 v220, v17, v220
v_mul_f32 v221, v17, v221
v_mul_f32 v222, v17, v222
v_mul_f32 v223, v17, v223
v_mul_f32 v224, v17, v224
v_mul_f32 v225, v17, v225
v_mul_f32 v226, v17, v226
v_mul_f32 v227, v17, v227
v_mul_f32 v228, v17, v228
v_mul_f32 v229, v17, v229
v_mul_f32 v230, v17, v230
v_mul_f32 v231, v17, v231
v_mul_f32 v232, v17, v232
v_mul_f32 v233, v17, v233
v_mul_f32 v234, v17, v234
v_mul_f32 v235, v17, v235
v_mul_f32 v236, v17, v236
v_mul_f32 v237, v17, v237
v_mul_f32 v238, v17, v238
v_mul_f32 v239, v17, v239
v_mul_f32 v240, v17, v240
v_mul_f32 v241, v17, v241
v_mul_f32 v242, v17, v242
v_mul_f32 v243, v17, v243
v_mul_f32 v244, v17, v244
v_mul_f32 v245, v17, v245
v_mul_f32 v246, v17, v246
v_mul_f32 v247, v17, v247
v_lshlrev_b32 v8, 16, v100
v_and_b32 v9, 0xffff0000, v100
v_mul_f32 v8, v17, v8
v_mul_f32 v9, v17, v9
v_cvt_pk_bf16_f32 v100, v8, v9
v_lshlrev_b32 v8, 16, v101
v_and_b32 v9, 0xffff0000, v101
v_mul_f32 v8, v17, v8
v_mul_f32 v9, v17, v9
v_cvt_pk_bf16_f32 v101, v8, v9
v_lshlrev_b32 v8, 16, v102
v_and_b32 v9, 0xffff0000, v102
v_mul_f32 v8, v17, v8
v_mul_f32 v9, v17, v9
v_cvt_pk_bf16_f32 v102, v8, v9
v_lshlrev_b32 v8, 16, v103
v_and_b32 v9, 0xffff0000, v103
v_mul_f32 v8, v17, v8
v_mul_f32 v9, v17, v9
v_cvt_pk_bf16_f32 v103, v8, v9
v_exp_f32 v8, v64
v_exp_f32 v9, v65
v_exp_f32 v10, v66
v_exp_f32 v11, v67
v_cvt_pk_bf16_f32 v88, v8, v9
v_cvt_pk_bf16_f32 v89, v10, v11
v_add_f32 v8, v8, v9
v_add_f32 v10, v10, v11
v_add_f32 v20, v8, v10
v_exp_f32 v8, v68
s_nop 3
s_setpc_b64 s[62:63]
RARE_4:
s_nop 15
v_max3_f32 v16, v68, v69, v70
v_max_f32 v16, v16, v71
v_mov_b32 v27, v16
s_nop 1
v_permlane32_swap_b32 v16, v27
v_max_f32 v16, v16, v27
v_mov_b32 v27, v16
s_nop 1
v_permlane16_swap_b32 v16, v27
v_max_f32 v16, v16, v27
v_ceil_f32 v16, v16
v_max_f32 v16, 0, v16
v_sub_f32 v17, 0, v16
v_exp_f32 v17, v17
v_sub_f32 v68, v68, v16
v_sub_f32 v56, v56, v16
v_sub_f32 v28, v28, v16
v_sub_f32 v69, v69, v16
v_sub_f32 v57, v57, v16
v_sub_f32 v29, v29, v16
v_sub_f32 v70, v70, v16
v_sub_f32 v58, v58, v16
v_sub_f32 v30, v30, v16
v_sub_f32 v71, v71, v16
v_sub_f32 v59, v59, v16
v_sub_f32 v31, v31, v16
v_mul_f32 v21, v17, v21
v_mul_f32 v152, v17, v152
v_mul_f32 v153, v17, v153
v_mul_f32 v154, v17, v154
v_mul_f32 v155, v17, v155
v_mul_f32 v156, v17, v156
v_mul_f32 v157, v17, v157
v_mul_f32 v158, v17, v158
v_mul_f32 v159, v17, v159
v_mul_f32 v160, v17, v160
v_mul_f32 v161, v17, v161
v_mul_f32 v162, v17, v162
v_mul_f32 v163, v17, v163
v_mul_f32 v164, v17, v164
v_mul_f32 v165, v17, v165
v_mul_f32 v166, v17, v166
v_mul_f32 v167, v17, v167
v_mul_f32 v168, v17, v168
v_mul_f32 v169, v17, v169
v_mul_f32 v170, v17, v170
v_mul_f32 v171, v17, v171
v_mul_f32 v172, v17, v172
v_mul_f32 v173, v17, v173
v_mul_f32 v174, v17, v174
v_mul_f32 v175, v17, v175
v_mul_f32 v176, v17, v176
v_mul_f32 v177, v17, v177
v_mul_f32 v178, v17, v178
v_mul_f32 v179, v17, v179
v_mul_f32 v180, v17, v180
v_mul_f32 v181, v17, v181
v_mul_f32 v182, v17, v182
v_mul_f32 v183, v17, v183
v_lshlrev_b32 v8, 16, v80
v_and_b32 v9, 0xffff0000, v80
v_mul_f32 v8, v17, v8
v_mul_f32 v9, v17, v9
v_cvt_pk_bf16_f32 v80, v8, v9
v_lshlrev_b32 v8, 16, v81
v_and_b32 v9, 0xffff0000, v81
v_mul_f32 v8, v17, v8
v_mul_f32 v9, v17, v9
v_cvt_pk_bf16_f32 v81, v8, v9
v_exp_f32 v8, v68
v_exp_f32 v9, v69
v_exp_f32 v10, v70
v_exp_f32 v11, v71
v_cvt_pk_bf16_f32 v82, v8, v9
v_cvt_pk_bf16_f32 v83, v10, v11
v_add_f32 v8, v8, v9
v_add_f32 v10, v10, v11
v_add_f32 v18, v8, v10
v_max3_f32 v16, v72, v73, v74
v_max_f32 v16, v16, v75
v_mov_b32 v27, v16
s_nop 1
v_permlane32_swap_b32 v16, v27
v_max_f32 v16, v16, v27
v_mov_b32 v27, v16
s_nop 1
v_permlane16_swap_b32 v16, v27
v_max_f32 v16, v16, v27
v_ceil_f32 v16, v16
v_max_f32 v16, 0, v16
v_sub_f32 v17, 0, v16
v_exp_f32 v17, v17
v_sub_f32 v72, v72, v16
v_sub_f32 v60, v60, v16
v_sub_f32 v32, v32, v16
v_sub_f32 v73, v73, v16
v_sub_f32 v61, v61, v16
v_sub_f32 v33, v33, v16
v_sub_f32 v74, v74, v16
v_sub_f32 v62, v62, v16
v_sub_f32 v34, v34, v16
v_sub_f32 v75, v75, v16
v_sub_f32 v63, v63, v16
v_sub_f32 v35, v35, v16
v_mul_f32 v22, v17, v22
v_mul_f32 v184, v17, v184
v_mul_f32 v185, v17, v185
v_mul_f32 v186, v17, v186
v_mul_f32 v187, v17, v187
v_mul_f32 v188, v17, v188
v_mul_f32 v189, v17, v189
v_mul_f32 v190, v17, v190
v_mul_f32 v191, v17, v191
v_mul_f32 v192, v17, v192
v_mul_f32 v193, v17, v193
v_mul_f32 v194, v17, v194
v_mul_f32 v195, v17, v195
v_mul_f32 v196, v17, v196
v_mul_f32 v197, v17, v197
v_mul_f32 v198, v17, v198
v_mul_f32 v199, v17, v199
v_mul_f32 v200, v17, v200
v_mul_f32 v201, v17, v201
v_mul_f32 v202, v17, v202
v_mul_f32 v203, v17, v203
v_mul_f32 v204, v17, v204
v_mul_f32 v205, v17, v205
v_mul_f32 v206, v17, v206
v_mul_f32 v207, v17, v207
v_mul_f32 v208, v17, v208
v_mul_f32 v209, v17, v209
v_mul_f32 v210, v17, v210
v_mul_f32 v211, v17, v211
v_mul_f32 v212, v17, v212
v_mul_f32 v213, v17, v213
v_mul_f32 v214, v17, v214
v_mul_f32 v215, v17, v215
v_lshlrev_b32 v8, 16, v84
v_and_b32 v9, 0xffff0000, v84
v_mul_f32 v8, v17, v8
v_mul_f32 v9, v17, v9
v_cvt_pk_bf16_f32 v84, v8, v9
v_lshlrev_b32 v8, 16, v85
v_and_b32 v9, 0xffff0000, v85
v_mul_f32 v8, v17, v8
v_mul_f32 v9, v17, v9
v_cvt_pk_bf16_f32 v85, v8, v9
v_exp_f32 v8, v72
v_exp_f32 v9, v73
v_exp_f32 v10, v74
v_exp_f32 v11, v75
v_cvt_pk_bf16_f32 v86, v8, v9
v_cvt_pk_bf16_f32 v87, v10, v11
v_add_f32 v8, v8, v9
v_add_f32 v10, v10, v11
v_add_f32 v19, v8, v10
v_max3_f32 v16, v76, v77, v78
v_max_f32 v16, v16, v79
v_mov_b32 v27, v16
s_nop 1
v_permlane32_swap_b32 v16, v27
v_max_f32 v16, v16, v27
v_mov_b32 v27, v16
s_nop 1
v_permlane16_swap_b32 v16, v27
v_max_f32 v16, v16, v27
v_ceil_f32 v16, v16
v_max_f32 v16, 0, v16
v_sub_f32 v17, 0, v16
v_exp_f32 v17, v17
v_sub_f32 v76, v76, v16
v_sub_f32 v64, v64, v16
v_sub_f32 v36, v36, v16
v_sub_f32 v77, v77, v16
v_sub_f32 v65, v65, v16
v_sub_f32 v37, v37, v16
v_sub_f32 v78, v78, v16
v_sub_f32 v66, v66, v16
v_sub_f32 v38, v38, v16
v_sub_f32 v79, v79, v16
v_sub_f32 v67, v67, v16
v_sub_f32 v39, v39, v16
v_mul_f32 v23, v17, v23
v_mul_f32 v216, v17, v216
v_mul_f32 v217, v17, v217
v_mul_f32 v218, v17, v218
v_mul_f32 v219, v17, v219
v_mul_f32 v220, v17, v220
v_mul_f32 v221, v17, v221
v_mul_f32 v222, v17, v222
v_mul_f32 v223, v17, v223
v_mul_f32 v224, v17, v224
v_mul_f32 v225, v17, v225
v_mul_f32 v226, v17, v226
v_mul_f32 v227, v17, v227
v_mul_f32 v228, v17, v228
v_mul_f32 v229, v17, v229
v_mul_f32 v230, v17, v230
v_mul_f32 v231, v17, v231
v_mul_f32 v232, v17, v232
v_mul_f32 v233, v17, v233
v_mul_f32 v234, v17, v234
v_mul_f32 v235, v17, v235
v_mul_f32 v236, v17, v236
v_mul_f32 v237, v17, v237
v_mul_f32 v238, v17, v238
v_mul_f32 v239, v17, v239
v_mul_f32 v240, v17, v240
v_mul_f32 v241, v17, v241
v_mul_f32 v242, v17, v242
v_mul_f32 v243, v17, v243
v_mul_f32 v244, v17, v244
v_mul_f32 v245, v17, v245
v_mul_f32 v246, v17, v246
v_mul_f32 v247, v17, v247
v_lshlrev_b32 v8, 16, v88
v_and_b32 v9, 0xffff0000, v88
v_mul_f32 v8, v17, v8
v_mul_f32 v9, v17, v9
v_cvt_pk_bf16_f32 v88, v8, v9
v_lshlrev_b32 v8, 16, v89
v_and_b32 v9, 0xffff0000, v89
v_mul_f32 v8, v17, v8
v_mul_f32 v9, v17, v9
v_cvt_pk_bf16_f32 v89, v8, v9
v_exp_f32 v8, v76
v_exp_f32 v9, v77
v_exp_f32 v10, v78
v_exp_f32 v11, v79
v_cvt_pk_bf16_f32 v90, v8, v9
v_cvt_pk_bf16_f32 v91, v10, v11
v_add_f32 v8, v8, v9
v_add_f32 v10, v10, v11
v_add_f32 v20, v8, v10
v_exp_f32 v8, v56
s_nop 3
s_setpc_b64 s[62:63]
RARE_5:
s_nop 15
v_max3_f32 v16, v68, v69, v70
v_max_f32 v16, v16, v71
v_mov_b32 v27, v16
s_nop 1
v_permlane32_swap_b32 v16, v27
v_max_f32 v16, v16, v27
v_mov_b32 v27, v16
s_nop 1
v_permlane16_swap_b32 v16, v27
v_max_f32 v16, v16, v27
v_ceil_f32 v16, v16
v_max_f32 v16, 0, v16
v_sub_f32 v17, 0, v16
v_exp_f32 v17, v17
v_sub_f32 v68, v68, v16
v_sub_f32 v28, v28, v16
v_sub_f32 v69, v69, v16
v_sub_f32 v29, v29, v16
v_sub_f32 v70, v70, v16
v_sub_f32 v30, v30, v16
v_sub_f32 v71, v71, v16
v_sub_f32 v31, v31, v16
v_mul_f32 v21, v17, v21
v_mul_f32 v152, v17, v152
v_mul_f32 v153, v17, v153
v_mul_f32 v154, v17, v154
v_mul_f32 v155, v17, v155
v_mul_f32 v156, v17, v156
v_mul_f32 v157, v17, v157
v_mul_f32 v158, v17, v158
v_mul_f32 v159, v17, v159
v_mul_f32 v160, v17, v160
v_mul_f32 v161, v17, v161
v_mul_f32 v162, v17, v162
v_mul_f32 v163, v17, v163
v_mul_f32 v164, v17, v164
v_mul_f32 v165, v17, v165
v_mul_f32 v166, v17, v166
v_mul_f32 v167, v17, v167
v_mul_f32 v168, v17, v168
v_mul_f32 v169, v17, v169
v_mul_f32 v170, v17, v170
v_mul_f32 v171, v17, v171
v_mul_f32 v172, v17, v172
v_mul_f32 v173, v17, v173
v_mul_f32 v174, v17, v174
v_mul_f32 v175, v17, v175
v_mul_f32 v176, v17, v176
v_mul_f32 v177, v17, v177
v_mul_f32 v178, v17, v178
v_mul_f32 v179, v17, v179
v_mul_f32 v180, v17, v180
v_mul_f32 v181, v17, v181
v_mul_f32 v182, v17, v182
v_mul_f32 v183, v17, v183
v_lshlrev_b32 v8, 16, v92
v_and_b32 v9, 0xffff0000, v92
v_mul_f32 v8, v17, v8
v_mul_f32 v9, v17, v9
v_cvt_pk_bf16_f32 v92, v8, v9
v_lshlrev_b32 v8, 16, v93
v_and_b32 v9, 0xffff0000, v93
v_mul_f32 v8, v17, v8
v_mul_f32 v9, v17, v9
v_cvt_pk_bf16_f32 v93, v8, v9
v_exp_f32 v8, v68
v_exp_f32 v9, v69
v_exp_f32 v10, v70
v_exp_f32 v11, v71
v_cvt_pk_bf16_f32 v94, v8, v9
v_cvt_pk_bf16_f32 v95, v10, v11
v_add_f32 v8, v8, v9
v_add_f32 v10, v10, v11
v_add_f32 v18, v8, v10
v_max3_f32 v16, v72, v73, v74
v_max_f32 v16, v16, v75
v_mov_b32 v27, v16
s_nop 1
v_permlane32_swap_b32 v16, v27
v_max_f32 v16, v16, v27
v_mov_b32 v27, v16
s_nop 1
v_permlane16_swap_b32 v16, v27
v_max_f32 v16, v16, v27
v_ceil_f32 v16, v16
v_max_f32 v16, 0, v16
v_sub_f32 v17, 0, v16
v_exp_f32 v17, v17
v_sub_f32 v72, v72, v16
v_sub_f32 v32, v32, v16
v_sub_f32 v73, v73, v16
v_sub_f32 v33, v33, v16
v_sub_f32 v74, v74, v16
v_sub_f32 v34, v34, v16
v_sub_f32 v75, v75, v16
v_sub_f32 v35, v35, v16
v_mul_f32 v22, v17, v22
v_mul_f32 v184, v17, v184
v_mul_f32 v185, v17, v185
v_mul_f32 v186, v17, v186
v_mul_f32 v187, v17, v187
v_mul_f32 v188, v17, v188
v_mul_f32 v189, v17, v189
v_mul_f32 v190, v17, v190
v_mul_f32 v191, v17, v191
v_mul_f32 v192, v17, v192
v_mul_f32 v193, v17, v193
v_mul_f32 v194, v17, v194
v_mul_f32 v195, v17, v195
v_mul_f32 v196, v17, v196
v_mul_f32 v197, v17, v197
v_mul_f32 v198, v17, v198
v_mul_f32 v199, v17, v199
v_mul_f32 v200, v17, v200
v_mul_f32 v201, v17, v201
v_mul_f32 v202, v17, v202
v_mul_f32 v203, v17, v203
v_mul_f32 v204, v17, v204
v_mul_f32 v205, v17, v205
v_mul_f32 v206, v17, v206
v_mul_f32 v207, v17, v207
v_mul_f32 v208, v17, v208
v_mul_f32 v209, v17, v209
v_mul_f32 v210, v17, v210
v_mul_f32 v211, v17, v211
v_mul_f32 v212, v17, v212
v_mul_f32 v213, v17, v213
v_mul_f32 v214, v17, v214
v_mul_f32 v215, v17, v215
v_lshlrev_b32 v8, 16, v96
v_and_b32 v9, 0xffff0000, v96
v_mul_f32 v8, v17, v8
v_mul_f32 v9, v17, v9
v_cvt_pk_bf16_f32 v96, v8, v9
v_lshlrev_b32 v8, 16, v97
v_and_b32 v9, 0xffff0000, v97
v_mul_f32 v8, v17, v8
v_mul_f32 v9, v17, v9
v_cvt_pk_bf16_f32 v97, v8, v9
v_exp_f32 v8, v72
v_exp_f32 v9, v73
v_exp_f32 v10, v74
v_exp_f32 v11, v75
v_cvt_pk_bf16_f32 v98, v8, v9
v_cvt_pk_bf16_f32 v99, v10, v11
v_add_f32 v8, v8, v9
v_add_f32 v10, v10, v11
v_add_f32 v19, v8, v10
v_max3_f32 v16, v76, v77, v78
v_max_f32 v16, v16, v79
v_mov_b32 v27, v16
s_nop 1
v_permlane32_swap_b32 v16, v27
v_max_f32 v16, v16, v27
v_mov_b32 v27, v16
s_nop 1
v_permlane16_swap_b32 v16, v27
v_max_f32 v16, v16, v27
v_ceil_f32 v16, v16
v_max_f32 v16, 0, v16
v_sub_f32 v17, 0, v16
v_exp_f32 v17, v17
v_sub_f32 v76, v76, v16
v_sub_f32 v36, v36, v16
v_sub_f32 v77, v77, v16
v_sub_f32 v37, v37, v16
v_sub_f32 v78, v78, v16
v_sub_f32 v38, v38, v16
v_sub_f32 v79, v79, v16
v_sub_f32 v39, v39, v16
v_mul_f32 v23, v17, v23
v_mul_f32 v216, v17, v216
v_mul_f32 v217, v17, v217
v_mul_f32 v218, v17, v218
v_mul_f32 v219, v17, v219
v_mul_f32 v220, v17, v220
v_mul_f32 v221, v17, v221
v_mul_f32 v222, v17, v222
v_mul_f32 v223, v17, v223
v_mul_f32 v224, v17, v224
v_mul_f32 v225, v17, v225
v_mul_f32 v226, v17, v226
v_mul_f32 v227, v17, v227
v_mul_f32 v228, v17, v228
v_mul_f32 v229, v17, v229
v_mul_f32 v230, v17, v230
v_mul_f32 v231, v17, v231
v_mul_f32 v232, v17, v232
v_mul_f32 v233, v17, v233
v_mul_f32 v234, v17, v234
v_mul_f32 v235, v17, v235
v_mul_f32 v236, v17, v236
v_mul_f32 v237, v17, v237
v_mul_f32 v238, v17, v238
v_mul_f32 v239, v17, v239
v_mul_f32 v240, v17, v240
v_mul_f32 v241, v17, v241
v_mul_f32 v242, v17, v242
v_mul_f32 v243, v17, v243
v_mul_f32 v244, v17, v244
v_mul_f32 v245, v17, v245
v_mul_f32 v246, v17, v246
v_mul_f32 v247, v17, v247
v_lshlrev_b32 v8, 16, v100
v_and_b32 v9, 0xffff0000, v100
v_mul_f32 v8, v17, v8
v_mul_f32 v9, v17, v9
v_cvt_pk_bf16_f32 v100, v8, v9
v_lshlrev_b32 v8, 16, v101
v_and_b32 v9, 0xffff0000, v101
v_mul_f32 v8, v17, v8
v_mul_f32 v9, v17, v9
v_cvt_pk_bf16_f32 v101, v8, v9
v_exp_f32 v8, v76
v_exp_f32 v9, v77
v_exp_f32 v10, v78
v_exp_f32 v11, v79
v_cvt_pk_bf16_f32 v102, v8, v9
v_cvt_pk_bf16_f32 v103, v10, v11
v_add_f32 v8, v8, v9
v_add_f32 v10, v10, v11
v_add_f32 v20, v8, v10
v_exp_f32 v8, v56
s_nop 3
s_setpc_b64 s[62:63]
L_A_tail:
s_waitcnt lgkmcnt(4)
v_mfma_f32_16x16x32_bf16 v[56:59], v[40:43], v[104:107], v[28:31]
v_exp_f32 v10, v70
v_mfma_f32_16x16x32_bf16 v[60:63], v[40:43], v[120:123], v[32:35]
ds_read_b64_tr_b16 v[54:55], v4 offset:45568
v_add_f32 v21, v21, v18
v_add_f32 v22, v22, v19
v_mfma_f32_16x16x32_bf16 v[64:67], v[40:43], v[136:139], v[36:39]
s_waitcnt lgkmcnt(3)
v_exp_f32 v11, v71
v_mfma_f32_16x16x32_bf16 v[168:171], v[44:47], v[92:95], v[168:171]
ds_read_b128 v[40:43], v2 offset:25088
v_add_f32 v16, v8, v9
v_cvt_pk_bf16_f32 v82, v8, v9
v_mfma_f32_16x16x32_bf16 v[200:203], v[44:47], v[96:99], v[200:203]
v_exp_f32 v12, v72
v_mfma_f32_16x16x32_bf16 v[232:235], v[44:47], v[100:103], v[232:235]
s_waitcnt lgkmcnt(3)
ds_read_b64_tr_b16 v[44:45], v3 offset:41728
v_add_f32 v17, v10, v11
v_cvt_pk_bf16_f32 v83, v10, v11
v_mfma_f32_16x16x32_bf16 v[56:59], v[48:51], v[108:111], v[56:59]
s_barrier
v_exp_f32 v13, v73
v_mfma_f32_16x16x32_bf16 v[60:63], v[48:51], v[124:127], v[60:63]
ds_read_b64_tr_b16 v[46:47], v3 offset:45824
v_add_f32 v23, v23, v20
v_add_f32 v18, v16, v17
v_mfma_f32_16x16x32_bf16 v[64:67], v[48:51], v[140:143], v[64:67]
s_waitcnt lgkmcnt(3)
v_exp_f32 v14, v74
v_mfma_f32_16x16x32_bf16 v[172:175], v[52:55], v[92:95], v[172:175]
ds_read_b128 v[48:51], v2 offset:25344
v_add_f32 v16, v12, v13
v_mfma_f32_16x16x32_bf16 v[204:207], v[52:55], v[96:99], v[204:207]
v_exp_f32 v15, v75
v_mfma_f32_16x16x32_bf16 v[236:239], v[52:55], v[100:103], v[236:239]
s_waitcnt lgkmcnt(3)
ds_read_b64_tr_b16 v[52:53], v4 offset:41728
v_cvt_pk_bf16_f32 v86, v12, v13
v_mfma_f32_16x16x32_bf16 v[56:59], v[40:43], v[112:115], v[56:59]
v_exp_f32 v8, v76
v_mfma_f32_16x16x32_bf16 v[60:63], v[40:43], v[128:131], v[60:63]
ds_read_b64_tr_b16 v[54:55], v4 offset:45824
v_add_f32 v17, v14, v15
v_cvt_pk_bf16_f32 v87, v14, v15
v_mfma_f32_16x16x32_bf16 v[64:67], v[40:43], v[144:147], v[64:67]
s_waitcnt lgkmcnt(3)
v_exp_f32 v9, v77
v_mfma_f32_16x16x32_bf16 v[176:179], v[44:47], v[92:95], v[176:179]
ds_read_b128 v[40:43], v2 offset:28672
v_add_f32 v19, v16, v17
v_mfma_f32_16x16x32_bf16 v[208:211], v[44:47], v[96:99], v[208:211]
v_exp_f32 v10, v78
v_mfma_f32_16x16x32_bf16 v[240:243], v[44:47], v[100:103], v[240:243]
s_waitcnt lgkmcnt(3)
ds_read_b64_tr_b16 v[44:45], v3 offset:49152
v_add_f32 v16, v8, v9
v_cvt_pk_bf16_f32 v90, v8, v9
v_mfma_f32_16x16x32_bf16 v[56:59], v[48:51], v[116:119], v[56:59]
v_exp_f32 v11, v79
v_mfma_f32_16x16x32_bf16 v[60:63], v[48:51], v[132:135], v[60:63]
ds_read_b64_tr_b16 v[46:47], v3 offset:53248
v_add_f32 v17, v10, v11
v_add_f32 v20, v16, v17
v_mfma_f32_16x16x32_bf16 v[64:67], v[48:51], v[148:151], v[64:67]
s_waitcnt lgkmcnt(3)
v_max3_f32 v27, v18, v19, v20
v_cmp_lt_f32 vcc, s60, v27
v_mfma_f32_16x16x32_bf16 v[180:183], v[52:55], v[92:95], v[180:183]
ds_read_b128 v[48:51], v2 offset:28928
v_cvt_pk_bf16_f32 v91, v10, v11
v_mfma_f32_16x16x32_bf16 v[212:215], v[52:55], v[96:99], v[212:215]
v_exp_f32 v8, v56
v_mfma_f32_16x16x32_bf16 v[244:247], v[52:55], v[100:103], v[244:247]
s_waitcnt lgkmcnt(3)
ds_read_b64_tr_b16 v[52:53], v4 offset:49152
s_cbranch_vccnz TR_Yt62
RET_Yt62:
v_exp_f32 v9, v57
v_mfma_f32_16x16x32_bf16 v[68:71], v[40:43], v[104:107], v[28:31]
v_exp_f32 v10, v58
v_mfma_f32_16x16x32_bf16 v[72:75], v[40:43], v[120:123], v[32:35]
ds_read_b64_tr_b16 v[54:55], v4 offset:53248
v_add_f32 v21, v21, v18
v_add_f32 v22, v22, v19
v_mfma_f32_16x16x32_bf16 v[76:79], v[40:43], v[136:139], v[36:39]
s_waitcnt lgkmcnt(3)
v_exp_f32 v11, v59
v_mfma_f32_16x16x32_bf16 v[152:155], v[44:47], v[80:83], v[152:155]
ds_read_b128 v[40:43], v2 offset:29184
ds_read_b128 v[104:107], v5
v_add_f32 v16, v8, v9
v_cvt_pk_bf16_f32 v92, v8, v9
v_mfma_f32_16x16x32_bf16 v[184:187], v[44:47], v[84:87], v[184:187]
ds_read_b128 v[120:123], v5 offset:4096
v_exp_f32 v12, v60
v_mfma_f32_16x16x32_bf16 v[216:219], v[44:47], v[88:91], v[216:219]
s_waitcnt lgkmcnt(5)
ds_read_b64_tr_b16 v[44:45], v3 offset:49408
ds_read_b128 v[136:139], v5 offset:8192
v_add_f32 v17, v10, v11
v_cvt_pk_bf16_f32 v93, v10, v11
v_mfma_f32_16x16x32_bf16 v[68:71], v[48:51], v[108:111], v[68:71]
v_exp_f32 v13, v61
v_mfma_f32_16x16x32_bf16 v[72:75], v[48:51], v[124:127], v[72:75]
ds_read_b64_tr_b16 v[46:47], v3 offset:53504
v_add_f32 v23, v23, v20
v_add_f32 v18, v16, v17
v_mfma_f32_16x16x32_bf16 v[76:79], v[48:51], v[140:143], v[76:79]
s_waitcnt lgkmcnt(6)
v_exp_f32 v14, v62
v_mfma_f32_16x16x32_bf16 v[156:159], v[52:55], v[80:83], v[156:159]
ds_read_b128 v[48:51], v2 offset:29440
ds_read_b128 v[108:111], v5 offset:1024
v_add_f32 v16, v12, v13
v_mfma_f32_16x16x32_bf16 v[188:191], v[52:55], v[84:87], v[188:191]
ds_read_b128 v[124:127], v5 offset:5120
v_exp_f32 v15, v63
v_mfma_f32_16x16x32_bf16 v[220:223], v[52:55], v[88:91], v[220:223]
s_waitcnt lgkmcnt(8)
ds_read_b64_tr_b16 v[52:53], v4 offset:49408
ds_read_b128 v[140:143], v5 offset:9216
v_cvt_pk_bf16_f32 v96, v12, v13
v_mfma_f32_16x16x32_bf16 v[68:71], v[40:43], v[112:115], v[68:71]
v_exp_f32 v8, v64
v_mfma_f32_16x16x32_bf16 v[72:75], v[40:43], v[128:131], v[72:75]
ds_read_b64_tr_b16 v[54:55], v4 offset:53504
v_add_f32 v17, v14, v15
v_cvt_pk_bf16_f32 v97, v14, v15
v_mfma_f32_16x16x32_bf16 v[76:79], v[40:43], v[144:147], v[76:79]
s_waitcnt lgkmcnt(6)
v_exp_f32 v9, v65
v_mfma_f32_16x16x32_bf16 v[160:163], v[44:47], v[80:83], v[160:163]
ds_read_b128 v[112:115], v5 offset:2048
v_add_f32 v19, v16, v17
v_mfma_f32_16x16x32_bf16 v[192:195], v[44:47], v[84:87], v[192:195]
ds_read_b128 v[128:131], v5 offset:6144
v_exp_f32 v10, v66
v_mfma_f32_16x16x32_bf16 v[224:227], v[44:47], v[88:91], v[224:227]
s_waitcnt lgkmcnt(7)
ds_read_b64_tr_b16 v[44:45], v3 offset:49664
ds_read_b128 v[144:147], v5 offset:10240
v_add_f32 v16, v8, v9
v_cvt_pk_bf16_f32 v100, v8, v9
v_mfma_f32_16x16x32_bf16 v[68:71], v[48:51], v[116:119], v[68:71]
v_exp_f32 v11, v67
v_mfma_f32_16x16x32_bf16 v[72:75], v[48:51], v[132:135], v[72:75]
ds_read_b64_tr_b16 v[46:47], v3 offset:53760
v_add_f32 v17, v10, v11
v_add_f32 v20, v16, v17
v_mfma_f32_16x16x32_bf16 v[76:79], v[48:51], v[148:151], v[76:79]
s_waitcnt lgkmcnt(5)
v_max3_f32 v27, v18, v19, v20
v_cmp_lt_f32 vcc, s60, v27
v_mfma_f32_16x16x32_bf16 v[164:167], v[52:55], v[80:83], v[164:167]
ds_read_b128 v[116:119], v5 offset:3072
v_cvt_pk_bf16_f32 v101, v10, v11
v_mfma_f32_16x16x32_bf16 v[196:199], v[52:55], v[84:87], v[196:199]
ds_read_b128 v[132:135], v5 offset:7168
v_exp_f32 v8, v68
v_mfma_f32_16x16x32_bf16 v[228:231], v[52:55], v[88:91], v[228:231]
ds_read_b64_tr_b16 v[52:53], v4 offset:49664
ds_read_b128 v[148:151], v5 offset:11264
s_cbranch_vccnz TR_Xt62
RET_Xt62:
v_exp_f32 v9, v69
v_exp_f32 v10, v70
ds_read_b64_tr_b16 v[54:55], v4 offset:53760
v_add_f32 v21, v21, v18
v_add_f32 v22, v22, v19
v_exp_f32 v11, v71
s_waitcnt lgkmcnt(5)
v_mfma_f32_16x16x32_bf16 v[168:171], v[44:47], v[80:83], v[168:171]
v_add_f32 v16, v8, v9
v_cvt_pk_bf16_f32 v94, v8, v9
v_mfma_f32_16x16x32_bf16 v[200:203], v[44:47], v[84:87], v[200:203]
v_exp_f32 v12, v72
v_mfma_f32_16x16x32_bf16 v[232:235], v[44:47], v[88:91], v[232:235]
ds_read_b64_tr_b16 v[44:45], v3 offset:49920
v_add_f32 v17, v10, v11
v_cvt_pk_bf16_f32 v95, v10, v11
s_barrier
v_exp_f32 v13, v73
ds_read_b64_tr_b16 v[46:47], v3 offset:54016
v_add_f32 v23, v23, v20
v_add_f32 v18, v16, v17
v_exp_f32 v14, v74
s_waitcnt lgkmcnt(2)
v_mfma_f32_16x16x32_bf16 v[172:175], v[52:55], v[80:83], v[172:175]
v_add_f32 v16, v12, v13
v_mfma_f32_16x16x32_bf16 v[204:207], v[52:55], v[84:87], v[204:207]
v_exp_f32 v15, v75
v_mfma_f32_16x16x32_bf16 v[236:239], v[52:55], v[88:91], v[236:239]
ds_read_b64_tr_b16 v[52:53], v4 offset:49920
v_cvt_pk_bf16_f32 v98, v12, v13
v_exp_f32 v8, v76
ds_read_b64_tr_b16 v[54:55], v4 offset:54016
v_add_f32 v17, v14, v15
v_cvt_pk_bf16_f32 v99, v14, v15
v_exp_f32 v9, v77
s_waitcnt lgkmcnt(2)
v_mfma_f32_16x16x32_bf16 v[176:179], v[44:47], v[80:83], v[176:179]
v_add_f32 v19, v16, v17
v_mfma_f32_16x16x32_bf16 v[208:211], v[44:47], v[84:87], v[208:211]
v_exp_f32 v10, v78
v_mfma_f32_16x16x32_bf16 v[240:243], v[44:47], v[88:91], v[240:243]
ds_read_b64_tr_b16 v[44:45], v3 offset:57344
v_add_f32 v16, v8, v9
v_cvt_pk_bf16_f32 v102, v8, v9
v_exp_f32 v11, v79
ds_read_b64_tr_b16 v[46:47], v3 offset:61440
v_add_f32 v17, v10, v11
v_add_f32 v20, v16, v17
v_max3_f32 v27, v18, v19, v20
v_cmp_lt_f32 vcc, s60, v27
s_waitcnt lgkmcnt(2)
v_mfma_f32_16x16x32_bf16 v[180:183], v[52:55], v[80:83], v[180:183]
v_cvt_pk_bf16_f32 v103, v10, v11
v_mfma_f32_16x16x32_bf16 v[212:215], v[52:55], v[84:87], v[212:215]
v_mfma_f32_16x16x32_bf16 v[244:247], v[52:55], v[88:91], v[244:247]
ds_read_b64_tr_b16 v[52:53], v4 offset:57344
s_cbranch_vccnz TR_Yt63
RET_Yt63:
v_add_f32 v21, v21, v18
v_add_f32 v22, v22, v19
ds_read_b64_tr_b16 v[54:55], v4 offset:61440
v_add_f32 v23, v23, v20
v_mov_b32 v24, v21
v_mov_b32 v25, v22
s_waitcnt lgkmcnt(2)
v_mfma_f32_16x16x32_bf16 v[152:155], v[44:47], v[92:95], v[152:155]
v_mov_b32 v26, v23
v_mov_b32 v248, v24
v_mfma_f32_16x16x32_bf16 v[184:187], v[44:47], v[96:99], v[184:187]
v_mov_b32 v249, v25
v_mfma_f32_16x16x32_bf16 v[216:219], v[44:47], v[100:103], v[216:219]
ds_read_b64_tr_b16 v[44:45], v3 offset:57600
v_mov_b32 v250, v26
v_permlane32_swap_b32 v24, v248
v_permlane32_swap_b32 v25, v249
v_permlane32_swap_b32 v26, v250
ds_read_b64_tr_b16 v[46:47], v3 offset:61696
v_add_f32 v24, v24, v248
v_add_f32 v25, v25, v249
v_add_f32 v26, v26, v250
s_waitcnt lgkmcnt(2)
v_mfma_f32_16x16x32_bf16 v[156:159], v[52:55], v[92:95], v[156:159]
v_mov_b32 v248, v24
v_mfma_f32_16x16x32_bf16 v[188:191], v[52:55], v[96:99], v[188:191]
v_mov_b32 v249, v25
v_mov_b32 v250, v26
v_mfma_f32_16x16x32_bf16 v[220:223], v[52:55], v[100:103], v[220:223]
ds_read_b64_tr_b16 v[52:53], v4 offset:57600
v_permlane16_swap_b32 v24, v248
v_permlane16_swap_b32 v25, v249
v_permlane16_swap_b32 v26, v250
ds_read_b64_tr_b16 v[54:55], v4 offset:61696
v_add_f32 v24, v24, v248
v_add_f32 v25, v25, v249
v_add_f32 v26, v26, v250
s_waitcnt lgkmcnt(2)
v_mfma_f32_16x16x32_bf16 v[160:163], v[44:47], v[92:95], v[160:163]
v_rcp_f32 v24, v24
v_rcp_f32 v25, v25
v_mfma_f32_16x16x32_bf16 v[192:195], v[44:47], v[96:99], v[192:195]
v_rcp_f32 v26, v26
v_mfma_f32_16x16x32_bf16 v[224:227], v[44:47], v[100:103], v[224:227]
ds_read_b64_tr_b16 v[44:45], v3 offset:57856
ds_read_b64_tr_b16 v[46:47], v3 offset:61952
s_waitcnt lgkmcnt(2)
v_mfma_f32_16x16x32_bf16 v[164:167], v[52:55], v[92:95], v[164:167]
v_mfma_f32_16x16x32_bf16 v[196:199], v[52:55], v[96:99], v[196:199]
v_mfma_f32_16x16x32_bf16 v[228:231], v[52:55], v[100:103], v[228:231]
ds_read_b64_tr_b16 v[52:53], v4 offset:57856
ds_read_b64_tr_b16 v[54:55], v4 offset:61952
s_waitcnt lgkmcnt(2)
v_mfma_f32_16x16x32_bf16 v[168:171], v[44:47], v[92:95], v[168:171]
v_mfma_f32_16x16x32_bf16 v[200:203], v[44:47], v[96:99], v[200:203]
v_mfma_f32_16x16x32_bf16 v[232:235], v[44:47], v[100:103], v[232:235]
ds_read_b64_tr_b16 v[44:45], v3 offset:58112
ds_read_b64_tr_b16 v[46:47], v3 offset:62208
s_waitcnt lgkmcnt(2)
v_mfma_f32_16x16x32_bf16 v[172:175], v[52:55], v[92:95], v[172:175]
v_mfma_f32_16x16x32_bf16 v[204:207], v[52:55], v[96:99], v[204:207]
v_mfma_f32_16x16x32_bf16 v[236:239], v[52:55], v[100:103], v[236:239]
ds_read_b64_tr_b16 v[52:53], v4 offset:58112
ds_read_b64_tr_b16 v[54:55], v4 offset:62208
s_waitcnt lgkmcnt(2)
v_mfma_f32_16x16x32_bf16 v[176:179], v[44:47], v[92:95], v[176:179]
v_mfma_f32_16x16x32_bf16 v[208:211], v[44:47], v[96:99], v[208:211]
v_mfma_f32_16x16x32_bf16 v[240:243], v[44:47], v[100:103], v[240:243]
s_waitcnt lgkmcnt(0)
v_mfma_f32_16x16x32_bf16 v[180:183], v[52:55], v[92:95], v[180:183]
v_mfma_f32_16x16x32_bf16 v[212:215], v[52:55], v[96:99], v[212:215]
v_mfma_f32_16x16x32_bf16 v[244:247], v[52:55], v[100:103], v[244:247]
v_mul_f32 v152, v24, v152
v_mul_f32 v153, v24, v153
v_mul_f32 v154, v24, v154
v_mul_f32 v155, v24, v155
v_cvt_pk_bf16_f32 v56, v152, v153
v_cvt_pk_bf16_f32 v57, v154, v155
v_mul_f32 v156, v24, v156
v_mul_f32 v157, v24, v157
v_mul_f32 v158, v24, v158
v_mul_f32 v159, v24, v159
v_cvt_pk_bf16_f32 v58, v156, v157
v_cvt_pk_bf16_f32 v59, v158, v159
ds_write_b128 v5, v[56:59]
v_mul_f32 v184, v25, v184
v_mul_f32 v185, v25, v185
v_mul_f32 v186, v25, v186
v_mul_f32 v187, v25, v187
v_cvt_pk_bf16_f32 v72, v184, v185
v_cvt_pk_bf16_f32 v73, v186, v187
v_mul_f32 v188, v25, v188
v_mul_f32 v189, v25, v189
v_mul_f32 v190, v25, v190
v_mul_f32 v191, v25, v191
v_cvt_pk_bf16_f32 v74, v188, v189
v_cvt_pk_bf16_f32 v75, v190, v191
ds_write_b128 v5, v[72:75] offset:4096
v_mul_f32 v216, v26, v216
v_mul_f32 v217, v26, v217
v_mul_f32 v218, v26, v218
v_mul_f32 v219, v26, v219
v_cvt_pk_bf16_f32 v88, v216, v217
v_cvt_pk_bf16_f32 v89, v218, v219
v_mul_f32 v220, v26, v220
v_mul_f32 v221, v26, v221
v_mul_f32 v222, v26, v222
v_mul_f32 v223, v26, v223
v_cvt_pk_bf16_f32 v90, v220, v221
v_cvt_pk_bf16_f32 v91, v222, v223
ds_write_b128 v5, v[88:91] offset:8192
v_mul_f32 v160, v24, v160
v_mul_f32 v161, v24, v161
v_mul_f32 v162, v24, v162
v_mul_f32 v163, v24, v163
v_cvt_pk_bf16_f32 v60, v160, v161
v_cvt_pk_bf16_f32 v61, v162, v163
v_mul_f32 v164, v24, v164
v_mul_f32 v165, v24, v165
v_mul_f32 v166, v24, v166
v_mul_f32 v167, v24, v167
v_cvt_pk_bf16_f32 v62, v164, v165
v_cvt_pk_bf16_f32 v63, v166, v167
ds_write_b128 v5, v[60:63] offset:1024
v_mul_f32 v192, v25, v192
v_mul_f32 v193, v25, v193
v_mul_f32 v194, v25, v194
v_mul_f32 v195, v25, v195
v_cvt_pk_bf16_f32 v76, v192, v193
v_cvt_pk_bf16_f32 v77, v194, v195
v_mul_f32 v196, v25, v196
v_mul_f32 v197, v25, v197
v_mul_f32 v198, v25, v198
v_mul_f32 v199, v25, v199
v_cvt_pk_bf16_f32 v78, v196, v197
v_cvt_pk_bf16_f32 v79, v198, v199
ds_write_b128 v5, v[76:79] offset:5120
v_mul_f32 v224, v26, v224
v_mul_f32 v225, v26, v225
v_mul_f32 v226, v26, v226
v_mul_f32 v227, v26, v227
v_cvt_pk_bf16_f32 v92, v224, v225
v_cvt_pk_bf16_f32 v93, v226, v227
v_mul_f32 v228, v26, v228
v_mul_f32 v229, v26, v229
v_mul_f32 v230, v26, v230
v_mul_f32 v231, v26, v231
v_cvt_pk_bf16_f32 v94, v228, v229
v_cvt_pk_bf16_f32 v95, v230, v231
ds_write_b128 v5, v[92:95] offset:9216
v_mul_f32 v168, v24, v168
v_mul_f32 v169, v24, v169
v_mul_f32 v170, v24, v170
v_mul_f32 v171, v24, v171
v_cvt_pk_bf16_f32 v64, v168, v169
v_cvt_pk_bf16_f32 v65, v170, v171
v_mul_f32 v172, v24, v172
v_mul_f32 v173, v24, v173
v_mul_f32 v174, v24, v174
v_mul_f32 v175, v24, v175
v_cvt_pk_bf16_f32 v66, v172, v173
v_cvt_pk_bf16_f32 v67, v174, v175
ds_write_b128 v5, v[64:67] offset:2048
v_mul_f32 v200, v25, v200
v_mul_f32 v201, v25, v201
v_mul_f32 v202, v25, v202
v_mul_f32 v203, v25, v203
v_cvt_pk_bf16_f32 v80, v200, v201
v_cvt_pk_bf16_f32 v81, v202, v203
v_mul_f32 v204, v25, v204
v_mul_f32 v205, v25, v205
v_mul_f32 v206, v25, v206
v_mul_f32 v207, v25, v207
v_cvt_pk_bf16_f32 v82, v204, v205
v_cvt_pk_bf16_f32 v83, v206, v207
ds_write_b128 v5, v[80:83] offset:6144
v_mul_f32 v232, v26, v232
v_mul_f32 v233, v26, v233
v_mul_f32 v234, v26, v234
v_mul_f32 v235, v26, v235
v_cvt_pk_bf16_f32 v96, v232, v233
v_cvt_pk_bf16_f32 v97, v234, v235
v_mul_f32 v236, v26, v236
v_mul_f32 v237, v26, v237
v_mul_f32 v238, v26, v238
v_mul_f32 v239, v26, v239
v_cvt_pk_bf16_f32 v98, v236, v237
v_cvt_pk_bf16_f32 v99, v238, v239
ds_write_b128 v5, v[96:99] offset:10240
v_mul_f32 v176, v24, v176
v_mul_f32 v177, v24, v177
v_mul_f32 v178, v24, v178
v_mul_f32 v179, v24, v179
v_cvt_pk_bf16_f32 v68, v176, v177
v_cvt_pk_bf16_f32 v69, v178, v179
v_mul_f32 v180, v24, v180
v_mul_f32 v181, v24, v181
v_mul_f32 v182, v24, v182
v_mul_f32 v183, v24, v183
v_cvt_pk_bf16_f32 v70, v180, v181
v_cvt_pk_bf16_f32 v71, v182, v183
ds_write_b128 v5, v[68:71] offset:3072
v_mul_f32 v208, v25, v208
v_mul_f32 v209, v25, v209
v_mul_f32 v210, v25, v210
v_mul_f32 v211, v25, v211
v_cvt_pk_bf16_f32 v84, v208, v209
v_cvt_pk_bf16_f32 v85, v210, v211
v_mul_f32 v212, v25, v212
v_mul_f32 v213, v25, v213
v_mul_f32 v214, v25, v214
v_mul_f32 v215, v25, v215
v_cvt_pk_bf16_f32 v86, v212, v213
v_cvt_pk_bf16_f32 v87, v214, v215
ds_write_b128 v5, v[84:87] offset:7168
v_mul_f32 v240, v26, v240
v_mul_f32 v241, v26, v241
v_mul_f32 v242, v26, v242
v_mul_f32 v243, v26, v243
v_cvt_pk_bf16_f32 v100, v240, v241
v_cvt_pk_bf16_f32 v101, v242, v243
v_mul_f32 v244, v26, v244
v_mul_f32 v245, v26, v245
v_mul_f32 v246, v26, v246
v_mul_f32 v247, v26, v247
v_cvt_pk_bf16_f32 v102, v244, v245
v_cvt_pk_bf16_f32 v103, v246, v247
ds_write_b128 v5, v[100:103] offset:11264
v_bfe_u32 v1, v0, 1, 1
v_bfe_u32 v7, v0, 4, 1
v_lshl_add_u32 v1, v7, 1, v1
v_lshrrev_b32 v7, 2, v0
v_lshl_add_u32 v1, v7, 2, v1
v_lshlrev_b32 v1, 4, v1
v_and_b32 v7, 1, v0
v_lshl_add_u32 v1, v7, 3, v1
v_add_u32 v2, 0, v1
v_xor_b32 v3, 32, v2
v_lshlrev_b32 v4, 4, v0
s_mul_i32 s74, s51, 0x36000
s_mul_i32 s54, s50, 0xd800
s_add_u32 s74, s74, s54
s_add_u32 s74, s74, 0
s_add_u32 s75, s74, 0x6c00
s_and_b32 s54, s34, 0
s_mul_i32 s55, s54, 0x1800
s_add_u32 s74, s74, s55
s_waitcnt lgkmcnt(0)
s_barrier
ds_read_b64_tr_b16 v[32:33], v2
ds_read_b64_tr_b16 v[34:35], v2 offset:1024
ds_read_b64_tr_b16 v[36:37], v3
ds_read_b64_tr_b16 v[38:39], v3 offset:1024
ds_read_b64_tr_b16 v[40:41], v2 offset:2048
ds_read_b64_tr_b16 v[42:43], v2 offset:3072
s_waitcnt lgkmcnt(4)
v_mfma_f32_16x16x32_bf16 v[8:11], v[32:35], v[56:59], 0
ds_read_b64_tr_b16 v[44:45], v3 offset:2048
ds_read_b64_tr_b16 v[46:47], v3 offset:3072
v_mfma_f32_16x16x32_bf16 v[16:19], v[32:35], v[72:75], 0
v_mfma_f32_16x16x32_bf16 v[24:27], v[32:35], v[88:91], 0
s_waitcnt lgkmcnt(4)
v_mfma_f32_16x16x32_bf16 v[12:15], v[36:39], v[56:59], 0
ds_read_b64_tr_b16 v[32:33], v2 offset:4096
ds_read_b64_tr_b16 v[34:35], v2 offset:5120
v_mfma_f32_16x16x32_bf16 v[20:23], v[36:39], v[72:75], 0
v_mfma_f32_16x16x32_bf16 v[28:31], v[36:39], v[88:91], 0
s_waitcnt lgkmcnt(4)
v_mfma_f32_16x16x32_bf16 v[8:11], v[40:43], v[60:63], v[8:11]
ds_read_b64_tr_b16 v[36:37], v3 offset:4096
ds_read_b64_tr_b16 v[38:39], v3 offset:5120
v_mfma_f32_16x16x32_bf16 v[16:19], v[40:43], v[76:79], v[16:19]
v_mfma_f32_16x16x32_bf16 v[24:27], v[40:43], v[92:95], v[24:27]
s_waitcnt lgkmcnt(4)
v_mfma_f32_16x16x32_bf16 v[12:15], v[44:47], v[60:63], v[12:15]
ds_read_b64_tr_b16 v[40:41], v2 offset:6144
ds_read_b64_tr_b16 v[42:43], v2 offset:7168
v_mfma_f32_16x16x32_bf16 v[20:23], v[44:47], v[76:79], v[20:23]
v_mfma_f32_16x16x32_bf16 v[28:31], v[44:47], v[92:95], v[28:31]
s_waitcnt lgkmcnt(4)
v_mfma_f32_16x16x32_bf16 v[8:11], v[32:35], v[64:67], v[8:11]
ds_read_b64_tr_b16 v[44:45], v3 offset:6144
ds_read_b64_tr_b16 v[46:47], v3 offset:7168
v_mfma_f32_16x16x32_bf16 v[16:19], v[32:35], v[80:83], v[16:19]
v_mfma_f32_16x16x32_bf16 v[24:27], v[32:35], v[96:99], v[24:27]
s_waitcnt lgkmcnt(4)
v_mfma_f32_16x16x32_bf16 v[12:15], v[36:39], v[64:67], v[12:15]
ds_read_b64_tr_b16 v[32:33], v2 offset:8192
ds_read_b64_tr_b16 v[34:35], v2 offset:9216
v_mfma_f32_16x16x32_bf16 v[20:23], v[36:39], v[80:83], v[20:23]
v_mfma_f32_16x16x32_bf16 v[28:31], v[36:39], v[96:99], v[28:31]
s_waitcnt lgkmcnt(4)
v_mfma_f32_16x16x32_bf16 v[8:11], v[40:43], v[68:71], v[8:11]
ds_read_b64_tr_b16 v[36:37], v3 offset:8192
ds_read_b64_tr_b16 v[38:39], v3 offset:9216
v_mfma_f32_16x16x32_bf16 v[16:19], v[40:43], v[84:87], v[16:19]
v_mfma_f32_16x16x32_bf16 v[24:27], v[40:43], v[100:103], v[24:27]
s_waitcnt lgkmcnt(4)
v_mfma_f32_16x16x32_bf16 v[12:15], v[44:47], v[68:71], v[12:15]
ds_read_b64_tr_b16 v[40:41], v2 offset:10240
ds_read_b64_tr_b16 v[42:43], v2 offset:11264
v_mfma_f32_16x16x32_bf16 v[20:23], v[44:47], v[84:87], v[20:23]
v_mfma_f32_16x16x32_bf16 v[28:31], v[44:47], v[100:103], v[28:31]
s_barrier
s_waitcnt lgkmcnt(4)
v_mfma_f32_16x16x32_bf16 v[8:11], v[32:35], v[104:107], v[8:11]
ds_read_b64_tr_b16 v[44:45], v3 offset:10240
ds_read_b64_tr_b16 v[46:47], v3 offset:11264
v_mfma_f32_16x16x32_bf16 v[16:19], v[32:35], v[120:123], v[16:19]
ds_read_b128 v[152:155], v5
v_mfma_f32_16x16x32_bf16 v[24:27], v[32:35], v[136:139], v[24:27]
ds_read_b128 v[168:171], v5 offset:4096
s_waitcnt lgkmcnt(6)
v_mfma_f32_16x16x32_bf16 v[12:15], v[36:39], v[104:107], v[12:15]
ds_read_b64_tr_b16 v[32:33], v2 offset:12288
ds_read_b64_tr_b16 v[34:35], v2 offset:13312
v_mfma_f32_16x16x32_bf16 v[20:23], v[36:39], v[120:123], v[20:23]
ds_read_b128 v[184:187], v5 offset:8192
v_mfma_f32_16x16x32_bf16 v[28:31], v[36:39], v[136:139], v[28:31]
ds_read_b128 v[156:159], v5 offset:1024
s_waitcnt lgkmcnt(8)
v_mfma_f32_16x16x32_bf16 v[8:11], v[40:43], v[108:111], v[8:11]
ds_read_b64_tr_b16 v[36:37], v3 offset:12288
ds_read_b64_tr_b16 v[38:39], v3 offset:13312
v_mfma_f32_16x16x32_bf16 v[16:19], v[40:43], v[124:127], v[16:19]
ds_read_b128 v[172:175], v5 offset:5120
v_mfma_f32_16x16x32_bf16 v[24:27], v[40:43], v[140:143], v[24:27]
ds_read_b128 v[188:191], v5 offset:9216
s_waitcnt lgkmcnt(10)
v_mfma_f32_16x16x32_bf16 v[12:15], v[44:47], v[108:111], v[12:15]
ds_read_b64_tr_b16 v[40:41], v2 offset:14336
ds_read_b64_tr_b16 v[42:43], v2 offset:15360
v_mfma_f32_16x16x32_bf16 v[20:23], v[44:47], v[124:127], v[20:23]
ds_read_b128 v[160:163], v5 offset:2048
v_mfma_f32_16x16x32_bf16 v[28:31], v[44:47], v[140:143], v[28:31]
ds_read_b128 v[176:179], v5 offset:6144
s_waitcnt lgkmcnt(10)
v_mfma_f32_16x16x32_bf16 v[8:11], v[32:35], v[112:115], v[8:11]
ds_read_b64_tr_b16 v[44:45], v3 offset:14336
ds_read_b64_tr_b16 v[46:47], v3 offset:15360
v_mfma_f32_16x16x32_bf16 v[16:19], v[32:35], v[128:131], v[16:19]
ds_read_b128 v[192:195], v5 offset:10240
v_mfma_f32_16x16x32_bf16 v[24:27], v[32:35], v[144:147], v[24:27]
ds_read_b128 v[164:167], v5 offset:3072
s_waitcnt lgkmcnt(10)
v_mfma_f32_16x16x32_bf16 v[12:15], v[36:39], v[112:115], v[12:15]
ds_read_b64_tr_b16 v[32:33], v2 offset:16384
ds_read_b64_tr_b16 v[34:35], v2 offset:17408
v_mfma_f32_16x16x32_bf16 v[20:23], v[36:39], v[128:131], v[20:23]
ds_read_b128 v[180:183], v5 offset:7168
v_mfma_f32_16x16x32_bf16 v[28:31], v[36:39], v[144:147], v[28:31]
ds_read_b128 v[196:199], v5 offset:11264
s_waitcnt lgkmcnt(10)
v_mfma_f32_16x16x32_bf16 v[8:11], v[40:43], v[116:119], v[8:11]
ds_read_b64_tr_b16 v[36:37], v3 offset:16384
ds_read_b64_tr_b16 v[38:39], v3 offset:17408
v_mfma_f32_16x16x32_bf16 v[16:19], v[40:43], v[132:135], v[16:19]
v_mfma_f32_16x16x32_bf16 v[24:27], v[40:43], v[148:151], v[24:27]
s_waitcnt lgkmcnt(8)
v_mfma_f32_16x16x32_bf16 v[12:15], v[44:47], v[116:119], v[12:15]
ds_read_b64_tr_b16 v[40:41], v2 offset:18432
ds_read_b64_tr_b16 v[42:43], v2 offset:19456
v_mfma_f32_16x16x32_bf16 v[20:23], v[44:47], v[132:135], v[20:23]
v_mfma_f32_16x16x32_bf16 v[28:31], v[44:47], v[148:151], v[28:31]
s_waitcnt lgkmcnt(4)
s_barrier
v_mfma_f32_16x16x32_bf16 v[8:11], v[32:35], v[152:155], v[8:11]
ds_read_b64_tr_b16 v[44:45], v3 offset:18432
ds_read_b64_tr_b16 v[46:47], v3 offset:19456
v_mfma_f32_16x16x32_bf16 v[16:19], v[32:35], v[168:171], v[16:19]
v_mfma_f32_16x16x32_bf16 v[24:27], v[32:35], v[184:187], v[24:27]
s_waitcnt lgkmcnt(4)
v_mfma_f32_16x16x32_bf16 v[12:15], v[36:39], v[152:155], v[12:15]
ds_read_b64_tr_b16 v[32:33], v2 offset:20480
ds_read_b64_tr_b16 v[34:35], v2 offset:21504
v_mfma_f32_16x16x32_bf16 v[20:23], v[36:39], v[168:171], v[20:23]
v_mfma_f32_16x16x32_bf16 v[28:31], v[36:39], v[184:187], v[28:31]
s_waitcnt lgkmcnt(4)
v_mfma_f32_16x16x32_bf16 v[8:11], v[40:43], v[156:159], v[8:11]
ds_read_b64_tr_b16 v[36:37], v3 offset:20480
ds_read_b64_tr_b16 v[38:39], v3 offset:21504
v_mfma_f32_16x16x32_bf16 v[16:19], v[40:43], v[172:175], v[16:19]
v_mfma_f32_16x16x32_bf16 v[24:27], v[40:43], v[188:191], v[24:27]
s_waitcnt lgkmcnt(4)
v_mfma_f32_16x16x32_bf16 v[12:15], v[44:47], v[156:159], v[12:15]
ds_read_b64_tr_b16 v[40:41], v2 offset:22528
ds_read_b64_tr_b16 v[42:43], v2 offset:23552
v_mfma_f32_16x16x32_bf16 v[20:23], v[44:47], v[172:175], v[20:23]
v_mfma_f32_16x16x32_bf16 v[28:31], v[44:47], v[188:191], v[28:31]
s_waitcnt lgkmcnt(4)
v_mfma_f32_16x16x32_bf16 v[8:11], v[32:35], v[160:163], v[8:11]
ds_read_b64_tr_b16 v[44:45], v3 offset:22528
ds_read_b64_tr_b16 v[46:47], v3 offset:23552
v_mfma_f32_16x16x32_bf16 v[16:19], v[32:35], v[176:179], v[16:19]
v_mfma_f32_16x16x32_bf16 v[24:27], v[32:35], v[192:195], v[24:27]
s_waitcnt lgkmcnt(4)
v_mfma_f32_16x16x32_bf16 v[12:15], v[36:39], v[160:163], v[12:15]
ds_read_b64_tr_b16 v[32:33], v2 offset:32768
ds_read_b64_tr_b16 v[34:35], v2 offset:33792
v_mfma_f32_16x16x32_bf16 v[20:23], v[36:39], v[176:179], v[20:23]
v_mfma_f32_16x16x32_bf16 v[28:31], v[36:39], v[192:195], v[28:31]
s_waitcnt lgkmcnt(4)
v_mfma_f32_16x16x32_bf16 v[8:11], v[40:43], v[164:167], v[8:11]
ds_read_b64_tr_b16 v[36:37], v3 offset:32768
ds_read_b64_tr_b16 v[38:39], v3 offset:33792
v_mfma_f32_16x16x32_bf16 v[16:19], v[40:43], v[180:183], v[16:19]
v_mfma_f32_16x16x32_bf16 v[24:27], v[40:43], v[196:199], v[24:27]
s_waitcnt lgkmcnt(4)
v_mfma_f32_16x16x32_bf16 v[12:15], v[44:47], v[164:167], v[12:15]
ds_read_b64_tr_b16 v[40:41], v2 offset:34816
ds_read_b64_tr_b16 v[42:43], v2 offset:35840
v_mfma_f32_16x16x32_bf16 v[20:23], v[44:47], v[180:183], v[20:23]
v_mfma_f32_16x16x32_bf16 v[28:31], v[44:47], v[196:199], v[28:31]
s_barrier
ds_read_b128 v[200:203], v5
ds_read_b128 v[216:219], v5 offset:4096
ds_read_b128 v[232:235], v5 offset:8192
ds_read_b128 v[204:207], v5 offset:1024
ds_read_b128 v[220:223], v5 offset:5120
ds_read_b128 v[236:239], v5 offset:9216
ds_read_b128 v[208:211], v5 offset:2048
ds_read_b128 v[224:227], v5 offset:6144
ds_read_b128 v[240:243], v5 offset:10240
ds_read_b128 v[212:215], v5 offset:3072
ds_read_b128 v[228:231], v5 offset:7168
ds_read_b128 v[244:247], v5 offset:11264
s_waitcnt lgkmcnt(9)
v_mfma_f32_16x16x32_bf16 v[8:11], v[32:35], v[200:203], v[8:11]
ds_read_b64_tr_b16 v[44:45], v3 offset:34816
ds_read_b64_tr_b16 v[46:47], v3 offset:35840
v_mfma_f32_16x16x32_bf16 v[16:19], v[32:35], v[216:219], v[16:19]
v_mfma_f32_16x16x32_bf16 v[24:27], v[32:35], v[232:235], v[24:27]
v_mfma_f32_16x16x32_bf16 v[12:15], v[36:39], v[200:203], v[12:15]
ds_read_b64_tr_b16 v[32:33], v2 offset:36864
ds_read_b64_tr_b16 v[34:35], v2 offset:37888
v_mfma_f32_16x16x32_bf16 v[20:23], v[36:39], v[216:219], v[20:23]
v_mfma_f32_16x16x32_bf16 v[28:31], v[36:39], v[232:235], v[28:31]
s_waitcnt lgkmcnt(10)
v_mfma_f32_16x16x32_bf16 v[8:11], v[40:43], v[204:207], v[8:11]
ds_read_b64_tr_b16 v[36:37], v3 offset:36864
ds_read_b64_tr_b16 v[38:39], v3 offset:37888
v_mfma_f32_16x16x32_bf16 v[16:19], v[40:43], v[220:223], v[16:19]
v_mfma_f32_16x16x32_bf16 v[24:27], v[40:43], v[236:239], v[24:27]
s_waitcnt lgkmcnt(4)
v_mfma_f32_16x16x32_bf16 v[12:15], v[44:47], v[204:207], v[12:15]
ds_read_b64_tr_b16 v[40:41], v2 offset:38912
ds_read_b64_tr_b16 v[42:43], v2 offset:39936
v_mfma_f32_16x16x32_bf16 v[20:23], v[44:47], v[220:223], v[20:23]
v_mfma_f32_16x16x32_bf16 v[28:31], v[44:47], v[236:239], v[28:31]
s_waitcnt lgkmcnt(4)
v_mfma_f32_16x16x32_bf16 v[8:11], v[32:35], v[208:211], v[8:11]
ds_read_b64_tr_b16 v[44:45], v3 offset:38912
ds_read_b64_tr_b16 v[46:47], v3 offset:39936
v_mfma_f32_16x16x32_bf16 v[16:19], v[32:35], v[224:227], v[16:19]
v_mfma_f32_16x16x32_bf16 v[24:27], v[32:35], v[240:243], v[24:27]
s_waitcnt lgkmcnt(4)
v_mfma_f32_16x16x32_bf16 v[12:15], v[36:39], v[208:211], v[12:15]
ds_read_b64_tr_b16 v[32:33], v2 offset:24576
ds_read_b64_tr_b16 v[34:35], v2 offset:25600
v_mfma_f32_16x16x32_bf16 v[20:23], v[36:39], v[224:227], v[20:23]
v_mfma_f32_16x16x32_bf16 v[28:31], v[36:39], v[240:243], v[28:31]
s_waitcnt lgkmcnt(4)
v_mfma_f32_16x16x32_bf16 v[8:11], v[40:43], v[212:215], v[8:11]
ds_read_b64_tr_b16 v[36:37], v3 offset:24576
ds_read_b64_tr_b16 v[38:39], v3 offset:25600
v_mfma_f32_16x16x32_bf16 v[16:19], v[40:43], v[228:231], v[16:19]
v_mfma_f32_16x16x32_bf16 v[24:27], v[40:43], v[244:247], v[24:27]
s_waitcnt lgkmcnt(4)
v_mfma_f32_16x16x32_bf16 v[12:15], v[44:47], v[212:215], v[12:15]
ds_read_b64_tr_b16 v[40:41], v2 offset:26624
ds_read_b64_tr_b16 v[42:43], v2 offset:27648
v_mfma_f32_16x16x32_bf16 v[20:23], v[44:47], v[228:231], v[20:23]
v_mfma_f32_16x16x32_bf16 v[28:31], v[44:47], v[244:247], v[28:31]
v_cvt_pk_bf16_f32 v48, v8, v9
v_cvt_pk_bf16_f32 v49, v10, v11
s_nop 1
v_cvt_pk_bf16_f32 v50, v12, v13
v_cvt_pk_bf16_f32 v51, v14, v15
v_cvt_pk_bf16_f32 v52, v16, v17
v_cvt_pk_bf16_f32 v53, v18, v19
v_cvt_pk_bf16_f32 v54, v20, v21
v_cvt_pk_bf16_f32 v55, v22, v23
v_cvt_pk_bf16_f32 v248, v24, v25
v_cvt_pk_bf16_f32 v249, v26, v27
v_cvt_pk_bf16_f32 v250, v28, v29
v_cvt_pk_bf16_f32 v251, v30, v31
s_barrier
s_waitcnt lgkmcnt(4)
v_mfma_f32_16x16x32_bf16 v[8:11], v[32:35], v[56:59], 0
ds_read_b64_tr_b16 v[44:45], v3 offset:26624
ds_read_b64_tr_b16 v[46:47], v3 offset:27648
v_mfma_f32_16x16x32_bf16 v[16:19], v[32:35], v[72:75], 0
buffer_store_dwordx4 v[48:51], v4, s[24:27], s74 offen sc1
v_mfma_f32_16x16x32_bf16 v[24:27], v[32:35], v[88:91], 0
s_waitcnt lgkmcnt(4)
v_mfma_f32_16x16x32_bf16 v[12:15], v[36:39], v[56:59], 0
ds_read_b64_tr_b16 v[32:33], v2 offset:28672
ds_read_b64_tr_b16 v[34:35], v2 offset:29696
v_mfma_f32_16x16x32_bf16 v[20:23], v[36:39], v[72:75], 0
v_mfma_f32_16x16x32_bf16 v[28:31], v[36:39], v[88:91], 0
s_waitcnt lgkmcnt(4)
v_mfma_f32_16x16x32_bf16 v[8:11], v[40:43], v[60:63], v[8:11]
ds_read_b64_tr_b16 v[36:37], v3 offset:28672
ds_read_b64_tr_b16 v[38:39], v3 offset:29696
v_mfma_f32_16x16x32_bf16 v[16:19], v[40:43], v[76:79], v[16:19]
v_mfma_f32_16x16x32_bf16 v[24:27], v[40:43], v[92:95], v[24:27]
s_waitcnt lgkmcnt(4)
v_mfma_f32_16x16x32_bf16 v[12:15], v[44:47], v[60:63], v[12:15]
ds_read_b64_tr_b16 v[40:41], v2 offset:30720
ds_read_b64_tr_b16 v[42:43], v2 offset:31744
v_mfma_f32_16x16x32_bf16 v[20:23], v[44:47], v[76:79], v[20:23]
v_mfma_f32_16x16x32_bf16 v[28:31], v[44:47], v[92:95], v[28:31]
s_waitcnt lgkmcnt(4)
v_mfma_f32_16x16x32_bf16 v[8:11], v[32:35], v[64:67], v[8:11]
ds_read_b64_tr_b16 v[44:45], v3 offset:30720
ds_read_b64_tr_b16 v[46:47], v3 offset:31744
v_mfma_f32_16x16x32_bf16 v[16:19], v[32:35], v[80:83], v[16:19]
v_mfma_f32_16x16x32_bf16 v[24:27], v[32:35], v[96:99], v[24:27]
s_waitcnt lgkmcnt(4)
v_mfma_f32_16x16x32_bf16 v[12:15], v[36:39], v[64:67], v[12:15]
ds_read_b64_tr_b16 v[32:33], v2 offset:40960
ds_read_b64_tr_b16 v[34:35], v2 offset:41984
v_mfma_f32_16x16x32_bf16 v[20:23], v[36:39], v[80:83], v[20:23]
v_mfma_f32_16x16x32_bf16 v[28:31], v[36:39], v[96:99], v[28:31]
s_waitcnt lgkmcnt(4)
v_mfma_f32_16x16x32_bf16 v[8:11], v[40:43], v[68:71], v[8:11]
ds_read_b64_tr_b16 v[36:37], v3 offset:40960
ds_read_b64_tr_b16 v[38:39], v3 offset:41984
v_mfma_f32_16x16x32_bf16 v[16:19], v[40:43], v[84:87], v[16:19]
v_mfma_f32_16x16x32_bf16 v[24:27], v[40:43], v[100:103], v[24:27]
s_waitcnt lgkmcnt(4)
v_mfma_f32_16x16x32_bf16 v[12:15], v[44:47], v[68:71], v[12:15]
ds_read_b64_tr_b16 v[40:41], v2 offset:43008
ds_read_b64_tr_b16 v[42:43], v2 offset:44032
v_mfma_f32_16x16x32_bf16 v[20:23], v[44:47], v[84:87], v[20:23]
v_mfma_f32_16x16x32_bf16 v[28:31], v[44:47], v[100:103], v[28:31]
s_barrier
s_waitcnt lgkmcnt(4)
v_mfma_f32_16x16x32_bf16 v[8:11], v[32:35], v[104:107], v[8:11]
ds_read_b64_tr_b16 v[44:45], v3 offset:43008
ds_read_b64_tr_b16 v[46:47], v3 offset:44032
v_mfma_f32_16x16x32_bf16 v[16:19], v[32:35], v[120:123], v[16:19]
buffer_store_dwordx4 v[52:55], v4, s[24:27], s74 offen offset:1024 sc1
v_mfma_f32_16x16x32_bf16 v[24:27], v[32:35], v[136:139], v[24:27]
s_waitcnt lgkmcnt(4)
v_mfma_f32_16x16x32_bf16 v[12:15], v[36:39], v[104:107], v[12:15]
ds_read_b64_tr_b16 v[32:33], v2 offset:45056
ds_read_b64_tr_b16 v[34:35], v2 offset:46080
v_mfma_f32_16x16x32_bf16 v[20:23], v[36:39], v[120:123], v[20:23]
v_mfma_f32_16x16x32_bf16 v[28:31], v[36:39], v[136:139], v[28:31]
s_waitcnt lgkmcnt(4)
v_mfma_f32_16x16x32_bf16 v[8:11], v[40:43], v[108:111], v[8:11]
ds_read_b64_tr_b16 v[36:37], v3 offset:45056
ds_read_b64_tr_b16 v[38:39], v3 offset:46080
v_mfma_f32_16x16x32_bf16 v[16:19], v[40:43], v[124:127], v[16:19]
v_mfma_f32_16x16x32_bf16 v[24:27], v[40:43], v[140:143], v[24:27]
s_waitcnt lgkmcnt(4)
v_mfma_f32_16x16x32_bf16 v[12:15], v[44:47], v[108:111], v[12:15]
ds_read_b64_tr_b16 v[40:41], v2 offset:47104
ds_read_b64_tr_b16 v[42:43], v2 offset:48128
v_mfma_f32_16x16x32_bf16 v[20:23], v[44:47], v[124:127], v[20:23]
v_mfma_f32_16x16x32_bf16 v[28:31], v[44:47], v[140:143], v[28:31]
s_waitcnt lgkmcnt(4)
v_mfma_f32_16x16x32_bf16 v[8:11], v[32:35], v[112:115], v[8:11]
ds_read_b64_tr_b16 v[44:45], v3 offset:47104
ds_read_b64_tr_b16 v[46:47], v3 offset:48128
v_mfma_f32_16x16x32_bf16 v[16:19], v[32:35], v[128:131], v[16:19]
v_mfma_f32_16x16x32_bf16 v[24:27], v[32:35], v[144:147], v[24:27]
s_waitcnt lgkmcnt(4)
v_mfma_f32_16x16x32_bf16 v[12:15], v[36:39], v[112:115], v[12:15]
ds_read_b64_tr_b16 v[32:33], v2 offset:49152
ds_read_b64_tr_b16 v[34:35], v2 offset:50176
v_mfma_f32_16x16x32_bf16 v[20:23], v[36:39], v[128:131], v[20:23]
v_mfma_f32_16x16x32_bf16 v[28:31], v[36:39], v[144:147], v[28:31]
s_waitcnt lgkmcnt(4)
v_mfma_f32_16x16x32_bf16 v[8:11], v[40:43], v[116:119], v[8:11]
ds_read_b64_tr_b16 v[36:37], v3 offset:49152
ds_read_b64_tr_b16 v[38:39], v3 offset:50176
v_mfma_f32_16x16x32_bf16 v[16:19], v[40:43], v[132:135], v[16:19]
v_mfma_f32_16x16x32_bf16 v[24:27], v[40:43], v[148:151], v[24:27]
s_waitcnt lgkmcnt(4)
v_mfma_f32_16x16x32_bf16 v[12:15], v[44:47], v[116:119], v[12:15]
ds_read_b64_tr_b16 v[40:41], v2 offset:51200
ds_read_b64_tr_b16 v[42:43], v2 offset:52224
v_mfma_f32_16x16x32_bf16 v[20:23], v[44:47], v[132:135], v[20:23]
v_mfma_f32_16x16x32_bf16 v[28:31], v[44:47], v[148:151], v[28:31]
s_barrier
s_waitcnt lgkmcnt(4)
v_mfma_f32_16x16x32_bf16 v[8:11], v[32:35], v[152:155], v[8:11]
ds_read_b64_tr_b16 v[44:45], v3 offset:51200
ds_read_b64_tr_b16 v[46:47], v3 offset:52224
v_mfma_f32_16x16x32_bf16 v[16:19], v[32:35], v[168:171], v[16:19]
buffer_store_dwordx4 v[248:251], v4, s[24:27], s74 offen offset:2048 sc1
s_add_u32 s74, s74, 0xc00
s_sub_u32 s55, s74, 0x6c00
s_cmp_ge_u32 s74, s75
s_cselect_b32 s74, s55, s74
v_mfma_f32_16x16x32_bf16 v[24:27], v[32:35], v[184:187], v[24:27]
s_waitcnt lgkmcnt(4)
v_mfma_f32_16x16x32_bf16 v[12:15], v[36:39], v[152:155], v[12:15]
ds_read_b64_tr_b16 v[32:33], v2 offset:53248
ds_read_b64_tr_b16 v[34:35], v2 offset:54272
v_mfma_f32_16x16x32_bf16 v[20:23], v[36:39], v[168:171], v[20:23]
v_mfma_f32_16x16x32_bf16 v[28:31], v[36:39], v[184:187], v[28:31]
s_waitcnt lgkmcnt(4)
v_mfma_f32_16x16x32_bf16 v[8:11], v[40:43], v[156:159], v[8:11]
ds_read_b64_tr_b16 v[36:37], v3 offset:53248
ds_read_b64_tr_b16 v[38:39], v3 offset:54272
v_mfma_f32_16x16x32_bf16 v[16:19], v[40:43], v[172:175], v[16:19]
v_mfma_f32_16x16x32_bf16 v[24:27], v[40:43], v[188:191], v[24:27]
s_waitcnt lgkmcnt(4)
v_mfma_f32_16x16x32_bf16 v[12:15], v[44:47], v[156:159], v[12:15]
ds_read_b64_tr_b16 v[40:41], v2 offset:55296
ds_read_b64_tr_b16 v[42:43], v2 offset:56320
v_mfma_f32_16x16x32_bf16 v[20:23], v[44:47], v[172:175], v[20:23]
v_mfma_f32_16x16x32_bf16 v[28:31], v[44:47], v[188:191], v[28:31]
s_waitcnt lgkmcnt(4)
v_mfma_f32_16x16x32_bf16 v[8:11], v[32:35], v[160:163], v[8:11]
ds_read_b64_tr_b16 v[44:45], v3 offset:55296
ds_read_b64_tr_b16 v[46:47], v3 offset:56320
v_mfma_f32_16x16x32_bf16 v[16:19], v[32:35], v[176:179], v[16:19]
v_mfma_f32_16x16x32_bf16 v[24:27], v[32:35], v[192:195], v[24:27]
s_waitcnt lgkmcnt(4)
v_mfma_f32_16x16x32_bf16 v[12:15], v[36:39], v[160:163], v[12:15]
ds_read_b64_tr_b16 v[32:33], v2 offset:57344
ds_read_b64_tr_b16 v[34:35], v2 offset:58368
v_mfma_f32_16x16x32_bf16 v[20:23], v[36:39], v[176:179], v[20:23]
v_mfma_f32_16x16x32_bf16 v[28:31], v[36:39], v[192:195], v[28:31]
s_waitcnt lgkmcnt(4)
v_mfma_f32_16x16x32_bf16 v[8:11], v[40:43], v[164:167], v[8:11]
ds_read_b64_tr_b16 v[36:37], v3 offset:57344
ds_read_b64_tr_b16 v[38:39], v3 offset:58368
v_mfma_f32_16x16x32_bf16 v[16:19], v[40:43], v[180:183], v[16:19]
v_mfma_f32_16x16x32_bf16 v[24:27], v[40:43], v[196:199], v[24:27]
s_waitcnt lgkmcnt(4)
v_mfma_f32_16x16x32_bf16 v[12:15], v[44:47], v[164:167], v[12:15]
ds_read_b64_tr_b16 v[40:41], v2 offset:59392
ds_read_b64_tr_b16 v[42:43], v2 offset:60416
v_mfma_f32_16x16x32_bf16 v[20:23], v[44:47], v[180:183], v[20:23]
v_mfma_f32_16x16x32_bf16 v[28:31], v[44:47], v[196:199], v[28:31]
s_barrier
s_waitcnt lgkmcnt(4)
v_mfma_f32_16x16x32_bf16 v[8:11], v[32:35], v[200:203], v[8:11]
ds_read_b64_tr_b16 v[44:45], v3 offset:59392
ds_read_b64_tr_b16 v[46:47], v3 offset:60416
v_mfma_f32_16x16x32_bf16 v[16:19], v[32:35], v[216:219], v[16:19]
v_mfma_f32_16x16x32_bf16 v[24:27], v[32:35], v[232:235], v[24:27]
s_waitcnt lgkmcnt(4)
v_mfma_f32_16x16x32_bf16 v[12:15], v[36:39], v[200:203], v[12:15]
ds_read_b64_tr_b16 v[32:33], v2 offset:61440
ds_read_b64_tr_b16 v[34:35], v2 offset:62464
v_mfma_f32_16x16x32_bf16 v[20:23], v[36:39], v[216:219], v[20:23]
v_mfma_f32_16x16x32_bf16 v[28:31], v[36:39], v[232:235], v[28:31]
s_waitcnt lgkmcnt(4)
v_mfma_f32_16x16x32_bf16 v[8:11], v[40:43], v[204:207], v[8:11]
ds_read_b64_tr_b16 v[36:37], v3 offset:61440
ds_read_b64_tr_b16 v[38:39], v3 offset:62464
v_mfma_f32_16x16x32_bf16 v[16:19], v[40:43], v[220:223], v[16:19]
v_mfma_f32_16x16x32_bf16 v[24:27], v[40:43], v[236:239], v[24:27]
s_waitcnt lgkmcnt(4)
v_mfma_f32_16x16x32_bf16 v[12:15], v[44:47], v[204:207], v[12:15]
ds_read_b64_tr_b16 v[40:41], v2 offset:63488
ds_read_b64_tr_b16 v[42:43], v2 offset:64512
v_mfma_f32_16x16x32_bf16 v[20:23], v[44:47], v[220:223], v[20:23]
v_mfma_f32_16x16x32_bf16 v[28:31], v[44:47], v[236:239], v[28:31]
s_waitcnt lgkmcnt(4)
v_mfma_f32_16x16x32_bf16 v[8:11], v[32:35], v[208:211], v[8:11]
ds_read_b64_tr_b16 v[44:45], v3 offset:63488
ds_read_b64_tr_b16 v[46:47], v3 offset:64512
v_mfma_f32_16x16x32_bf16 v[16:19], v[32:35], v[224:227], v[16:19]
v_mfma_f32_16x16x32_bf16 v[24:27], v[32:35], v[240:243], v[24:27]
s_waitcnt lgkmcnt(4)
v_mfma_f32_16x16x32_bf16 v[12:15], v[36:39], v[208:211], v[12:15]
ds_read_b64_tr_b16 v[32:33], v2
ds_read_b64_tr_b16 v[34:35], v2 offset:1024
v_mfma_f32_16x16x32_bf16 v[20:23], v[36:39], v[224:227], v[20:23]
v_mfma_f32_16x16x32_bf16 v[28:31], v[36:39], v[240:243], v[28:31]
s_waitcnt lgkmcnt(4)
v_mfma_f32_16x16x32_bf16 v[8:11], v[40:43], v[212:215], v[8:11]
ds_read_b64_tr_b16 v[36:37], v3
ds_read_b64_tr_b16 v[38:39], v3 offset:1024
v_mfma_f32_16x16x32_bf16 v[16:19], v[40:43], v[228:231], v[16:19]
v_mfma_f32_16x16x32_bf16 v[24:27], v[40:43], v[244:247], v[24:27]
s_waitcnt lgkmcnt(4)
v_mfma_f32_16x16x32_bf16 v[12:15], v[44:47], v[212:215], v[12:15]
ds_read_b64_tr_b16 v[40:41], v2 offset:2048
ds_read_b64_tr_b16 v[42:43], v2 offset:3072
v_mfma_f32_16x16x32_bf16 v[20:23], v[44:47], v[228:231], v[20:23]
v_mfma_f32_16x16x32_bf16 v[28:31], v[44:47], v[244:247], v[28:31]
v_cvt_pk_bf16_f32 v48, v8, v9
v_cvt_pk_bf16_f32 v49, v10, v11
s_nop 1
v_cvt_pk_bf16_f32 v50, v12, v13
v_cvt_pk_bf16_f32 v51, v14, v15
v_cvt_pk_bf16_f32 v52, v16, v17
v_cvt_pk_bf16_f32 v53, v18, v19
v_cvt_pk_bf16_f32 v54, v20, v21
v_cvt_pk_bf16_f32 v55, v22, v23
v_cvt_pk_bf16_f32 v248, v24, v25
v_cvt_pk_bf16_f32 v249, v26, v27
v_cvt_pk_bf16_f32 v250, v28, v29
v_cvt_pk_bf16_f32 v251, v30, v31
s_barrier
s_waitcnt lgkmcnt(4)
v_mfma_f32_16x16x32_bf16 v[8:11], v[32:35], v[56:59], 0
ds_read_b64_tr_b16 v[44:45], v3 offset:2048
ds_read_b64_tr_b16 v[46:47], v3 offset:3072
v_mfma_f32_16x16x32_bf16 v[16:19], v[32:35], v[72:75], 0
buffer_store_dwordx4 v[48:51], v4, s[24:27], s74 offen sc1
v_mfma_f32_16x16x32_bf16 v[24:27], v[32:35], v[88:91], 0
s_waitcnt lgkmcnt(4)
v_mfma_f32_16x16x32_bf16 v[12:15], v[36:39], v[56:59], 0
ds_read_b64_tr_b16 v[32:33], v2 offset:4096
ds_read_b64_tr_b16 v[34:35], v2 offset:5120
v_mfma_f32_16x16x32_bf16 v[20:23], v[36:39], v[72:75], 0
v_mfma_f32_16x16x32_bf16 v[28:31], v[36:39], v[88:91], 0
s_waitcnt lgkmcnt(4)
v_mfma_f32_16x16x32_bf16 v[8:11], v[40:43], v[60:63], v[8:11]
ds_read_b64_tr_b16 v[36:37], v3 offset:4096
ds_read_b64_tr_b16 v[38:39], v3 offset:5120
v_mfma_f32_16x16x32_bf16 v[16:19], v[40:43], v[76:79], v[16:19]
v_mfma_f32_16x16x32_bf16 v[24:27], v[40:43], v[92:95], v[24:27]
s_waitcnt lgkmcnt(4)
v_mfma_f32_16x16x32_bf16 v[12:15], v[44:47], v[60:63], v[12:15]
ds_read_b64_tr_b16 v[40:41], v2 offset:6144
ds_read_b64_tr_b16 v[42:43], v2 offset:7168
v_mfma_f32_16x16x32_bf16 v[20:23], v[44:47], v[76:79], v[20:23]
v_mfma_f32_16x16x32_bf16 v[28:31], v[44:47], v[92:95], v[28:31]
s_waitcnt lgkmcnt(4)
v_mfma_f32_16x16x32_bf16 v[8:11], v[32:35], v[64:67], v[8:11]
ds_read_b64_tr_b16 v[44:45], v3 offset:6144
ds_read_b64_tr_b16 v[46:47], v3 offset:7168
v_mfma_f32_16x16x32_bf16 v[16:19], v[32:35], v[80:83], v[16:19]
v_mfma_f32_16x16x32_bf16 v[24:27], v[32:35], v[96:99], v[24:27]
s_waitcnt lgkmcnt(4)
v_mfma_f32_16x16x32_bf16 v[12:15], v[36:39], v[64:67], v[12:15]
ds_read_b64_tr_b16 v[32:33], v2 offset:8192
ds_read_b64_tr_b16 v[34:35], v2 offset:9216
v_mfma_f32_16x16x32_bf16 v[20:23], v[36:39], v[80:83], v[20:23]
v_mfma_f32_16x16x32_bf16 v[28:31], v[36:39], v[96:99], v[28:31]
s_waitcnt lgkmcnt(4)
v_mfma_f32_16x16x32_bf16 v[8:11], v[40:43], v[68:71], v[8:11]
ds_read_b64_tr_b16 v[36:37], v3 offset:8192
ds_read_b64_tr_b16 v[38:39], v3 offset:9216
v_mfma_f32_16x16x32_bf16 v[16:19], v[40:43], v[84:87], v[16:19]
v_mfma_f32_16x16x32_bf16 v[24:27], v[40:43], v[100:103], v[24:27]
s_waitcnt lgkmcnt(4)
v_mfma_f32_16x16x32_bf16 v[12:15], v[44:47], v[68:71], v[12:15]
ds_read_b64_tr_b16 v[40:41], v2 offset:10240
ds_read_b64_tr_b16 v[42:43], v2 offset:11264
v_mfma_f32_16x16x32_bf16 v[20:23], v[44:47], v[84:87], v[20:23]
v_mfma_f32_16x16x32_bf16 v[28:31], v[44:47], v[100:103], v[28:31]
s_barrier
s_waitcnt lgkmcnt(4)
v_mfma_f32_16x16x32_bf16 v[8:11], v[32:35], v[104:107], v[8:11]
ds_read_b64_tr_b16 v[44:45], v3 offset:10240
ds_read_b64_tr_b16 v[46:47], v3 offset:11264
v_mfma_f32_16x16x32_bf16 v[16:19], v[32:35], v[120:123], v[16:19]
buffer_store_dwordx4 v[52:55], v4, s[24:27], s74 offen offset:1024 sc1
v_mfma_f32_16x16x32_bf16 v[24:27], v[32:35], v[136:139], v[24:27]
s_waitcnt lgkmcnt(4)
v_mfma_f32_16x16x32_bf16 v[12:15], v[36:39], v[104:107], v[12:15]
ds_read_b64_tr_b16 v[32:33], v2 offset:12288
ds_read_b64_tr_b16 v[34:35], v2 offset:13312
v_mfma_f32_16x16x32_bf16 v[20:23], v[36:39], v[120:123], v[20:23]
v_mfma_f32_16x16x32_bf16 v[28:31], v[36:39], v[136:139], v[28:31]
s_waitcnt lgkmcnt(4)
v_mfma_f32_16x16x32_bf16 v[8:11], v[40:43], v[108:111], v[8:11]
ds_read_b64_tr_b16 v[36:37], v3 offset:12288
ds_read_b64_tr_b16 v[38:39], v3 offset:13312
v_mfma_f32_16x16x32_bf16 v[16:19], v[40:43], v[124:127], v[16:19]
v_mfma_f32_16x16x32_bf16 v[24:27], v[40:43], v[140:143], v[24:27]
s_waitcnt lgkmcnt(4)
v_mfma_f32_16x16x32_bf16 v[12:15], v[44:47], v[108:111], v[12:15]
ds_read_b64_tr_b16 v[40:41], v2 offset:14336
ds_read_b64_tr_b16 v[42:43], v2 offset:15360
v_mfma_f32_16x16x32_bf16 v[20:23], v[44:47], v[124:127], v[20:23]
v_mfma_f32_16x16x32_bf16 v[28:31], v[44:47], v[140:143], v[28:31]
s_waitcnt lgkmcnt(4)
v_mfma_f32_16x16x32_bf16 v[8:11], v[32:35], v[112:115], v[8:11]
ds_read_b64_tr_b16 v[44:45], v3 offset:14336
ds_read_b64_tr_b16 v[46:47], v3 offset:15360
v_mfma_f32_16x16x32_bf16 v[16:19], v[32:35], v[128:131], v[16:19]
v_mfma_f32_16x16x32_bf16 v[24:27], v[32:35], v[144:147], v[24:27]
s_waitcnt lgkmcnt(4)
v_mfma_f32_16x16x32_bf16 v[12:15], v[36:39], v[112:115], v[12:15]
ds_read_b64_tr_b16 v[32:33], v2 offset:16384
ds_read_b64_tr_b16 v[34:35], v2 offset:17408
v_mfma_f32_16x16x32_bf16 v[20:23], v[36:39], v[128:131], v[20:23]
v_mfma_f32_16x16x32_bf16 v[28:31], v[36:39], v[144:147], v[28:31]
s_waitcnt lgkmcnt(4)
v_mfma_f32_16x16x32_bf16 v[8:11], v[40:43], v[116:119], v[8:11]
ds_read_b64_tr_b16 v[36:37], v3 offset:16384
ds_read_b64_tr_b16 v[38:39], v3 offset:17408
v_mfma_f32_16x16x32_bf16 v[16:19], v[40:43], v[132:135], v[16:19]
v_mfma_f32_16x16x32_bf16 v[24:27], v[40:43], v[148:151], v[24:27]
s_waitcnt lgkmcnt(4)
v_mfma_f32_16x16x32_bf16 v[12:15], v[44:47], v[116:119], v[12:15]
ds_read_b64_tr_b16 v[40:41], v2 offset:18432
ds_read_b64_tr_b16 v[42:43], v2 offset:19456
v_mfma_f32_16x16x32_bf16 v[20:23], v[44:47], v[132:135], v[20:23]
v_mfma_f32_16x16x32_bf16 v[28:31], v[44:47], v[148:151], v[28:31]
s_barrier
s_waitcnt lgkmcnt(4)
v_mfma_f32_16x16x32_bf16 v[8:11], v[32:35], v[152:155], v[8:11]
ds_read_b64_tr_b16 v[44:45], v3 offset:18432
ds_read_b64_tr_b16 v[46:47], v3 offset:19456
v_mfma_f32_16x16x32_bf16 v[16:19], v[32:35], v[168:171], v[16:19]
buffer_store_dwordx4 v[248:251], v4, s[24:27], s74 offen offset:2048 sc1
s_add_u32 s74, s74, 0xc00
s_sub_u32 s55, s74, 0x6c00
s_cmp_ge_u32 s74, s75
s_cselect_b32 s74, s55, s74
v_mfma_f32_16x16x32_bf16 v[24:27], v[32:35], v[184:187], v[24:27]
s_waitcnt lgkmcnt(4)
v_mfma_f32_16x16x32_bf16 v[12:15], v[36:39], v[152:155], v[12:15]
ds_read_b64_tr_b16 v[32:33], v2 offset:20480
ds_read_b64_tr_b16 v[34:35], v2 offset:21504
v_mfma_f32_16x16x32_bf16 v[20:23], v[36:39], v[168:171], v[20:23]
v_mfma_f32_16x16x32_bf16 v[28:31], v[36:39], v[184:187], v[28:31]
s_waitcnt lgkmcnt(4)
v_mfma_f32_16x16x32_bf16 v[8:11], v[40:43], v[156:159], v[8:11]
ds_read_b64_tr_b16 v[36:37], v3 offset:20480
ds_read_b64_tr_b16 v[38:39], v3 offset:21504
v_mfma_f32_16x16x32_bf16 v[16:19], v[40:43], v[172:175], v[16:19]
v_mfma_f32_16x16x32_bf16 v[24:27], v[40:43], v[188:191], v[24:27]
s_waitcnt lgkmcnt(4)
v_mfma_f32_16x16x32_bf16 v[12:15], v[44:47], v[156:159], v[12:15]
ds_read_b64_tr_b16 v[40:41], v2 offset:22528
ds_read_b64_tr_b16 v[42:43], v2 offset:23552
v_mfma_f32_16x16x32_bf16 v[20:23], v[44:47], v[172:175], v[20:23]
v_mfma_f32_16x16x32_bf16 v[28:31], v[44:47], v[188:191], v[28:31]
s_waitcnt lgkmcnt(4)
v_mfma_f32_16x16x32_bf16 v[8:11], v[32:35], v[160:163], v[8:11]
ds_read_b64_tr_b16 v[44:45], v3 offset:22528
ds_read_b64_tr_b16 v[46:47], v3 offset:23552
v_mfma_f32_16x16x32_bf16 v[16:19], v[32:35], v[176:179], v[16:19]
v_mfma_f32_16x16x32_bf16 v[24:27], v[32:35], v[192:195], v[24:27]
s_waitcnt lgkmcnt(4)
v_mfma_f32_16x16x32_bf16 v[12:15], v[36:39], v[160:163], v[12:15]
ds_read_b64_tr_b16 v[32:33], v2 offset:32768
ds_read_b64_tr_b16 v[34:35], v2 offset:33792
v_mfma_f32_16x16x32_bf16 v[20:23], v[36:39], v[176:179], v[20:23]
v_mfma_f32_16x16x32_bf16 v[28:31], v[36:39], v[192:195], v[28:31]
s_waitcnt lgkmcnt(4)
v_mfma_f32_16x16x32_bf16 v[8:11], v[40:43], v[164:167], v[8:11]
ds_read_b64_tr_b16 v[36:37], v3 offset:32768
ds_read_b64_tr_b16 v[38:39], v3 offset:33792
v_mfma_f32_16x16x32_bf16 v[16:19], v[40:43], v[180:183], v[16:19]
v_mfma_f32_16x16x32_bf16 v[24:27], v[40:43], v[196:199], v[24:27]
s_waitcnt lgkmcnt(4)
v_mfma_f32_16x16x32_bf16 v[12:15], v[44:47], v[164:167], v[12:15]
ds_read_b64_tr_b16 v[40:41], v2 offset:34816
ds_read_b64_tr_b16 v[42:43], v2 offset:35840
v_mfma_f32_16x16x32_bf16 v[20:23], v[44:47], v[180:183], v[20:23]
v_mfma_f32_16x16x32_bf16 v[28:31], v[44:47], v[196:199], v[28:31]
s_barrier
s_waitcnt lgkmcnt(4)
v_mfma_f32_16x16x32_bf16 v[8:11], v[32:35], v[200:203], v[8:11]
ds_read_b64_tr_b16 v[44:45], v3 offset:34816
ds_read_b64_tr_b16 v[46:47], v3 offset:35840
v_mfma_f32_16x16x32_bf16 v[16:19], v[32:35], v[216:219], v[16:19]
v_mfma_f32_16x16x32_bf16 v[24:27], v[32:35], v[232:235], v[24:27]
s_waitcnt lgkmcnt(4)
v_mfma_f32_16x16x32_bf16 v[12:15], v[36:39], v[200:203], v[12:15]
ds_read_b64_tr_b16 v[32:33], v2 offset:36864
ds_read_b64_tr_b16 v[34:35], v2 offset:37888
v_mfma_f32_16x16x32_bf16 v[20:23], v[36:39], v[216:219], v[20:23]
v_mfma_f32_16x16x32_bf16 v[28:31], v[36:39], v[232:235], v[28:31]
s_waitcnt lgkmcnt(4)
v_mfma_f32_16x16x32_bf16 v[8:11], v[40:43], v[204:207], v[8:11]
ds_read_b64_tr_b16 v[36:37], v3 offset:36864
ds_read_b64_tr_b16 v[38:39], v3 offset:37888
v_mfma_f32_16x16x32_bf16 v[16:19], v[40:43], v[220:223], v[16:19]
v_mfma_f32_16x16x32_bf16 v[24:27], v[40:43], v[236:239], v[24:27]
s_waitcnt lgkmcnt(4)
v_mfma_f32_16x16x32_bf16 v[12:15], v[44:47], v[204:207], v[12:15]
ds_read_b64_tr_b16 v[40:41], v2 offset:38912
ds_read_b64_tr_b16 v[42:43], v2 offset:39936
v_mfma_f32_16x16x32_bf16 v[20:23], v[44:47], v[220:223], v[20:23]
v_mfma_f32_16x16x32_bf16 v[28:31], v[44:47], v[236:239], v[28:31]
s_waitcnt lgkmcnt(4)
v_mfma_f32_16x16x32_bf16 v[8:11], v[32:35], v[208:211], v[8:11]
ds_read_b64_tr_b16 v[44:45], v3 offset:38912
ds_read_b64_tr_b16 v[46:47], v3 offset:39936
v_mfma_f32_16x16x32_bf16 v[16:19], v[32:35], v[224:227], v[16:19]
v_mfma_f32_16x16x32_bf16 v[24:27], v[32:35], v[240:243], v[24:27]
s_waitcnt lgkmcnt(4)
v_mfma_f32_16x16x32_bf16 v[12:15], v[36:39], v[208:211], v[12:15]
ds_read_b64_tr_b16 v[32:33], v2 offset:24576
ds_read_b64_tr_b16 v[34:35], v2 offset:25600
v_mfma_f32_16x16x32_bf16 v[20:23], v[36:39], v[224:227], v[20:23]
v_mfma_f32_16x16x32_bf16 v[28:31], v[36:39], v[240:243], v[28:31]
s_waitcnt lgkmcnt(4)
v_mfma_f32_16x16x32_bf16 v[8:11], v[40:43], v[212:215], v[8:11]
ds_read_b64_tr_b16 v[36:37], v3 offset:24576
ds_read_b64_tr_b16 v[38:39], v3 offset:25600
v_mfma_f32_16x16x32_bf16 v[16:19], v[40:43], v[228:231], v[16:19]
v_mfma_f32_16x16x32_bf16 v[24:27], v[40:43], v[244:247], v[24:27]
s_waitcnt lgkmcnt(4)
v_mfma_f32_16x16x32_bf16 v[12:15], v[44:47], v[212:215], v[12:15]
ds_read_b64_tr_b16 v[40:41], v2 offset:26624
ds_read_b64_tr_b16 v[42:43], v2 offset:27648
v_mfma_f32_16x16x32_bf16 v[20:23], v[44:47], v[228:231], v[20:23]
v_mfma_f32_16x16x32_bf16 v[28:31], v[44:47], v[244:247], v[28:31]
v_cvt_pk_bf16_f32 v48, v8, v9
v_cvt_pk_bf16_f32 v49, v10, v11
s_nop 1
v_cvt_pk_bf16_f32 v50, v12, v13
v_cvt_pk_bf16_f32 v51, v14, v15
v_cvt_pk_bf16_f32 v52, v16, v17
v_cvt_pk_bf16_f32 v53, v18, v19
v_cvt_pk_bf16_f32 v54, v20, v21
v_cvt_pk_bf16_f32 v55, v22, v23
v_cvt_pk_bf16_f32 v248, v24, v25
v_cvt_pk_bf16_f32 v249, v26, v27
v_cvt_pk_bf16_f32 v250, v28, v29
v_cvt_pk_bf16_f32 v251, v30, v31
s_barrier
s_waitcnt lgkmcnt(4)
v_mfma_f32_16x16x32_bf16 v[8:11], v[32:35], v[56:59], 0
ds_read_b64_tr_b16 v[44:45], v3 offset:26624
ds_read_b64_tr_b16 v[46:47], v3 offset:27648
v_mfma_f32_16x16x32_bf16 v[16:19], v[32:35], v[72:75], 0
buffer_store_dwordx4 v[48:51], v4, s[24:27], s74 offen sc1
v_mfma_f32_16x16x32_bf16 v[24:27], v[32:35], v[88:91], 0
s_waitcnt lgkmcnt(4)
v_mfma_f32_16x16x32_bf16 v[12:15], v[36:39], v[56:59], 0
ds_read_b64_tr_b16 v[32:33], v2 offset:28672
ds_read_b64_tr_b16 v[34:35], v2 offset:29696
v_mfma_f32_16x16x32_bf16 v[20:23], v[36:39], v[72:75], 0
v_mfma_f32_16x16x32_bf16 v[28:31], v[36:39], v[88:91], 0
s_waitcnt lgkmcnt(4)
v_mfma_f32_16x16x32_bf16 v[8:11], v[40:43], v[60:63], v[8:11]
ds_read_b64_tr_b16 v[36:37], v3 offset:28672
ds_read_b64_tr_b16 v[38:39], v3 offset:29696
v_mfma_f32_16x16x32_bf16 v[16:19], v[40:43], v[76:79], v[16:19]
v_mfma_f32_16x16x32_bf16 v[24:27], v[40:43], v[92:95], v[24:27]
s_waitcnt lgkmcnt(4)
v_mfma_f32_16x16x32_bf16 v[12:15], v[44:47], v[60:63], v[12:15]
ds_read_b64_tr_b16 v[40:41], v2 offset:30720
ds_read_b64_tr_b16 v[42:43], v2 offset:31744
v_mfma_f32_16x16x32_bf16 v[20:23], v[44:47], v[76:79], v[20:23]
v_mfma_f32_16x16x32_bf16 v[28:31], v[44:47], v[92:95], v[28:31]
s_waitcnt lgkmcnt(4)
v_mfma_f32_16x16x32_bf16 v[8:11], v[32:35], v[64:67], v[8:11]
ds_read_b64_tr_b16 v[44:45], v3 offset:30720
ds_read_b64_tr_b16 v[46:47], v3 offset:31744
v_mfma_f32_16x16x32_bf16 v[16:19], v[32:35], v[80:83], v[16:19]
v_mfma_f32_16x16x32_bf16 v[24:27], v[32:35], v[96:99], v[24:27]
s_waitcnt lgkmcnt(4)
v_mfma_f32_16x16x32_bf16 v[12:15], v[36:39], v[64:67], v[12:15]
ds_read_b64_tr_b16 v[32:33], v2 offset:40960
ds_read_b64_tr_b16 v[34:35], v2 offset:41984
v_mfma_f32_16x16x32_bf16 v[20:23], v[36:39], v[80:83], v[20:23]
v_mfma_f32_16x16x32_bf16 v[28:31], v[36:39], v[96:99], v[28:31]
s_waitcnt lgkmcnt(4)
v_mfma_f32_16x16x32_bf16 v[8:11], v[40:43], v[68:71], v[8:11]
ds_read_b64_tr_b16 v[36:37], v3 offset:40960
ds_read_b64_tr_b16 v[38:39], v3 offset:41984
v_mfma_f32_16x16x32_bf16 v[16:19], v[40:43], v[84:87], v[16:19]
v_mfma_f32_16x16x32_bf16 v[24:27], v[40:43], v[100:103], v[24:27]
s_waitcnt lgkmcnt(4)
v_mfma_f32_16x16x32_bf16 v[12:15], v[44:47], v[68:71], v[12:15]
ds_read_b64_tr_b16 v[40:41], v2 offset:43008
ds_read_b64_tr_b16 v[42:43], v2 offset:44032
v_mfma_f32_16x16x32_bf16 v[20:23], v[44:47], v[84:87], v[20:23]
v_mfma_f32_16x16x32_bf16 v[28:31], v[44:47], v[100:103], v[28:31]
s_barrier
s_waitcnt lgkmcnt(4)
v_mfma_f32_16x16x32_bf16 v[8:11], v[32:35], v[104:107], v[8:11]
ds_read_b64_tr_b16 v[44:45], v3 offset:43008
ds_read_b64_tr_b16 v[46:47], v3 offset:44032
v_mfma_f32_16x16x32_bf16 v[16:19], v[32:35], v[120:123], v[16:19]
buffer_store_dwordx4 v[52:55], v4, s[24:27], s74 offen offset:1024 sc1
v_mfma_f32_16x16x32_bf16 v[24:27], v[32:35], v[136:139], v[24:27]
s_waitcnt lgkmcnt(4)
v_mfma_f32_16x16x32_bf16 v[12:15], v[36:39], v[104:107], v[12:15]
ds_read_b64_tr_b16 v[32:33], v2 offset:45056
ds_read_b64_tr_b16 v[34:35], v2 offset:46080
v_mfma_f32_16x16x32_bf16 v[20:23], v[36:39], v[120:123], v[20:23]
v_mfma_f32_16x16x32_bf16 v[28:31], v[36:39], v[136:139], v[28:31]
s_waitcnt lgkmcnt(4)
v_mfma_f32_16x16x32_bf16 v[8:11], v[40:43], v[108:111], v[8:11]
ds_read_b64_tr_b16 v[36:37], v3 offset:45056
ds_read_b64_tr_b16 v[38:39], v3 offset:46080
v_mfma_f32_16x16x32_bf16 v[16:19], v[40:43], v[124:127], v[16:19]
v_mfma_f32_16x16x32_bf16 v[24:27], v[40:43], v[140:143], v[24:27]
s_waitcnt lgkmcnt(4)
v_mfma_f32_16x16x32_bf16 v[12:15], v[44:47], v[108:111], v[12:15]
ds_read_b64_tr_b16 v[40:41], v2 offset:47104
ds_read_b64_tr_b16 v[42:43], v2 offset:48128
v_mfma_f32_16x16x32_bf16 v[20:23], v[44:47], v[124:127], v[20:23]
v_mfma_f32_16x16x32_bf16 v[28:31], v[44:47], v[140:143], v[28:31]
s_waitcnt lgkmcnt(4)
v_mfma_f32_16x16x32_bf16 v[8:11], v[32:35], v[112:115], v[8:11]
ds_read_b64_tr_b16 v[44:45], v3 offset:47104
ds_read_b64_tr_b16 v[46:47], v3 offset:48128
v_mfma_f32_16x16x32_bf16 v[16:19], v[32:35], v[128:131], v[16:19]
v_mfma_f32_16x16x32_bf16 v[24:27], v[32:35], v[144:147], v[24:27]
s_waitcnt lgkmcnt(4)
v_mfma_f32_16x16x32_bf16 v[12:15], v[36:39], v[112:115], v[12:15]
ds_read_b64_tr_b16 v[32:33], v2 offset:49152
ds_read_b64_tr_b16 v[34:35], v2 offset:50176
v_mfma_f32_16x16x32_bf16 v[20:23], v[36:39], v[128:131], v[20:23]
v_mfma_f32_16x16x32_bf16 v[28:31], v[36:39], v[144:147], v[28:31]
s_waitcnt lgkmcnt(4)
v_mfma_f32_16x16x32_bf16 v[8:11], v[40:43], v[116:119], v[8:11]
ds_read_b64_tr_b16 v[36:37], v3 offset:49152
ds_read_b64_tr_b16 v[38:39], v3 offset:50176
v_mfma_f32_16x16x32_bf16 v[16:19], v[40:43], v[132:135], v[16:19]
v_mfma_f32_16x16x32_bf16 v[24:27], v[40:43], v[148:151], v[24:27]
s_waitcnt lgkmcnt(4)
v_mfma_f32_16x16x32_bf16 v[12:15], v[44:47], v[116:119], v[12:15]
ds_read_b64_tr_b16 v[40:41], v2 offset:51200
ds_read_b64_tr_b16 v[42:43], v2 offset:52224
v_mfma_f32_16x16x32_bf16 v[20:23], v[44:47], v[132:135], v[20:23]
v_mfma_f32_16x16x32_bf16 v[28:31], v[44:47], v[148:151], v[28:31]
s_barrier
s_waitcnt lgkmcnt(4)
v_mfma_f32_16x16x32_bf16 v[8:11], v[32:35], v[152:155], v[8:11]
ds_read_b64_tr_b16 v[44:45], v3 offset:51200
ds_read_b64_tr_b16 v[46:47], v3 offset:52224
v_mfma_f32_16x16x32_bf16 v[16:19], v[32:35], v[168:171], v[16:19]
buffer_store_dwordx4 v[248:251], v4, s[24:27], s74 offen offset:2048 sc1
s_add_u32 s74, s74, 0xc00
s_sub_u32 s55, s74, 0x6c00
s_cmp_ge_u32 s74, s75
s_cselect_b32 s74, s55, s74
v_mfma_f32_16x16x32_bf16 v[24:27], v[32:35], v[184:187], v[24:27]
s_waitcnt lgkmcnt(4)
v_mfma_f32_16x16x32_bf16 v[12:15], v[36:39], v[152:155], v[12:15]
ds_read_b64_tr_b16 v[32:33], v2 offset:53248
ds_read_b64_tr_b16 v[34:35], v2 offset:54272
v_mfma_f32_16x16x32_bf16 v[20:23], v[36:39], v[168:171], v[20:23]
v_mfma_f32_16x16x32_bf16 v[28:31], v[36:39], v[184:187], v[28:31]
s_waitcnt lgkmcnt(4)
v_mfma_f32_16x16x32_bf16 v[8:11], v[40:43], v[156:159], v[8:11]
ds_read_b64_tr_b16 v[36:37], v3 offset:53248
ds_read_b64_tr_b16 v[38:39], v3 offset:54272
v_mfma_f32_16x16x32_bf16 v[16:19], v[40:43], v[172:175], v[16:19]
v_mfma_f32_16x16x32_bf16 v[24:27], v[40:43], v[188:191], v[24:27]
s_waitcnt lgkmcnt(4)
v_mfma_f32_16x16x32_bf16 v[12:15], v[44:47], v[156:159], v[12:15]
ds_read_b64_tr_b16 v[40:41], v2 offset:55296
ds_read_b64_tr_b16 v[42:43], v2 offset:56320
v_mfma_f32_16x16x32_bf16 v[20:23], v[44:47], v[172:175], v[20:23]
v_mfma_f32_16x16x32_bf16 v[28:31], v[44:47], v[188:191], v[28:31]
s_waitcnt lgkmcnt(4)
v_mfma_f32_16x16x32_bf16 v[8:11], v[32:35], v[160:163], v[8:11]
ds_read_b64_tr_b16 v[44:45], v3 offset:55296
ds_read_b64_tr_b16 v[46:47], v3 offset:56320
v_mfma_f32_16x16x32_bf16 v[16:19], v[32:35], v[176:179], v[16:19]
v_mfma_f32_16x16x32_bf16 v[24:27], v[32:35], v[192:195], v[24:27]
s_waitcnt lgkmcnt(4)
v_mfma_f32_16x16x32_bf16 v[12:15], v[36:39], v[160:163], v[12:15]
ds_read_b64_tr_b16 v[32:33], v2 offset:57344
ds_read_b64_tr_b16 v[34:35], v2 offset:58368
v_mfma_f32_16x16x32_bf16 v[20:23], v[36:39], v[176:179], v[20:23]
v_mfma_f32_16x16x32_bf16 v[28:31], v[36:39], v[192:195], v[28:31]
s_waitcnt lgkmcnt(4)
v_mfma_f32_16x16x32_bf16 v[8:11], v[40:43], v[164:167], v[8:11]
ds_read_b64_tr_b16 v[36:37], v3 offset:57344
ds_read_b64_tr_b16 v[38:39], v3 offset:58368
v_mfma_f32_16x16x32_bf16 v[16:19], v[40:43], v[180:183], v[16:19]
v_mfma_f32_16x16x32_bf16 v[24:27], v[40:43], v[196:199], v[24:27]
s_waitcnt lgkmcnt(4)
v_mfma_f32_16x16x32_bf16 v[12:15], v[44:47], v[164:167], v[12:15]
ds_read_b64_tr_b16 v[40:41], v2 offset:59392
ds_read_b64_tr_b16 v[42:43], v2 offset:60416
v_mfma_f32_16x16x32_bf16 v[20:23], v[44:47], v[180:183], v[20:23]
v_mfma_f32_16x16x32_bf16 v[28:31], v[44:47], v[196:199], v[28:31]
s_barrier
s_waitcnt lgkmcnt(4)
v_mfma_f32_16x16x32_bf16 v[8:11], v[32:35], v[200:203], v[8:11]
ds_read_b64_tr_b16 v[44:45], v3 offset:59392
ds_read_b64_tr_b16 v[46:47], v3 offset:60416
v_mfma_f32_16x16x32_bf16 v[16:19], v[32:35], v[216:219], v[16:19]
v_mfma_f32_16x16x32_bf16 v[24:27], v[32:35], v[232:235], v[24:27]
s_waitcnt lgkmcnt(4)
v_mfma_f32_16x16x32_bf16 v[12:15], v[36:39], v[200:203], v[12:15]
ds_read_b64_tr_b16 v[32:33], v2 offset:61440
ds_read_b64_tr_b16 v[34:35], v2 offset:62464
v_mfma_f32_16x16x32_bf16 v[20:23], v[36:39], v[216:219], v[20:23]
v_mfma_f32_16x16x32_bf16 v[28:31], v[36:39], v[232:235], v[28:31]
s_waitcnt lgkmcnt(4)
v_mfma_f32_16x16x32_bf16 v[8:11], v[40:43], v[204:207], v[8:11]
ds_read_b64_tr_b16 v[36:37], v3 offset:61440
ds_read_b64_tr_b16 v[38:39], v3 offset:62464
v_mfma_f32_16x16x32_bf16 v[16:19], v[40:43], v[220:223], v[16:19]
v_mfma_f32_16x16x32_bf16 v[24:27], v[40:43], v[236:239], v[24:27]
s_waitcnt lgkmcnt(4)
v_mfma_f32_16x16x32_bf16 v[12:15], v[44:47], v[204:207], v[12:15]
ds_read_b64_tr_b16 v[40:41], v2 offset:63488
ds_read_b64_tr_b16 v[42:43], v2 offset:64512
v_mfma_f32_16x16x32_bf16 v[20:23], v[44:47], v[220:223], v[20:23]
v_mfma_f32_16x16x32_bf16 v[28:31], v[44:47], v[236:239], v[28:31]
s_waitcnt lgkmcnt(4)
v_mfma_f32_16x16x32_bf16 v[8:11], v[32:35], v[208:211], v[8:11]
ds_read_b64_tr_b16 v[44:45], v3 offset:63488
ds_read_b64_tr_b16 v[46:47], v3 offset:64512
v_mfma_f32_16x16x32_bf16 v[16:19], v[32:35], v[224:227], v[16:19]
v_mfma_f32_16x16x32_bf16 v[24:27], v[32:35], v[240:243], v[24:27]
s_waitcnt lgkmcnt(4)
v_mfma_f32_16x16x32_bf16 v[12:15], v[36:39], v[208:211], v[12:15]
ds_read_b64_tr_b16 v[32:33], v2
ds_read_b64_tr_b16 v[34:35], v2 offset:1024
v_mfma_f32_16x16x32_bf16 v[20:23], v[36:39], v[224:227], v[20:23]
v_mfma_f32_16x16x32_bf16 v[28:31], v[36:39], v[240:243], v[28:31]
s_waitcnt lgkmcnt(4)
v_mfma_f32_16x16x32_bf16 v[8:11], v[40:43], v[212:215], v[8:11]
ds_read_b64_tr_b16 v[36:37], v3
ds_read_b64_tr_b16 v[38:39], v3 offset:1024
v_mfma_f32_16x16x32_bf16 v[16:19], v[40:43], v[228:231], v[16:19]
v_mfma_f32_16x16x32_bf16 v[24:27], v[40:43], v[244:247], v[24:27]
s_waitcnt lgkmcnt(4)
v_mfma_f32_16x16x32_bf16 v[12:15], v[44:47], v[212:215], v[12:15]
ds_read_b64_tr_b16 v[40:41], v2 offset:2048
ds_read_b64_tr_b16 v[42:43], v2 offset:3072
v_mfma_f32_16x16x32_bf16 v[20:23], v[44:47], v[228:231], v[20:23]
v_mfma_f32_16x16x32_bf16 v[28:31], v[44:47], v[244:247], v[28:31]
v_cvt_pk_bf16_f32 v48, v8, v9
v_cvt_pk_bf16_f32 v49, v10, v11
s_nop 1
v_cvt_pk_bf16_f32 v50, v12, v13
v_cvt_pk_bf16_f32 v51, v14, v15
v_cvt_pk_bf16_f32 v52, v16, v17
v_cvt_pk_bf16_f32 v53, v18, v19
v_cvt_pk_bf16_f32 v54, v20, v21
v_cvt_pk_bf16_f32 v55, v22, v23
v_cvt_pk_bf16_f32 v248, v24, v25
v_cvt_pk_bf16_f32 v249, v26, v27
v_cvt_pk_bf16_f32 v250, v28, v29
v_cvt_pk_bf16_f32 v251, v30, v31
s_barrier
s_waitcnt lgkmcnt(4)
v_mfma_f32_16x16x32_bf16 v[8:11], v[32:35], v[56:59], 0
ds_read_b64_tr_b16 v[44:45], v3 offset:2048
ds_read_b64_tr_b16 v[46:47], v3 offset:3072
v_mfma_f32_16x16x32_bf16 v[16:19], v[32:35], v[72:75], 0
buffer_store_dwordx4 v[48:51], v4, s[24:27], s74 offen sc1
v_mfma_f32_16x16x32_bf16 v[24:27], v[32:35], v[88:91], 0
s_waitcnt lgkmcnt(4)
v_mfma_f32_16x16x32_bf16 v[12:15], v[36:39], v[56:59], 0
ds_read_b64_tr_b16 v[32:33], v2 offset:4096
ds_read_b64_tr_b16 v[34:35], v2 offset:5120
v_mfma_f32_16x16x32_bf16 v[20:23], v[36:39], v[72:75], 0
v_mfma_f32_16x16x32_bf16 v[28:31], v[36:39], v[88:91], 0
s_waitcnt lgkmcnt(4)
v_mfma_f32_16x16x32_bf16 v[8:11], v[40:43], v[60:63], v[8:11]
ds_read_b64_tr_b16 v[36:37], v3 offset:4096
ds_read_b64_tr_b16 v[38:39], v3 offset:5120
v_mfma_f32_16x16x32_bf16 v[16:19], v[40:43], v[76:79], v[16:19]
v_mfma_f32_16x16x32_bf16 v[24:27], v[40:43], v[92:95], v[24:27]
s_waitcnt lgkmcnt(4)
v_mfma_f32_16x16x32_bf16 v[12:15], v[44:47], v[60:63], v[12:15]
ds_read_b64_tr_b16 v[40:41], v2 offset:6144
ds_read_b64_tr_b16 v[42:43], v2 offset:7168
v_mfma_f32_16x16x32_bf16 v[20:23], v[44:47], v[76:79], v[20:23]
v_mfma_f32_16x16x32_bf16 v[28:31], v[44:47], v[92:95], v[28:31]
s_waitcnt lgkmcnt(4)
v_mfma_f32_16x16x32_bf16 v[8:11], v[32:35], v[64:67], v[8:11]
ds_read_b64_tr_b16 v[44:45], v3 offset:6144
ds_read_b64_tr_b16 v[46:47], v3 offset:7168
v_mfma_f32_16x16x32_bf16 v[16:19], v[32:35], v[80:83], v[16:19]
v_mfma_f32_16x16x32_bf16 v[24:27], v[32:35], v[96:99], v[24:27]
s_waitcnt lgkmcnt(4)
v_mfma_f32_16x16x32_bf16 v[12:15], v[36:39], v[64:67], v[12:15]
ds_read_b64_tr_b16 v[32:33], v2 offset:8192
ds_read_b64_tr_b16 v[34:35], v2 offset:9216
v_mfma_f32_16x16x32_bf16 v[20:23], v[36:39], v[80:83], v[20:23]
v_mfma_f32_16x16x32_bf16 v[28:31], v[36:39], v[96:99], v[28:31]
s_waitcnt lgkmcnt(4)
v_mfma_f32_16x16x32_bf16 v[8:11], v[40:43], v[68:71], v[8:11]
ds_read_b64_tr_b16 v[36:37], v3 offset:8192
ds_read_b64_tr_b16 v[38:39], v3 offset:9216
v_mfma_f32_16x16x32_bf16 v[16:19], v[40:43], v[84:87], v[16:19]
v_mfma_f32_16x16x32_bf16 v[24:27], v[40:43], v[100:103], v[24:27]
s_waitcnt lgkmcnt(4)
v_mfma_f32_16x16x32_bf16 v[12:15], v[44:47], v[68:71], v[12:15]
ds_read_b64_tr_b16 v[40:41], v2 offset:10240
ds_read_b64_tr_b16 v[42:43], v2 offset:11264
v_mfma_f32_16x16x32_bf16 v[20:23], v[44:47], v[84:87], v[20:23]
v_mfma_f32_16x16x32_bf16 v[28:31], v[44:47], v[100:103], v[28:31]
s_barrier
s_waitcnt lgkmcnt(4)
v_mfma_f32_16x16x32_bf16 v[8:11], v[32:35], v[104:107], v[8:11]
ds_read_b64_tr_b16 v[44:45], v3 offset:10240
ds_read_b64_tr_b16 v[46:47], v3 offset:11264
v_mfma_f32_16x16x32_bf16 v[16:19], v[32:35], v[120:123], v[16:19]
buffer_store_dwordx4 v[52:55], v4, s[24:27], s74 offen offset:1024 sc1
v_mfma_f32_16x16x32_bf16 v[24:27], v[32:35], v[136:139], v[24:27]
s_waitcnt lgkmcnt(4)
v_mfma_f32_16x16x32_bf16 v[12:15], v[36:39], v[104:107], v[12:15]
ds_read_b64_tr_b16 v[32:33], v2 offset:12288
ds_read_b64_tr_b16 v[34:35], v2 offset:13312
v_mfma_f32_16x16x32_bf16 v[20:23], v[36:39], v[120:123], v[20:23]
v_mfma_f32_16x16x32_bf16 v[28:31], v[36:39], v[136:139], v[28:31]
s_waitcnt lgkmcnt(4)
v_mfma_f32_16x16x32_bf16 v[8:11], v[40:43], v[108:111], v[8:11]
ds_read_b64_tr_b16 v[36:37], v3 offset:12288
ds_read_b64_tr_b16 v[38:39], v3 offset:13312
v_mfma_f32_16x16x32_bf16 v[16:19], v[40:43], v[124:127], v[16:19]
v_mfma_f32_16x16x32_bf16 v[24:27], v[40:43], v[140:143], v[24:27]
s_waitcnt lgkmcnt(4)
v_mfma_f32_16x16x32_bf16 v[12:15], v[44:47], v[108:111], v[12:15]
ds_read_b64_tr_b16 v[40:41], v2 offset:14336
ds_read_b64_tr_b16 v[42:43], v2 offset:15360
v_mfma_f32_16x16x32_bf16 v[20:23], v[44:47], v[124:127], v[20:23]
v_mfma_f32_16x16x32_bf16 v[28:31], v[44:47], v[140:143], v[28:31]
s_waitcnt lgkmcnt(4)
v_mfma_f32_16x16x32_bf16 v[8:11], v[32:35], v[112:115], v[8:11]
ds_read_b64_tr_b16 v[44:45], v3 offset:14336
ds_read_b64_tr_b16 v[46:47], v3 offset:15360
v_mfma_f32_16x16x32_bf16 v[16:19], v[32:35], v[128:131], v[16:19]
v_mfma_f32_16x16x32_bf16 v[24:27], v[32:35], v[144:147], v[24:27]
s_waitcnt lgkmcnt(4)
v_mfma_f32_16x16x32_bf16 v[12:15], v[36:39], v[112:115], v[12:15]
ds_read_b64_tr_b16 v[32:33], v2 offset:16384
ds_read_b64_tr_b16 v[34:35], v2 offset:17408
v_mfma_f32_16x16x32_bf16 v[20:23], v[36:39], v[128:131], v[20:23]
v_mfma_f32_16x16x32_bf16 v[28:31], v[36:39], v[144:147], v[28:31]
s_waitcnt lgkmcnt(4)
v_mfma_f32_16x16x32_bf16 v[8:11], v[40:43], v[116:119], v[8:11]
ds_read_b64_tr_b16 v[36:37], v3 offset:16384
ds_read_b64_tr_b16 v[38:39], v3 offset:17408
v_mfma_f32_16x16x32_bf16 v[16:19], v[40:43], v[132:135], v[16:19]
v_mfma_f32_16x16x32_bf16 v[24:27], v[40:43], v[148:151], v[24:27]
s_waitcnt lgkmcnt(4)
v_mfma_f32_16x16x32_bf16 v[12:15], v[44:47], v[116:119], v[12:15]
ds_read_b64_tr_b16 v[40:41], v2 offset:18432
ds_read_b64_tr_b16 v[42:43], v2 offset:19456
v_mfma_f32_16x16x32_bf16 v[20:23], v[44:47], v[132:135], v[20:23]
v_mfma_f32_16x16x32_bf16 v[28:31], v[44:47], v[148:151], v[28:31]
s_barrier
s_waitcnt lgkmcnt(4)
v_mfma_f32_16x16x32_bf16 v[8:11], v[32:35], v[152:155], v[8:11]
ds_read_b64_tr_b16 v[44:45], v3 offset:18432
ds_read_b64_tr_b16 v[46:47], v3 offset:19456
v_mfma_f32_16x16x32_bf16 v[16:19], v[32:35], v[168:171], v[16:19]
buffer_store_dwordx4 v[248:251], v4, s[24:27], s74 offen offset:2048 sc1
s_add_u32 s74, s74, 0xc00
s_sub_u32 s55, s74, 0x6c00
s_cmp_ge_u32 s74, s75
s_cselect_b32 s74, s55, s74
v_mfma_f32_16x16x32_bf16 v[24:27], v[32:35], v[184:187], v[24:27]
s_waitcnt lgkmcnt(4)
v_mfma_f32_16x16x32_bf16 v[12:15], v[36:39], v[152:155], v[12:15]
ds_read_b64_tr_b16 v[32:33], v2 offset:20480
ds_read_b64_tr_b16 v[34:35], v2 offset:21504
v_mfma_f32_16x16x32_bf16 v[20:23], v[36:39], v[168:171], v[20:23]
v_mfma_f32_16x16x32_bf16 v[28:31], v[36:39], v[184:187], v[28:31]
s_waitcnt lgkmcnt(4)
v_mfma_f32_16x16x32_bf16 v[8:11], v[40:43], v[156:159], v[8:11]
ds_read_b64_tr_b16 v[36:37], v3 offset:20480
ds_read_b64_tr_b16 v[38:39], v3 offset:21504
v_mfma_f32_16x16x32_bf16 v[16:19], v[40:43], v[172:175], v[16:19]
v_mfma_f32_16x16x32_bf16 v[24:27], v[40:43], v[188:191], v[24:27]
s_waitcnt lgkmcnt(4)
v_mfma_f32_16x16x32_bf16 v[12:15], v[44:47], v[156:159], v[12:15]
ds_read_b64_tr_b16 v[40:41], v2 offset:22528
ds_read_b64_tr_b16 v[42:43], v2 offset:23552
v_mfma_f32_16x16x32_bf16 v[20:23], v[44:47], v[172:175], v[20:23]
v_mfma_f32_16x16x32_bf16 v[28:31], v[44:47], v[188:191], v[28:31]
s_waitcnt lgkmcnt(4)
v_mfma_f32_16x16x32_bf16 v[8:11], v[32:35], v[160:163], v[8:11]
ds_read_b64_tr_b16 v[44:45], v3 offset:22528
ds_read_b64_tr_b16 v[46:47], v3 offset:23552
v_mfma_f32_16x16x32_bf16 v[16:19], v[32:35], v[176:179], v[16:19]
v_mfma_f32_16x16x32_bf16 v[24:27], v[32:35], v[192:195], v[24:27]
s_waitcnt lgkmcnt(4)
v_mfma_f32_16x16x32_bf16 v[12:15], v[36:39], v[160:163], v[12:15]
ds_read_b64_tr_b16 v[32:33], v2 offset:32768
ds_read_b64_tr_b16 v[34:35], v2 offset:33792
v_mfma_f32_16x16x32_bf16 v[20:23], v[36:39], v[176:179], v[20:23]
v_mfma_f32_16x16x32_bf16 v[28:31], v[36:39], v[192:195], v[28:31]
s_waitcnt lgkmcnt(4)
v_mfma_f32_16x16x32_bf16 v[8:11], v[40:43], v[164:167], v[8:11]
ds_read_b64_tr_b16 v[36:37], v3 offset:32768
ds_read_b64_tr_b16 v[38:39], v3 offset:33792
v_mfma_f32_16x16x32_bf16 v[16:19], v[40:43], v[180:183], v[16:19]
v_mfma_f32_16x16x32_bf16 v[24:27], v[40:43], v[196:199], v[24:27]
s_waitcnt lgkmcnt(4)
v_mfma_f32_16x16x32_bf16 v[12:15], v[44:47], v[164:167], v[12:15]
ds_read_b64_tr_b16 v[40:41], v2 offset:34816
ds_read_b64_tr_b16 v[42:43], v2 offset:35840
v_mfma_f32_16x16x32_bf16 v[20:23], v[44:47], v[180:183], v[20:23]
v_mfma_f32_16x16x32_bf16 v[28:31], v[44:47], v[196:199], v[28:31]
s_barrier
s_waitcnt lgkmcnt(4)
v_mfma_f32_16x16x32_bf16 v[8:11], v[32:35], v[200:203], v[8:11]
ds_read_b64_tr_b16 v[44:45], v3 offset:34816
ds_read_b64_tr_b16 v[46:47], v3 offset:35840
v_mfma_f32_16x16x32_bf16 v[16:19], v[32:35], v[216:219], v[16:19]
v_mfma_f32_16x16x32_bf16 v[24:27], v[32:35], v[232:235], v[24:27]
s_waitcnt lgkmcnt(4)
v_mfma_f32_16x16x32_bf16 v[12:15], v[36:39], v[200:203], v[12:15]
ds_read_b64_tr_b16 v[32:33], v2 offset:36864
ds_read_b64_tr_b16 v[34:35], v2 offset:37888
v_mfma_f32_16x16x32_bf16 v[20:23], v[36:39], v[216:219], v[20:23]
v_mfma_f32_16x16x32_bf16 v[28:31], v[36:39], v[232:235], v[28:31]
s_waitcnt lgkmcnt(4)
v_mfma_f32_16x16x32_bf16 v[8:11], v[40:43], v[204:207], v[8:11]
ds_read_b64_tr_b16 v[36:37], v3 offset:36864
ds_read_b64_tr_b16 v[38:39], v3 offset:37888
v_mfma_f32_16x16x32_bf16 v[16:19], v[40:43], v[220:223], v[16:19]
v_mfma_f32_16x16x32_bf16 v[24:27], v[40:43], v[236:239], v[24:27]
s_waitcnt lgkmcnt(4)
v_mfma_f32_16x16x32_bf16 v[12:15], v[44:47], v[204:207], v[12:15]
ds_read_b64_tr_b16 v[40:41], v2 offset:38912
ds_read_b64_tr_b16 v[42:43], v2 offset:39936
v_mfma_f32_16x16x32_bf16 v[20:23], v[44:47], v[220:223], v[20:23]
v_mfma_f32_16x16x32_bf16 v[28:31], v[44:47], v[236:239], v[28:31]
s_waitcnt lgkmcnt(4)
v_mfma_f32_16x16x32_bf16 v[8:11], v[32:35], v[208:211], v[8:11]
ds_read_b64_tr_b16 v[44:45], v3 offset:38912
ds_read_b64_tr_b16 v[46:47], v3 offset:39936
v_mfma_f32_16x16x32_bf16 v[16:19], v[32:35], v[224:227], v[16:19]
v_mfma_f32_16x16x32_bf16 v[24:27], v[32:35], v[240:243], v[24:27]
s_waitcnt lgkmcnt(4)
v_mfma_f32_16x16x32_bf16 v[12:15], v[36:39], v[208:211], v[12:15]
ds_read_b64_tr_b16 v[32:33], v2 offset:24576
ds_read_b64_tr_b16 v[34:35], v2 offset:25600
v_mfma_f32_16x16x32_bf16 v[20:23], v[36:39], v[224:227], v[20:23]
v_mfma_f32_16x16x32_bf16 v[28:31], v[36:39], v[240:243], v[28:31]
s_waitcnt lgkmcnt(4)
v_mfma_f32_16x16x32_bf16 v[8:11], v[40:43], v[212:215], v[8:11]
ds_read_b64_tr_b16 v[36:37], v3 offset:24576
ds_read_b64_tr_b16 v[38:39], v3 offset:25600
v_mfma_f32_16x16x32_bf16 v[16:19], v[40:43], v[228:231], v[16:19]
v_mfma_f32_16x16x32_bf16 v[24:27], v[40:43], v[244:247], v[24:27]
s_waitcnt lgkmcnt(4)
v_mfma_f32_16x16x32_bf16 v[12:15], v[44:47], v[212:215], v[12:15]
ds_read_b64_tr_b16 v[40:41], v2 offset:26624
ds_read_b64_tr_b16 v[42:43], v2 offset:27648
v_mfma_f32_16x16x32_bf16 v[20:23], v[44:47], v[228:231], v[20:23]
v_mfma_f32_16x16x32_bf16 v[28:31], v[44:47], v[244:247], v[28:31]
v_cvt_pk_bf16_f32 v48, v8, v9
v_cvt_pk_bf16_f32 v49, v10, v11
s_nop 1
v_cvt_pk_bf16_f32 v50, v12, v13
v_cvt_pk_bf16_f32 v51, v14, v15
v_cvt_pk_bf16_f32 v52, v16, v17
v_cvt_pk_bf16_f32 v53, v18, v19
v_cvt_pk_bf16_f32 v54, v20, v21
v_cvt_pk_bf16_f32 v55, v22, v23
v_cvt_pk_bf16_f32 v248, v24, v25
v_cvt_pk_bf16_f32 v249, v26, v27
v_cvt_pk_bf16_f32 v250, v28, v29
v_cvt_pk_bf16_f32 v251, v30, v31
s_barrier
s_waitcnt lgkmcnt(4)
v_mfma_f32_16x16x32_bf16 v[8:11], v[32:35], v[56:59], 0
ds_read_b64_tr_b16 v[44:45], v3 offset:26624
ds_read_b64_tr_b16 v[46:47], v3 offset:27648
v_mfma_f32_16x16x32_bf16 v[16:19], v[32:35], v[72:75], 0
buffer_store_dwordx4 v[48:51], v4, s[24:27], s74 offen sc1
v_mfma_f32_16x16x32_bf16 v[24:27], v[32:35], v[88:91], 0
s_waitcnt lgkmcnt(4)
v_mfma_f32_16x16x32_bf16 v[12:15], v[36:39], v[56:59], 0
ds_read_b64_tr_b16 v[32:33], v2 offset:28672
ds_read_b64_tr_b16 v[34:35], v2 offset:29696
v_mfma_f32_16x16x32_bf16 v[20:23], v[36:39], v[72:75], 0
v_mfma_f32_16x16x32_bf16 v[28:31], v[36:39], v[88:91], 0
s_waitcnt lgkmcnt(4)
v_mfma_f32_16x16x32_bf16 v[8:11], v[40:43], v[60:63], v[8:11]
ds_read_b64_tr_b16 v[36:37], v3 offset:28672
ds_read_b64_tr_b16 v[38:39], v3 offset:29696
v_mfma_f32_16x16x32_bf16 v[16:19], v[40:43], v[76:79], v[16:19]
v_mfma_f32_16x16x32_bf16 v[24:27], v[40:43], v[92:95], v[24:27]
s_waitcnt lgkmcnt(4)
v_mfma_f32_16x16x32_bf16 v[12:15], v[44:47], v[60:63], v[12:15]
ds_read_b64_tr_b16 v[40:41], v2 offset:30720
ds_read_b64_tr_b16 v[42:43], v2 offset:31744
v_mfma_f32_16x16x32_bf16 v[20:23], v[44:47], v[76:79], v[20:23]
v_mfma_f32_16x16x32_bf16 v[28:31], v[44:47], v[92:95], v[28:31]
s_waitcnt lgkmcnt(4)
v_mfma_f32_16x16x32_bf16 v[8:11], v[32:35], v[64:67], v[8:11]
ds_read_b64_tr_b16 v[44:45], v3 offset:30720
ds_read_b64_tr_b16 v[46:47], v3 offset:31744
v_mfma_f32_16x16x32_bf16 v[16:19], v[32:35], v[80:83], v[16:19]
v_mfma_f32_16x16x32_bf16 v[24:27], v[32:35], v[96:99], v[24:27]
s_waitcnt lgkmcnt(4)
v_mfma_f32_16x16x32_bf16 v[12:15], v[36:39], v[64:67], v[12:15]
ds_read_b64_tr_b16 v[32:33], v2 offset:40960
ds_read_b64_tr_b16 v[34:35], v2 offset:41984
v_mfma_f32_16x16x32_bf16 v[20:23], v[36:39], v[80:83], v[20:23]
v_mfma_f32_16x16x32_bf16 v[28:31], v[36:39], v[96:99], v[28:31]
s_waitcnt lgkmcnt(4)
v_mfma_f32_16x16x32_bf16 v[8:11], v[40:43], v[68:71], v[8:11]
ds_read_b64_tr_b16 v[36:37], v3 offset:40960
ds_read_b64_tr_b16 v[38:39], v3 offset:41984
v_mfma_f32_16x16x32_bf16 v[16:19], v[40:43], v[84:87], v[16:19]
v_mfma_f32_16x16x32_bf16 v[24:27], v[40:43], v[100:103], v[24:27]
s_waitcnt lgkmcnt(4)
v_mfma_f32_16x16x32_bf16 v[12:15], v[44:47], v[68:71], v[12:15]
ds_read_b64_tr_b16 v[40:41], v2 offset:43008
ds_read_b64_tr_b16 v[42:43], v2 offset:44032
v_mfma_f32_16x16x32_bf16 v[20:23], v[44:47], v[84:87], v[20:23]
v_mfma_f32_16x16x32_bf16 v[28:31], v[44:47], v[100:103], v[28:31]
s_barrier
s_waitcnt lgkmcnt(4)
v_mfma_f32_16x16x32_bf16 v[8:11], v[32:35], v[104:107], v[8:11]
ds_read_b64_tr_b16 v[44:45], v3 offset:43008
ds_read_b64_tr_b16 v[46:47], v3 offset:44032
v_mfma_f32_16x16x32_bf16 v[16:19], v[32:35], v[120:123], v[16:19]
buffer_store_dwordx4 v[52:55], v4, s[24:27], s74 offen offset:1024 sc1
v_mfma_f32_16x16x32_bf16 v[24:27], v[32:35], v[136:139], v[24:27]
s_waitcnt lgkmcnt(4)
v_mfma_f32_16x16x32_bf16 v[12:15], v[36:39], v[104:107], v[12:15]
ds_read_b64_tr_b16 v[32:33], v2 offset:45056
ds_read_b64_tr_b16 v[34:35], v2 offset:46080
v_mfma_f32_16x16x32_bf16 v[20:23], v[36:39], v[120:123], v[20:23]
v_mfma_f32_16x16x32_bf16 v[28:31], v[36:39], v[136:139], v[28:31]
s_waitcnt lgkmcnt(4)
v_mfma_f32_16x16x32_bf16 v[8:11], v[40:43], v[108:111], v[8:11]
ds_read_b64_tr_b16 v[36:37], v3 offset:45056
ds_read_b64_tr_b16 v[38:39], v3 offset:46080
v_mfma_f32_16x16x32_bf16 v[16:19], v[40:43], v[124:127], v[16:19]
v_mfma_f32_16x16x32_bf16 v[24:27], v[40:43], v[140:143], v[24:27]
s_waitcnt lgkmcnt(4)
v_mfma_f32_16x16x32_bf16 v[12:15], v[44:47], v[108:111], v[12:15]
ds_read_b64_tr_b16 v[40:41], v2 offset:47104
ds_read_b64_tr_b16 v[42:43], v2 offset:48128
v_mfma_f32_16x16x32_bf16 v[20:23], v[44:47], v[124:127], v[20:23]
v_mfma_f32_16x16x32_bf16 v[28:31], v[44:47], v[140:143], v[28:31]
s_waitcnt lgkmcnt(4)
v_mfma_f32_16x16x32_bf16 v[8:11], v[32:35], v[112:115], v[8:11]
ds_read_b64_tr_b16 v[44:45], v3 offset:47104
ds_read_b64_tr_b16 v[46:47], v3 offset:48128
v_mfma_f32_16x16x32_bf16 v[16:19], v[32:35], v[128:131], v[16:19]
v_mfma_f32_16x16x32_bf16 v[24:27], v[32:35], v[144:147], v[24:27]
s_waitcnt lgkmcnt(4)
v_mfma_f32_16x16x32_bf16 v[12:15], v[36:39], v[112:115], v[12:15]
ds_read_b64_tr_b16 v[32:33], v2 offset:49152
ds_read_b64_tr_b16 v[34:35], v2 offset:50176
v_mfma_f32_16x16x32_bf16 v[20:23], v[36:39], v[128:131], v[20:23]
v_mfma_f32_16x16x32_bf16 v[28:31], v[36:39], v[144:147], v[28:31]
s_waitcnt lgkmcnt(4)
v_mfma_f32_16x16x32_bf16 v[8:11], v[40:43], v[116:119], v[8:11]
ds_read_b64_tr_b16 v[36:37], v3 offset:49152
ds_read_b64_tr_b16 v[38:39], v3 offset:50176
v_mfma_f32_16x16x32_bf16 v[16:19], v[40:43], v[132:135], v[16:19]
v_mfma_f32_16x16x32_bf16 v[24:27], v[40:43], v[148:151], v[24:27]
s_waitcnt lgkmcnt(4)
v_mfma_f32_16x16x32_bf16 v[12:15], v[44:47], v[116:119], v[12:15]
ds_read_b64_tr_b16 v[40:41], v2 offset:51200
ds_read_b64_tr_b16 v[42:43], v2 offset:52224
v_mfma_f32_16x16x32_bf16 v[20:23], v[44:47], v[132:135], v[20:23]
v_mfma_f32_16x16x32_bf16 v[28:31], v[44:47], v[148:151], v[28:31]
s_barrier
s_waitcnt lgkmcnt(4)
v_mfma_f32_16x16x32_bf16 v[8:11], v[32:35], v[152:155], v[8:11]
ds_read_b64_tr_b16 v[44:45], v3 offset:51200
ds_read_b64_tr_b16 v[46:47], v3 offset:52224
v_mfma_f32_16x16x32_bf16 v[16:19], v[32:35], v[168:171], v[16:19]
buffer_store_dwordx4 v[248:251], v4, s[24:27], s74 offen offset:2048 sc1
s_add_u32 s74, s74, 0xc00
s_sub_u32 s55, s74, 0x6c00
s_cmp_ge_u32 s74, s75
s_cselect_b32 s74, s55, s74
v_mfma_f32_16x16x32_bf16 v[24:27], v[32:35], v[184:187], v[24:27]
s_waitcnt lgkmcnt(4)
v_mfma_f32_16x16x32_bf16 v[12:15], v[36:39], v[152:155], v[12:15]
ds_read_b64_tr_b16 v[32:33], v2 offset:53248
ds_read_b64_tr_b16 v[34:35], v2 offset:54272
v_mfma_f32_16x16x32_bf16 v[20:23], v[36:39], v[168:171], v[20:23]
v_mfma_f32_16x16x32_bf16 v[28:31], v[36:39], v[184:187], v[28:31]
s_waitcnt lgkmcnt(4)
v_mfma_f32_16x16x32_bf16 v[8:11], v[40:43], v[156:159], v[8:11]
ds_read_b64_tr_b16 v[36:37], v3 offset:53248
ds_read_b64_tr_b16 v[38:39], v3 offset:54272
v_mfma_f32_16x16x32_bf16 v[16:19], v[40:43], v[172:175], v[16:19]
v_mfma_f32_16x16x32_bf16 v[24:27], v[40:43], v[188:191], v[24:27]
s_waitcnt lgkmcnt(4)
v_mfma_f32_16x16x32_bf16 v[12:15], v[44:47], v[156:159], v[12:15]
ds_read_b64_tr_b16 v[40:41], v2 offset:55296
ds_read_b64_tr_b16 v[42:43], v2 offset:56320
v_mfma_f32_16x16x32_bf16 v[20:23], v[44:47], v[172:175], v[20:23]
v_mfma_f32_16x16x32_bf16 v[28:31], v[44:47], v[188:191], v[28:31]
s_waitcnt lgkmcnt(4)
v_mfma_f32_16x16x32_bf16 v[8:11], v[32:35], v[160:163], v[8:11]
ds_read_b64_tr_b16 v[44:45], v3 offset:55296
ds_read_b64_tr_b16 v[46:47], v3 offset:56320
v_mfma_f32_16x16x32_bf16 v[16:19], v[32:35], v[176:179], v[16:19]
v_mfma_f32_16x16x32_bf16 v[24:27], v[32:35], v[192:195], v[24:27]
s_waitcnt lgkmcnt(4)
v_mfma_f32_16x16x32_bf16 v[12:15], v[36:39], v[160:163], v[12:15]
ds_read_b64_tr_b16 v[32:33], v2 offset:57344
ds_read_b64_tr_b16 v[34:35], v2 offset:58368
v_mfma_f32_16x16x32_bf16 v[20:23], v[36:39], v[176:179], v[20:23]
v_mfma_f32_16x16x32_bf16 v[28:31], v[36:39], v[192:195], v[28:31]
s_waitcnt lgkmcnt(4)
v_mfma_f32_16x16x32_bf16 v[8:11], v[40:43], v[164:167], v[8:11]
ds_read_b64_tr_b16 v[36:37], v3 offset:57344
ds_read_b64_tr_b16 v[38:39], v3 offset:58368
v_mfma_f32_16x16x32_bf16 v[16:19], v[40:43], v[180:183], v[16:19]
v_mfma_f32_16x16x32_bf16 v[24:27], v[40:43], v[196:199], v[24:27]
s_waitcnt lgkmcnt(4)
v_mfma_f32_16x16x32_bf16 v[12:15], v[44:47], v[164:167], v[12:15]
ds_read_b64_tr_b16 v[40:41], v2 offset:59392
ds_read_b64_tr_b16 v[42:43], v2 offset:60416
v_mfma_f32_16x16x32_bf16 v[20:23], v[44:47], v[180:183], v[20:23]
v_mfma_f32_16x16x32_bf16 v[28:31], v[44:47], v[196:199], v[28:31]
s_barrier
s_waitcnt lgkmcnt(4)
v_mfma_f32_16x16x32_bf16 v[8:11], v[32:35], v[200:203], v[8:11]
ds_read_b64_tr_b16 v[44:45], v3 offset:59392
ds_read_b64_tr_b16 v[46:47], v3 offset:60416
v_mfma_f32_16x16x32_bf16 v[16:19], v[32:35], v[216:219], v[16:19]
v_mfma_f32_16x16x32_bf16 v[24:27], v[32:35], v[232:235], v[24:27]
s_waitcnt lgkmcnt(4)
v_mfma_f32_16x16x32_bf16 v[12:15], v[36:39], v[200:203], v[12:15]
ds_read_b64_tr_b16 v[32:33], v2 offset:61440
ds_read_b64_tr_b16 v[34:35], v2 offset:62464
v_mfma_f32_16x16x32_bf16 v[20:23], v[36:39], v[216:219], v[20:23]
v_mfma_f32_16x16x32_bf16 v[28:31], v[36:39], v[232:235], v[28:31]
s_waitcnt lgkmcnt(4)
v_mfma_f32_16x16x32_bf16 v[8:11], v[40:43], v[204:207], v[8:11]
ds_read_b64_tr_b16 v[36:37], v3 offset:61440
ds_read_b64_tr_b16 v[38:39], v3 offset:62464
v_mfma_f32_16x16x32_bf16 v[16:19], v[40:43], v[220:223], v[16:19]
v_mfma_f32_16x16x32_bf16 v[24:27], v[40:43], v[236:239], v[24:27]
s_waitcnt lgkmcnt(4)
v_mfma_f32_16x16x32_bf16 v[12:15], v[44:47], v[204:207], v[12:15]
ds_read_b64_tr_b16 v[40:41], v2 offset:63488
ds_read_b64_tr_b16 v[42:43], v2 offset:64512
v_mfma_f32_16x16x32_bf16 v[20:23], v[44:47], v[220:223], v[20:23]
v_mfma_f32_16x16x32_bf16 v[28:31], v[44:47], v[236:239], v[28:31]
s_waitcnt lgkmcnt(4)
v_mfma_f32_16x16x32_bf16 v[8:11], v[32:35], v[208:211], v[8:11]
ds_read_b64_tr_b16 v[44:45], v3 offset:63488
ds_read_b64_tr_b16 v[46:47], v3 offset:64512
v_mfma_f32_16x16x32_bf16 v[16:19], v[32:35], v[224:227], v[16:19]
v_mfma_f32_16x16x32_bf16 v[24:27], v[32:35], v[240:243], v[24:27]
s_waitcnt lgkmcnt(4)
v_mfma_f32_16x16x32_bf16 v[12:15], v[36:39], v[208:211], v[12:15]
ds_read_b64_tr_b16 v[32:33], v2
ds_read_b64_tr_b16 v[34:35], v2 offset:1024
v_mfma_f32_16x16x32_bf16 v[20:23], v[36:39], v[224:227], v[20:23]
v_mfma_f32_16x16x32_bf16 v[28:31], v[36:39], v[240:243], v[28:31]
s_waitcnt lgkmcnt(4)
v_mfma_f32_16x16x32_bf16 v[8:11], v[40:43], v[212:215], v[8:11]
ds_read_b64_tr_b16 v[36:37], v3
ds_read_b64_tr_b16 v[38:39], v3 offset:1024
v_mfma_f32_16x16x32_bf16 v[16:19], v[40:43], v[228:231], v[16:19]
v_mfma_f32_16x16x32_bf16 v[24:27], v[40:43], v[244:247], v[24:27]
s_waitcnt lgkmcnt(4)
v_mfma_f32_16x16x32_bf16 v[12:15], v[44:47], v[212:215], v[12:15]
ds_read_b64_tr_b16 v[40:41], v2 offset:2048
ds_read_b64_tr_b16 v[42:43], v2 offset:3072
v_mfma_f32_16x16x32_bf16 v[20:23], v[44:47], v[228:231], v[20:23]
v_mfma_f32_16x16x32_bf16 v[28:31], v[44:47], v[244:247], v[28:31]
v_cvt_pk_bf16_f32 v48, v8, v9
v_cvt_pk_bf16_f32 v49, v10, v11
s_nop 1
v_cvt_pk_bf16_f32 v50, v12, v13
v_cvt_pk_bf16_f32 v51, v14, v15
v_cvt_pk_bf16_f32 v52, v16, v17
v_cvt_pk_bf16_f32 v53, v18, v19
v_cvt_pk_bf16_f32 v54, v20, v21
v_cvt_pk_bf16_f32 v55, v22, v23
v_cvt_pk_bf16_f32 v248, v24, v25
v_cvt_pk_bf16_f32 v249, v26, v27
v_cvt_pk_bf16_f32 v250, v28, v29
v_cvt_pk_bf16_f32 v251, v30, v31
s_barrier
s_waitcnt lgkmcnt(4)
v_mfma_f32_16x16x32_bf16 v[8:11], v[32:35], v[56:59], 0
ds_read_b64_tr_b16 v[44:45], v3 offset:2048
ds_read_b64_tr_b16 v[46:47], v3 offset:3072
v_mfma_f32_16x16x32_bf16 v[16:19], v[32:35], v[72:75], 0
buffer_store_dwordx4 v[48:51], v4, s[24:27], s74 offen sc1
v_mfma_f32_16x16x32_bf16 v[24:27], v[32:35], v[88:91], 0
s_waitcnt lgkmcnt(4)
v_mfma_f32_16x16x32_bf16 v[12:15], v[36:39], v[56:59], 0
ds_read_b64_tr_b16 v[32:33], v2 offset:4096
ds_read_b64_tr_b16 v[34:35], v2 offset:5120
v_mfma_f32_16x16x32_bf16 v[20:23], v[36:39], v[72:75], 0
v_mfma_f32_16x16x32_bf16 v[28:31], v[36:39], v[88:91], 0
s_waitcnt lgkmcnt(4)
v_mfma_f32_16x16x32_bf16 v[8:11], v[40:43], v[60:63], v[8:11]
ds_read_b64_tr_b16 v[36:37], v3 offset:4096
ds_read_b64_tr_b16 v[38:39], v3 offset:5120
v_mfma_f32_16x16x32_bf16 v[16:19], v[40:43], v[76:79], v[16:19]
v_mfma_f32_16x16x32_bf16 v[24:27], v[40:43], v[92:95], v[24:27]
s_waitcnt lgkmcnt(4)
v_mfma_f32_16x16x32_bf16 v[12:15], v[44:47], v[60:63], v[12:15]
ds_read_b64_tr_b16 v[40:41], v2 offset:6144
ds_read_b64_tr_b16 v[42:43], v2 offset:7168
v_mfma_f32_16x16x32_bf16 v[20:23], v[44:47], v[76:79], v[20:23]
v_mfma_f32_16x16x32_bf16 v[28:31], v[44:47], v[92:95], v[28:31]
s_waitcnt lgkmcnt(4)
v_mfma_f32_16x16x32_bf16 v[8:11], v[32:35], v[64:67], v[8:11]
ds_read_b64_tr_b16 v[44:45], v3 offset:6144
ds_read_b64_tr_b16 v[46:47], v3 offset:7168
v_mfma_f32_16x16x32_bf16 v[16:19], v[32:35], v[80:83], v[16:19]
v_mfma_f32_16x16x32_bf16 v[24:27], v[32:35], v[96:99], v[24:27]
s_waitcnt lgkmcnt(4)
v_mfma_f32_16x16x32_bf16 v[12:15], v[36:39], v[64:67], v[12:15]
ds_read_b64_tr_b16 v[32:33], v2 offset:8192
ds_read_b64_tr_b16 v[34:35], v2 offset:9216
v_mfma_f32_16x16x32_bf16 v[20:23], v[36:39], v[80:83], v[20:23]
v_mfma_f32_16x16x32_bf16 v[28:31], v[36:39], v[96:99], v[28:31]
s_waitcnt lgkmcnt(4)
v_mfma_f32_16x16x32_bf16 v[8:11], v[40:43], v[68:71], v[8:11]
ds_read_b64_tr_b16 v[36:37], v3 offset:8192
ds_read_b64_tr_b16 v[38:39], v3 offset:9216
v_mfma_f32_16x16x32_bf16 v[16:19], v[40:43], v[84:87], v[16:19]
v_mfma_f32_16x16x32_bf16 v[24:27], v[40:43], v[100:103], v[24:27]
s_waitcnt lgkmcnt(4)
v_mfma_f32_16x16x32_bf16 v[12:15], v[44:47], v[68:71], v[12:15]
ds_read_b64_tr_b16 v[40:41], v2 offset:10240
ds_read_b64_tr_b16 v[42:43], v2 offset:11264
v_mfma_f32_16x16x32_bf16 v[20:23], v[44:47], v[84:87], v[20:23]
v_mfma_f32_16x16x32_bf16 v[28:31], v[44:47], v[100:103], v[28:31]
s_barrier
s_waitcnt lgkmcnt(4)
v_mfma_f32_16x16x32_bf16 v[8:11], v[32:35], v[104:107], v[8:11]
ds_read_b64_tr_b16 v[44:45], v3 offset:10240
ds_read_b64_tr_b16 v[46:47], v3 offset:11264
v_mfma_f32_16x16x32_bf16 v[16:19], v[32:35], v[120:123], v[16:19]
buffer_store_dwordx4 v[52:55], v4, s[24:27], s74 offen offset:1024 sc1
v_mfma_f32_16x16x32_bf16 v[24:27], v[32:35], v[136:139], v[24:27]
s_waitcnt lgkmcnt(4)
v_mfma_f32_16x16x32_bf16 v[12:15], v[36:39], v[104:107], v[12:15]
ds_read_b64_tr_b16 v[32:33], v2 offset:12288
ds_read_b64_tr_b16 v[34:35], v2 offset:13312
v_mfma_f32_16x16x32_bf16 v[20:23], v[36:39], v[120:123], v[20:23]
v_mfma_f32_16x16x32_bf16 v[28:31], v[36:39], v[136:139], v[28:31]
s_waitcnt lgkmcnt(4)
v_mfma_f32_16x16x32_bf16 v[8:11], v[40:43], v[108:111], v[8:11]
ds_read_b64_tr_b16 v[36:37], v3 offset:12288
ds_read_b64_tr_b16 v[38:39], v3 offset:13312
v_mfma_f32_16x16x32_bf16 v[16:19], v[40:43], v[124:127], v[16:19]
v_mfma_f32_16x16x32_bf16 v[24:27], v[40:43], v[140:143], v[24:27]
s_waitcnt lgkmcnt(4)
v_mfma_f32_16x16x32_bf16 v[12:15], v[44:47], v[108:111], v[12:15]
ds_read_b64_tr_b16 v[40:41], v2 offset:14336
ds_read_b64_tr_b16 v[42:43], v2 offset:15360
v_mfma_f32_16x16x32_bf16 v[20:23], v[44:47], v[124:127], v[20:23]
v_mfma_f32_16x16x32_bf16 v[28:31], v[44:47], v[140:143], v[28:31]
s_waitcnt lgkmcnt(4)
v_mfma_f32_16x16x32_bf16 v[8:11], v[32:35], v[112:115], v[8:11]
ds_read_b64_tr_b16 v[44:45], v3 offset:14336
ds_read_b64_tr_b16 v[46:47], v3 offset:15360
v_mfma_f32_16x16x32_bf16 v[16:19], v[32:35], v[128:131], v[16:19]
v_mfma_f32_16x16x32_bf16 v[24:27], v[32:35], v[144:147], v[24:27]
s_waitcnt lgkmcnt(4)
v_mfma_f32_16x16x32_bf16 v[12:15], v[36:39], v[112:115], v[12:15]
ds_read_b64_tr_b16 v[32:33], v2 offset:16384
ds_read_b64_tr_b16 v[34:35], v2 offset:17408
v_mfma_f32_16x16x32_bf16 v[20:23], v[36:39], v[128:131], v[20:23]
v_mfma_f32_16x16x32_bf16 v[28:31], v[36:39], v[144:147], v[28:31]
s_waitcnt lgkmcnt(4)
v_mfma_f32_16x16x32_bf16 v[8:11], v[40:43], v[116:119], v[8:11]
ds_read_b64_tr_b16 v[36:37], v3 offset:16384
ds_read_b64_tr_b16 v[38:39], v3 offset:17408
v_mfma_f32_16x16x32_bf16 v[16:19], v[40:43], v[132:135], v[16:19]
v_mfma_f32_16x16x32_bf16 v[24:27], v[40:43], v[148:151], v[24:27]
s_waitcnt lgkmcnt(4)
v_mfma_f32_16x16x32_bf16 v[12:15], v[44:47], v[116:119], v[12:15]
ds_read_b64_tr_b16 v[40:41], v2 offset:18432
ds_read_b64_tr_b16 v[42:43], v2 offset:19456
v_mfma_f32_16x16x32_bf16 v[20:23], v[44:47], v[132:135], v[20:23]
v_mfma_f32_16x16x32_bf16 v[28:31], v[44:47], v[148:151], v[28:31]
s_barrier
s_waitcnt lgkmcnt(4)
v_mfma_f32_16x16x32_bf16 v[8:11], v[32:35], v[152:155], v[8:11]
ds_read_b64_tr_b16 v[44:45], v3 offset:18432
ds_read_b64_tr_b16 v[46:47], v3 offset:19456
v_mfma_f32_16x16x32_bf16 v[16:19], v[32:35], v[168:171], v[16:19]
buffer_store_dwordx4 v[248:251], v4, s[24:27], s74 offen offset:2048 sc1
s_add_u32 s74, s74, 0xc00
s_sub_u32 s55, s74, 0x6c00
s_cmp_ge_u32 s74, s75
s_cselect_b32 s74, s55, s74
v_mfma_f32_16x16x32_bf16 v[24:27], v[32:35], v[184:187], v[24:27]
s_waitcnt lgkmcnt(4)
v_mfma_f32_16x16x32_bf16 v[12:15], v[36:39], v[152:155], v[12:15]
ds_read_b64_tr_b16 v[32:33], v2 offset:20480
ds_read_b64_tr_b16 v[34:35], v2 offset:21504
v_mfma_f32_16x16x32_bf16 v[20:23], v[36:39], v[168:171], v[20:23]
v_mfma_f32_16x16x32_bf16 v[28:31], v[36:39], v[184:187], v[28:31]
s_waitcnt lgkmcnt(4)
v_mfma_f32_16x16x32_bf16 v[8:11], v[40:43], v[156:159], v[8:11]
ds_read_b64_tr_b16 v[36:37], v3 offset:20480
ds_read_b64_tr_b16 v[38:39], v3 offset:21504
v_mfma_f32_16x16x32_bf16 v[16:19], v[40:43], v[172:175], v[16:19]
v_mfma_f32_16x16x32_bf16 v[24:27], v[40:43], v[188:191], v[24:27]
s_waitcnt lgkmcnt(4)
v_mfma_f32_16x16x32_bf16 v[12:15], v[44:47], v[156:159], v[12:15]
ds_read_b64_tr_b16 v[40:41], v2 offset:22528
ds_read_b64_tr_b16 v[42:43], v2 offset:23552
v_mfma_f32_16x16x32_bf16 v[20:23], v[44:47], v[172:175], v[20:23]
v_mfma_f32_16x16x32_bf16 v[28:31], v[44:47], v[188:191], v[28:31]
s_waitcnt lgkmcnt(4)
v_mfma_f32_16x16x32_bf16 v[8:11], v[32:35], v[160:163], v[8:11]
ds_read_b64_tr_b16 v[44:45], v3 offset:22528
ds_read_b64_tr_b16 v[46:47], v3 offset:23552
v_mfma_f32_16x16x32_bf16 v[16:19], v[32:35], v[176:179], v[16:19]
v_mfma_f32_16x16x32_bf16 v[24:27], v[32:35], v[192:195], v[24:27]
s_waitcnt lgkmcnt(4)
v_mfma_f32_16x16x32_bf16 v[12:15], v[36:39], v[160:163], v[12:15]
ds_read_b64_tr_b16 v[32:33], v2 offset:32768
ds_read_b64_tr_b16 v[34:35], v2 offset:33792
v_mfma_f32_16x16x32_bf16 v[20:23], v[36:39], v[176:179], v[20:23]
v_mfma_f32_16x16x32_bf16 v[28:31], v[36:39], v[192:195], v[28:31]
s_waitcnt lgkmcnt(4)
v_mfma_f32_16x16x32_bf16 v[8:11], v[40:43], v[164:167], v[8:11]
ds_read_b64_tr_b16 v[36:37], v3 offset:32768
ds_read_b64_tr_b16 v[38:39], v3 offset:33792
v_mfma_f32_16x16x32_bf16 v[16:19], v[40:43], v[180:183], v[16:19]
v_mfma_f32_16x16x32_bf16 v[24:27], v[40:43], v[196:199], v[24:27]
s_waitcnt lgkmcnt(4)
v_mfma_f32_16x16x32_bf16 v[12:15], v[44:47], v[164:167], v[12:15]
ds_read_b64_tr_b16 v[40:41], v2 offset:34816
ds_read_b64_tr_b16 v[42:43], v2 offset:35840
v_mfma_f32_16x16x32_bf16 v[20:23], v[44:47], v[180:183], v[20:23]
v_mfma_f32_16x16x32_bf16 v[28:31], v[44:47], v[196:199], v[28:31]
s_barrier
s_waitcnt lgkmcnt(4)
v_mfma_f32_16x16x32_bf16 v[8:11], v[32:35], v[200:203], v[8:11]
ds_read_b64_tr_b16 v[44:45], v3 offset:34816
ds_read_b64_tr_b16 v[46:47], v3 offset:35840
v_mfma_f32_16x16x32_bf16 v[16:19], v[32:35], v[216:219], v[16:19]
v_mfma_f32_16x16x32_bf16 v[24:27], v[32:35], v[232:235], v[24:27]
s_waitcnt lgkmcnt(4)
v_mfma_f32_16x16x32_bf16 v[12:15], v[36:39], v[200:203], v[12:15]
ds_read_b64_tr_b16 v[32:33], v2 offset:36864
ds_read_b64_tr_b16 v[34:35], v2 offset:37888
v_mfma_f32_16x16x32_bf16 v[20:23], v[36:39], v[216:219], v[20:23]
v_mfma_f32_16x16x32_bf16 v[28:31], v[36:39], v[232:235], v[28:31]
s_waitcnt lgkmcnt(4)
v_mfma_f32_16x16x32_bf16 v[8:11], v[40:43], v[204:207], v[8:11]
ds_read_b64_tr_b16 v[36:37], v3 offset:36864
ds_read_b64_tr_b16 v[38:39], v3 offset:37888
v_mfma_f32_16x16x32_bf16 v[16:19], v[40:43], v[220:223], v[16:19]
v_mfma_f32_16x16x32_bf16 v[24:27], v[40:43], v[236:239], v[24:27]
s_waitcnt lgkmcnt(4)
v_mfma_f32_16x16x32_bf16 v[12:15], v[44:47], v[204:207], v[12:15]
ds_read_b64_tr_b16 v[40:41], v2 offset:38912
ds_read_b64_tr_b16 v[42:43], v2 offset:39936
v_mfma_f32_16x16x32_bf16 v[20:23], v[44:47], v[220:223], v[20:23]
v_mfma_f32_16x16x32_bf16 v[28:31], v[44:47], v[236:239], v[28:31]
s_waitcnt lgkmcnt(4)
v_mfma_f32_16x16x32_bf16 v[8:11], v[32:35], v[208:211], v[8:11]
ds_read_b64_tr_b16 v[44:45], v3 offset:38912
ds_read_b64_tr_b16 v[46:47], v3 offset:39936
v_mfma_f32_16x16x32_bf16 v[16:19], v[32:35], v[224:227], v[16:19]
v_mfma_f32_16x16x32_bf16 v[24:27], v[32:35], v[240:243], v[24:27]
s_waitcnt lgkmcnt(4)
v_mfma_f32_16x16x32_bf16 v[12:15], v[36:39], v[208:211], v[12:15]
ds_read_b64_tr_b16 v[32:33], v2 offset:24576
ds_read_b64_tr_b16 v[34:35], v2 offset:25600
v_mfma_f32_16x16x32_bf16 v[20:23], v[36:39], v[224:227], v[20:23]
v_mfma_f32_16x16x32_bf16 v[28:31], v[36:39], v[240:243], v[28:31]
s_waitcnt lgkmcnt(4)
v_mfma_f32_16x16x32_bf16 v[8:11], v[40:43], v[212:215], v[8:11]
ds_read_b64_tr_b16 v[36:37], v3 offset:24576
ds_read_b64_tr_b16 v[38:39], v3 offset:25600
v_mfma_f32_16x16x32_bf16 v[16:19], v[40:43], v[228:231], v[16:19]
v_mfma_f32_16x16x32_bf16 v[24:27], v[40:43], v[244:247], v[24:27]
s_waitcnt lgkmcnt(4)
v_mfma_f32_16x16x32_bf16 v[12:15], v[44:47], v[212:215], v[12:15]
ds_read_b64_tr_b16 v[40:41], v2 offset:26624
ds_read_b64_tr_b16 v[42:43], v2 offset:27648
v_mfma_f32_16x16x32_bf16 v[20:23], v[44:47], v[228:231], v[20:23]
v_mfma_f32_16x16x32_bf16 v[28:31], v[44:47], v[244:247], v[28:31]
v_cvt_pk_bf16_f32 v48, v8, v9
v_cvt_pk_bf16_f32 v49, v10, v11
s_nop 1
v_cvt_pk_bf16_f32 v50, v12, v13
v_cvt_pk_bf16_f32 v51, v14, v15
v_cvt_pk_bf16_f32 v52, v16, v17
v_cvt_pk_bf16_f32 v53, v18, v19
v_cvt_pk_bf16_f32 v54, v20, v21
v_cvt_pk_bf16_f32 v55, v22, v23
v_cvt_pk_bf16_f32 v248, v24, v25
v_cvt_pk_bf16_f32 v249, v26, v27
v_cvt_pk_bf16_f32 v250, v28, v29
v_cvt_pk_bf16_f32 v251, v30, v31
s_barrier
s_waitcnt lgkmcnt(4)
v_mfma_f32_16x16x32_bf16 v[8:11], v[32:35], v[56:59], 0
ds_read_b64_tr_b16 v[44:45], v3 offset:26624
ds_read_b64_tr_b16 v[46:47], v3 offset:27648
v_mfma_f32_16x16x32_bf16 v[16:19], v[32:35], v[72:75], 0
buffer_store_dwordx4 v[48:51], v4, s[24:27], s74 offen sc1
v_mfma_f32_16x16x32_bf16 v[24:27], v[32:35], v[88:91], 0
s_waitcnt lgkmcnt(4)
v_mfma_f32_16x16x32_bf16 v[12:15], v[36:39], v[56:59], 0
ds_read_b64_tr_b16 v[32:33], v2 offset:28672
ds_read_b64_tr_b16 v[34:35], v2 offset:29696
v_mfma_f32_16x16x32_bf16 v[20:23], v[36:39], v[72:75], 0
v_mfma_f32_16x16x32_bf16 v[28:31], v[36:39], v[88:91], 0
s_waitcnt lgkmcnt(4)
v_mfma_f32_16x16x32_bf16 v[8:11], v[40:43], v[60:63], v[8:11]
ds_read_b64_tr_b16 v[36:37], v3 offset:28672
ds_read_b64_tr_b16 v[38:39], v3 offset:29696
v_mfma_f32_16x16x32_bf16 v[16:19], v[40:43], v[76:79], v[16:19]
v_mfma_f32_16x16x32_bf16 v[24:27], v[40:43], v[92:95], v[24:27]
s_waitcnt lgkmcnt(4)
v_mfma_f32_16x16x32_bf16 v[12:15], v[44:47], v[60:63], v[12:15]
ds_read_b64_tr_b16 v[40:41], v2 offset:30720
ds_read_b64_tr_b16 v[42:43], v2 offset:31744
v_mfma_f32_16x16x32_bf16 v[20:23], v[44:47], v[76:79], v[20:23]
v_mfma_f32_16x16x32_bf16 v[28:31], v[44:47], v[92:95], v[28:31]
s_waitcnt lgkmcnt(4)
v_mfma_f32_16x16x32_bf16 v[8:11], v[32:35], v[64:67], v[8:11]
ds_read_b64_tr_b16 v[44:45], v3 offset:30720
ds_read_b64_tr_b16 v[46:47], v3 offset:31744
v_mfma_f32_16x16x32_bf16 v[16:19], v[32:35], v[80:83], v[16:19]
v_mfma_f32_16x16x32_bf16 v[24:27], v[32:35], v[96:99], v[24:27]
s_waitcnt lgkmcnt(4)
v_mfma_f32_16x16x32_bf16 v[12:15], v[36:39], v[64:67], v[12:15]
ds_read_b64_tr_b16 v[32:33], v2 offset:40960
ds_read_b64_tr_b16 v[34:35], v2 offset:41984
v_mfma_f32_16x16x32_bf16 v[20:23], v[36:39], v[80:83], v[20:23]
v_mfma_f32_16x16x32_bf16 v[28:31], v[36:39], v[96:99], v[28:31]
s_waitcnt lgkmcnt(4)
v_mfma_f32_16x16x32_bf16 v[8:11], v[40:43], v[68:71], v[8:11]
ds_read_b64_tr_b16 v[36:37], v3 offset:40960
ds_read_b64_tr_b16 v[38:39], v3 offset:41984
v_mfma_f32_16x16x32_bf16 v[16:19], v[40:43], v[84:87], v[16:19]
v_mfma_f32_16x16x32_bf16 v[24:27], v[40:43], v[100:103], v[24:27]
s_waitcnt lgkmcnt(4)
v_mfma_f32_16x16x32_bf16 v[12:15], v[44:47], v[68:71], v[12:15]
ds_read_b64_tr_b16 v[40:41], v2 offset:43008
ds_read_b64_tr_b16 v[42:43], v2 offset:44032
v_mfma_f32_16x16x32_bf16 v[20:23], v[44:47], v[84:87], v[20:23]
v_mfma_f32_16x16x32_bf16 v[28:31], v[44:47], v[100:103], v[28:31]
s_barrier
s_waitcnt lgkmcnt(4)
v_mfma_f32_16x16x32_bf16 v[8:11], v[32:35], v[104:107], v[8:11]
ds_read_b64_tr_b16 v[44:45], v3 offset:43008
ds_read_b64_tr_b16 v[46:47], v3 offset:44032
v_mfma_f32_16x16x32_bf16 v[16:19], v[32:35], v[120:123], v[16:19]
buffer_store_dwordx4 v[52:55], v4, s[24:27], s74 offen offset:1024 sc1
v_mfma_f32_16x16x32_bf16 v[24:27], v[32:35], v[136:139], v[24:27]
s_waitcnt lgkmcnt(4)
v_mfma_f32_16x16x32_bf16 v[12:15], v[36:39], v[104:107], v[12:15]
ds_read_b64_tr_b16 v[32:33], v2 offset:45056
ds_read_b64_tr_b16 v[34:35], v2 offset:46080
v_mfma_f32_16x16x32_bf16 v[20:23], v[36:39], v[120:123], v[20:23]
v_mfma_f32_16x16x32_bf16 v[28:31], v[36:39], v[136:139], v[28:31]
s_waitcnt lgkmcnt(4)
v_mfma_f32_16x16x32_bf16 v[8:11], v[40:43], v[108:111], v[8:11]
ds_read_b64_tr_b16 v[36:37], v3 offset:45056
ds_read_b64_tr_b16 v[38:39], v3 offset:46080
v_mfma_f32_16x16x32_bf16 v[16:19], v[40:43], v[124:127], v[16:19]
v_mfma_f32_16x16x32_bf16 v[24:27], v[40:43], v[140:143], v[24:27]
s_waitcnt lgkmcnt(4)
v_mfma_f32_16x16x32_bf16 v[12:15], v[44:47], v[108:111], v[12:15]
ds_read_b64_tr_b16 v[40:41], v2 offset:47104
ds_read_b64_tr_b16 v[42:43], v2 offset:48128
v_mfma_f32_16x16x32_bf16 v[20:23], v[44:47], v[124:127], v[20:23]
v_mfma_f32_16x16x32_bf16 v[28:31], v[44:47], v[140:143], v[28:31]
s_waitcnt lgkmcnt(4)
v_mfma_f32_16x16x32_bf16 v[8:11], v[32:35], v[112:115], v[8:11]
ds_read_b64_tr_b16 v[44:45], v3 offset:47104
ds_read_b64_tr_b16 v[46:47], v3 offset:48128
v_mfma_f32_16x16x32_bf16 v[16:19], v[32:35], v[128:131], v[16:19]
v_mfma_f32_16x16x32_bf16 v[24:27], v[32:35], v[144:147], v[24:27]
s_waitcnt lgkmcnt(4)
v_mfma_f32_16x16x32_bf16 v[12:15], v[36:39], v[112:115], v[12:15]
ds_read_b64_tr_b16 v[32:33], v2 offset:49152
ds_read_b64_tr_b16 v[34:35], v2 offset:50176
v_mfma_f32_16x16x32_bf16 v[20:23], v[36:39], v[128:131], v[20:23]
v_mfma_f32_16x16x32_bf16 v[28:31], v[36:39], v[144:147], v[28:31]
s_waitcnt lgkmcnt(4)
v_mfma_f32_16x16x32_bf16 v[8:11], v[40:43], v[116:119], v[8:11]
ds_read_b64_tr_b16 v[36:37], v3 offset:49152
ds_read_b64_tr_b16 v[38:39], v3 offset:50176
v_mfma_f32_16x16x32_bf16 v[16:19], v[40:43], v[132:135], v[16:19]
v_mfma_f32_16x16x32_bf16 v[24:27], v[40:43], v[148:151], v[24:27]
s_waitcnt lgkmcnt(4)
v_mfma_f32_16x16x32_bf16 v[12:15], v[44:47], v[116:119], v[12:15]
ds_read_b64_tr_b16 v[40:41], v2 offset:51200
ds_read_b64_tr_b16 v[42:43], v2 offset:52224
v_mfma_f32_16x16x32_bf16 v[20:23], v[44:47], v[132:135], v[20:23]
v_mfma_f32_16x16x32_bf16 v[28:31], v[44:47], v[148:151], v[28:31]
s_barrier
s_waitcnt lgkmcnt(4)
v_mfma_f32_16x16x32_bf16 v[8:11], v[32:35], v[152:155], v[8:11]
ds_read_b64_tr_b16 v[44:45], v3 offset:51200
ds_read_b64_tr_b16 v[46:47], v3 offset:52224
v_mfma_f32_16x16x32_bf16 v[16:19], v[32:35], v[168:171], v[16:19]
buffer_store_dwordx4 v[248:251], v4, s[24:27], s74 offen offset:2048 sc1
s_add_u32 s74, s74, 0xc00
s_sub_u32 s55, s74, 0x6c00
s_cmp_ge_u32 s74, s75
s_cselect_b32 s74, s55, s74
v_mfma_f32_16x16x32_bf16 v[24:27], v[32:35], v[184:187], v[24:27]
s_waitcnt lgkmcnt(4)
v_mfma_f32_16x16x32_bf16 v[12:15], v[36:39], v[152:155], v[12:15]
ds_read_b64_tr_b16 v[32:33], v2 offset:53248
ds_read_b64_tr_b16 v[34:35], v2 offset:54272
v_mfma_f32_16x16x32_bf16 v[20:23], v[36:39], v[168:171], v[20:23]
v_mfma_f32_16x16x32_bf16 v[28:31], v[36:39], v[184:187], v[28:31]
s_waitcnt lgkmcnt(4)
v_mfma_f32_16x16x32_bf16 v[8:11], v[40:43], v[156:159], v[8:11]
ds_read_b64_tr_b16 v[36:37], v3 offset:53248
ds_read_b64_tr_b16 v[38:39], v3 offset:54272
v_mfma_f32_16x16x32_bf16 v[16:19], v[40:43], v[172:175], v[16:19]
v_mfma_f32_16x16x32_bf16 v[24:27], v[40:43], v[188:191], v[24:27]
s_waitcnt lgkmcnt(4)
v_mfma_f32_16x16x32_bf16 v[12:15], v[44:47], v[156:159], v[12:15]
ds_read_b64_tr_b16 v[40:41], v2 offset:55296
ds_read_b64_tr_b16 v[42:43], v2 offset:56320
v_mfma_f32_16x16x32_bf16 v[20:23], v[44:47], v[172:175], v[20:23]
v_mfma_f32_16x16x32_bf16 v[28:31], v[44:47], v[188:191], v[28:31]
s_waitcnt lgkmcnt(4)
v_mfma_f32_16x16x32_bf16 v[8:11], v[32:35], v[160:163], v[8:11]
ds_read_b64_tr_b16 v[44:45], v3 offset:55296
ds_read_b64_tr_b16 v[46:47], v3 offset:56320
v_mfma_f32_16x16x32_bf16 v[16:19], v[32:35], v[176:179], v[16:19]
v_mfma_f32_16x16x32_bf16 v[24:27], v[32:35], v[192:195], v[24:27]
s_waitcnt lgkmcnt(4)
v_mfma_f32_16x16x32_bf16 v[12:15], v[36:39], v[160:163], v[12:15]
ds_read_b64_tr_b16 v[32:33], v2 offset:57344
ds_read_b64_tr_b16 v[34:35], v2 offset:58368
v_mfma_f32_16x16x32_bf16 v[20:23], v[36:39], v[176:179], v[20:23]
v_mfma_f32_16x16x32_bf16 v[28:31], v[36:39], v[192:195], v[28:31]
s_waitcnt lgkmcnt(4)
v_mfma_f32_16x16x32_bf16 v[8:11], v[40:43], v[164:167], v[8:11]
ds_read_b64_tr_b16 v[36:37], v3 offset:57344
ds_read_b64_tr_b16 v[38:39], v3 offset:58368
v_mfma_f32_16x16x32_bf16 v[16:19], v[40:43], v[180:183], v[16:19]
v_mfma_f32_16x16x32_bf16 v[24:27], v[40:43], v[196:199], v[24:27]
s_waitcnt lgkmcnt(4)
v_mfma_f32_16x16x32_bf16 v[12:15], v[44:47], v[164:167], v[12:15]
ds_read_b64_tr_b16 v[40:41], v2 offset:59392
ds_read_b64_tr_b16 v[42:43], v2 offset:60416
v_mfma_f32_16x16x32_bf16 v[20:23], v[44:47], v[180:183], v[20:23]
v_mfma_f32_16x16x32_bf16 v[28:31], v[44:47], v[196:199], v[28:31]
s_barrier
s_waitcnt lgkmcnt(4)
v_mfma_f32_16x16x32_bf16 v[8:11], v[32:35], v[200:203], v[8:11]
ds_read_b64_tr_b16 v[44:45], v3 offset:59392
ds_read_b64_tr_b16 v[46:47], v3 offset:60416
v_mfma_f32_16x16x32_bf16 v[16:19], v[32:35], v[216:219], v[16:19]
v_mfma_f32_16x16x32_bf16 v[24:27], v[32:35], v[232:235], v[24:27]
s_waitcnt lgkmcnt(4)
v_mfma_f32_16x16x32_bf16 v[12:15], v[36:39], v[200:203], v[12:15]
ds_read_b64_tr_b16 v[32:33], v2 offset:61440
ds_read_b64_tr_b16 v[34:35], v2 offset:62464
v_mfma_f32_16x16x32_bf16 v[20:23], v[36:39], v[216:219], v[20:23]
v_mfma_f32_16x16x32_bf16 v[28:31], v[36:39], v[232:235], v[28:31]
s_waitcnt lgkmcnt(4)
v_mfma_f32_16x16x32_bf16 v[8:11], v[40:43], v[204:207], v[8:11]
ds_read_b64_tr_b16 v[36:37], v3 offset:61440
ds_read_b64_tr_b16 v[38:39], v3 offset:62464
v_mfma_f32_16x16x32_bf16 v[16:19], v[40:43], v[220:223], v[16:19]
v_mfma_f32_16x16x32_bf16 v[24:27], v[40:43], v[236:239], v[24:27]
s_waitcnt lgkmcnt(4)
v_mfma_f32_16x16x32_bf16 v[12:15], v[44:47], v[204:207], v[12:15]
ds_read_b64_tr_b16 v[40:41], v2 offset:63488
ds_read_b64_tr_b16 v[42:43], v2 offset:64512
v_mfma_f32_16x16x32_bf16 v[20:23], v[44:47], v[220:223], v[20:23]
v_mfma_f32_16x16x32_bf16 v[28:31], v[44:47], v[236:239], v[28:31]
s_waitcnt lgkmcnt(4)
v_mfma_f32_16x16x32_bf16 v[8:11], v[32:35], v[208:211], v[8:11]
ds_read_b64_tr_b16 v[44:45], v3 offset:63488
ds_read_b64_tr_b16 v[46:47], v3 offset:64512
v_mfma_f32_16x16x32_bf16 v[16:19], v[32:35], v[224:227], v[16:19]
v_mfma_f32_16x16x32_bf16 v[24:27], v[32:35], v[240:243], v[24:27]
s_waitcnt lgkmcnt(4)
v_mfma_f32_16x16x32_bf16 v[12:15], v[36:39], v[208:211], v[12:15]
ds_read_b64_tr_b16 v[32:33], v2
ds_read_b64_tr_b16 v[34:35], v2 offset:1024
v_mfma_f32_16x16x32_bf16 v[20:23], v[36:39], v[224:227], v[20:23]
v_mfma_f32_16x16x32_bf16 v[28:31], v[36:39], v[240:243], v[28:31]
s_waitcnt lgkmcnt(4)
v_mfma_f32_16x16x32_bf16 v[8:11], v[40:43], v[212:215], v[8:11]
ds_read_b64_tr_b16 v[36:37], v3
ds_read_b64_tr_b16 v[38:39], v3 offset:1024
v_mfma_f32_16x16x32_bf16 v[16:19], v[40:43], v[228:231], v[16:19]
v_mfma_f32_16x16x32_bf16 v[24:27], v[40:43], v[244:247], v[24:27]
s_waitcnt lgkmcnt(4)
v_mfma_f32_16x16x32_bf16 v[12:15], v[44:47], v[212:215], v[12:15]
ds_read_b64_tr_b16 v[40:41], v2 offset:2048
ds_read_b64_tr_b16 v[42:43], v2 offset:3072
v_mfma_f32_16x16x32_bf16 v[20:23], v[44:47], v[228:231], v[20:23]
v_mfma_f32_16x16x32_bf16 v[28:31], v[44:47], v[244:247], v[28:31]
v_cvt_pk_bf16_f32 v48, v8, v9
v_cvt_pk_bf16_f32 v49, v10, v11
s_nop 1
v_cvt_pk_bf16_f32 v50, v12, v13
v_cvt_pk_bf16_f32 v51, v14, v15
v_cvt_pk_bf16_f32 v52, v16, v17
v_cvt_pk_bf16_f32 v53, v18, v19
v_cvt_pk_bf16_f32 v54, v20, v21
v_cvt_pk_bf16_f32 v55, v22, v23
v_cvt_pk_bf16_f32 v248, v24, v25
v_cvt_pk_bf16_f32 v249, v26, v27
v_cvt_pk_bf16_f32 v250, v28, v29
v_cvt_pk_bf16_f32 v251, v30, v31
s_barrier
s_waitcnt lgkmcnt(4)
v_mfma_f32_16x16x32_bf16 v[8:11], v[32:35], v[56:59], 0
ds_read_b64_tr_b16 v[44:45], v3 offset:2048
ds_read_b64_tr_b16 v[46:47], v3 offset:3072
v_mfma_f32_16x16x32_bf16 v[16:19], v[32:35], v[72:75], 0
buffer_store_dwordx4 v[48:51], v4, s[24:27], s74 offen sc1
v_mfma_f32_16x16x32_bf16 v[24:27], v[32:35], v[88:91], 0
s_waitcnt lgkmcnt(4)
v_mfma_f32_16x16x32_bf16 v[12:15], v[36:39], v[56:59], 0
ds_read_b64_tr_b16 v[32:33], v2 offset:4096
ds_read_b64_tr_b16 v[34:35], v2 offset:5120
v_mfma_f32_16x16x32_bf16 v[20:23], v[36:39], v[72:75], 0
v_mfma_f32_16x16x32_bf16 v[28:31], v[36:39], v[88:91], 0
s_waitcnt lgkmcnt(4)
v_mfma_f32_16x16x32_bf16 v[8:11], v[40:43], v[60:63], v[8:11]
ds_read_b64_tr_b16 v[36:37], v3 offset:4096
ds_read_b64_tr_b16 v[38:39], v3 offset:5120
v_mfma_f32_16x16x32_bf16 v[16:19], v[40:43], v[76:79], v[16:19]
v_mfma_f32_16x16x32_bf16 v[24:27], v[40:43], v[92:95], v[24:27]
s_waitcnt lgkmcnt(4)
v_mfma_f32_16x16x32_bf16 v[12:15], v[44:47], v[60:63], v[12:15]
ds_read_b64_tr_b16 v[40:41], v2 offset:6144
ds_read_b64_tr_b16 v[42:43], v2 offset:7168
v_mfma_f32_16x16x32_bf16 v[20:23], v[44:47], v[76:79], v[20:23]
v_mfma_f32_16x16x32_bf16 v[28:31], v[44:47], v[92:95], v[28:31]
s_waitcnt lgkmcnt(4)
v_mfma_f32_16x16x32_bf16 v[8:11], v[32:35], v[64:67], v[8:11]
ds_read_b64_tr_b16 v[44:45], v3 offset:6144
ds_read_b64_tr_b16 v[46:47], v3 offset:7168
v_mfma_f32_16x16x32_bf16 v[16:19], v[32:35], v[80:83], v[16:19]
v_mfma_f32_16x16x32_bf16 v[24:27], v[32:35], v[96:99], v[24:27]
s_waitcnt lgkmcnt(4)
v_mfma_f32_16x16x32_bf16 v[12:15], v[36:39], v[64:67], v[12:15]
ds_read_b64_tr_b16 v[32:33], v2 offset:8192
ds_read_b64_tr_b16 v[34:35], v2 offset:9216
v_mfma_f32_16x16x32_bf16 v[20:23], v[36:39], v[80:83], v[20:23]
v_mfma_f32_16x16x32_bf16 v[28:31], v[36:39], v[96:99], v[28:31]
s_waitcnt lgkmcnt(4)
v_mfma_f32_16x16x32_bf16 v[8:11], v[40:43], v[68:71], v[8:11]
ds_read_b64_tr_b16 v[36:37], v3 offset:8192
ds_read_b64_tr_b16 v[38:39], v3 offset:9216
v_mfma_f32_16x16x32_bf16 v[16:19], v[40:43], v[84:87], v[16:19]
v_mfma_f32_16x16x32_bf16 v[24:27], v[40:43], v[100:103], v[24:27]
s_waitcnt lgkmcnt(4)
v_mfma_f32_16x16x32_bf16 v[12:15], v[44:47], v[68:71], v[12:15]
ds_read_b64_tr_b16 v[40:41], v2 offset:10240
ds_read_b64_tr_b16 v[42:43], v2 offset:11264
v_mfma_f32_16x16x32_bf16 v[20:23], v[44:47], v[84:87], v[20:23]
v_mfma_f32_16x16x32_bf16 v[28:31], v[44:47], v[100:103], v[28:31]
s_barrier
s_waitcnt lgkmcnt(4)
v_mfma_f32_16x16x32_bf16 v[8:11], v[32:35], v[104:107], v[8:11]
ds_read_b64_tr_b16 v[44:45], v3 offset:10240
ds_read_b64_tr_b16 v[46:47], v3 offset:11264
v_mfma_f32_16x16x32_bf16 v[16:19], v[32:35], v[120:123], v[16:19]
buffer_store_dwordx4 v[52:55], v4, s[24:27], s74 offen offset:1024 sc1
v_mfma_f32_16x16x32_bf16 v[24:27], v[32:35], v[136:139], v[24:27]
s_waitcnt lgkmcnt(4)
v_mfma_f32_16x16x32_bf16 v[12:15], v[36:39], v[104:107], v[12:15]
ds_read_b64_tr_b16 v[32:33], v2 offset:12288
ds_read_b64_tr_b16 v[34:35], v2 offset:13312
v_mfma_f32_16x16x32_bf16 v[20:23], v[36:39], v[120:123], v[20:23]
v_mfma_f32_16x16x32_bf16 v[28:31], v[36:39], v[136:139], v[28:31]
s_waitcnt lgkmcnt(4)
v_mfma_f32_16x16x32_bf16 v[8:11], v[40:43], v[108:111], v[8:11]
ds_read_b64_tr_b16 v[36:37], v3 offset:12288
ds_read_b64_tr_b16 v[38:39], v3 offset:13312
v_mfma_f32_16x16x32_bf16 v[16:19], v[40:43], v[124:127], v[16:19]
v_mfma_f32_16x16x32_bf16 v[24:27], v[40:43], v[140:143], v[24:27]
s_waitcnt lgkmcnt(4)
v_mfma_f32_16x16x32_bf16 v[12:15], v[44:47], v[108:111], v[12:15]
ds_read_b64_tr_b16 v[40:41], v2 offset:14336
ds_read_b64_tr_b16 v[42:43], v2 offset:15360
v_mfma_f32_16x16x32_bf16 v[20:23], v[44:47], v[124:127], v[20:23]
v_mfma_f32_16x16x32_bf16 v[28:31], v[44:47], v[140:143], v[28:31]
s_waitcnt lgkmcnt(4)
v_mfma_f32_16x16x32_bf16 v[8:11], v[32:35], v[112:115], v[8:11]
ds_read_b64_tr_b16 v[44:45], v3 offset:14336
ds_read_b64_tr_b16 v[46:47], v3 offset:15360
v_mfma_f32_16x16x32_bf16 v[16:19], v[32:35], v[128:131], v[16:19]
v_mfma_f32_16x16x32_bf16 v[24:27], v[32:35], v[144:147], v[24:27]
s_waitcnt lgkmcnt(4)
v_mfma_f32_16x16x32_bf16 v[12:15], v[36:39], v[112:115], v[12:15]
ds_read_b64_tr_b16 v[32:33], v2 offset:16384
ds_read_b64_tr_b16 v[34:35], v2 offset:17408
v_mfma_f32_16x16x32_bf16 v[20:23], v[36:39], v[128:131], v[20:23]
v_mfma_f32_16x16x32_bf16 v[28:31], v[36:39], v[144:147], v[28:31]
s_waitcnt lgkmcnt(4)
v_mfma_f32_16x16x32_bf16 v[8:11], v[40:43], v[116:119], v[8:11]
ds_read_b64_tr_b16 v[36:37], v3 offset:16384
ds_read_b64_tr_b16 v[38:39], v3 offset:17408
v_mfma_f32_16x16x32_bf16 v[16:19], v[40:43], v[132:135], v[16:19]
v_mfma_f32_16x16x32_bf16 v[24:27], v[40:43], v[148:151], v[24:27]
s_waitcnt lgkmcnt(4)
v_mfma_f32_16x16x32_bf16 v[12:15], v[44:47], v[116:119], v[12:15]
ds_read_b64_tr_b16 v[40:41], v2 offset:18432
ds_read_b64_tr_b16 v[42:43], v2 offset:19456
v_mfma_f32_16x16x32_bf16 v[20:23], v[44:47], v[132:135], v[20:23]
v_mfma_f32_16x16x32_bf16 v[28:31], v[44:47], v[148:151], v[28:31]
s_waitcnt lgkmcnt(4)
v_mfma_f32_16x16x32_bf16 v[8:11], v[32:35], v[152:155], v[8:11]
ds_read_b64_tr_b16 v[44:45], v3 offset:18432
ds_read_b64_tr_b16 v[46:47], v3 offset:19456
v_mfma_f32_16x16x32_bf16 v[16:19], v[32:35], v[168:171], v[16:19]
buffer_store_dwordx4 v[248:251], v4, s[24:27], s74 offen offset:2048 sc1
s_add_u32 s74, s74, 0xc00
s_sub_u32 s55, s74, 0x6c00
s_cmp_ge_u32 s74, s75
s_cselect_b32 s74, s55, s74
v_mfma_f32_16x16x32_bf16 v[24:27], v[32:35], v[184:187], v[24:27]
s_waitcnt lgkmcnt(4)
v_mfma_f32_16x16x32_bf16 v[12:15], v[36:39], v[152:155], v[12:15]
ds_read_b64_tr_b16 v[32:33], v2 offset:20480
ds_read_b64_tr_b16 v[34:35], v2 offset:21504
v_mfma_f32_16x16x32_bf16 v[20:23], v[36:39], v[168:171], v[20:23]
v_mfma_f32_16x16x32_bf16 v[28:31], v[36:39], v[184:187], v[28:31]
s_waitcnt lgkmcnt(4)
v_mfma_f32_16x16x32_bf16 v[8:11], v[40:43], v[156:159], v[8:11]
ds_read_b64_tr_b16 v[36:37], v3 offset:20480
ds_read_b64_tr_b16 v[38:39], v3 offset:21504
v_mfma_f32_16x16x32_bf16 v[16:19], v[40:43], v[172:175], v[16:19]
v_mfma_f32_16x16x32_bf16 v[24:27], v[40:43], v[188:191], v[24:27]
s_waitcnt lgkmcnt(4)
v_mfma_f32_16x16x32_bf16 v[12:15], v[44:47], v[156:159], v[12:15]
ds_read_b64_tr_b16 v[40:41], v2 offset:22528
ds_read_b64_tr_b16 v[42:43], v2 offset:23552
v_mfma_f32_16x16x32_bf16 v[20:23], v[44:47], v[172:175], v[20:23]
v_mfma_f32_16x16x32_bf16 v[28:31], v[44:47], v[188:191], v[28:31]
s_waitcnt lgkmcnt(4)
v_mfma_f32_16x16x32_bf16 v[8:11], v[32:35], v[160:163], v[8:11]
ds_read_b64_tr_b16 v[44:45], v3 offset:22528
ds_read_b64_tr_b16 v[46:47], v3 offset:23552
v_mfma_f32_16x16x32_bf16 v[16:19], v[32:35], v[176:179], v[16:19]
v_mfma_f32_16x16x32_bf16 v[24:27], v[32:35], v[192:195], v[24:27]
s_waitcnt lgkmcnt(4)
v_mfma_f32_16x16x32_bf16 v[12:15], v[36:39], v[160:163], v[12:15]
ds_read_b64_tr_b16 v[32:33], v2 offset:32768
ds_read_b64_tr_b16 v[34:35], v2 offset:33792
v_mfma_f32_16x16x32_bf16 v[20:23], v[36:39], v[176:179], v[20:23]
v_mfma_f32_16x16x32_bf16 v[28:31], v[36:39], v[192:195], v[28:31]
s_waitcnt lgkmcnt(4)
v_mfma_f32_16x16x32_bf16 v[8:11], v[40:43], v[164:167], v[8:11]
ds_read_b64_tr_b16 v[36:37], v3 offset:32768
ds_read_b64_tr_b16 v[38:39], v3 offset:33792
v_mfma_f32_16x16x32_bf16 v[16:19], v[40:43], v[180:183], v[16:19]
v_mfma_f32_16x16x32_bf16 v[24:27], v[40:43], v[196:199], v[24:27]
s_waitcnt lgkmcnt(4)
v_mfma_f32_16x16x32_bf16 v[12:15], v[44:47], v[164:167], v[12:15]
ds_read_b64_tr_b16 v[40:41], v2 offset:34816
ds_read_b64_tr_b16 v[42:43], v2 offset:35840
v_mfma_f32_16x16x32_bf16 v[20:23], v[44:47], v[180:183], v[20:23]
v_mfma_f32_16x16x32_bf16 v[28:31], v[44:47], v[196:199], v[28:31]
s_waitcnt lgkmcnt(4)
v_mfma_f32_16x16x32_bf16 v[8:11], v[32:35], v[200:203], v[8:11]
ds_read_b64_tr_b16 v[44:45], v3 offset:34816
ds_read_b64_tr_b16 v[46:47], v3 offset:35840
v_mfma_f32_16x16x32_bf16 v[16:19], v[32:35], v[216:219], v[16:19]
v_mfma_f32_16x16x32_bf16 v[24:27], v[32:35], v[232:235], v[24:27]
s_waitcnt lgkmcnt(4)
v_mfma_f32_16x16x32_bf16 v[12:15], v[36:39], v[200:203], v[12:15]
ds_read_b64_tr_b16 v[32:33], v2 offset:36864
ds_read_b64_tr_b16 v[34:35], v2 offset:37888
v_mfma_f32_16x16x32_bf16 v[20:23], v[36:39], v[216:219], v[20:23]
v_mfma_f32_16x16x32_bf16 v[28:31], v[36:39], v[232:235], v[28:31]
s_waitcnt lgkmcnt(4)
v_mfma_f32_16x16x32_bf16 v[8:11], v[40:43], v[204:207], v[8:11]
ds_read_b64_tr_b16 v[36:37], v3 offset:36864
ds_read_b64_tr_b16 v[38:39], v3 offset:37888
v_mfma_f32_16x16x32_bf16 v[16:19], v[40:43], v[220:223], v[16:19]
v_mfma_f32_16x16x32_bf16 v[24:27], v[40:43], v[236:239], v[24:27]
s_waitcnt lgkmcnt(4)
v_mfma_f32_16x16x32_bf16 v[12:15], v[44:47], v[204:207], v[12:15]
ds_read_b64_tr_b16 v[40:41], v2 offset:38912
ds_read_b64_tr_b16 v[42:43], v2 offset:39936
v_mfma_f32_16x16x32_bf16 v[20:23], v[44:47], v[220:223], v[20:23]
v_mfma_f32_16x16x32_bf16 v[28:31], v[44:47], v[236:239], v[28:31]
s_waitcnt lgkmcnt(4)
v_mfma_f32_16x16x32_bf16 v[8:11], v[32:35], v[208:211], v[8:11]
ds_read_b64_tr_b16 v[44:45], v3 offset:38912
ds_read_b64_tr_b16 v[46:47], v3 offset:39936
v_mfma_f32_16x16x32_bf16 v[16:19], v[32:35], v[224:227], v[16:19]
v_mfma_f32_16x16x32_bf16 v[24:27], v[32:35], v[240:243], v[24:27]
s_waitcnt lgkmcnt(4)
v_mfma_f32_16x16x32_bf16 v[12:15], v[36:39], v[208:211], v[12:15]
v_mfma_f32_16x16x32_bf16 v[20:23], v[36:39], v[224:227], v[20:23]
v_mfma_f32_16x16x32_bf16 v[28:31], v[36:39], v[240:243], v[28:31]
s_waitcnt lgkmcnt(2)
v_mfma_f32_16x16x32_bf16 v[8:11], v[40:43], v[212:215], v[8:11]
v_mfma_f32_16x16x32_bf16 v[16:19], v[40:43], v[228:231], v[16:19]
v_mfma_f32_16x16x32_bf16 v[24:27], v[40:43], v[244:247], v[24:27]
s_waitcnt lgkmcnt(0)
v_mfma_f32_16x16x32_bf16 v[12:15], v[44:47], v[212:215], v[12:15]
v_mfma_f32_16x16x32_bf16 v[20:23], v[44:47], v[228:231], v[20:23]
v_mfma_f32_16x16x32_bf16 v[28:31], v[44:47], v[244:247], v[28:31]
s_nop 1
v_cvt_pk_bf16_f32 v48, v8, v9
v_cvt_pk_bf16_f32 v49, v10, v11
s_nop 1
v_cvt_pk_bf16_f32 v50, v12, v13
v_cvt_pk_bf16_f32 v51, v14, v15
v_cvt_pk_bf16_f32 v52, v16, v17
v_cvt_pk_bf16_f32 v53, v18, v19
v_cvt_pk_bf16_f32 v54, v20, v21
v_cvt_pk_bf16_f32 v55, v22, v23
v_cvt_pk_bf16_f32 v248, v24, v25
v_cvt_pk_bf16_f32 v249, v26, v27
v_cvt_pk_bf16_f32 v250, v28, v29
v_cvt_pk_bf16_f32 v251, v30, v31
buffer_store_dwordx4 v[48:51], v4, s[24:27], s74 offen sc1
buffer_store_dwordx4 v[52:55], v4, s[24:27], s74 offen offset:1024 sc1
buffer_store_dwordx4 v[248:251], v4, s[24:27], s74 offen offset:2048 sc1
s_add_u32 s74, s74, 0xc00
s_sub_u32 s55, s74, 0x6c00
s_cmp_ge_u32 s74, s75
s_cselect_b32 s74, s55, s74
s_endpgm
.p2align 6
L_P:
s_mul_i32 s54, s50, 0x1800
s_add_u32 s54, s54, 0x10000
v_lshlrev_b32 v1, 4, v0
v_add_u32 v1, s54, v1
ds_write_b128 v1, v[104:107]
ds_write_b128 v1, v[120:123] offset:2048
ds_write_b128 v1, v[136:139] offset:4096
ds_write_b128 v1, v[108:111] offset:1024
ds_write_b128 v1, v[124:127] offset:3072
ds_write_b128 v1, v[140:143] offset:5120
s_waitcnt lgkmcnt(0)
s_barrier
s_and_b32 s54, s50, 1
s_lshl_b32 s55, s54, 1
v_and_b32 v1, 3, v0
v_xor_b32 v1, s55, v1
v_lshrrev_b32 v12, 4, v0
v_lshl_add_u32 v1, v12, 2, v1
v_lshlrev_b32 v1, 4, v1
v_bfe_u32 v12, v0, 2, 2
v_lshl_add_u32 v1, v12, 8, v1
s_lshl_b32 s56, s50, 11
s_lshr_b32 s57, s50, 1
s_lshl_b32 s57, s57, 2
s_add_u32 s57, s57, s54
s_lshl_b32 s57, s57, 10
v_add_u32 v2, s56, v1
v_add_u32 v3, s57, v1
s_and_b32 s54, s50, 1
v_and_b32 v1, 3, v0
v_xor_b32 v1, s54, v1
v_lshrrev_b32 v12, 4, v0
v_lshl_add_u32 v1, v12, 2, v1
v_lshlrev_b32 v1, 4, v1
v_bfe_u32 v12, v0, 2, 2
v_lshl_add_u32 v1, v12, 13, v1
s_lshl_b32 s54, s50, 16
v_add_u32 v4, s54, v1
s_and_b32 s54, s34, 3
s_lshl_b32 s54, s54, 1
s_add_u32 s54, s54, s35
s_lshl_b32 s54, s54, 7
s_sub_u32 s55, s54, 0x480
s_cmp_ge_u32 s54, 0x480
s_cselect_b32 s40, s55, s54
s_add_u32 s54, s40, 0x80
s_sub_u32 s55, s54, 0x480
s_cmp_ge_u32 s54, 0x480
s_cselect_b32 s41, s55, s54
s_add_u32 s54, s41, 0x80
s_sub_u32 s55, s54, 0x480
s_cmp_ge_u32 s54, 0x480
s_cselect_b32 s42, s55, s54
s_add_u32 s54, s42, 0x80
s_sub_u32 s55, s54, 0x480
s_cmp_ge_u32 s54, 0x480
s_cselect_b32 s43, s55, s54
s_add_u32 s54, s43, 0x80
s_sub_u32 s55, s54, 0x480
s_cmp_ge_u32 s54, 0x480
s_cselect_b32 s44, s55, s54
s_add_u32 s54, s44, 0x80
s_sub_u32 s55, s54, 0x480
s_cmp_ge_u32 s54, 0x480
s_cselect_b32 s45, s55, s54
s_add_u32 s54, s45, 0x80
s_sub_u32 s55, s54, 0x480
s_cmp_ge_u32 s54, 0x480
s_cselect_b32 s46, s55, s54
s_add_u32 s54, s46, 0x80
s_sub_u32 s55, s54, 0x480
s_cmp_ge_u32 s54, 0x480
s_cselect_b32 s47, s55, s54
s_add_u32 s54, s47, 0x80
s_sub_u32 s55, s54, 0x480
s_cmp_ge_u32 s54, 0x480
s_cselect_b32 s48, s55, s54
s_add_u32 s54, s48, 0x80
s_mul_i32 s54, s50, 0xd800
v_and_b32 v1, 7, v0
v_lshrrev_b32 v12, 3, v0
v_mul_u32_u24 v12, 0x480, v12
v_lshl_add_u32 v1, v1, 4, v12
v_add_u32 v5, s54, v1
v_xor_b32 v1, 32, v5
v_add_u32 v200, 0x2400, v1
buffer_load_dwordx4 v[176:179], v5, s[20:23], s40 offen
buffer_load_dwordx4 v[180:183], v200, s[20:23], s40 offen
s_add_u32 s64, s40, 0x4800
buffer_load_dwordx4 v[184:187], v5, s[20:23], s64 offen
s_add_u32 s64, s40, 0x4800
buffer_load_dwordx4 v[188:191], v200, s[20:23], s64 offen
s_add_u32 s64, s40, 0x9000
buffer_load_dwordx4 v[192:195], v5, s[20:23], s64 offen
s_add_u32 s64, s40, 0x9000
buffer_load_dwordx4 v[196:199], v200, s[20:23], s64 offen
buffer_load_dwordx4 v[152:155], v5, s[20:23], s41 offen
buffer_load_dwordx4 v[156:159], v200, s[20:23], s41 offen
s_add_u32 s64, s41, 0x4800
buffer_load_dwordx4 v[160:163], v5, s[20:23], s64 offen
s_add_u32 s64, s41, 0x4800
buffer_load_dwordx4 v[164:167], v200, s[20:23], s64 offen
s_add_u32 s64, s41, 0x9000
buffer_load_dwordx4 v[168:171], v5, s[20:23], s64 offen
s_add_u32 s64, s41, 0x9000
buffer_load_dwordx4 v[172:175], v200, s[20:23], s64 offen
s_lshl_b32 s54, s50, 12
s_add_u32 s54, s54, 0x18000
v_and_b32 v1, 3, v0
v_lshrrev_b32 v12, 3, v0
v_lshl_add_u32 v1, v12, 2, v1
v_lshlrev_b32 v1, 4, v1
v_bfe_u32 v12, v0, 2, 1
v_xor_b32 v12, 1, v12
v_mul_u32_u24 v12, 0x440, v12
v_xor_b32 v1, v1, v12
v_add_u32 v10, s54, v1
v_and_b32 v12, 0x400, v12
v_add_u32 v202, v10, v12
v_bfe_u32 v1, v0, 3, 1
v_lshlrev_b32 v1, 1, v1
v_lshrrev_b32 v12, 4, v0
v_xor_b32 v1, v1, v12
v_and_b32 v12, 15, v0
v_lshl_add_u32 v1, v12, 2, v1
v_lshlrev_b32 v1, 4, v1
v_add_u32 v11, s54, v1
v_xor_b32 v201, 64, v11
v_and_b32 v1, 3, v0
v_bfe_u32 v12, v0, 4, 1
v_xor_b32 v1, v1, v12
v_bfe_u32 v12, v0, 2, 2
v_lshl_add_u32 v1, v12, 2, v1
v_lshrrev_b32 v12, 4, v0
v_lshl_add_u32 v1, v12, 7, v1
v_lshlrev_b32 v1, 4, v1
v_and_b32 v12, 1, v0
v_lshl_add_u32 v1, v12, 3, v1
v_add_u32 v6, 0x10000, v1
v_xor_b32 v7, 8, v6
s_mul_i32 s54, s50, 0x3000
s_add_u32 s54, s54, 0x1c000
v_lshlrev_b32 v1, 4, v0
v_bfe_u32 v12, v0, 4, 1
v_lshl_add_u32 v1, v12, 3, v1
v_add_u32 v8, s54, v1
v_xor_b32 v9, 8, v8
s_mov_b32 s61, 0x3e0293ee
s_mul_i32 s75, s37, 0x9000
s_mul_i32 s55, s50, 0x2400
s_add_u32 s75, s75, s55
s_sub_u32 s75, s75, 0x480
v_lshlrev_b32 v203, 7, v0
v_mov_b32 v204, 0x7fffff00
v_cmp_gt_u32 vcc, 9, v0
s_nop 1
v_cndmask_b32 v203, v204, v203, vcc
s_add_u32 m0, s56, 0x16000
s_lshl_b32 s66, s40, 12
s_add_u32 s66, s66, 0x100
buffer_load_dwordx4 v4, s[16:19], s66 offen lds
s_add_u32 s67, s66, 0x7c00
buffer_load_dwordx4 v4, s[16:19], s67 offen offset:1024 lds
s_waitcnt vmcnt(13)
ds_write_b128 v10, v[176:179]
s_waitcnt vmcnt(12)
ds_write_b128 v10, v[180:183] offset:512
s_waitcnt vmcnt(11)
ds_write_b128 v10, v[184:187] offset:2048
s_waitcnt vmcnt(10)
ds_write_b128 v10, v[188:191] offset:2560
ds_read_b128 v[128:131], v201 offset:1024
ds_read_b128 v[132:135], v201 offset:3072
s_waitcnt vmcnt(9)
ds_write_b128 v202, v[192:195] offset:1024
s_waitcnt vmcnt(8)
ds_write_b128 v202, v[196:199] offset:1536
ds_read_b128 v[136:139], v201 offset:3072
s_waitcnt lgkmcnt(8)
buffer_load_dwordx4 v[176:179], v5, s[20:23], s42 offen
s_waitcnt lgkmcnt(7)
buffer_load_dwordx4 v[180:183], v200, s[20:23], s42 offen
s_waitcnt lgkmcnt(6)
s_add_u32 s64, s42, 0x4800
buffer_load_dwordx4 v[184:187], v5, s[20:23], s64 offen
s_waitcnt vmcnt(3)
s_barrier
ds_read_b64_tr_b16 v[16:17], v6 offset:24576
ds_read_b64_tr_b16 v[18:19], v6 offset:25600
ds_read_b64_tr_b16 v[20:21], v7 offset:24576
ds_read_b64_tr_b16 v[22:23], v7 offset:25600
ds_read_b64_tr_b16 v[24:25], v6 offset:24832
ds_read_b64_tr_b16 v[26:27], v6 offset:25856
s_add_u32 m0, s56, 0x10000
s_lshl_b32 s66, s40, 12
s_add_u32 s66, s66, 0x40100
buffer_load_dwordx4 v4, s[16:19], s66 offen lds
s_waitcnt lgkmcnt(4)
v_mfma_f32_16x16x32_bf16 v[32:35], v[16:19], v[128:131], 0
ds_read_b64_tr_b16 v[28:29], v7 offset:24832
s_add_u32 s67, s66, 0x7c00
buffer_load_dwordx4 v4, s[16:19], s67 offen offset:1024 lds
v_mfma_f32_16x16x32_bf16 v[64:67], v[16:19], v[132:135], 0
ds_read_b64_tr_b16 v[30:31], v7 offset:25856
ds_read_b128 v[140:143], v11
ds_read_b128 v[144:147], v11 offset:2048
ds_read_b128 v[148:151], v11 offset:1024
v_mfma_f32_16x16x32_bf16 v[96:99], v[16:19], v[136:139], 0
s_add_u32 m0, s56, 0x12000
s_lshl_b32 s66, s41, 12
s_add_u32 s66, s66, 0x100
buffer_load_dwordx4 v4, s[16:19], s66 offen lds
s_waitcnt lgkmcnt(7)
v_mfma_f32_16x16x32_bf16 v[36:39], v[20:23], v[128:131], 0
ds_read_b64_tr_b16 v[16:17], v6 offset:25088
s_add_u32 s64, s42, 0x4800
buffer_load_dwordx4 v[188:191], v200, s[20:23], s64 offen
v_mfma_f32_16x16x32_bf16 v[68:71], v[20:23], v[132:135], 0
ds_read_b64_tr_b16 v[18:19], v6 offset:26112
s_add_u32 s67, s66, 0x7c00
buffer_load_dwordx4 v4, s[16:19], s67 offen offset:1024 lds
v_mfma_f32_16x16x32_bf16 v[100:103], v[20:23], v[136:139], 0
ds_write_b128 v10, v[152:155]
s_waitcnt lgkmcnt(8)
v_mfma_f32_16x16x32_bf16 v[40:43], v[24:27], v[128:131], 0
ds_read_b64_tr_b16 v[20:21], v7 offset:25088
s_add_u32 m0, s56, 0x14000
s_lshl_b32 s66, s41, 12
s_add_u32 s66, s66, 0x40100
buffer_load_dwordx4 v4, s[16:19], s66 offen lds
v_mfma_f32_16x16x32_bf16 v[72:75], v[24:27], v[132:135], 0
ds_read_b64_tr_b16 v[22:23], v7 offset:26112
s_add_u32 s64, s42, 0x9000
buffer_load_dwordx4 v[192:195], v5, s[20:23], s64 offen
v_mfma_f32_16x16x32_bf16 v[104:107], v[24:27], v[136:139], 0
s_add_u32 s67, s66, 0x7c00
buffer_load_dwordx4 v4, s[16:19], s67 offen offset:1024 lds
s_waitcnt lgkmcnt(8)
v_mfma_f32_16x16x32_bf16 v[44:47], v[28:31], v[128:131], 0
ds_read_b64_tr_b16 v[24:25], v6 offset:25344
ds_write_b128 v10, v[156:159] offset:512
v_mfma_f32_16x16x32_bf16 v[76:79], v[28:31], v[132:135], 0
ds_read_b64_tr_b16 v[26:27], v6 offset:26368
s_add_u32 m0, s56, 0
s_mov_b32 s58, 0x8000
buffer_load_dwordx4 v2, s[8:11], s58 offen nt lds
v_mfma_f32_16x16x32_bf16 v[108:111], v[28:31], v[136:139], 0
s_add_u32 s64, s42, 0x9000
buffer_load_dwordx4 v[196:199], v200, s[20:23], s64 offen
s_waitcnt lgkmcnt(6)
v_mfma_f32_16x16x32_bf16 v[48:51], v[16:19], v[128:131], 0
ds_read_b64_tr_b16 v[28:29], v7 offset:25344
buffer_load_dwordx4 v2, s[8:11], s58 offen offset:1024 nt lds
v_mfma_f32_16x16x32_bf16 v[80:83], v[16:19], v[132:135], 0
ds_read_b64_tr_b16 v[30:31], v7 offset:26368
ds_write_b128 v10, v[160:163] offset:2048
v_mfma_f32_16x16x32_bf16 v[112:115], v[16:19], v[136:139], 0
s_waitcnt lgkmcnt(6)
v_mfma_f32_16x16x32_bf16 v[52:55], v[20:23], v[128:131], 0
v_mfma_f32_16x16x32_bf16 v[84:87], v[20:23], v[132:135], 0
v_mfma_f32_16x16x32_bf16 v[116:119], v[20:23], v[136:139], 0
s_waitcnt lgkmcnt(3)
v_mfma_f32_16x16x32_bf16 v[56:59], v[24:27], v[128:131], 0
v_mfma_f32_16x16x32_bf16 v[88:91], v[24:27], v[132:135], 0
v_mfma_f32_16x16x32_bf16 v[120:123], v[24:27], v[136:139], 0
s_waitcnt lgkmcnt(1)
v_mfma_f32_16x16x32_bf16 v[60:63], v[28:31], v[128:131], 0
v_mfma_f32_16x16x32_bf16 v[92:95], v[28:31], v[132:135], 0
v_mfma_f32_16x16x32_bf16 v[124:127], v[28:31], v[136:139], 0
s_waitcnt vmcnt(6)
s_barrier
ds_read_b64_tr_b16 v[16:17], v6
ds_read_b64_tr_b16 v[18:19], v6 offset:1024
ds_read_b64_tr_b16 v[20:21], v7
ds_read_b64_tr_b16 v[22:23], v7 offset:1024
ds_read_b64_tr_b16 v[24:25], v6 offset:256
ds_read_b64_tr_b16 v[26:27], v6 offset:1280
s_add_u32 m0, s56, 0x16000
s_lshl_b32 s66, s42, 12
s_add_u32 s66, s66, 0x100
buffer_load_dwordx4 v4, s[16:19], s66 offen lds
s_waitcnt lgkmcnt(4)
v_mfma_f32_16x16x32_bf16 v[32:35], v[16:19], v[140:143], v[32:35]
ds_read_b64_tr_b16 v[28:29], v7 offset:256
s_add_u32 s67, s66, 0x7c00
buffer_load_dwordx4 v4, s[16:19], s67 offen offset:1024 lds
v_mfma_f32_16x16x32_bf16 v[64:67], v[16:19], v[144:147], v[64:67]
ds_read_b64_tr_b16 v[30:31], v7 offset:1280
ds_write_b128 v10, v[164:167] offset:2560
v_mfma_f32_16x16x32_bf16 v[96:99], v[16:19], v[148:151], v[96:99]
s_waitcnt lgkmcnt(5)
v_mfma_f32_16x16x32_bf16 v[36:39], v[20:23], v[140:143], v[36:39]
ds_read_b64_tr_b16 v[16:17], v6 offset:512
ds_read_b128 v[128:131], v201 offset:1024
ds_read_b128 v[132:135], v201 offset:3072
v_mfma_f32_16x16x32_bf16 v[68:71], v[20:23], v[144:147], v[68:71]
ds_read_b64_tr_b16 v[18:19], v6 offset:1536
v_mfma_f32_16x16x32_bf16 v[100:103], v[20:23], v[148:151], v[100:103]
buffer_load_dwordx4 v[152:155], v5, s[20:23], s43 offen
s_waitcnt lgkmcnt(7)
v_mfma_f32_16x16x32_bf16 v[40:43], v[24:27], v[140:143], v[40:43]
ds_read_b64_tr_b16 v[20:21], v7 offset:512
s_add_u32 m0, s56, 0x2000
s_mov_b32 s58, 0xa000
buffer_load_dwordx4 v2, s[8:11], s58 offen nt lds
v_mfma_f32_16x16x32_bf16 v[72:75], v[24:27], v[144:147], v[72:75]
ds_read_b64_tr_b16 v[22:23], v7 offset:1536
ds_write_b128 v202, v[168:171] offset:1024
v_mfma_f32_16x16x32_bf16 v[104:107], v[24:27], v[148:151], v[104:107]
s_waitcnt lgkmcnt(8)
v_mfma_f32_16x16x32_bf16 v[44:47], v[28:31], v[140:143], v[44:47]
ds_read_b64_tr_b16 v[24:25], v6 offset:768
v_mfma_f32_16x16x32_bf16 v[76:79], v[28:31], v[144:147], v[76:79]
ds_read_b64_tr_b16 v[26:27], v6 offset:1792
buffer_load_dwordx4 v[156:159], v200, s[20:23], s43 offen
v_mfma_f32_16x16x32_bf16 v[108:111], v[28:31], v[148:151], v[108:111]
s_waitcnt lgkmcnt(5)
v_mfma_f32_16x16x32_bf16 v[48:51], v[16:19], v[140:143], v[48:51]
ds_read_b64_tr_b16 v[28:29], v7 offset:768
ds_write_b128 v202, v[172:175] offset:1536
buffer_load_dwordx4 v2, s[8:11], s58 offen offset:1024 nt lds
v_mfma_f32_16x16x32_bf16 v[80:83], v[16:19], v[144:147], v[80:83]
ds_read_b64_tr_b16 v[30:31], v7 offset:1792
v_mfma_f32_16x16x32_bf16 v[112:115], v[16:19], v[148:151], v[112:115]
ds_read_b128 v[136:139], v201 offset:3072
s_waitcnt lgkmcnt(7)
v_mfma_f32_16x16x32_bf16 v[52:55], v[20:23], v[140:143], v[52:55]
ds_read_b64_tr_b16 v[16:17], v6 offset:8192
v_mfma_f32_16x16x32_bf16 v[84:87], v[20:23], v[144:147], v[84:87]
ds_read_b64_tr_b16 v[18:19], v6 offset:9216
v_mfma_f32_16x16x32_bf16 v[116:119], v[20:23], v[148:151], v[116:119]
s_add_u32 s64, s43, 0x4800
buffer_load_dwordx4 v[160:163], v5, s[20:23], s64 offen
s_waitcnt lgkmcnt(6)
v_mfma_f32_16x16x32_bf16 v[56:59], v[24:27], v[140:143], v[56:59]
ds_read_b64_tr_b16 v[20:21], v7 offset:8192
v_mfma_f32_16x16x32_bf16 v[88:91], v[24:27], v[144:147], v[88:91]
ds_read_b64_tr_b16 v[22:23], v7 offset:9216
v_mfma_f32_16x16x32_bf16 v[120:123], v[24:27], v[148:151], v[120:123]
s_waitcnt lgkmcnt(5)
v_mfma_f32_16x16x32_bf16 v[60:63], v[28:31], v[140:143], v[60:63]
ds_read_b64_tr_b16 v[24:25], v6 offset:8448
v_mfma_f32_16x16x32_bf16 v[92:95], v[28:31], v[144:147], v[92:95]
ds_read_b64_tr_b16 v[26:27], v6 offset:9472
v_mfma_f32_16x16x32_bf16 v[124:127], v[28:31], v[148:151], v[124:127]
s_waitcnt lgkmcnt(4)
v_mfma_f32_16x16x32_bf16 v[32:35], v[16:19], v[128:131], v[32:35]
ds_read_b64_tr_b16 v[28:29], v7 offset:8448
v_mfma_f32_16x16x32_bf16 v[64:67], v[16:19], v[132:135], v[64:67]
ds_read_b64_tr_b16 v[30:31], v7 offset:9472
v_mfma_f32_16x16x32_bf16 v[96:99], v[16:19], v[136:139], v[96:99]
s_waitcnt lgkmcnt(4)
v_mfma_f32_16x16x32_bf16 v[36:39], v[20:23], v[128:131], v[36:39]
ds_read_b64_tr_b16 v[16:17], v6 offset:8704
v_mfma_f32_16x16x32_bf16 v[68:71], v[20:23], v[132:135], v[68:71]
ds_read_b64_tr_b16 v[18:19], v6 offset:9728
v_mfma_f32_16x16x32_bf16 v[100:103], v[20:23], v[136:139], v[100:103]
s_waitcnt vmcnt(7)
s_barrier
s_add_u32 m0, s56, 0x10000
s_lshl_b32 s66, s42, 12
s_add_u32 s66, s66, 0x40100
buffer_load_dwordx4 v4, s[16:19], s66 offen lds
s_waitcnt lgkmcnt(4)
v_mfma_f32_16x16x32_bf16 v[40:43], v[24:27], v[128:131], v[40:43]
ds_read_b64_tr_b16 v[20:21], v7 offset:8704
ds_read_b128 v[140:143], v11
ds_read_b128 v[144:147], v11 offset:2048
ds_read_b128 v[148:151], v11 offset:1024
s_add_u32 s67, s66, 0x7c00
buffer_load_dwordx4 v4, s[16:19], s67 offen offset:1024 lds
v_mfma_f32_16x16x32_bf16 v[72:75], v[24:27], v[132:135], v[72:75]
ds_read_b64_tr_b16 v[22:23], v7 offset:9728
v_mfma_f32_16x16x32_bf16 v[104:107], v[24:27], v[136:139], v[104:107]
s_add_u32 s64, s43, 0x4800
buffer_load_dwordx4 v[164:167], v200, s[20:23], s64 offen
s_waitcnt lgkmcnt(7)
v_mfma_f32_16x16x32_bf16 v[44:47], v[28:31], v[128:131], v[44:47]
ds_read_b64_tr_b16 v[24:25], v6 offset:8960
v_mfma_f32_16x16x32_bf16 v[76:79], v[28:31], v[132:135], v[76:79]
ds_read_b64_tr_b16 v[26:27], v6 offset:9984
s_add_u32 m0, s56, 0x4000
s_mov_b32 s58, 0xc000
buffer_load_dwordx4 v2, s[8:11], s58 offen nt lds
v_mfma_f32_16x16x32_bf16 v[108:111], v[28:31], v[136:139], v[108:111]
ds_write_b128 v10, v[176:179]
s_waitcnt lgkmcnt(8)
v_mfma_f32_16x16x32_bf16 v[48:51], v[16:19], v[128:131], v[48:51]
ds_read_b64_tr_b16 v[28:29], v7 offset:8960
v_mfma_f32_16x16x32_bf16 v[80:83], v[16:19], v[132:135], v[80:83]
ds_read_b64_tr_b16 v[30:31], v7 offset:9984
s_add_u32 s64, s43, 0x9000
buffer_load_dwordx4 v[168:171], v5, s[20:23], s64 offen
v_mfma_f32_16x16x32_bf16 v[112:115], v[16:19], v[136:139], v[112:115]
buffer_load_dwordx4 v2, s[8:11], s58 offen offset:1024 nt lds
s_waitcnt lgkmcnt(5)
v_mfma_f32_16x16x32_bf16 v[52:55], v[20:23], v[128:131], v[52:55]
ds_read_b64_tr_b16 v[16:17], v6 offset:16384
v_mfma_f32_16x16x32_bf16 v[84:87], v[20:23], v[132:135], v[84:87]
ds_read_b64_tr_b16 v[18:19], v6 offset:17408
ds_write_b128 v10, v[180:183] offset:512
v_mfma_f32_16x16x32_bf16 v[116:119], v[20:23], v[136:139], v[116:119]
s_waitcnt lgkmcnt(6)
v_mfma_f32_16x16x32_bf16 v[56:59], v[24:27], v[128:131], v[56:59]
ds_read_b64_tr_b16 v[20:21], v7 offset:16384
s_add_u32 s64, s43, 0x9000
buffer_load_dwordx4 v[172:175], v200, s[20:23], s64 offen
s_add_u32 m0, s57, 0x8000
s_mov_b32 s59, 0x8000
buffer_load_dwordx4 v3, s[12:15], s59 offen nt lds
v_mfma_f32_16x16x32_bf16 v[88:91], v[24:27], v[132:135], v[88:91]
ds_read_b64_tr_b16 v[22:23], v7 offset:17408
v_mfma_f32_16x16x32_bf16 v[120:123], v[24:27], v[136:139], v[120:123]
s_waitcnt lgkmcnt(5)
v_mfma_f32_16x16x32_bf16 v[60:63], v[28:31], v[128:131], v[60:63]
ds_read_b64_tr_b16 v[24:25], v6 offset:16640
ds_write_b128 v10, v[184:187] offset:2048
v_mfma_f32_16x16x32_bf16 v[92:95], v[28:31], v[132:135], v[92:95]
ds_read_b64_tr_b16 v[26:27], v6 offset:17664
buffer_load_dwordx4 v3, s[12:15], s59 offen offset:2048 nt lds
v_mfma_f32_16x16x32_bf16 v[124:127], v[28:31], v[136:139], v[124:127]
s_waitcnt lgkmcnt(6)
v_mfma_f32_16x16x32_bf16 v[32:35], v[16:19], v[140:143], v[32:35]
ds_read_b64_tr_b16 v[28:29], v7 offset:16640
v_mfma_f32_16x16x32_bf16 v[64:67], v[16:19], v[144:147], v[64:67]
ds_read_b64_tr_b16 v[30:31], v7 offset:17664
ds_write_b128 v10, v[188:191] offset:2560
v_mfma_f32_16x16x32_bf16 v[96:99], v[16:19], v[148:151], v[96:99]
s_waitcnt lgkmcnt(6)
v_mfma_f32_16x16x32_bf16 v[36:39], v[20:23], v[140:143], v[36:39]
ds_read_b64_tr_b16 v[16:17], v6 offset:16896
v_mfma_f32_16x16x32_bf16 v[68:71], v[20:23], v[144:147], v[68:71]
ds_read_b64_tr_b16 v[18:19], v6 offset:17920
v_mfma_f32_16x16x32_bf16 v[100:103], v[20:23], v[148:151], v[100:103]
s_waitcnt lgkmcnt(5)
v_mfma_f32_16x16x32_bf16 v[40:43], v[24:27], v[140:143], v[40:43]
ds_read_b64_tr_b16 v[20:21], v7 offset:16896
v_mfma_f32_16x16x32_bf16 v[72:75], v[24:27], v[144:147], v[72:75]
ds_read_b64_tr_b16 v[22:23], v7 offset:17920
v_mfma_f32_16x16x32_bf16 v[104:107], v[24:27], v[148:151], v[104:107]
s_waitcnt lgkmcnt(5)
v_mfma_f32_16x16x32_bf16 v[44:47], v[28:31], v[140:143], v[44:47]
ds_read_b64_tr_b16 v[24:25], v6 offset:17152
v_mfma_f32_16x16x32_bf16 v[76:79], v[28:31], v[144:147], v[76:79]
ds_read_b64_tr_b16 v[26:27], v6 offset:18176
v_mfma_f32_16x16x32_bf16 v[108:111], v[28:31], v[148:151], v[108:111]
s_waitcnt lgkmcnt(4)
v_mfma_f32_16x16x32_bf16 v[48:51], v[16:19], v[140:143], v[48:51]
ds_read_b64_tr_b16 v[28:29], v7 offset:17152
v_mfma_f32_16x16x32_bf16 v[80:83], v[16:19], v[144:147], v[80:83]
ds_read_b64_tr_b16 v[30:31], v7 offset:18176
v_mfma_f32_16x16x32_bf16 v[112:115], v[16:19], v[148:151], v[112:115]
s_waitcnt vmcnt(10)
s_barrier
s_add_u32 m0, s56, 0x12000
s_lshl_b32 s66, s43, 12
s_add_u32 s66, s66, 0x100
buffer_load_dwordx4 v4, s[16:19], s66 offen lds
s_waitcnt lgkmcnt(4)
v_mfma_f32_16x16x32_bf16 v[52:55], v[20:23], v[140:143], v[52:55]
ds_read_b64_tr_b16 v[16:17], v6 offset:24576
ds_read_b128 v[128:131], v201 offset:1024
ds_read_b128 v[132:135], v201 offset:3072
s_add_u32 s67, s66, 0x7c00
buffer_load_dwordx4 v4, s[16:19], s67 offen offset:1024 lds
v_mfma_f32_16x16x32_bf16 v[84:87], v[20:23], v[144:147], v[84:87]
ds_read_b64_tr_b16 v[18:19], v6 offset:25600
buffer_load_dwordx4 v[176:179], v5, s[20:23], s44 offen
v_mfma_f32_16x16x32_bf16 v[116:119], v[20:23], v[148:151], v[116:119]
ds_write_b128 v202, v[192:195] offset:1024
s_waitcnt lgkmcnt(7)
v_mfma_f32_16x16x32_bf16 v[56:59], v[24:27], v[140:143], v[56:59]
ds_read_b64_tr_b16 v[20:21], v7 offset:24576
buffer_load_dwordx4 v[180:183], v200, s[20:23], s44 offen
s_add_u32 m0, s56, 0x6000
s_mov_b32 s58, 0xe000
buffer_load_dwordx4 v2, s[8:11], s58 offen nt lds
v_mfma_f32_16x16x32_bf16 v[88:91], v[24:27], v[144:147], v[88:91]
ds_read_b64_tr_b16 v[22:23], v7 offset:25600
ds_write_b128 v202, v[196:199] offset:1536
v_mfma_f32_16x16x32_bf16 v[120:123], v[24:27], v[148:151], v[120:123]
ds_read_b128 v[136:139], v201 offset:3072
s_waitcnt lgkmcnt(9)
v_mfma_f32_16x16x32_bf16 v[60:63], v[28:31], v[140:143], v[60:63]
ds_read_b64_tr_b16 v[24:25], v6 offset:24832
s_add_u32 s64, s44, 0x4800
buffer_load_dwordx4 v[184:187], v5, s[20:23], s64 offen
buffer_load_dwordx4 v2, s[8:11], s58 offen offset:1024 nt lds
v_mfma_f32_16x16x32_bf16 v[92:95], v[28:31], v[144:147], v[92:95]
ds_read_b64_tr_b16 v[26:27], v6 offset:25856
v_mfma_f32_16x16x32_bf16 v[124:127], v[28:31], v[148:151], v[124:127]
s_waitcnt lgkmcnt(2)
v_mfma_f32_16x16x32_bf16 v[32:35], v[16:19], v[128:131], v[32:35]
ds_read_b64_tr_b16 v[28:29], v7 offset:24832
v_mfma_f32_16x16x32_bf16 v[64:67], v[16:19], v[132:135], v[64:67]
ds_read_b64_tr_b16 v[30:31], v7 offset:25856
ds_read_b128 v[140:143], v11
ds_read_b128 v[144:147], v11 offset:2048
ds_read_b128 v[148:151], v11 offset:1024
s_add_u32 m0, s57, 0xa000
s_mov_b32 s59, 0xa000
buffer_load_dwordx4 v3, s[12:15], s59 offen nt lds
v_mfma_f32_16x16x32_bf16 v[96:99], v[16:19], v[136:139], v[96:99]
s_add_u32 s64, s44, 0x4800
buffer_load_dwordx4 v[188:191], v200, s[20:23], s64 offen
v_mfma_f32_16x16x32_bf16 v[36:39], v[20:23], v[128:131], v[36:39]
ds_read_b64_tr_b16 v[16:17], v6 offset:25088
v_mfma_f32_16x16x32_bf16 v[68:71], v[20:23], v[132:135], v[68:71]
ds_read_b64_tr_b16 v[18:19], v6 offset:26112
ds_write_b128 v10, v[152:155]
buffer_load_dwordx4 v3, s[12:15], s59 offen offset:2048 nt lds
v_mfma_f32_16x16x32_bf16 v[100:103], v[20:23], v[136:139], v[100:103]
s_add_u32 s64, s44, 0x9000
buffer_load_dwordx4 v[192:195], v5, s[20:23], s64 offen
s_waitcnt lgkmcnt(8)
v_mfma_f32_16x16x32_bf16 v[40:43], v[24:27], v[128:131], v[40:43]
ds_read_b64_tr_b16 v[20:21], v7 offset:25088
v_mfma_f32_16x16x32_bf16 v[72:75], v[24:27], v[132:135], v[72:75]
ds_read_b64_tr_b16 v[22:23], v7 offset:26112
ds_write_b128 v10, v[156:159] offset:512
s_add_u32 s75, s75, 0x480
buffer_load_dword v204, v203, s[28:31], s75 offen
v_mfma_f32_16x16x32_bf16 v[104:107], v[24:27], v[136:139], v[104:107]
s_add_u32 s64, s44, 0x9000
buffer_load_dwordx4 v[196:199], v200, s[20:23], s64 offen
s_waitcnt lgkmcnt(9)
v_mfma_f32_16x16x32_bf16 v[44:47], v[28:31], v[128:131], v[44:47]
ds_read_b64_tr_b16 v[24:25], v6 offset:25344
v_mfma_f32_16x16x32_bf16 v[76:79], v[28:31], v[132:135], v[76:79]
ds_read_b64_tr_b16 v[26:27], v6 offset:26368
s_waitcnt vmcnt(22)
ds_write_b128 v10, v[160:163] offset:2048
v_mfma_f32_16x16x32_bf16 v[108:111], v[28:31], v[136:139], v[108:111]
s_waitcnt lgkmcnt(7)
v_mfma_f32_16x16x32_bf16 v[48:51], v[16:19], v[128:131], v[48:51]
ds_read_b64_tr_b16 v[28:29], v7 offset:25344
v_mfma_f32_16x16x32_bf16 v[80:83], v[16:19], v[132:135], v[80:83]
ds_read_b64_tr_b16 v[30:31], v7 offset:26368
v_mfma_f32_16x16x32_bf16 v[112:115], v[16:19], v[136:139], v[112:115]
s_waitcnt lgkmcnt(6)
v_mfma_f32_16x16x32_bf16 v[52:55], v[20:23], v[128:131], v[52:55]
v_mfma_f32_16x16x32_bf16 v[84:87], v[20:23], v[132:135], v[84:87]
v_mfma_f32_16x16x32_bf16 v[116:119], v[20:23], v[136:139], v[116:119]
s_waitcnt lgkmcnt(3)
v_mfma_f32_16x16x32_bf16 v[56:59], v[24:27], v[128:131], v[56:59]
v_mfma_f32_16x16x32_bf16 v[88:91], v[24:27], v[132:135], v[88:91]
v_mfma_f32_16x16x32_bf16 v[120:123], v[24:27], v[136:139], v[120:123]
s_waitcnt lgkmcnt(0)
v_mfma_f32_16x16x32_bf16 v[60:63], v[28:31], v[128:131], v[60:63]
v_mfma_f32_16x16x32_bf16 v[92:95], v[28:31], v[132:135], v[92:95]
v_mfma_f32_16x16x32_bf16 v[124:127], v[28:31], v[136:139], v[124:127]
s_waitcnt vmcnt(11)
s_barrier
ds_read_b64_tr_b16 v[16:17], v6
ds_read_b64_tr_b16 v[18:19], v6 offset:1024
ds_read_b64_tr_b16 v[20:21], v7
ds_read_b64_tr_b16 v[22:23], v7 offset:1024
ds_read_b64_tr_b16 v[24:25], v6 offset:256
ds_read_b64_tr_b16 v[26:27], v6 offset:1280
s_add_u32 m0, s56, 0x14000
s_lshl_b32 s66, s43, 12
s_add_u32 s66, s66, 0x40100
buffer_load_dwordx4 v4, s[16:19], s66 offen lds
s_waitcnt lgkmcnt(4)
v_mfma_f32_16x16x32_bf16 v[32:35], v[16:19], v[140:143], v[32:35]
ds_read_b64_tr_b16 v[28:29], v7 offset:256
s_add_u32 s67, s66, 0x7c00
buffer_load_dwordx4 v4, s[16:19], s67 offen offset:1024 lds
v_mfma_f32_16x16x32_bf16 v[64:67], v[16:19], v[144:147], v[64:67]
ds_read_b64_tr_b16 v[30:31], v7 offset:1280
ds_write_b128 v10, v[164:167] offset:2560
v_mfma_f32_16x16x32_bf16 v[96:99], v[16:19], v[148:151], v[96:99]
s_add_u32 m0, s56, 0x16000
s_lshl_b32 s66, s44, 12
s_add_u32 s66, s66, 0x100
buffer_load_dwordx4 v4, s[16:19], s66 offen lds
s_waitcnt lgkmcnt(5)
v_mfma_f32_16x16x32_bf16 v[36:39], v[20:23], v[140:143], v[36:39]
ds_read_b64_tr_b16 v[16:17], v6 offset:512
ds_read_b128 v[128:131], v201 offset:1024
ds_read_b128 v[132:135], v201 offset:3072
v_mfma_f32_16x16x32_bf16 v[68:71], v[20:23], v[144:147], v[68:71]
ds_read_b64_tr_b16 v[18:19], v6 offset:1536
v_mfma_f32_16x16x32_bf16 v[100:103], v[20:23], v[148:151], v[100:103]
s_add_u32 s67, s66, 0x7c00
buffer_load_dwordx4 v4, s[16:19], s67 offen offset:1024 lds
s_waitcnt lgkmcnt(7)
v_mfma_f32_16x16x32_bf16 v[40:43], v[24:27], v[140:143], v[40:43]
ds_read_b64_tr_b16 v[20:21], v7 offset:512
buffer_load_dwordx4 v[152:155], v5, s[20:23], s45 offen
v_mfma_f32_16x16x32_bf16 v[72:75], v[24:27], v[144:147], v[72:75]
ds_read_b64_tr_b16 v[22:23], v7 offset:1536
v_mfma_f32_16x16x32_bf16 v[104:107], v[24:27], v[148:151], v[104:107]
ds_write_b128 v202, v[168:171] offset:1024
s_add_u32 m0, s56, 0
s_mov_b32 s58, 0x10000
buffer_load_dwordx4 v2, s[8:11], s58 offen nt lds
s_waitcnt lgkmcnt(8)
v_mfma_f32_16x16x32_bf16 v[44:47], v[28:31], v[140:143], v[44:47]
ds_read_b64_tr_b16 v[24:25], v6 offset:768
v_mfma_f32_16x16x32_bf16 v[76:79], v[28:31], v[144:147], v[76:79]
ds_read_b64_tr_b16 v[26:27], v6 offset:1792
v_mfma_f32_16x16x32_bf16 v[108:111], v[28:31], v[148:151], v[108:111]
buffer_load_dwordx4 v[156:159], v200, s[20:23], s45 offen
buffer_load_dwordx4 v2, s[8:11], s58 offen offset:1024 nt lds
s_waitcnt lgkmcnt(5)
v_mfma_f32_16x16x32_bf16 v[48:51], v[16:19], v[140:143], v[48:51]
ds_read_b64_tr_b16 v[28:29], v7 offset:768
v_mfma_f32_16x16x32_bf16 v[80:83], v[16:19], v[144:147], v[80:83]
ds_read_b64_tr_b16 v[30:31], v7 offset:1792
ds_write_b128 v202, v[172:175] offset:1536
v_mfma_f32_16x16x32_bf16 v[112:115], v[16:19], v[148:151], v[112:115]
s_add_u32 m0, s57, 0xc000
s_mov_b32 s59, 0xc000
buffer_load_dwordx4 v3, s[12:15], s59 offen nt lds
s_waitcnt lgkmcnt(6)
v_mfma_f32_16x16x32_bf16 v[52:55], v[20:23], v[140:143], v[52:55]
ds_read_b64_tr_b16 v[16:17], v6 offset:8192
v_mfma_f32_16x16x32_bf16 v[84:87], v[20:23], v[144:147], v[84:87]
ds_read_b64_tr_b16 v[18:19], v6 offset:9216
ds_read_b128 v[136:139], v201 offset:3072
v_mfma_f32_16x16x32_bf16 v[116:119], v[20:23], v[148:151], v[116:119]
buffer_load_dwordx4 v3, s[12:15], s59 offen offset:2048 nt lds
s_waitcnt lgkmcnt(6)
v_mfma_f32_16x16x32_bf16 v[56:59], v[24:27], v[140:143], v[56:59]
ds_read_b64_tr_b16 v[20:21], v7 offset:8192
v_mfma_f32_16x16x32_bf16 v[88:91], v[24:27], v[144:147], v[88:91]
ds_read_b64_tr_b16 v[22:23], v7 offset:9216
s_add_u32 s64, s45, 0x4800
buffer_load_dwordx4 v[160:163], v5, s[20:23], s64 offen
v_mfma_f32_16x16x32_bf16 v[120:123], v[24:27], v[148:151], v[120:123]
s_waitcnt lgkmcnt(6)
v_mfma_f32_16x16x32_bf16 v[60:63], v[28:31], v[140:143], v[60:63]
ds_read_b64_tr_b16 v[24:25], v6 offset:8448
v_mfma_f32_16x16x32_bf16 v[92:95], v[28:31], v[144:147], v[92:95]
ds_read_b64_tr_b16 v[26:27], v6 offset:9472
v_mfma_f32_16x16x32_bf16 v[124:127], v[28:31], v[148:151], v[124:127]
s_waitcnt lgkmcnt(4)
v_mfma_f32_16x16x32_bf16 v[32:35], v[16:19], v[128:131], v[32:35]
ds_read_b64_tr_b16 v[28:29], v7 offset:8448
v_mfma_f32_16x16x32_bf16 v[64:67], v[16:19], v[132:135], v[64:67]
ds_read_b64_tr_b16 v[30:31], v7 offset:9472
v_mfma_f32_16x16x32_bf16 v[96:99], v[16:19], v[136:139], v[96:99]
s_waitcnt lgkmcnt(4)
v_mfma_f32_16x16x32_bf16 v[36:39], v[20:23], v[128:131], v[36:39]
ds_read_b64_tr_b16 v[16:17], v6 offset:8704
v_mfma_f32_16x16x32_bf16 v[68:71], v[20:23], v[132:135], v[68:71]
ds_read_b64_tr_b16 v[18:19], v6 offset:9728
v_mfma_f32_16x16x32_bf16 v[100:103], v[20:23], v[136:139], v[100:103]
s_waitcnt lgkmcnt(4)
v_mfma_f32_16x16x32_bf16 v[40:43], v[24:27], v[128:131], v[40:43]
ds_read_b64_tr_b16 v[20:21], v7 offset:8704
v_mfma_f32_16x16x32_bf16 v[72:75], v[24:27], v[132:135], v[72:75]
ds_read_b64_tr_b16 v[22:23], v7 offset:9728
v_mfma_f32_16x16x32_bf16 v[104:107], v[24:27], v[136:139], v[104:107]
s_waitcnt vmcnt(9)
s_barrier
s_add_u32 m0, s56, 0x10000
s_lshl_b32 s66, s44, 12
s_add_u32 s66, s66, 0x40100
buffer_load_dwordx4 v4, s[16:19], s66 offen lds
s_waitcnt lgkmcnt(4)
v_mfma_f32_16x16x32_bf16 v[44:47], v[28:31], v[128:131], v[44:47]
ds_read_b64_tr_b16 v[24:25], v6 offset:8960
ds_read_b128 v[140:143], v11
ds_read_b128 v[144:147], v11 offset:2048
ds_read_b128 v[148:151], v11 offset:1024
s_add_u32 s67, s66, 0x7c00
buffer_load_dwordx4 v4, s[16:19], s67 offen offset:1024 lds
v_mfma_f32_16x16x32_bf16 v[76:79], v[28:31], v[132:135], v[76:79]
ds_read_b64_tr_b16 v[26:27], v6 offset:9984
v_mfma_f32_16x16x32_bf16 v[108:111], v[28:31], v[136:139], v[108:111]
s_add_u32 s64, s45, 0x4800
buffer_load_dwordx4 v[164:167], v200, s[20:23], s64 offen
s_waitcnt lgkmcnt(7)
v_mfma_f32_16x16x32_bf16 v[48:51], v[16:19], v[128:131], v[48:51]
ds_read_b64_tr_b16 v[28:29], v7 offset:8960
v_mfma_f32_16x16x32_bf16 v[80:83], v[16:19], v[132:135], v[80:83]
ds_read_b64_tr_b16 v[30:31], v7 offset:9984
ds_write_b128 v10, v[176:179]
s_add_u32 m0, s56, 0x2000
s_mov_b32 s58, 0x12000
buffer_load_dwordx4 v2, s[8:11], s58 offen nt lds
v_mfma_f32_16x16x32_bf16 v[112:115], v[16:19], v[136:139], v[112:115]
s_waitcnt lgkmcnt(8)
v_mfma_f32_16x16x32_bf16 v[52:55], v[20:23], v[128:131], v[52:55]
ds_read_b64_tr_b16 v[16:17], v6 offset:16384
s_add_u32 s64, s45, 0x9000
buffer_load_dwordx4 v[168:171], v5, s[20:23], s64 offen
v_mfma_f32_16x16x32_bf16 v[84:87], v[20:23], v[132:135], v[84:87]
ds_read_b64_tr_b16 v[18:19], v6 offset:17408
v_mfma_f32_16x16x32_bf16 v[116:119], v[20:23], v[136:139], v[116:119]
ds_write_b128 v10, v[180:183] offset:512
buffer_load_dwordx4 v2, s[8:11], s58 offen offset:1024 nt lds
s_waitcnt lgkmcnt(6)
v_mfma_f32_16x16x32_bf16 v[56:59], v[24:27], v[128:131], v[56:59]
ds_read_b64_tr_b16 v[20:21], v7 offset:16384
v_mfma_f32_16x16x32_bf16 v[88:91], v[24:27], v[132:135], v[88:91]
ds_read_b64_tr_b16 v[22:23], v7 offset:17408
s_add_u32 s64, s45, 0x9000
buffer_load_dwordx4 v[172:175], v200, s[20:23], s64 offen
v_mfma_f32_16x16x32_bf16 v[120:123], v[24:27], v[136:139], v[120:123]
s_waitcnt lgkmcnt(6)
v_mfma_f32_16x16x32_bf16 v[60:63], v[28:31], v[128:131], v[60:63]
ds_read_b64_tr_b16 v[24:25], v6 offset:16640
ds_write_b128 v10, v[184:187] offset:2048
s_add_u32 m0, s57, 0xe000
s_mov_b32 s59, 0xe000
buffer_load_dwordx4 v3, s[12:15], s59 offen nt lds
v_mfma_f32_16x16x32_bf16 v[92:95], v[28:31], v[132:135], v[92:95]
ds_read_b64_tr_b16 v[26:27], v6 offset:17664
v_mfma_f32_16x16x32_bf16 v[124:127], v[28:31], v[136:139], v[124:127]
s_waitcnt lgkmcnt(6)
v_mfma_f32_16x16x32_bf16 v[32:35], v[16:19], v[140:143], v[32:35]
ds_read_b64_tr_b16 v[28:29], v7 offset:16640
v_mfma_f32_16x16x32_bf16 v[64:67], v[16:19], v[144:147], v[64:67]
ds_read_b64_tr_b16 v[30:31], v7 offset:17664
ds_write_b128 v10, v[188:191] offset:2560
buffer_load_dwordx4 v3, s[12:15], s59 offen offset:2048 nt lds
v_mfma_f32_16x16x32_bf16 v[96:99], v[16:19], v[148:151], v[96:99]
ds_read_b128 v[128:131], v201 offset:1024
ds_read_b128 v[132:135], v201 offset:3072
s_waitcnt lgkmcnt(8)
v_mfma_f32_16x16x32_bf16 v[36:39], v[20:23], v[140:143], v[36:39]
ds_read_b64_tr_b16 v[16:17], v6 offset:16896
buffer_load_dwordx4 v[176:179], v5, s[20:23], s46 offen
v_mfma_f32_16x16x32_bf16 v[68:71], v[20:23], v[144:147], v[68:71]
ds_read_b64_tr_b16 v[18:19], v6 offset:17920
ds_write_b128 v202, v[192:195] offset:1024
v_mfma_f32_16x16x32_bf16 v[100:103], v[20:23], v[148:151], v[100:103]
s_waitcnt lgkmcnt(8)
v_mfma_f32_16x16x32_bf16 v[40:43], v[24:27], v[140:143], v[40:43]
ds_read_b64_tr_b16 v[20:21], v7 offset:16896
v_mfma_f32_16x16x32_bf16 v[72:75], v[24:27], v[144:147], v[72:75]
ds_read_b64_tr_b16 v[22:23], v7 offset:17920
v_mfma_f32_16x16x32_bf16 v[104:107], v[24:27], v[148:151], v[104:107]
s_waitcnt lgkmcnt(8)
v_mfma_f32_16x16x32_bf16 v[44:47], v[28:31], v[140:143], v[44:47]
ds_read_b64_tr_b16 v[24:25], v6 offset:17152
v_mfma_f32_16x16x32_bf16 v[76:79], v[28:31], v[144:147], v[76:79]
ds_read_b64_tr_b16 v[26:27], v6 offset:18176
v_mfma_f32_16x16x32_bf16 v[108:111], v[28:31], v[148:151], v[108:111]
s_waitcnt lgkmcnt(5)
v_mfma_f32_16x16x32_bf16 v[48:51], v[16:19], v[140:143], v[48:51]
ds_read_b64_tr_b16 v[28:29], v7 offset:17152
v_mfma_f32_16x16x32_bf16 v[80:83], v[16:19], v[144:147], v[80:83]
ds_read_b64_tr_b16 v[30:31], v7 offset:18176
v_mfma_f32_16x16x32_bf16 v[112:115], v[16:19], v[148:151], v[112:115]
s_waitcnt lgkmcnt(4)
v_mfma_f32_16x16x32_bf16 v[52:55], v[20:23], v[140:143], v[52:55]
v_mfma_f32_16x16x32_bf16 v[84:87], v[20:23], v[144:147], v[84:87]
v_mfma_f32_16x16x32_bf16 v[116:119], v[20:23], v[148:151], v[116:119]
s_waitcnt vmcnt(8)
s_barrier
ds_read_b64_tr_b16 v[16:17], v6 offset:24576
ds_read_b64_tr_b16 v[18:19], v6 offset:25600
s_add_u32 m0, s56, 0x12000
s_lshl_b32 s66, s45, 12
s_add_u32 s66, s66, 0x100
buffer_load_dwordx4 v4, s[16:19], s66 offen lds
s_waitcnt lgkmcnt(4)
v_mfma_f32_16x16x32_bf16 v[56:59], v[24:27], v[140:143], v[56:59]
ds_read_b64_tr_b16 v[20:21], v7 offset:24576
buffer_load_dwordx4 v[180:183], v200, s[20:23], s46 offen
s_add_u32 s67, s66, 0x7c00
buffer_load_dwordx4 v4, s[16:19], s67 offen offset:1024 lds
v_mfma_f32_16x16x32_bf16 v[88:91], v[24:27], v[144:147], v[88:91]
ds_read_b64_tr_b16 v[22:23], v7 offset:25600
ds_write_b128 v202, v[196:199] offset:1536
v_mfma_f32_16x16x32_bf16 v[120:123], v[24:27], v[148:151], v[120:123]
ds_read_b128 v[136:139], v201 offset:3072
s_waitcnt lgkmcnt(6)
v_mfma_f32_16x16x32_bf16 v[60:63], v[28:31], v[140:143], v[60:63]
ds_read_b64_tr_b16 v[24:25], v6 offset:24832
s_add_u32 s64, s46, 0x4800
buffer_load_dwordx4 v[184:187], v5, s[20:23], s64 offen
v_mfma_f32_16x16x32_bf16 v[92:95], v[28:31], v[144:147], v[92:95]
ds_read_b64_tr_b16 v[26:27], v6 offset:25856
s_add_u32 m0, s56, 0x4000
s_mov_b32 s58, 0x14000
buffer_load_dwordx4 v2, s[8:11], s58 offen nt lds
v_mfma_f32_16x16x32_bf16 v[124:127], v[28:31], v[148:151], v[124:127]
s_waitcnt lgkmcnt(2)
v_mfma_f32_16x16x32_bf16 v[32:35], v[16:19], v[128:131], v[32:35]
ds_read_b64_tr_b16 v[28:29], v7 offset:24832
v_mfma_f32_16x16x32_bf16 v[64:67], v[16:19], v[132:135], v[64:67]
ds_read_b64_tr_b16 v[30:31], v7 offset:25856
ds_read_b128 v[140:143], v11
ds_read_b128 v[144:147], v11 offset:2048
ds_read_b128 v[148:151], v11 offset:1024
v_mfma_f32_16x16x32_bf16 v[96:99], v[16:19], v[136:139], v[96:99]
buffer_load_dwordx4 v2, s[8:11], s58 offen offset:1024 nt lds
v_mfma_f32_16x16x32_bf16 v[36:39], v[20:23], v[128:131], v[36:39]
ds_read_b64_tr_b16 v[16:17], v6 offset:25088
s_add_u32 s64, s46, 0x4800
buffer_load_dwordx4 v[188:191], v200, s[20:23], s64 offen
v_mfma_f32_16x16x32_bf16 v[68:71], v[20:23], v[132:135], v[68:71]
ds_read_b64_tr_b16 v[18:19], v6 offset:26112
v_mfma_f32_16x16x32_bf16 v[100:103], v[20:23], v[136:139], v[100:103]
ds_write_b128 v10, v[152:155]
s_waitcnt lgkmcnt(8)
v_mfma_f32_16x16x32_bf16 v[40:43], v[24:27], v[128:131], v[40:43]
ds_read_b64_tr_b16 v[20:21], v7 offset:25088
s_add_u32 m0, s57, 0x8000
s_mov_b32 s59, 0x10000
buffer_load_dwordx4 v3, s[12:15], s59 offen nt lds
v_mfma_f32_16x16x32_bf16 v[72:75], v[24:27], v[132:135], v[72:75]
ds_read_b64_tr_b16 v[22:23], v7 offset:26112
s_add_u32 s64, s46, 0x9000
buffer_load_dwordx4 v[192:195], v5, s[20:23], s64 offen
v_mfma_f32_16x16x32_bf16 v[104:107], v[24:27], v[136:139], v[104:107]
s_waitcnt lgkmcnt(8)
v_mfma_f32_16x16x32_bf16 v[44:47], v[28:31], v[128:131], v[44:47]
ds_read_b64_tr_b16 v[24:25], v6 offset:25344
ds_write_b128 v10, v[156:159] offset:512
v_mfma_f32_16x16x32_bf16 v[76:79], v[28:31], v[132:135], v[76:79]
ds_read_b64_tr_b16 v[26:27], v6 offset:26368
buffer_load_dwordx4 v3, s[12:15], s59 offen offset:2048 nt lds
v_mfma_f32_16x16x32_bf16 v[108:111], v[28:31], v[136:139], v[108:111]
s_add_u32 s64, s46, 0x9000
buffer_load_dwordx4 v[196:199], v200, s[20:23], s64 offen
s_waitcnt lgkmcnt(6)
v_mfma_f32_16x16x32_bf16 v[48:51], v[16:19], v[128:131], v[48:51]
ds_read_b64_tr_b16 v[28:29], v7 offset:25344
v_mfma_f32_16x16x32_bf16 v[80:83], v[16:19], v[132:135], v[80:83]
ds_read_b64_tr_b16 v[30:31], v7 offset:26368
ds_write_b128 v10, v[160:163] offset:2048
v_mfma_f32_16x16x32_bf16 v[112:115], v[16:19], v[136:139], v[112:115]
s_waitcnt lgkmcnt(6)
v_mfma_f32_16x16x32_bf16 v[52:55], v[20:23], v[128:131], v[52:55]
ds_read_b64_tr_b16 v[16:17], v6
v_mfma_f32_16x16x32_bf16 v[84:87], v[20:23], v[132:135], v[84:87]
ds_read_b64_tr_b16 v[18:19], v6 offset:1024
v_mfma_f32_16x16x32_bf16 v[116:119], v[20:23], v[136:139], v[116:119]
s_waitcnt lgkmcnt(5)
v_mfma_f32_16x16x32_bf16 v[56:59], v[24:27], v[128:131], v[56:59]
ds_read_b64_tr_b16 v[20:21], v7
v_mfma_f32_16x16x32_bf16 v[88:91], v[24:27], v[132:135], v[88:91]
ds_read_b64_tr_b16 v[22:23], v7 offset:1024
v_mfma_f32_16x16x32_bf16 v[120:123], v[24:27], v[136:139], v[120:123]
s_waitcnt lgkmcnt(5)
v_mfma_f32_16x16x32_bf16 v[60:63], v[28:31], v[128:131], v[60:63]
ds_read_b64_tr_b16 v[24:25], v6 offset:256
v_mfma_f32_16x16x32_bf16 v[92:95], v[28:31], v[132:135], v[92:95]
ds_read_b64_tr_b16 v[26:27], v6 offset:1280
v_mfma_f32_16x16x32_bf16 v[124:127], v[28:31], v[136:139], v[124:127]
s_waitcnt lgkmcnt(4)
v_mfma_f32_16x16x32_bf16 v[32:35], v[16:19], v[140:143], v[32:35]
ds_read_b64_tr_b16 v[28:29], v7 offset:256
v_mfma_f32_16x16x32_bf16 v[64:67], v[16:19], v[144:147], v[64:67]
ds_read_b64_tr_b16 v[30:31], v7 offset:1280
v_mfma_f32_16x16x32_bf16 v[96:99], v[16:19], v[148:151], v[96:99]
s_waitcnt vmcnt(8)
s_barrier
s_add_u32 m0, s56, 0x14000
s_lshl_b32 s66, s45, 12
s_add_u32 s66, s66, 0x40100
buffer_load_dwordx4 v4, s[16:19], s66 offen lds
s_waitcnt lgkmcnt(4)
v_mfma_f32_16x16x32_bf16 v[36:39], v[20:23], v[140:143], v[36:39]
ds_read_b64_tr_b16 v[16:17], v6 offset:512
ds_write_b128 v10, v[164:167] offset:2560
s_add_u32 s67, s66, 0x7c00
buffer_load_dwordx4 v4, s[16:19], s67 offen offset:1024 lds
v_mfma_f32_16x16x32_bf16 v[68:71], v[20:23], v[144:147], v[68:71]
ds_read_b64_tr_b16 v[18:19], v6 offset:1536
v_mfma_f32_16x16x32_bf16 v[100:103], v[20:23], v[148:151], v[100:103]
ds_read_b128 v[128:131], v201 offset:1024
ds_read_b128 v[132:135], v201 offset:3072
s_add_u32 m0, s56, 0x16000
s_lshl_b32 s66, s46, 12
s_add_u32 s66, s66, 0x100
buffer_load_dwordx4 v4, s[16:19], s66 offen lds
s_waitcnt lgkmcnt(7)
v_mfma_f32_16x16x32_bf16 v[40:43], v[24:27], v[140:143], v[40:43]
ds_read_b64_tr_b16 v[20:21], v7 offset:512
v_mfma_f32_16x16x32_bf16 v[72:75], v[24:27], v[144:147], v[72:75]
ds_read_b64_tr_b16 v[22:23], v7 offset:1536
v_mfma_f32_16x16x32_bf16 v[104:107], v[24:27], v[148:151], v[104:107]
buffer_load_dwordx4 v[152:155], v5, s[20:23], s47 offen
s_add_u32 s67, s66, 0x7c00
buffer_load_dwordx4 v4, s[16:19], s67 offen offset:1024 lds
s_waitcnt lgkmcnt(7)
v_mfma_f32_16x16x32_bf16 v[44:47], v[28:31], v[140:143], v[44:47]
ds_read_b64_tr_b16 v[24:25], v6 offset:768
v_mfma_f32_16x16x32_bf16 v[76:79], v[28:31], v[144:147], v[76:79]
ds_read_b64_tr_b16 v[26:27], v6 offset:1792
ds_write_b128 v202, v[168:171] offset:1024
s_add_u32 m0, s56, 0x6000
s_mov_b32 s58, 0x16000
buffer_load_dwordx4 v2, s[8:11], s58 offen nt lds
v_mfma_f32_16x16x32_bf16 v[108:111], v[28:31], v[148:151], v[108:111]
s_waitcnt lgkmcnt(7)
v_mfma_f32_16x16x32_bf16 v[48:51], v[16:19], v[140:143], v[48:51]
ds_read_b64_tr_b16 v[28:29], v7 offset:768
v_mfma_f32_16x16x32_bf16 v[80:83], v[16:19], v[144:147], v[80:83]
ds_read_b64_tr_b16 v[30:31], v7 offset:1792
buffer_load_dwordx4 v[156:159], v200, s[20:23], s47 offen
buffer_load_dwordx4 v2, s[8:11], s58 offen offset:1024 nt lds
v_mfma_f32_16x16x32_bf16 v[112:115], v[16:19], v[148:151], v[112:115]
s_waitcnt lgkmcnt(5)
v_mfma_f32_16x16x32_bf16 v[52:55], v[20:23], v[140:143], v[52:55]
ds_read_b64_tr_b16 v[16:17], v6 offset:8192
ds_write_b128 v202, v[172:175] offset:1536
s_add_u32 m0, s57, 0xa000
s_mov_b32 s59, 0x12000
buffer_load_dwordx4 v3, s[12:15], s59 offen nt lds
v_mfma_f32_16x16x32_bf16 v[84:87], v[20:23], v[144:147], v[84:87]
ds_read_b64_tr_b16 v[18:19], v6 offset:9216
v_mfma_f32_16x16x32_bf16 v[116:119], v[20:23], v[148:151], v[116:119]
s_waitcnt lgkmcnt(6)
v_mfma_f32_16x16x32_bf16 v[56:59], v[24:27], v[140:143], v[56:59]
ds_read_b64_tr_b16 v[20:21], v7 offset:8192
ds_read_b128 v[136:139], v201 offset:3072
buffer_load_dwordx4 v3, s[12:15], s59 offen offset:2048 nt lds
v_mfma_f32_16x16x32_bf16 v[88:91], v[24:27], v[144:147], v[88:91]
ds_read_b64_tr_b16 v[22:23], v7 offset:9216
v_mfma_f32_16x16x32_bf16 v[120:123], v[24:27], v[148:151], v[120:123]
s_add_u32 s75, s75, 0x480
buffer_load_dword v204, v203, s[28:31], s75 offen
s_waitcnt lgkmcnt(6)
v_mfma_f32_16x16x32_bf16 v[60:63], v[28:31], v[140:143], v[60:63]
ds_read_b64_tr_b16 v[24:25], v6 offset:8448
s_add_u32 s64, s47, 0x4800
buffer_load_dwordx4 v[160:163], v5, s[20:23], s64 offen
v_mfma_f32_16x16x32_bf16 v[92:95], v[28:31], v[144:147], v[92:95]
ds_read_b64_tr_b16 v[26:27], v6 offset:9472
v_mfma_f32_16x16x32_bf16 v[124:127], v[28:31], v[148:151], v[124:127]
s_waitcnt lgkmcnt(3)
v_mfma_f32_16x16x32_bf16 v[32:35], v[16:19], v[128:131], v[32:35]
ds_read_b64_tr_b16 v[28:29], v7 offset:8448
v_mfma_f32_16x16x32_bf16 v[64:67], v[16:19], v[132:135], v[64:67]
ds_read_b64_tr_b16 v[30:31], v7 offset:9472
v_mfma_f32_16x16x32_bf16 v[96:99], v[16:19], v[136:139], v[96:99]
s_waitcnt lgkmcnt(4)
v_mfma_f32_16x16x32_bf16 v[36:39], v[20:23], v[128:131], v[36:39]
ds_read_b64_tr_b16 v[16:17], v6 offset:8704
v_mfma_f32_16x16x32_bf16 v[68:71], v[20:23], v[132:135], v[68:71]
ds_read_b64_tr_b16 v[18:19], v6 offset:9728
v_mfma_f32_16x16x32_bf16 v[100:103], v[20:23], v[136:139], v[100:103]
s_waitcnt lgkmcnt(4)
v_mfma_f32_16x16x32_bf16 v[40:43], v[24:27], v[128:131], v[40:43]
ds_read_b64_tr_b16 v[20:21], v7 offset:8704
v_mfma_f32_16x16x32_bf16 v[72:75], v[24:27], v[132:135], v[72:75]
ds_read_b64_tr_b16 v[22:23], v7 offset:9728
v_mfma_f32_16x16x32_bf16 v[104:107], v[24:27], v[136:139], v[104:107]
s_waitcnt lgkmcnt(4)
v_mfma_f32_16x16x32_bf16 v[44:47], v[28:31], v[128:131], v[44:47]
ds_read_b64_tr_b16 v[24:25], v6 offset:8960
v_mfma_f32_16x16x32_bf16 v[76:79], v[28:31], v[132:135], v[76:79]
ds_read_b64_tr_b16 v[26:27], v6 offset:9984
v_mfma_f32_16x16x32_bf16 v[108:111], v[28:31], v[136:139], v[108:111]
s_waitcnt vmcnt(10)
s_barrier
s_add_u32 m0, s56, 0x10000
s_lshl_b32 s66, s46, 12
s_add_u32 s66, s66, 0x40100
buffer_load_dwordx4 v4, s[16:19], s66 offen lds
s_waitcnt lgkmcnt(4)
v_mfma_f32_16x16x32_bf16 v[48:51], v[16:19], v[128:131], v[48:51]
ds_read_b64_tr_b16 v[28:29], v7 offset:8960
ds_read_b128 v[140:143], v11
ds_read_b128 v[144:147], v11 offset:2048
ds_read_b128 v[148:151], v11 offset:1024
s_add_u32 s67, s66, 0x7c00
buffer_load_dwordx4 v4, s[16:19], s67 offen offset:1024 lds
v_mfma_f32_16x16x32_bf16 v[80:83], v[16:19], v[132:135], v[80:83]
ds_read_b64_tr_b16 v[30:31], v7 offset:9984
s_add_u32 s64, s47, 0x4800
buffer_load_dwordx4 v[164:167], v200, s[20:23], s64 offen
v_mfma_f32_16x16x32_bf16 v[112:115], v[16:19], v[136:139], v[112:115]
s_waitcnt lgkmcnt(7)
v_mfma_f32_16x16x32_bf16 v[52:55], v[20:23], v[128:131], v[52:55]
ds_read_b64_tr_b16 v[16:17], v6 offset:16384
ds_write_b128 v10, v[176:179]
v_mfma_f32_16x16x32_bf16 v[84:87], v[20:23], v[132:135], v[84:87]
ds_read_b64_tr_b16 v[18:19], v6 offset:17408
s_add_u32 s64, s47, 0x9000
buffer_load_dwordx4 v[168:171], v5, s[20:23], s64 offen
s_add_u32 m0, s56, 0
s_mov_b32 s58, 0x18000
buffer_load_dwordx4 v2, s[8:11], s58 offen nt lds
v_mfma_f32_16x16x32_bf16 v[116:119], v[20:23], v[136:139], v[116:119]
s_waitcnt lgkmcnt(8)
v_mfma_f32_16x16x32_bf16 v[56:59], v[24:27], v[128:131], v[56:59]
ds_read_b64_tr_b16 v[20:21], v7 offset:16384
ds_write_b128 v10, v[180:183] offset:512
v_mfma_f32_16x16x32_bf16 v[88:91], v[24:27], v[132:135], v[88:91]
ds_read_b64_tr_b16 v[22:23], v7 offset:17408
s_add_u32 s64, s47, 0x9000
buffer_load_dwordx4 v[172:175], v200, s[20:23], s64 offen
v_mfma_f32_16x16x32_bf16 v[120:123], v[24:27], v[136:139], v[120:123]
buffer_load_dwordx4 v2, s[8:11], s58 offen offset:1024 nt lds
s_waitcnt lgkmcnt(6)
v_mfma_f32_16x16x32_bf16 v[60:63], v[28:31], v[128:131], v[60:63]
ds_read_b64_tr_b16 v[24:25], v6 offset:16640
ds_write_b128 v10, v[184:187] offset:2048
v_mfma_f32_16x16x32_bf16 v[92:95], v[28:31], v[132:135], v[92:95]
ds_read_b64_tr_b16 v[26:27], v6 offset:17664
v_mfma_f32_16x16x32_bf16 v[124:127], v[28:31], v[136:139], v[124:127]
s_waitcnt lgkmcnt(6)
v_mfma_f32_16x16x32_bf16 v[32:35], v[16:19], v[140:143], v[32:35]
ds_read_b64_tr_b16 v[28:29], v7 offset:16640
s_add_u32 m0, s57, 0xc000
s_mov_b32 s59, 0x14000
buffer_load_dwordx4 v3, s[12:15], s59 offen nt lds
v_mfma_f32_16x16x32_bf16 v[64:67], v[16:19], v[144:147], v[64:67]
ds_read_b64_tr_b16 v[30:31], v7 offset:17664
ds_write_b128 v10, v[188:191] offset:2560
v_mfma_f32_16x16x32_bf16 v[96:99], v[16:19], v[148:151], v[96:99]
ds_read_b128 v[128:131], v201 offset:1024
ds_read_b128 v[132:135], v201 offset:3072
s_waitcnt lgkmcnt(8)
v_mfma_f32_16x16x32_bf16 v[36:39], v[20:23], v[140:143], v[36:39]
ds_read_b64_tr_b16 v[16:17], v6 offset:16896
buffer_load_dwordx4 v[176:179], v5, s[20:23], s48 offen
v_mfma_f32_16x16x32_bf16 v[68:71], v[20:23], v[144:147], v[68:71]
ds_read_b64_tr_b16 v[18:19], v6 offset:17920
ds_write_b128 v202, v[192:195] offset:1024
buffer_load_dwordx4 v3, s[12:15], s59 offen offset:2048 nt lds
v_mfma_f32_16x16x32_bf16 v[100:103], v[20:23], v[148:151], v[100:103]
buffer_load_dwordx4 v[180:183], v200, s[20:23], s48 offen
s_waitcnt lgkmcnt(8)
v_mfma_f32_16x16x32_bf16 v[40:43], v[24:27], v[140:143], v[40:43]
ds_read_b64_tr_b16 v[20:21], v7 offset:16896
ds_write_b128 v202, v[196:199] offset:1536
v_mfma_f32_16x16x32_bf16 v[72:75], v[24:27], v[144:147], v[72:75]
ds_read_b64_tr_b16 v[22:23], v7 offset:17920
ds_read_b128 v[136:139], v201 offset:3072
v_mfma_f32_16x16x32_bf16 v[104:107], v[24:27], v[148:151], v[104:107]
s_waitcnt lgkmcnt(10)
v_mfma_f32_16x16x32_bf16 v[44:47], v[28:31], v[140:143], v[44:47]
ds_read_b64_tr_b16 v[24:25], v6 offset:17152
v_mfma_f32_16x16x32_bf16 v[76:79], v[28:31], v[144:147], v[76:79]
ds_read_b64_tr_b16 v[26:27], v6 offset:18176
v_mfma_f32_16x16x32_bf16 v[108:111], v[28:31], v[148:151], v[108:111]
s_waitcnt lgkmcnt(7)
v_mfma_f32_16x16x32_bf16 v[48:51], v[16:19], v[140:143], v[48:51]
ds_read_b64_tr_b16 v[28:29], v7 offset:17152
v_mfma_f32_16x16x32_bf16 v[80:83], v[16:19], v[144:147], v[80:83]
ds_read_b64_tr_b16 v[30:31], v7 offset:18176
v_mfma_f32_16x16x32_bf16 v[112:115], v[16:19], v[148:151], v[112:115]
s_waitcnt lgkmcnt(5)
v_mfma_f32_16x16x32_bf16 v[52:55], v[20:23], v[140:143], v[52:55]
v_mfma_f32_16x16x32_bf16 v[84:87], v[20:23], v[144:147], v[84:87]
v_mfma_f32_16x16x32_bf16 v[116:119], v[20:23], v[148:151], v[116:119]
s_waitcnt lgkmcnt(2)
v_mfma_f32_16x16x32_bf16 v[56:59], v[24:27], v[140:143], v[56:59]
v_mfma_f32_16x16x32_bf16 v[88:91], v[24:27], v[144:147], v[88:91]
v_mfma_f32_16x16x32_bf16 v[120:123], v[24:27], v[148:151], v[120:123]
s_waitcnt vmcnt(9)
s_barrier
ds_read_b64_tr_b16 v[16:17], v6 offset:24576
ds_read_b64_tr_b16 v[18:19], v6 offset:25600
ds_read_b64_tr_b16 v[20:21], v7 offset:24576
ds_read_b64_tr_b16 v[22:23], v7 offset:25600
s_add_u32 m0, s56, 0x12000
s_lshl_b32 s66, s47, 12
s_add_u32 s66, s66, 0x100
buffer_load_dwordx4 v4, s[16:19], s66 offen lds
s_waitcnt lgkmcnt(4)
v_mfma_f32_16x16x32_bf16 v[60:63], v[28:31], v[140:143], v[60:63]
ds_read_b64_tr_b16 v[24:25], v6 offset:24832
s_add_u32 s64, s48, 0x4800
buffer_load_dwordx4 v[184:187], v5, s[20:23], s64 offen
s_add_u32 s67, s66, 0x7c00
buffer_load_dwordx4 v4, s[16:19], s67 offen offset:1024 lds
v_mfma_f32_16x16x32_bf16 v[92:95], v[28:31], v[144:147], v[92:95]
ds_read_b64_tr_b16 v[26:27], v6 offset:25856
v_mfma_f32_16x16x32_bf16 v[124:127], v[28:31], v[148:151], v[124:127]
s_waitcnt lgkmcnt(4)
v_mfma_f32_16x16x32_bf16 v[32:35], v[16:19], v[128:131], v[32:35]
ds_read_b64_tr_b16 v[28:29], v7 offset:24832
v_mfma_f32_16x16x32_bf16 v[64:67], v[16:19], v[132:135], v[64:67]
ds_read_b64_tr_b16 v[30:31], v7 offset:25856
ds_read_b128 v[140:143], v11
ds_read_b128 v[144:147], v11 offset:2048
ds_read_b128 v[148:151], v11 offset:1024
s_add_u32 m0, s56, 0x2000
s_mov_b32 s58, 0x1a000
buffer_load_dwordx4 v2, s[8:11], s58 offen nt lds
v_mfma_f32_16x16x32_bf16 v[96:99], v[16:19], v[136:139], v[96:99]
s_waitcnt lgkmcnt(7)
v_mfma_f32_16x16x32_bf16 v[36:39], v[20:23], v[128:131], v[36:39]
ds_read_b64_tr_b16 v[16:17], v6 offset:25088
s_add_u32 s64, s48, 0x4800
buffer_load_dwordx4 v[188:191], v200, s[20:23], s64 offen
v_mfma_f32_16x16x32_bf16 v[68:71], v[20:23], v[132:135], v[68:71]
ds_read_b64_tr_b16 v[18:19], v6 offset:26112
v_mfma_f32_16x16x32_bf16 v[100:103], v[20:23], v[136:139], v[100:103]
buffer_load_dwordx4 v2, s[8:11], s58 offen offset:1024 nt lds
s_waitcnt lgkmcnt(7)
v_mfma_f32_16x16x32_bf16 v[40:43], v[24:27], v[128:131], v[40:43]
ds_read_b64_tr_b16 v[20:21], v7 offset:25088
ds_write_b128 v10, v[152:155]
v_mfma_f32_16x16x32_bf16 v[72:75], v[24:27], v[132:135], v[72:75]
ds_read_b64_tr_b16 v[22:23], v7 offset:26112
v_mfma_f32_16x16x32_bf16 v[104:107], v[24:27], v[136:139], v[104:107]
s_add_u32 s64, s48, 0x9000
buffer_load_dwordx4 v[192:195], v5, s[20:23], s64 offen
s_waitcnt lgkmcnt(8)
v_mfma_f32_16x16x32_bf16 v[44:47], v[28:31], v[128:131], v[44:47]
ds_read_b64_tr_b16 v[24:25], v6 offset:25344
s_add_u32 m0, s57, 0xe000
s_mov_b32 s59, 0x16000
buffer_load_dwordx4 v3, s[12:15], s59 offen nt lds
v_mfma_f32_16x16x32_bf16 v[76:79], v[28:31], v[132:135], v[76:79]
ds_read_b64_tr_b16 v[26:27], v6 offset:26368
v_mfma_f32_16x16x32_bf16 v[108:111], v[28:31], v[136:139], v[108:111]
ds_write_b128 v10, v[156:159] offset:512
s_waitcnt lgkmcnt(6)
v_mfma_f32_16x16x32_bf16 v[48:51], v[16:19], v[128:131], v[48:51]
ds_read_b64_tr_b16 v[28:29], v7 offset:25344
v_mfma_f32_16x16x32_bf16 v[80:83], v[16:19], v[132:135], v[80:83]
ds_read_b64_tr_b16 v[30:31], v7 offset:26368
s_add_u32 s64, s48, 0x9000
buffer_load_dwordx4 v[196:199], v200, s[20:23], s64 offen
buffer_load_dwordx4 v3, s[12:15], s59 offen offset:2048 nt lds
v_mfma_f32_16x16x32_bf16 v[112:115], v[16:19], v[136:139], v[112:115]
s_waitcnt lgkmcnt(5)
v_mfma_f32_16x16x32_bf16 v[52:55], v[20:23], v[128:131], v[52:55]
ds_read_b64_tr_b16 v[16:17], v6
v_mfma_f32_16x16x32_bf16 v[84:87], v[20:23], v[132:135], v[84:87]
ds_read_b64_tr_b16 v[18:19], v6 offset:1024
ds_write_b128 v10, v[160:163] offset:2048
v_mfma_f32_16x16x32_bf16 v[116:119], v[20:23], v[136:139], v[116:119]
s_waitcnt lgkmcnt(6)
v_mfma_f32_16x16x32_bf16 v[56:59], v[24:27], v[128:131], v[56:59]
ds_read_b64_tr_b16 v[20:21], v7
v_mfma_f32_16x16x32_bf16 v[88:91], v[24:27], v[132:135], v[88:91]
ds_read_b64_tr_b16 v[22:23], v7 offset:1024
v_mfma_f32_16x16x32_bf16 v[120:123], v[24:27], v[136:139], v[120:123]
s_waitcnt lgkmcnt(5)
v_mfma_f32_16x16x32_bf16 v[60:63], v[28:31], v[128:131], v[60:63]
ds_read_b64_tr_b16 v[24:25], v6 offset:256
v_mfma_f32_16x16x32_bf16 v[92:95], v[28:31], v[132:135], v[92:95]
ds_read_b64_tr_b16 v[26:27], v6 offset:1280
v_mfma_f32_16x16x32_bf16 v[124:127], v[28:31], v[136:139], v[124:127]
s_waitcnt lgkmcnt(5)
v_mfma_f32_16x16x32_bf16 v[32:35], v[16:19], v[140:143], v[32:35]
ds_read_b64_tr_b16 v[28:29], v7 offset:256
v_mfma_f32_16x16x32_bf16 v[64:67], v[16:19], v[144:147], v[64:67]
ds_read_b64_tr_b16 v[30:31], v7 offset:1280
v_mfma_f32_16x16x32_bf16 v[96:99], v[16:19], v[148:151], v[96:99]
s_waitcnt lgkmcnt(4)
v_mfma_f32_16x16x32_bf16 v[36:39], v[20:23], v[140:143], v[36:39]
ds_read_b64_tr_b16 v[16:17], v6 offset:512
v_mfma_f32_16x16x32_bf16 v[68:71], v[20:23], v[144:147], v[68:71]
ds_read_b64_tr_b16 v[18:19], v6 offset:1536
v_mfma_f32_16x16x32_bf16 v[100:103], v[20:23], v[148:151], v[100:103]
s_waitcnt vmcnt(7)
s_barrier
s_add_u32 m0, s56, 0x14000
s_lshl_b32 s66, s47, 12
s_add_u32 s66, s66, 0x40100
buffer_load_dwordx4 v4, s[16:19], s66 offen lds
s_waitcnt lgkmcnt(4)
v_mfma_f32_16x16x32_bf16 v[40:43], v[24:27], v[140:143], v[40:43]
ds_read_b64_tr_b16 v[20:21], v7 offset:512
ds_write_b128 v10, v[164:167] offset:2560
s_add_u32 s67, s66, 0x7c00
buffer_load_dwordx4 v4, s[16:19], s67 offen offset:1024 lds
v_mfma_f32_16x16x32_bf16 v[72:75], v[24:27], v[144:147], v[72:75]
ds_read_b64_tr_b16 v[22:23], v7 offset:1536
v_mfma_f32_16x16x32_bf16 v[104:107], v[24:27], v[148:151], v[104:107]
ds_read_b128 v[128:131], v201 offset:1024
ds_read_b128 v[132:135], v201 offset:3072
s_add_u32 m0, s56, 0x16000
s_lshl_b32 s66, s48, 12
s_add_u32 s66, s66, 0x100
buffer_load_dwordx4 v4, s[16:19], s66 offen lds
s_waitcnt lgkmcnt(7)
v_mfma_f32_16x16x32_bf16 v[44:47], v[28:31], v[140:143], v[44:47]
ds_read_b64_tr_b16 v[24:25], v6 offset:768
v_mfma_f32_16x16x32_bf16 v[76:79], v[28:31], v[144:147], v[76:79]
ds_read_b64_tr_b16 v[26:27], v6 offset:1792
buffer_load_dwordx4 v[152:155], v5, s[20:23], s40 offen
v_mfma_f32_16x16x32_bf16 v[108:111], v[28:31], v[148:151], v[108:111]
s_add_u32 s67, s66, 0x7c00
buffer_load_dwordx4 v4, s[16:19], s67 offen offset:1024 lds
s_waitcnt lgkmcnt(7)
v_mfma_f32_16x16x32_bf16 v[48:51], v[16:19], v[140:143], v[48:51]
ds_read_b64_tr_b16 v[28:29], v7 offset:768
ds_write_b128 v202, v[168:171] offset:1024
v_mfma_f32_16x16x32_bf16 v[80:83], v[16:19], v[144:147], v[80:83]
ds_read_b64_tr_b16 v[30:31], v7 offset:1792
v_mfma_f32_16x16x32_bf16 v[112:115], v[16:19], v[148:151], v[112:115]
buffer_load_dwordx4 v[156:159], v200, s[20:23], s40 offen
s_add_u32 m0, s56, 0x4000
s_mov_b32 s58, 0x1c000
buffer_load_dwordx4 v2, s[8:11], s58 offen nt lds
s_waitcnt lgkmcnt(7)
v_mfma_f32_16x16x32_bf16 v[52:55], v[20:23], v[140:143], v[52:55]
ds_read_b64_tr_b16 v[16:17], v6 offset:8192
v_mfma_f32_16x16x32_bf16 v[84:87], v[20:23], v[144:147], v[84:87]
ds_read_b64_tr_b16 v[18:19], v6 offset:9216
ds_write_b128 v202, v[172:175] offset:1536
v_mfma_f32_16x16x32_bf16 v[116:119], v[20:23], v[148:151], v[116:119]
buffer_load_dwordx4 v2, s[8:11], s58 offen offset:1024 nt lds
s_waitcnt lgkmcnt(6)
v_mfma_f32_16x16x32_bf16 v[56:59], v[24:27], v[140:143], v[56:59]
ds_read_b64_tr_b16 v[20:21], v7 offset:8192
ds_read_b128 v[136:139], v201 offset:3072
v_mfma_f32_16x16x32_bf16 v[88:91], v[24:27], v[144:147], v[88:91]
ds_read_b64_tr_b16 v[22:23], v7 offset:9216
v_mfma_f32_16x16x32_bf16 v[120:123], v[24:27], v[148:151], v[120:123]
s_add_u32 m0, s57, 0x8000
s_mov_b32 s59, 0x18000
buffer_load_dwordx4 v3, s[12:15], s59 offen nt lds
s_waitcnt lgkmcnt(6)
v_mfma_f32_16x16x32_bf16 v[60:63], v[28:31], v[140:143], v[60:63]
ds_read_b64_tr_b16 v[24:25], v6 offset:8448
s_add_u32 s64, s40, 0x4800
buffer_load_dwordx4 v[160:163], v5, s[20:23], s64 offen
v_mfma_f32_16x16x32_bf16 v[92:95], v[28:31], v[144:147], v[92:95]
ds_read_b64_tr_b16 v[26:27], v6 offset:9472
v_mfma_f32_16x16x32_bf16 v[124:127], v[28:31], v[148:151], v[124:127]
buffer_load_dwordx4 v3, s[12:15], s59 offen offset:2048 nt lds
s_waitcnt lgkmcnt(3)
v_mfma_f32_16x16x32_bf16 v[32:35], v[16:19], v[128:131], v[32:35]
ds_read_b64_tr_b16 v[28:29], v7 offset:8448
v_mfma_f32_16x16x32_bf16 v[64:67], v[16:19], v[132:135], v[64:67]
ds_read_b64_tr_b16 v[30:31], v7 offset:9472
ds_read_b128 v[140:143], v11
ds_read_b128 v[144:147], v11 offset:2048
ds_read_b128 v[148:151], v11 offset:1024
v_mfma_f32_16x16x32_bf16 v[96:99], v[16:19], v[136:139], v[96:99]
s_waitcnt lgkmcnt(7)
v_mfma_f32_16x16x32_bf16 v[36:39], v[20:23], v[128:131], v[36:39]
ds_read_b64_tr_b16 v[16:17], v6 offset:8704
v_mfma_f32_16x16x32_bf16 v[68:71], v[20:23], v[132:135], v[68:71]
ds_read_b64_tr_b16 v[18:19], v6 offset:9728
v_mfma_f32_16x16x32_bf16 v[100:103], v[20:23], v[136:139], v[100:103]
s_waitcnt lgkmcnt(7)
v_mfma_f32_16x16x32_bf16 v[40:43], v[24:27], v[128:131], v[40:43]
ds_read_b64_tr_b16 v[20:21], v7 offset:8704
v_mfma_f32_16x16x32_bf16 v[72:75], v[24:27], v[132:135], v[72:75]
ds_read_b64_tr_b16 v[22:23], v7 offset:9728
v_mfma_f32_16x16x32_bf16 v[104:107], v[24:27], v[136:139], v[104:107]
s_waitcnt lgkmcnt(7)
v_mfma_f32_16x16x32_bf16 v[44:47], v[28:31], v[128:131], v[44:47]
ds_read_b64_tr_b16 v[24:25], v6 offset:8960
v_mfma_f32_16x16x32_bf16 v[76:79], v[28:31], v[132:135], v[76:79]
ds_read_b64_tr_b16 v[26:27], v6 offset:9984
v_mfma_f32_16x16x32_bf16 v[108:111], v[28:31], v[136:139], v[108:111]
s_waitcnt lgkmcnt(4)
v_mfma_f32_16x16x32_bf16 v[48:51], v[16:19], v[128:131], v[48:51]
ds_read_b64_tr_b16 v[28:29], v7 offset:8960
v_mfma_f32_16x16x32_bf16 v[80:83], v[16:19], v[132:135], v[80:83]
ds_read_b64_tr_b16 v[30:31], v7 offset:9984
v_mfma_f32_16x16x32_bf16 v[112:115], v[16:19], v[136:139], v[112:115]
s_waitcnt vmcnt(9)
s_barrier
s_add_u32 m0, s56, 0x10000
s_lshl_b32 s66, s48, 12
s_add_u32 s66, s66, 0x40100
buffer_load_dwordx4 v4, s[16:19], s66 offen lds
s_waitcnt lgkmcnt(4)
v_mfma_f32_16x16x32_bf16 v[52:55], v[20:23], v[128:131], v[52:55]
ds_read_b64_tr_b16 v[16:17], v6 offset:16384
s_add_u32 s64, s40, 0x4800
buffer_load_dwordx4 v[164:167], v200, s[20:23], s64 offen
s_add_u32 s67, s66, 0x7c00
buffer_load_dwordx4 v4, s[16:19], s67 offen offset:1024 lds
v_mfma_f32_16x16x32_bf16 v[84:87], v[20:23], v[132:135], v[84:87]
ds_read_b64_tr_b16 v[18:19], v6 offset:17408
ds_write_b128 v10, v[176:179]
v_mfma_f32_16x16x32_bf16 v[116:119], v[20:23], v[136:139], v[116:119]
s_add_u32 s64, s40, 0x9000
buffer_load_dwordx4 v[168:171], v5, s[20:23], s64 offen
s_waitcnt lgkmcnt(5)
v_mfma_f32_16x16x32_bf16 v[56:59], v[24:27], v[128:131], v[56:59]
ds_read_b64_tr_b16 v[20:21], v7 offset:16384
ds_write_b128 v10, v[180:183] offset:512
s_add_u32 m0, s56, 0x6000
s_mov_b32 s58, 0x1e000
buffer_load_dwordx4 v2, s[8:11], s58 offen nt lds
v_mfma_f32_16x16x32_bf16 v[88:91], v[24:27], v[132:135], v[88:91]
ds_read_b64_tr_b16 v[22:23], v7 offset:17408
s_add_u32 s64, s40, 0x9000
buffer_load_dwordx4 v[172:175], v200, s[20:23], s64 offen
v_mfma_f32_16x16x32_bf16 v[120:123], v[24:27], v[136:139], v[120:123]
s_waitcnt lgkmcnt(6)
v_mfma_f32_16x16x32_bf16 v[60:63], v[28:31], v[128:131], v[60:63]
ds_read_b64_tr_b16 v[24:25], v6 offset:16640
ds_write_b128 v10, v[184:187] offset:2048
buffer_load_dwordx4 v2, s[8:11], s58 offen offset:1024 nt lds
v_mfma_f32_16x16x32_bf16 v[92:95], v[28:31], v[132:135], v[92:95]
ds_read_b64_tr_b16 v[26:27], v6 offset:17664
v_mfma_f32_16x16x32_bf16 v[124:127], v[28:31], v[136:139], v[124:127]
s_waitcnt lgkmcnt(7)
v_mfma_f32_16x16x32_bf16 v[32:35], v[16:19], v[140:143], v[32:35]
ds_read_b64_tr_b16 v[28:29], v7 offset:16640
v_mfma_f32_16x16x32_bf16 v[64:67], v[16:19], v[144:147], v[64:67]
ds_read_b64_tr_b16 v[30:31], v7 offset:17664
ds_write_b128 v10, v[188:191] offset:2560
s_add_u32 m0, s57, 0xa000
s_mov_b32 s59, 0x1a000
buffer_load_dwordx4 v3, s[12:15], s59 offen nt lds
v_mfma_f32_16x16x32_bf16 v[96:99], v[16:19], v[148:151], v[96:99]
ds_read_b128 v[128:131], v201 offset:1024
ds_read_b128 v[132:135], v201 offset:3072
s_waitcnt lgkmcnt(8)
v_mfma_f32_16x16x32_bf16 v[36:39], v[20:23], v[140:143], v[36:39]
ds_read_b64_tr_b16 v[16:17], v6 offset:16896
buffer_load_dwordx4 v[176:179], v5, s[20:23], s41 offen
v_mfma_f32_16x16x32_bf16 v[68:71], v[20:23], v[144:147], v[68:71]
ds_read_b64_tr_b16 v[18:19], v6 offset:17920
ds_write_b128 v202, v[192:195] offset:1024
buffer_load_dwordx4 v3, s[12:15], s59 offen offset:2048 nt lds
v_mfma_f32_16x16x32_bf16 v[100:103], v[20:23], v[148:151], v[100:103]
s_waitcnt lgkmcnt(8)
v_mfma_f32_16x16x32_bf16 v[40:43], v[24:27], v[140:143], v[40:43]
ds_read_b64_tr_b16 v[20:21], v7 offset:16896
buffer_load_dwordx4 v[180:183], v200, s[20:23], s41 offen
v_mfma_f32_16x16x32_bf16 v[72:75], v[24:27], v[144:147], v[72:75]
ds_read_b64_tr_b16 v[22:23], v7 offset:17920
ds_write_b128 v202, v[196:199] offset:1536
s_add_u32 s75, s75, 0x480
buffer_load_dword v204, v203, s[28:31], s75 offen
v_mfma_f32_16x16x32_bf16 v[104:107], v[24:27], v[148:151], v[104:107]
ds_read_b128 v[136:139], v201 offset:3072
s_waitcnt lgkmcnt(10)
v_mfma_f32_16x16x32_bf16 v[44:47], v[28:31], v[140:143], v[44:47]
ds_read_b64_tr_b16 v[24:25], v6 offset:17152
v_mfma_f32_16x16x32_bf16 v[76:79], v[28:31], v[144:147], v[76:79]
ds_read_b64_tr_b16 v[26:27], v6 offset:18176
s_add_u32 s64, s41, 0x4800
buffer_load_dwordx4 v[184:187], v5, s[20:23], s64 offen
v_mfma_f32_16x16x32_bf16 v[108:111], v[28:31], v[148:151], v[108:111]
s_waitcnt lgkmcnt(7)
v_mfma_f32_16x16x32_bf16 v[48:51], v[16:19], v[140:143], v[48:51]
ds_read_b64_tr_b16 v[28:29], v7 offset:17152
v_mfma_f32_16x16x32_bf16 v[80:83], v[16:19], v[144:147], v[80:83]
ds_read_b64_tr_b16 v[30:31], v7 offset:18176
v_mfma_f32_16x16x32_bf16 v[112:115], v[16:19], v[148:151], v[112:115]
s_waitcnt lgkmcnt(6)
v_mfma_f32_16x16x32_bf16 v[52:55], v[20:23], v[140:143], v[52:55]
v_mfma_f32_16x16x32_bf16 v[84:87], v[20:23], v[144:147], v[84:87]
v_mfma_f32_16x16x32_bf16 v[116:119], v[20:23], v[148:151], v[116:119]
s_waitcnt lgkmcnt(2)
v_mfma_f32_16x16x32_bf16 v[56:59], v[24:27], v[140:143], v[56:59]
v_mfma_f32_16x16x32_bf16 v[88:91], v[24:27], v[144:147], v[88:91]
v_mfma_f32_16x16x32_bf16 v[120:123], v[24:27], v[148:151], v[120:123]
s_waitcnt lgkmcnt(0)
v_mfma_f32_16x16x32_bf16 v[60:63], v[28:31], v[140:143], v[60:63]
v_mfma_f32_16x16x32_bf16 v[92:95], v[28:31], v[144:147], v[92:95]
v_mfma_f32_16x16x32_bf16 v[124:127], v[28:31], v[148:151], v[124:127]
s_waitcnt vmcnt(10)
s_barrier
ds_read_b64_tr_b16 v[16:17], v6 offset:24576
ds_read_b64_tr_b16 v[18:19], v6 offset:25600
ds_read_b64_tr_b16 v[20:21], v7 offset:24576
ds_read_b64_tr_b16 v[22:23], v7 offset:25600
ds_read_b64_tr_b16 v[24:25], v6 offset:24832
ds_read_b64_tr_b16 v[26:27], v6 offset:25856
s_add_u32 m0, s56, 0x12000
s_lshl_b32 s66, s40, 12
s_add_u32 s66, s66, 0x200
buffer_load_dwordx4 v4, s[16:19], s66 offen lds
s_waitcnt lgkmcnt(4)
v_mfma_f32_16x16x32_bf16 v[32:35], v[16:19], v[128:131], v[32:35]
ds_read_b64_tr_b16 v[28:29], v7 offset:24832
s_add_u32 s67, s66, 0x7c00
buffer_load_dwordx4 v4, s[16:19], s67 offen offset:1024 lds
v_mfma_f32_16x16x32_bf16 v[64:67], v[16:19], v[132:135], v[64:67]
ds_read_b64_tr_b16 v[30:31], v7 offset:25856
ds_read_b128 v[140:143], v11
ds_read_b128 v[144:147], v11 offset:2048
ds_read_b128 v[148:151], v11 offset:1024
v_mfma_f32_16x16x32_bf16 v[96:99], v[16:19], v[136:139], v[96:99]
s_add_u32 m0, s56, 0x14000
s_lshl_b32 s66, s40, 12
s_add_u32 s66, s66, 0x40200
buffer_load_dwordx4 v4, s[16:19], s66 offen lds
s_waitcnt lgkmcnt(7)
v_mfma_f32_16x16x32_bf16 v[36:39], v[20:23], v[128:131], v[36:39]
ds_read_b64_tr_b16 v[16:17], v6 offset:25088
v_mfma_f32_16x16x32_bf16 v[68:71], v[20:23], v[132:135], v[68:71]
ds_read_b64_tr_b16 v[18:19], v6 offset:26112
s_add_u32 s64, s41, 0x4800
buffer_load_dwordx4 v[188:191], v200, s[20:23], s64 offen
v_mfma_f32_16x16x32_bf16 v[100:103], v[20:23], v[136:139], v[100:103]
s_add_u32 s67, s66, 0x7c00
buffer_load_dwordx4 v4, s[16:19], s67 offen offset:1024 lds
s_waitcnt lgkmcnt(7)
v_mfma_f32_16x16x32_bf16 v[40:43], v[24:27], v[128:131], v[40:43]
ds_read_b64_tr_b16 v[20:21], v7 offset:25088
v_mfma_f32_16x16x32_bf16 v[72:75], v[24:27], v[132:135], v[72:75]
ds_read_b64_tr_b16 v[22:23], v7 offset:26112
ds_write_b128 v10, v[152:155]
v_mfma_f32_16x16x32_bf16 v[104:107], v[24:27], v[136:139], v[104:107]
s_add_u32 m0, s56, 0
s_mov_b32 s58, 0x20000
buffer_load_dwordx4 v2, s[8:11], s58 offen nt lds
s_waitcnt lgkmcnt(8)
v_mfma_f32_16x16x32_bf16 v[44:47], v[28:31], v[128:131], v[44:47]
ds_read_b64_tr_b16 v[24:25], v6 offset:25344
v_mfma_f32_16x16x32_bf16 v[76:79], v[28:31], v[132:135], v[76:79]
ds_read_b64_tr_b16 v[26:27], v6 offset:26368
s_add_u32 s64, s41, 0x9000
buffer_load_dwordx4 v[192:195], v5, s[20:23], s64 offen
v_mfma_f32_16x16x32_bf16 v[108:111], v[28:31], v[136:139], v[108:111]
buffer_load_dwordx4 v2, s[8:11], s58 offen offset:1024 nt lds
s_waitcnt lgkmcnt(5)
v_mfma_f32_16x16x32_bf16 v[48:51], v[16:19], v[128:131], v[48:51]
ds_read_b64_tr_b16 v[28:29], v7 offset:25344
v_mfma_f32_16x16x32_bf16 v[80:83], v[16:19], v[132:135], v[80:83]
ds_read_b64_tr_b16 v[30:31], v7 offset:26368
ds_write_b128 v10, v[156:159] offset:512
v_mfma_f32_16x16x32_bf16 v[112:115], v[16:19], v[136:139], v[112:115]
s_add_u32 m0, s57, 0xc000
s_mov_b32 s59, 0x1c000
buffer_load_dwordx4 v3, s[12:15], s59 offen nt lds
s_waitcnt lgkmcnt(6)
v_mfma_f32_16x16x32_bf16 v[52:55], v[20:23], v[128:131], v[52:55]
ds_read_b64_tr_b16 v[16:17], v6
v_mfma_f32_16x16x32_bf16 v[84:87], v[20:23], v[132:135], v[84:87]
ds_read_b64_tr_b16 v[18:19], v6 offset:1024
s_add_u32 s64, s41, 0x9000
buffer_load_dwordx4 v[196:199], v200, s[20:23], s64 offen
v_mfma_f32_16x16x32_bf16 v[116:119], v[20:23], v[136:139], v[116:119]
buffer_load_dwordx4 v3, s[12:15], s59 offen offset:2048 nt lds
s_waitcnt lgkmcnt(5)
v_mfma_f32_16x16x32_bf16 v[56:59], v[24:27], v[128:131], v[56:59]
ds_read_b64_tr_b16 v[20:21], v7
v_mfma_f32_16x16x32_bf16 v[88:91], v[24:27], v[132:135], v[88:91]
ds_read_b64_tr_b16 v[22:23], v7 offset:1024
ds_write_b128 v10, v[160:163] offset:2048
v_mfma_f32_16x16x32_bf16 v[120:123], v[24:27], v[136:139], v[120:123]
s_waitcnt lgkmcnt(6)
v_mfma_f32_16x16x32_bf16 v[60:63], v[28:31], v[128:131], v[60:63]
ds_read_b64_tr_b16 v[24:25], v6 offset:256
v_mfma_f32_16x16x32_bf16 v[92:95], v[28:31], v[132:135], v[92:95]
ds_read_b64_tr_b16 v[26:27], v6 offset:1280
v_mfma_f32_16x16x32_bf16 v[124:127], v[28:31], v[136:139], v[124:127]
s_waitcnt lgkmcnt(5)
v_mfma_f32_16x16x32_bf16 v[32:35], v[16:19], v[140:143], v[32:35]
ds_read_b64_tr_b16 v[28:29], v7 offset:256
v_mfma_f32_16x16x32_bf16 v[64:67], v[16:19], v[144:147], v[64:67]
ds_read_b64_tr_b16 v[30:31], v7 offset:1280
v_mfma_f32_16x16x32_bf16 v[96:99], v[16:19], v[148:151], v[96:99]
s_waitcnt lgkmcnt(5)
v_mfma_f32_16x16x32_bf16 v[36:39], v[20:23], v[140:143], v[36:39]
ds_read_b64_tr_b16 v[16:17], v6 offset:512
v_mfma_f32_16x16x32_bf16 v[68:71], v[20:23], v[144:147], v[68:71]
ds_read_b64_tr_b16 v[18:19], v6 offset:1536
v_mfma_f32_16x16x32_bf16 v[100:103], v[20:23], v[148:151], v[100:103]
s_waitcnt lgkmcnt(4)
v_mfma_f32_16x16x32_bf16 v[40:43], v[24:27], v[140:143], v[40:43]
ds_read_b64_tr_b16 v[20:21], v7 offset:512
v_mul_f32 v32, s61, v32
v_mul_f32 v33, s61, v33
v_mul_f32 v34, s61, v34
v_mul_f32 v35, s61, v35
v_cvt_pk_bf16_f32 v12, v32, v33
v_cvt_pk_bf16_f32 v13, v34, v35
ds_write_b64 v8, v[12:13]
v_mfma_f32_16x16x32_bf16 v[72:75], v[24:27], v[144:147], v[72:75]
ds_read_b64_tr_b16 v[22:23], v7 offset:1536
v_mul_f32 v64, s61, v64
v_mul_f32 v65, s61, v65
v_mul_f32 v66, s61, v66
v_mul_f32 v67, s61, v67
v_mfma_f32_16x16x32_bf16 v[104:107], v[24:27], v[148:151], v[104:107]
v_cvt_pk_bf16_f32 v14, v64, v65
v_cvt_pk_bf16_f32 v15, v66, v67
ds_write_b64 v8, v[14:15] offset:4096
v_mul_f32 v96, s61, v96
v_mul_f32 v97, s61, v97
v_mul_f32 v98, s61, v98
v_mul_f32 v99, s61, v99
s_waitcnt vmcnt(9)
s_barrier
s_add_u32 m0, s56, 0x16000
s_lshl_b32 s66, s41, 12
s_add_u32 s66, s66, 0x200
buffer_load_dwordx4 v4, s[16:19], s66 offen lds
s_waitcnt lgkmcnt(6)
v_mfma_f32_16x16x32_bf16 v[44:47], v[28:31], v[140:143], v[44:47]
ds_read_b64_tr_b16 v[24:25], v6 offset:768
ds_write_b128 v10, v[164:167] offset:2560
v_cvt_pk_bf16_f32 v12, v96, v97
v_cvt_pk_bf16_f32 v13, v98, v99
ds_write_b64 v8, v[12:13] offset:8192
s_add_u32 s67, s66, 0x7c00
buffer_load_dwordx4 v4, s[16:19], s67 offen offset:1024 lds
v_mfma_f32_16x16x32_bf16 v[76:79], v[28:31], v[144:147], v[76:79]
ds_read_b64_tr_b16 v[26:27], v6 offset:1792
ds_read_b128 v[128:131], v201 offset:1024
ds_read_b128 v[132:135], v201 offset:3072
v_mul_f32 v36, s61, v36
v_mul_f32 v37, s61, v37
v_mul_f32 v38, s61, v38
v_mul_f32 v39, s61, v39
v_cvt_pk_bf16_f32 v14, v36, v37
v_cvt_pk_bf16_f32 v15, v38, v39
ds_write_b64 v9, v[14:15]
v_mfma_f32_16x16x32_bf16 v[108:111], v[28:31], v[148:151], v[108:111]
v_mul_f32 v68, s61, v68
v_mul_f32 v69, s61, v69
v_mul_f32 v70, s61, v70
v_mul_f32 v71, s61, v71
s_waitcnt lgkmcnt(11)
v_mfma_f32_16x16x32_bf16 v[48:51], v[16:19], v[140:143], v[48:51]
ds_read_b64_tr_b16 v[28:29], v7 offset:768
buffer_load_dwordx4 v[152:155], v5, s[20:23], s42 offen
v_cvt_pk_bf16_f32 v12, v68, v69
v_cvt_pk_bf16_f32 v13, v70, v71
ds_write_b64 v9, v[12:13] offset:4096
v_mfma_f32_16x16x32_bf16 v[80:83], v[16:19], v[144:147], v[80:83]
ds_read_b64_tr_b16 v[30:31], v7 offset:1792
v_mul_f32 v100, s61, v100
v_mul_f32 v101, s61, v101
v_mul_f32 v102, s61, v102
v_mul_f32 v103, s61, v103
v_cvt_pk_bf16_f32 v14, v100, v101
v_cvt_pk_bf16_f32 v15, v102, v103
ds_write_b64 v9, v[14:15] offset:8192
s_add_u32 m0, s56, 0x2000
s_mov_b32 s58, 0x22000
buffer_load_dwordx4 v2, s[8:11], s58 offen nt lds
v_mfma_f32_16x16x32_bf16 v[112:115], v[16:19], v[148:151], v[112:115]
ds_write_b128 v202, v[168:171] offset:1024
v_mul_f32 v40, s61, v40
v_mul_f32 v41, s61, v41
v_mul_f32 v42, s61, v42
v_mul_f32 v43, s61, v43
s_waitcnt lgkmcnt(13)
v_mfma_f32_16x16x32_bf16 v[52:55], v[20:23], v[140:143], v[52:55]
ds_read_b64_tr_b16 v[16:17], v6 offset:8192
buffer_load_dwordx4 v[156:159], v200, s[20:23], s42 offen
v_cvt_pk_bf16_f32 v12, v40, v41
v_cvt_pk_bf16_f32 v13, v42, v43
ds_write_b64 v8, v[12:13] offset:1024
v_mul_f32 v72, s61, v72
v_mul_f32 v73, s61, v73
v_mul_f32 v74, s61, v74
v_mul_f32 v75, s61, v75
v_mfma_f32_16x16x32_bf16 v[84:87], v[20:23], v[144:147], v[84:87]
ds_read_b64_tr_b16 v[18:19], v6 offset:9216
v_cvt_pk_bf16_f32 v14, v72, v73
v_cvt_pk_bf16_f32 v15, v74, v75
ds_write_b64 v8, v[14:15] offset:5120
v_mfma_f32_16x16x32_bf16 v[116:119], v[20:23], v[148:151], v[116:119]
ds_write_b128 v202, v[172:175] offset:1536
v_mul_f32 v104, s61, v104
v_mul_f32 v105, s61, v105
v_mul_f32 v106, s61, v106
v_mul_f32 v107, s61, v107
v_cvt_pk_bf16_f32 v12, v104, v105
v_cvt_pk_bf16_f32 v13, v106, v107
ds_write_b64 v8, v[12:13] offset:9216
buffer_load_dwordx4 v2, s[8:11], s58 offen offset:1024 nt lds
s_waitcnt lgkmcnt(14)
v_mfma_f32_16x16x32_bf16 v[56:59], v[24:27], v[140:143], v[56:59]
ds_read_b64_tr_b16 v[20:21], v7 offset:8192
v_mul_f32 v44, s61, v44
v_mul_f32 v45, s61, v45
v_mul_f32 v46, s61, v46
v_mul_f32 v47, s61, v47
v_mfma_f32_16x16x32_bf16 v[88:91], v[24:27], v[144:147], v[88:91]
ds_read_b64_tr_b16 v[22:23], v7 offset:9216
ds_read_b128 v[136:139], v201 offset:3072
v_cvt_pk_bf16_f32 v14, v44, v45
v_cvt_pk_bf16_f32 v15, v46, v47
ds_write_b64 v9, v[14:15] offset:1024
v_mfma_f32_16x16x32_bf16 v[120:123], v[24:27], v[148:151], v[120:123]
v_mul_f32 v76, s61, v76
v_mul_f32 v77, s61, v77
v_mul_f32 v78, s61, v78
v_mul_f32 v79, s61, v79
v_cvt_pk_bf16_f32 v12, v76, v77
v_cvt_pk_bf16_f32 v13, v78, v79
ds_write_b64 v9, v[12:13] offset:5120
s_waitcnt lgkmcnt(13)
v_mfma_f32_16x16x32_bf16 v[60:63], v[28:31], v[140:143], v[60:63]
ds_read_b64_tr_b16 v[24:25], v6 offset:8448
s_add_u32 s64, s42, 0x4800
buffer_load_dwordx4 v[160:163], v5, s[20:23], s64 offen
v_mul_f32 v108, s61, v108
v_mul_f32 v109, s61, v109
v_mul_f32 v110, s61, v110
v_mul_f32 v111, s61, v111
s_add_u32 m0, s57, 0xe000
s_mov_b32 s59, 0x1e000
buffer_load_dwordx4 v3, s[12:15], s59 offen nt lds
v_mfma_f32_16x16x32_bf16 v[92:95], v[28:31], v[144:147], v[92:95]
ds_read_b64_tr_b16 v[26:27], v6 offset:9472
v_cvt_pk_bf16_f32 v14, v108, v109
v_cvt_pk_bf16_f32 v15, v110, v111
ds_write_b64 v9, v[14:15] offset:9216
v_mul_f32 v48, s61, v48
v_mul_f32 v49, s61, v49
v_mul_f32 v50, s61, v50
v_mul_f32 v51, s61, v51
v_mfma_f32_16x16x32_bf16 v[124:127], v[28:31], v[148:151], v[124:127]
v_cvt_pk_bf16_f32 v12, v48, v49
v_cvt_pk_bf16_f32 v13, v50, v51
ds_write_b64 v8, v[12:13] offset:2048
s_waitcnt lgkmcnt(6)
v_mfma_f32_16x16x32_bf16 v[32:35], v[16:19], v[128:131], 0
ds_read_b64_tr_b16 v[28:29], v7 offset:8448
v_mul_f32 v80, s61, v80
v_mul_f32 v81, s61, v81
v_mul_f32 v82, s61, v82
v_mul_f32 v83, s61, v83
v_cvt_pk_bf16_f32 v14, v80, v81
v_cvt_pk_bf16_f32 v15, v82, v83
ds_write_b64 v8, v[14:15] offset:6144
v_mfma_f32_16x16x32_bf16 v[64:67], v[16:19], v[132:135], 0
ds_read_b64_tr_b16 v[30:31], v7 offset:9472
v_mul_f32 v112, s61, v112
v_mul_f32 v113, s61, v113
v_mul_f32 v114, s61, v114
v_mul_f32 v115, s61, v115
ds_read_b128 v[140:143], v11
ds_read_b128 v[144:147], v11 offset:2048
ds_read_b128 v[148:151], v11 offset:1024
buffer_load_dwordx4 v3, s[12:15], s59 offen offset:2048 nt lds
v_mfma_f32_16x16x32_bf16 v[96:99], v[16:19], v[136:139], 0
v_cvt_pk_bf16_f32 v12, v112, v113
v_cvt_pk_bf16_f32 v13, v114, v115
ds_write_b64 v8, v[12:13] offset:10240
s_add_u32 s64, s42, 0x4800
buffer_load_dwordx4 v[164:167], v200, s[20:23], s64 offen
v_mfma_f32_16x16x32_bf16 v[36:39], v[20:23], v[128:131], 0
ds_read_b64_tr_b16 v[16:17], v6 offset:8704
v_mul_f32 v52, s61, v52
v_mul_f32 v53, s61, v53
v_mul_f32 v54, s61, v54
v_mul_f32 v55, s61, v55
v_cvt_pk_bf16_f32 v14, v52, v53
v_cvt_pk_bf16_f32 v15, v54, v55
ds_write_b64 v9, v[14:15] offset:2048
ds_write_b128 v10, v[176:179]
v_mfma_f32_16x16x32_bf16 v[68:71], v[20:23], v[132:135], 0
ds_read_b64_tr_b16 v[18:19], v6 offset:9728
v_mul_f32 v84, s61, v84
v_mul_f32 v85, s61, v85
v_mul_f32 v86, s61, v86
v_mul_f32 v87, s61, v87
s_add_u32 s64, s42, 0x9000
buffer_load_dwordx4 v[168:171], v5, s[20:23], s64 offen
v_mfma_f32_16x16x32_bf16 v[100:103], v[20:23], v[136:139], 0
v_cvt_pk_bf16_f32 v12, v84, v85
v_cvt_pk_bf16_f32 v13, v86, v87
ds_write_b64 v9, v[12:13] offset:6144
v_mul_f32 v116, s61, v116
v_mul_f32 v117, s61, v117
v_mul_f32 v118, s61, v118
v_mul_f32 v119, s61, v119
s_waitcnt lgkmcnt(14)
v_mfma_f32_16x16x32_bf16 v[40:43], v[24:27], v[128:131], 0
ds_read_b64_tr_b16 v[20:21], v7 offset:8704
v_cvt_pk_bf16_f32 v14, v116, v117
v_cvt_pk_bf16_f32 v15, v118, v119
ds_write_b64 v9, v[14:15] offset:10240
v_mfma_f32_16x16x32_bf16 v[72:75], v[24:27], v[132:135], 0
ds_read_b64_tr_b16 v[22:23], v7 offset:9728
v_mul_f32 v56, s61, v56
v_mul_f32 v57, s61, v57
v_mul_f32 v58, s61, v58
v_mul_f32 v59, s61, v59
v_cvt_pk_bf16_f32 v12, v56, v57
v_cvt_pk_bf16_f32 v13, v58, v59
ds_write_b64 v8, v[12:13] offset:3072
v_mfma_f32_16x16x32_bf16 v[104:107], v[24:27], v[136:139], 0
v_mul_f32 v88, s61, v88
v_mul_f32 v89, s61, v89
v_mul_f32 v90, s61, v90
v_mul_f32 v91, s61, v91
s_waitcnt lgkmcnt(13)
v_mfma_f32_16x16x32_bf16 v[44:47], v[28:31], v[128:131], 0
ds_read_b64_tr_b16 v[24:25], v6 offset:8960
v_cvt_pk_bf16_f32 v14, v88, v89
v_cvt_pk_bf16_f32 v15, v90, v91
ds_write_b64 v8, v[14:15] offset:7168
v_mfma_f32_16x16x32_bf16 v[76:79], v[28:31], v[132:135], 0
ds_read_b64_tr_b16 v[26:27], v6 offset:9984
v_mul_f32 v120, s61, v120
v_mul_f32 v121, s61, v121
v_mul_f32 v122, s61, v122
v_mul_f32 v123, s61, v123
v_cvt_pk_bf16_f32 v12, v120, v121
v_cvt_pk_bf16_f32 v13, v122, v123
ds_write_b64 v8, v[12:13] offset:11264
v_mfma_f32_16x16x32_bf16 v[108:111], v[28:31], v[136:139], 0
v_mul_f32 v60, s61, v60
v_mul_f32 v61, s61, v61
v_mul_f32 v62, s61, v62
v_mul_f32 v63, s61, v63
s_waitcnt lgkmcnt(9)
v_mfma_f32_16x16x32_bf16 v[48:51], v[16:19], v[128:131], 0
ds_read_b64_tr_b16 v[28:29], v7 offset:8960
v_cvt_pk_bf16_f32 v14, v60, v61
v_cvt_pk_bf16_f32 v15, v62, v63
ds_write_b64 v9, v[14:15] offset:3072
v_mul_f32 v92, s61, v92
v_mul_f32 v93, s61, v93
v_mul_f32 v94, s61, v94
v_mul_f32 v95, s61, v95
v_mfma_f32_16x16x32_bf16 v[80:83], v[16:19], v[132:135], 0
ds_read_b64_tr_b16 v[30:31], v7 offset:9984
v_cvt_pk_bf16_f32 v12, v92, v93
v_cvt_pk_bf16_f32 v13, v94, v95
ds_write_b64 v9, v[12:13] offset:7168
v_mfma_f32_16x16x32_bf16 v[112:115], v[16:19], v[136:139], 0
v_mul_f32 v124, s61, v124
v_mul_f32 v125, s61, v125
v_mul_f32 v126, s61, v126
v_mul_f32 v127, s61, v127
s_waitcnt lgkmcnt(9)
v_mfma_f32_16x16x32_bf16 v[52:55], v[20:23], v[128:131], 0
v_cvt_pk_bf16_f32 v14, v124, v125
v_cvt_pk_bf16_f32 v15, v126, v127
ds_write_b64 v9, v[14:15] offset:11264
v_mfma_f32_16x16x32_bf16 v[84:87], v[20:23], v[132:135], 0
v_mfma_f32_16x16x32_bf16 v[116:119], v[20:23], v[136:139], 0
s_waitcnt vmcnt(11) lgkmcnt(0)
s_barrier
ds_read_b64_tr_b16 v[16:17], v6 offset:16384
ds_read_b64_tr_b16 v[18:19], v6 offset:17408
s_add_u32 m0, s56, 0x10000
s_lshl_b32 s66, s41, 12
s_add_u32 s66, s66, 0x40200
buffer_load_dwordx4 v4, s[16:19], s66 offen lds
v_mfma_f32_16x16x32_bf16 v[56:59], v[24:27], v[128:131], 0
ds_read_b64_tr_b16 v[20:21], v7 offset:16384
ds_write_b128 v10, v[180:183] offset:512
s_add_u32 s67, s66, 0x7c00
buffer_load_dwordx4 v4, s[16:19], s67 offen offset:1024 lds
v_mfma_f32_16x16x32_bf16 v[88:91], v[24:27], v[132:135], 0
ds_read_b64_tr_b16 v[22:23], v7 offset:17408
s_add_u32 s64, s42, 0x9000
buffer_load_dwordx4 v[172:175], v200, s[20:23], s64 offen
v_mfma_f32_16x16x32_bf16 v[120:123], v[24:27], v[136:139], 0
s_add_u32 m0, s56, 0x4000
s_mov_b32 s58, 0x24000
buffer_load_dwordx4 v2, s[8:11], s58 offen nt lds
v_mfma_f32_16x16x32_bf16 v[60:63], v[28:31], v[128:131], 0
ds_read_b64_tr_b16 v[24:25], v6 offset:16640
ds_write_b128 v10, v[184:187] offset:2048
v_mfma_f32_16x16x32_bf16 v[92:95], v[28:31], v[132:135], 0
ds_read_b64_tr_b16 v[26:27], v6 offset:17664
v_mfma_f32_16x16x32_bf16 v[124:127], v[28:31], v[136:139], 0
buffer_load_dwordx4 v2, s[8:11], s58 offen offset:1024 nt lds
s_waitcnt lgkmcnt(6)
v_mfma_f32_16x16x32_bf16 v[32:35], v[16:19], v[140:143], v[32:35]
ds_read_b64_tr_b16 v[28:29], v7 offset:16640
v_mfma_f32_16x16x32_bf16 v[64:67], v[16:19], v[144:147], v[64:67]
ds_read_b64_tr_b16 v[30:31], v7 offset:17664
ds_write_b128 v10, v[188:191] offset:2560
v_mfma_f32_16x16x32_bf16 v[96:99], v[16:19], v[148:151], v[96:99]
ds_read_b128 v[128:131], v201 offset:1024
ds_read_b128 v[132:135], v201 offset:3072
s_add_u32 m0, s57, 0x8000
s_mov_b32 s59, 0x20000
buffer_load_dwordx4 v3, s[12:15], s59 offen nt lds
s_waitcnt lgkmcnt(8)
v_mfma_f32_16x16x32_bf16 v[36:39], v[20:23], v[140:143], v[36:39]
ds_read_b64_tr_b16 v[16:17], v6 offset:16896
buffer_load_dwordx4 v[176:179], v5, s[20:23], s43 offen
v_mfma_f32_16x16x32_bf16 v[68:71], v[20:23], v[144:147], v[68:71]
ds_read_b64_tr_b16 v[18:19], v6 offset:17920
v_mfma_f32_16x16x32_bf16 v[100:103], v[20:23], v[148:151], v[100:103]
ds_write_b128 v202, v[192:195] offset:1024
buffer_load_dwordx4 v3, s[12:15], s59 offen offset:2048 nt lds
s_waitcnt lgkmcnt(8)
v_mfma_f32_16x16x32_bf16 v[40:43], v[24:27], v[140:143], v[40:43]
ds_read_b64_tr_b16 v[20:21], v7 offset:16896
buffer_load_dwordx4 v[180:183], v200, s[20:23], s43 offen
v_mfma_f32_16x16x32_bf16 v[72:75], v[24:27], v[144:147], v[72:75]
ds_read_b64_tr_b16 v[22:23], v7 offset:17920
v_mfma_f32_16x16x32_bf16 v[104:107], v[24:27], v[148:151], v[104:107]
s_waitcnt lgkmcnt(8)
v_mfma_f32_16x16x32_bf16 v[44:47], v[28:31], v[140:143], v[44:47]
ds_read_b64_tr_b16 v[24:25], v6 offset:17152
v_mfma_f32_16x16x32_bf16 v[76:79], v[28:31], v[144:147], v[76:79]
ds_read_b64_tr_b16 v[26:27], v6 offset:18176
v_mfma_f32_16x16x32_bf16 v[108:111], v[28:31], v[148:151], v[108:111]
s_waitcnt lgkmcnt(5)
v_mfma_f32_16x16x32_bf16 v[48:51], v[16:19], v[140:143], v[48:51]
ds_read_b64_tr_b16 v[28:29], v7 offset:17152
v_mfma_f32_16x16x32_bf16 v[80:83], v[16:19], v[144:147], v[80:83]
ds_read_b64_tr_b16 v[30:31], v7 offset:18176
v_mfma_f32_16x16x32_bf16 v[112:115], v[16:19], v[148:151], v[112:115]
s_waitcnt lgkmcnt(4)
v_mfma_f32_16x16x32_bf16 v[52:55], v[20:23], v[140:143], v[52:55]
v_mfma_f32_16x16x32_bf16 v[84:87], v[20:23], v[144:147], v[84:87]
v_mfma_f32_16x16x32_bf16 v[116:119], v[20:23], v[148:151], v[116:119]
s_waitcnt vmcnt(7)
s_barrier
ds_read_b64_tr_b16 v[16:17], v6 offset:24576
ds_read_b64_tr_b16 v[18:19], v6 offset:25600
s_add_u32 m0, s56, 0x12000
s_lshl_b32 s66, s42, 12
s_add_u32 s66, s66, 0x200
buffer_load_dwordx4 v4, s[16:19], s66 offen lds
s_waitcnt lgkmcnt(4)
v_mfma_f32_16x16x32_bf16 v[56:59], v[24:27], v[140:143], v[56:59]
ds_read_b64_tr_b16 v[20:21], v7 offset:24576
ds_write_b128 v202, v[196:199] offset:1536
s_add_u32 s67, s66, 0x7c00
buffer_load_dwordx4 v4, s[16:19], s67 offen offset:1024 lds
v_mfma_f32_16x16x32_bf16 v[88:91], v[24:27], v[144:147], v[88:91]
ds_read_b64_tr_b16 v[22:23], v7 offset:25600
ds_read_b128 v[136:139], v201 offset:3072
v_mfma_f32_16x16x32_bf16 v[120:123], v[24:27], v[148:151], v[120:123]
s_waitcnt lgkmcnt(6)
v_mfma_f32_16x16x32_bf16 v[60:63], v[28:31], v[140:143], v[60:63]
ds_read_b64_tr_b16 v[24:25], v6 offset:24832
s_add_u32 s64, s43, 0x4800
buffer_load_dwordx4 v[184:187], v5, s[20:23], s64 offen
s_add_u32 m0, s56, 0x6000
s_mov_b32 s58, 0x26000
buffer_load_dwordx4 v2, s[8:11], s58 offen nt lds
v_mfma_f32_16x16x32_bf16 v[92:95], v[28:31], v[144:147], v[92:95]
ds_read_b64_tr_b16 v[26:27], v6 offset:25856
v_mfma_f32_16x16x32_bf16 v[124:127], v[28:31], v[148:151], v[124:127]
s_waitcnt lgkmcnt(2)
v_mfma_f32_16x16x32_bf16 v[32:35], v[16:19], v[128:131], v[32:35]
ds_read_b64_tr_b16 v[28:29], v7 offset:24832
buffer_load_dwordx4 v2, s[8:11], s58 offen offset:1024 nt lds
v_mfma_f32_16x16x32_bf16 v[64:67], v[16:19], v[132:135], v[64:67]
ds_read_b64_tr_b16 v[30:31], v7 offset:25856
ds_read_b128 v[140:143], v11
ds_read_b128 v[144:147], v11 offset:2048
ds_read_b128 v[148:151], v11 offset:1024
v_mfma_f32_16x16x32_bf16 v[96:99], v[16:19], v[136:139], v[96:99]
v_mfma_f32_16x16x32_bf16 v[36:39], v[20:23], v[128:131], v[36:39]
ds_read_b64_tr_b16 v[16:17], v6 offset:25088
s_add_u32 s64, s43, 0x4800
buffer_load_dwordx4 v[188:191], v200, s[20:23], s64 offen
v_mfma_f32_16x16x32_bf16 v[68:71], v[20:23], v[132:135], v[68:71]
ds_read_b64_tr_b16 v[18:19], v6 offset:26112
s_add_u32 m0, s57, 0xa000
s_mov_b32 s59, 0x22000
buffer_load_dwordx4 v3, s[12:15], s59 offen nt lds
v_mfma_f32_16x16x32_bf16 v[100:103], v[20:23], v[136:139], v[100:103]
ds_write_b128 v10, v[152:155]
s_waitcnt lgkmcnt(8)
v_mfma_f32_16x16x32_bf16 v[40:43], v[24:27], v[128:131], v[40:43]
ds_read_b64_tr_b16 v[20:21], v7 offset:25088
v_mfma_f32_16x16x32_bf16 v[72:75], v[24:27], v[132:135], v[72:75]
ds_read_b64_tr_b16 v[22:23], v7 offset:26112
s_add_u32 s64, s43, 0x9000
buffer_load_dwordx4 v[192:195], v5, s[20:23], s64 offen
buffer_load_dwordx4 v3, s[12:15], s59 offen offset:2048 nt lds
v_mfma_f32_16x16x32_bf16 v[104:107], v[24:27], v[136:139], v[104:107]
s_waitcnt lgkmcnt(8)
v_mfma_f32_16x16x32_bf16 v[44:47], v[28:31], v[128:131], v[44:47]
ds_read_b64_tr_b16 v[24:25], v6 offset:25344
ds_write_b128 v10, v[156:159] offset:512
v_mfma_f32_16x16x32_bf16 v[76:79], v[28:31], v[132:135], v[76:79]
ds_read_b64_tr_b16 v[26:27], v6 offset:26368
s_add_u32 s75, s75, 0x480
buffer_load_dword v204, v203, s[28:31], s75 offen
v_mfma_f32_16x16x32_bf16 v[108:111], v[28:31], v[136:139], v[108:111]
s_add_u32 s64, s43, 0x9000
buffer_load_dwordx4 v[196:199], v200, s[20:23], s64 offen
s_waitcnt lgkmcnt(6)
v_mfma_f32_16x16x32_bf16 v[48:51], v[16:19], v[128:131], v[48:51]
ds_read_b64_tr_b16 v[28:29], v7 offset:25344
v_mfma_f32_16x16x32_bf16 v[80:83], v[16:19], v[132:135], v[80:83]
ds_read_b64_tr_b16 v[30:31], v7 offset:26368
ds_write_b128 v10, v[160:163] offset:2048
v_mfma_f32_16x16x32_bf16 v[112:115], v[16:19], v[136:139], v[112:115]
s_waitcnt lgkmcnt(6)
v_mfma_f32_16x16x32_bf16 v[52:55], v[20:23], v[128:131], v[52:55]
ds_read_b64_tr_b16 v[16:17], v6
v_mfma_f32_16x16x32_bf16 v[84:87], v[20:23], v[132:135], v[84:87]
ds_read_b64_tr_b16 v[18:19], v6 offset:1024
v_mfma_f32_16x16x32_bf16 v[116:119], v[20:23], v[136:139], v[116:119]
s_waitcnt lgkmcnt(5)
v_mfma_f32_16x16x32_bf16 v[56:59], v[24:27], v[128:131], v[56:59]
ds_read_b64_tr_b16 v[20:21], v7
v_mfma_f32_16x16x32_bf16 v[88:91], v[24:27], v[132:135], v[88:91]
ds_read_b64_tr_b16 v[22:23], v7 offset:1024
v_mfma_f32_16x16x32_bf16 v[120:123], v[24:27], v[136:139], v[120:123]
s_waitcnt lgkmcnt(5)
v_mfma_f32_16x16x32_bf16 v[60:63], v[28:31], v[128:131], v[60:63]
ds_read_b64_tr_b16 v[24:25], v6 offset:256
v_mfma_f32_16x16x32_bf16 v[92:95], v[28:31], v[132:135], v[92:95]
ds_read_b64_tr_b16 v[26:27], v6 offset:1280
v_mfma_f32_16x16x32_bf16 v[124:127], v[28:31], v[136:139], v[124:127]
s_waitcnt lgkmcnt(4)
v_mfma_f32_16x16x32_bf16 v[32:35], v[16:19], v[140:143], v[32:35]
ds_read_b64_tr_b16 v[28:29], v7 offset:256
v_mfma_f32_16x16x32_bf16 v[64:67], v[16:19], v[144:147], v[64:67]
ds_read_b64_tr_b16 v[30:31], v7 offset:1280
v_mfma_f32_16x16x32_bf16 v[96:99], v[16:19], v[148:151], v[96:99]
s_waitcnt vmcnt(9)
s_barrier
s_add_u32 m0, s56, 0x14000
s_lshl_b32 s66, s42, 12
s_add_u32 s66, s66, 0x40200
buffer_load_dwordx4 v4, s[16:19], s66 offen lds
s_waitcnt lgkmcnt(4)
v_mfma_f32_16x16x32_bf16 v[36:39], v[20:23], v[140:143], v[36:39]
ds_read_b64_tr_b16 v[16:17], v6 offset:512
ds_write_b128 v10, v[164:167] offset:2560
s_add_u32 s67, s66, 0x7c00
buffer_load_dwordx4 v4, s[16:19], s67 offen offset:1024 lds
v_mfma_f32_16x16x32_bf16 v[68:71], v[20:23], v[144:147], v[68:71]
ds_read_b64_tr_b16 v[18:19], v6 offset:1536
v_mfma_f32_16x16x32_bf16 v[100:103], v[20:23], v[148:151], v[100:103]
ds_read_b128 v[128:131], v201 offset:1024
ds_read_b128 v[132:135], v201 offset:3072
s_waitcnt lgkmcnt(7)
v_mfma_f32_16x16x32_bf16 v[40:43], v[24:27], v[140:143], v[40:43]
ds_read_b64_tr_b16 v[20:21], v7 offset:512
s_add_u32 m0, s56, 0x16000
s_lshl_b32 s66, s43, 12
s_add_u32 s66, s66, 0x200
buffer_load_dwordx4 v4, s[16:19], s66 offen lds
v_mfma_f32_16x16x32_bf16 v[72:75], v[24:27], v[144:147], v[72:75]
ds_read_b64_tr_b16 v[22:23], v7 offset:1536
v_mfma_f32_16x16x32_bf16 v[104:107], v[24:27], v[148:151], v[104:107]
buffer_load_dwordx4 v[152:155], v5, s[20:23], s44 offen
s_waitcnt lgkmcnt(7)
v_mfma_f32_16x16x32_bf16 v[44:47], v[28:31], v[140:143], v[44:47]
ds_read_b64_tr_b16 v[24:25], v6 offset:768
v_mfma_f32_16x16x32_bf16 v[76:79], v[28:31], v[144:147], v[76:79]
ds_read_b64_tr_b16 v[26:27], v6 offset:1792
ds_write_b128 v202, v[168:171] offset:1024
s_add_u32 s67, s66, 0x7c00
buffer_load_dwordx4 v4, s[16:19], s67 offen offset:1024 lds
v_mfma_f32_16x16x32_bf16 v[108:111], v[28:31], v[148:151], v[108:111]
s_waitcnt lgkmcnt(7)
v_mfma_f32_16x16x32_bf16 v[48:51], v[16:19], v[140:143], v[48:51]
ds_read_b64_tr_b16 v[28:29], v7 offset:768
v_mfma_f32_16x16x32_bf16 v[80:83], v[16:19], v[144:147], v[80:83]
ds_read_b64_tr_b16 v[30:31], v7 offset:1792
buffer_load_dwordx4 v[156:159], v200, s[20:23], s44 offen
v_mfma_f32_16x16x32_bf16 v[112:115], v[16:19], v[148:151], v[112:115]
s_add_u32 m0, s56, 0
s_mov_b32 s58, 0x28000
buffer_load_dwordx4 v2, s[8:11], s58 offen nt lds
s_waitcnt lgkmcnt(5)
v_mfma_f32_16x16x32_bf16 v[52:55], v[20:23], v[140:143], v[52:55]
ds_read_b64_tr_b16 v[16:17], v6 offset:8192
ds_write_b128 v202, v[172:175] offset:1536
v_mfma_f32_16x16x32_bf16 v[84:87], v[20:23], v[144:147], v[84:87]
ds_read_b64_tr_b16 v[18:19], v6 offset:9216
v_mfma_f32_16x16x32_bf16 v[116:119], v[20:23], v[148:151], v[116:119]
buffer_load_dwordx4 v2, s[8:11], s58 offen offset:1024 nt lds
s_waitcnt lgkmcnt(6)
v_mfma_f32_16x16x32_bf16 v[56:59], v[24:27], v[140:143], v[56:59]
ds_read_b64_tr_b16 v[20:21], v7 offset:8192
ds_read_b128 v[136:139], v201 offset:3072
v_mfma_f32_16x16x32_bf16 v[88:91], v[24:27], v[144:147], v[88:91]
ds_read_b64_tr_b16 v[22:23], v7 offset:9216
v_mfma_f32_16x16x32_bf16 v[120:123], v[24:27], v[148:151], v[120:123]
s_waitcnt lgkmcnt(6)
v_mfma_f32_16x16x32_bf16 v[60:63], v[28:31], v[140:143], v[60:63]
ds_read_b64_tr_b16 v[24:25], v6 offset:8448
s_add_u32 s64, s44, 0x4800
buffer_load_dwordx4 v[160:163], v5, s[20:23], s64 offen
s_add_u32 m0, s57, 0xc000
s_mov_b32 s59, 0x24000
buffer_load_dwordx4 v3, s[12:15], s59 offen nt lds
v_mfma_f32_16x16x32_bf16 v[92:95], v[28:31], v[144:147], v[92:95]
ds_read_b64_tr_b16 v[26:27], v6 offset:9472
v_mfma_f32_16x16x32_bf16 v[124:127], v[28:31], v[148:151], v[124:127]
s_waitcnt lgkmcnt(3)
v_mfma_f32_16x16x32_bf16 v[32:35], v[16:19], v[128:131], v[32:35]
ds_read_b64_tr_b16 v[28:29], v7 offset:8448
v_mfma_f32_16x16x32_bf16 v[64:67], v[16:19], v[132:135], v[64:67]
ds_read_b64_tr_b16 v[30:31], v7 offset:9472
ds_read_b128 v[140:143], v11
ds_read_b128 v[144:147], v11 offset:2048
ds_read_b128 v[148:151], v11 offset:1024
s_add_u32 s64, s44, 0x4800
buffer_load_dwordx4 v[164:167], v200, s[20:23], s64 offen
buffer_load_dwordx4 v3, s[12:15], s59 offen offset:2048 nt lds
v_mfma_f32_16x16x32_bf16 v[96:99], v[16:19], v[136:139], v[96:99]
ds_write_b128 v10, v[176:179]
s_waitcnt lgkmcnt(8)
v_mfma_f32_16x16x32_bf16 v[36:39], v[20:23], v[128:131], v[36:39]
ds_read_b64_tr_b16 v[16:17], v6 offset:8704
s_add_u32 s64, s44, 0x9000
buffer_load_dwordx4 v[168:171], v5, s[20:23], s64 offen
ds_write_b128 v10, v[180:183] offset:512
v_mfma_f32_16x16x32_bf16 v[68:71], v[20:23], v[132:135], v[68:71]
ds_read_b64_tr_b16 v[18:19], v6 offset:9728
s_add_u32 s64, s44, 0x9000
buffer_load_dwordx4 v[172:175], v200, s[20:23], s64 offen
v_mfma_f32_16x16x32_bf16 v[100:103], v[20:23], v[136:139], v[100:103]
s_waitcnt lgkmcnt(9)
v_mfma_f32_16x16x32_bf16 v[40:43], v[24:27], v[128:131], v[40:43]
ds_read_b64_tr_b16 v[20:21], v7 offset:8704
v_mfma_f32_16x16x32_bf16 v[72:75], v[24:27], v[132:135], v[72:75]
ds_read_b64_tr_b16 v[22:23], v7 offset:9728
v_mfma_f32_16x16x32_bf16 v[104:107], v[24:27], v[136:139], v[104:107]
s_waitcnt lgkmcnt(9)
v_mfma_f32_16x16x32_bf16 v[44:47], v[28:31], v[128:131], v[44:47]
ds_read_b64_tr_b16 v[24:25], v6 offset:8960
v_mfma_f32_16x16x32_bf16 v[76:79], v[28:31], v[132:135], v[76:79]
ds_read_b64_tr_b16 v[26:27], v6 offset:9984
v_mfma_f32_16x16x32_bf16 v[108:111], v[28:31], v[136:139], v[108:111]
s_waitcnt lgkmcnt(4)
v_mfma_f32_16x16x32_bf16 v[48:51], v[16:19], v[128:131], v[48:51]
ds_read_b64_tr_b16 v[28:29], v7 offset:8960
v_mfma_f32_16x16x32_bf16 v[80:83], v[16:19], v[132:135], v[80:83]
ds_read_b64_tr_b16 v[30:31], v7 offset:9984
v_mfma_f32_16x16x32_bf16 v[112:115], v[16:19], v[136:139], v[112:115]
s_waitcnt lgkmcnt(4)
v_mfma_f32_16x16x32_bf16 v[52:55], v[20:23], v[128:131], v[52:55]
v_mfma_f32_16x16x32_bf16 v[84:87], v[20:23], v[132:135], v[84:87]
v_mfma_f32_16x16x32_bf16 v[116:119], v[20:23], v[136:139], v[116:119]
s_waitcnt lgkmcnt(2)
v_mfma_f32_16x16x32_bf16 v[56:59], v[24:27], v[128:131], v[56:59]
v_mfma_f32_16x16x32_bf16 v[88:91], v[24:27], v[132:135], v[88:91]
v_mfma_f32_16x16x32_bf16 v[120:123], v[24:27], v[136:139], v[120:123]
s_waitcnt vmcnt(12)
s_barrier
ds_read_b64_tr_b16 v[16:17], v6 offset:16384
ds_read_b64_tr_b16 v[18:19], v6 offset:17408
ds_read_b64_tr_b16 v[20:21], v7 offset:16384
ds_read_b64_tr_b16 v[22:23], v7 offset:17408
s_add_u32 m0, s56, 0x10000
s_lshl_b32 s66, s43, 12
s_add_u32 s66, s66, 0x40200
buffer_load_dwordx4 v4, s[16:19], s66 offen lds
s_waitcnt lgkmcnt(4)
v_mfma_f32_16x16x32_bf16 v[60:63], v[28:31], v[128:131], v[60:63]
ds_read_b64_tr_b16 v[24:25], v6 offset:16640
ds_write_b128 v10, v[184:187] offset:2048
s_add_u32 s67, s66, 0x7c00
buffer_load_dwordx4 v4, s[16:19], s67 offen offset:1024 lds
v_mfma_f32_16x16x32_bf16 v[92:95], v[28:31], v[132:135], v[92:95]
ds_read_b64_tr_b16 v[26:27], v6 offset:17664
v_mfma_f32_16x16x32_bf16 v[124:127], v[28:31], v[136:139], v[124:127]
s_waitcnt lgkmcnt(5)
v_mfma_f32_16x16x32_bf16 v[32:35], v[16:19], v[140:143], v[32:35]
ds_read_b64_tr_b16 v[28:29], v7 offset:16640
s_add_u32 m0, s56, 0x2000
s_mov_b32 s58, 0x2a000
buffer_load_dwordx4 v2, s[8:11], s58 offen nt lds
v_mfma_f32_16x16x32_bf16 v[64:67], v[16:19], v[144:147], v[64:67]
ds_read_b64_tr_b16 v[30:31], v7 offset:17664
ds_write_b128 v10, v[188:191] offset:2560
v_mfma_f32_16x16x32_bf16 v[96:99], v[16:19], v[148:151], v[96:99]
ds_read_b128 v[128:131], v201 offset:1024
ds_read_b128 v[132:135], v201 offset:3072
s_waitcnt lgkmcnt(8)
v_mfma_f32_16x16x32_bf16 v[36:39], v[20:23], v[140:143], v[36:39]
ds_read_b64_tr_b16 v[16:17], v6 offset:16896
buffer_load_dwordx4 v2, s[8:11], s58 offen offset:1024 nt lds
v_mfma_f32_16x16x32_bf16 v[68:71], v[20:23], v[144:147], v[68:71]
ds_read_b64_tr_b16 v[18:19], v6 offset:17920
buffer_load_dwordx4 v[176:179], v5, s[20:23], s45 offen
v_mfma_f32_16x16x32_bf16 v[100:103], v[20:23], v[148:151], v[100:103]
ds_write_b128 v202, v[192:195] offset:1024
s_waitcnt lgkmcnt(8)
v_mfma_f32_16x16x32_bf16 v[40:43], v[24:27], v[140:143], v[40:43]
ds_read_b64_tr_b16 v[20:21], v7 offset:16896
s_add_u32 m0, s57, 0xe000
s_mov_b32 s59, 0x26000
buffer_load_dwordx4 v3, s[12:15], s59 offen nt lds
v_mfma_f32_16x16x32_bf16 v[72:75], v[24:27], v[144:147], v[72:75]
ds_read_b64_tr_b16 v[22:23], v7 offset:17920
buffer_load_dwordx4 v[180:183], v200, s[20:23], s45 offen
v_mfma_f32_16x16x32_bf16 v[104:107], v[24:27], v[148:151], v[104:107]
ds_write_b128 v202, v[196:199] offset:1536
s_waitcnt lgkmcnt(9)
v_mfma_f32_16x16x32_bf16 v[44:47], v[28:31], v[140:143], v[44:47]
ds_read_b64_tr_b16 v[24:25], v6 offset:17152
buffer_load_dwordx4 v3, s[12:15], s59 offen offset:2048 nt lds
v_mfma_f32_16x16x32_bf16 v[76:79], v[28:31], v[144:147], v[76:79]
ds_read_b64_tr_b16 v[26:27], v6 offset:18176
ds_read_b128 v[136:139], v201 offset:3072
v_mfma_f32_16x16x32_bf16 v[108:111], v[28:31], v[148:151], v[108:111]
s_waitcnt lgkmcnt(7)
v_mfma_f32_16x16x32_bf16 v[48:51], v[16:19], v[140:143], v[48:51]
ds_read_b64_tr_b16 v[28:29], v7 offset:17152
s_add_u32 s64, s45, 0x4800
buffer_load_dwordx4 v[184:187], v5, s[20:23], s64 offen
v_mfma_f32_16x16x32_bf16 v[80:83], v[16:19], v[144:147], v[80:83]
ds_read_b64_tr_b16 v[30:31], v7 offset:18176
v_mfma_f32_16x16x32_bf16 v[112:115], v[16:19], v[148:151], v[112:115]
s_waitcnt lgkmcnt(6)
v_mfma_f32_16x16x32_bf16 v[52:55], v[20:23], v[140:143], v[52:55]
v_mfma_f32_16x16x32_bf16 v[84:87], v[20:23], v[144:147], v[84:87]
v_mfma_f32_16x16x32_bf16 v[116:119], v[20:23], v[148:151], v[116:119]
s_waitcnt lgkmcnt(3)
v_mfma_f32_16x16x32_bf16 v[56:59], v[24:27], v[140:143], v[56:59]
v_mfma_f32_16x16x32_bf16 v[88:91], v[24:27], v[144:147], v[88:91]
v_mfma_f32_16x16x32_bf16 v[120:123], v[24:27], v[148:151], v[120:123]
s_waitcnt lgkmcnt(0)
v_mfma_f32_16x16x32_bf16 v[60:63], v[28:31], v[140:143], v[60:63]
v_mfma_f32_16x16x32_bf16 v[92:95], v[28:31], v[144:147], v[92:95]
v_mfma_f32_16x16x32_bf16 v[124:127], v[28:31], v[148:151], v[124:127]
s_waitcnt vmcnt(7)
s_barrier
ds_read_b64_tr_b16 v[16:17], v6 offset:24576
ds_read_b64_tr_b16 v[18:19], v6 offset:25600
ds_read_b64_tr_b16 v[20:21], v7 offset:24576
ds_read_b64_tr_b16 v[22:23], v7 offset:25600
ds_read_b64_tr_b16 v[24:25], v6 offset:24832
ds_read_b64_tr_b16 v[26:27], v6 offset:25856
s_add_u32 m0, s56, 0x12000
s_lshl_b32 s66, s44, 12
s_add_u32 s66, s66, 0x200
buffer_load_dwordx4 v4, s[16:19], s66 offen lds
s_waitcnt lgkmcnt(4)
v_mfma_f32_16x16x32_bf16 v[32:35], v[16:19], v[128:131], v[32:35]
ds_read_b64_tr_b16 v[28:29], v7 offset:24832
s_add_u32 s67, s66, 0x7c00
buffer_load_dwordx4 v4, s[16:19], s67 offen offset:1024 lds
v_mfma_f32_16x16x32_bf16 v[64:67], v[16:19], v[132:135], v[64:67]
ds_read_b64_tr_b16 v[30:31], v7 offset:25856
ds_read_b128 v[140:143], v11
ds_read_b128 v[144:147], v11 offset:2048
ds_read_b128 v[148:151], v11 offset:1024
v_mfma_f32_16x16x32_bf16 v[96:99], v[16:19], v[136:139], v[96:99]
s_add_u32 m0, s56, 0x14000
s_lshl_b32 s66, s44, 12
s_add_u32 s66, s66, 0x40200
buffer_load_dwordx4 v4, s[16:19], s66 offen lds
s_waitcnt lgkmcnt(7)
v_mfma_f32_16x16x32_bf16 v[36:39], v[20:23], v[128:131], v[36:39]
ds_read_b64_tr_b16 v[16:17], v6 offset:25088
s_add_u32 s64, s45, 0x4800
buffer_load_dwordx4 v[188:191], v200, s[20:23], s64 offen
v_mfma_f32_16x16x32_bf16 v[68:71], v[20:23], v[132:135], v[68:71]
ds_read_b64_tr_b16 v[18:19], v6 offset:26112
s_add_u32 s67, s66, 0x7c00
buffer_load_dwordx4 v4, s[16:19], s67 offen offset:1024 lds
v_mfma_f32_16x16x32_bf16 v[100:103], v[20:23], v[136:139], v[100:103]
ds_write_b128 v10, v[152:155]
s_waitcnt lgkmcnt(8)
v_mfma_f32_16x16x32_bf16 v[40:43], v[24:27], v[128:131], v[40:43]
ds_read_b64_tr_b16 v[20:21], v7 offset:25088
s_add_u32 m0, s56, 0x4000
s_mov_b32 s58, 0x2c000
buffer_load_dwordx4 v2, s[8:11], s58 offen nt lds
v_mfma_f32_16x16x32_bf16 v[72:75], v[24:27], v[132:135], v[72:75]
ds_read_b64_tr_b16 v[22:23], v7 offset:26112
v_mfma_f32_16x16x32_bf16 v[104:107], v[24:27], v[136:139], v[104:107]
s_add_u32 s64, s45, 0x9000
buffer_load_dwordx4 v[192:195], v5, s[20:23], s64 offen
s_waitcnt lgkmcnt(8)
v_mfma_f32_16x16x32_bf16 v[44:47], v[28:31], v[128:131], v[44:47]
ds_read_b64_tr_b16 v[24:25], v6 offset:25344
buffer_load_dwordx4 v2, s[8:11], s58 offen offset:1024 nt lds
v_mfma_f32_16x16x32_bf16 v[76:79], v[28:31], v[132:135], v[76:79]
ds_read_b64_tr_b16 v[26:27], v6 offset:26368
ds_write_b128 v10, v[156:159] offset:512
v_mfma_f32_16x16x32_bf16 v[108:111], v[28:31], v[136:139], v[108:111]
s_add_u32 m0, s57, 0x8000
s_mov_b32 s59, 0x28000
buffer_load_dwordx4 v3, s[12:15], s59 offen nt lds
s_waitcnt lgkmcnt(6)
v_mfma_f32_16x16x32_bf16 v[48:51], v[16:19], v[128:131], v[48:51]
ds_read_b64_tr_b16 v[28:29], v7 offset:25344
s_add_u32 s64, s45, 0x9000
buffer_load_dwordx4 v[196:199], v200, s[20:23], s64 offen
v_mfma_f32_16x16x32_bf16 v[80:83], v[16:19], v[132:135], v[80:83]
ds_read_b64_tr_b16 v[30:31], v7 offset:26368
buffer_load_dwordx4 v3, s[12:15], s59 offen offset:2048 nt lds
v_mfma_f32_16x16x32_bf16 v[112:115], v[16:19], v[136:139], v[112:115]
s_waitcnt lgkmcnt(5)
v_mfma_f32_16x16x32_bf16 v[52:55], v[20:23], v[128:131], v[52:55]
ds_read_b64_tr_b16 v[16:17], v6
ds_write_b128 v10, v[160:163] offset:2048
v_mfma_f32_16x16x32_bf16 v[84:87], v[20:23], v[132:135], v[84:87]
ds_read_b64_tr_b16 v[18:19], v6 offset:1024
v_mfma_f32_16x16x32_bf16 v[116:119], v[20:23], v[136:139], v[116:119]
s_waitcnt lgkmcnt(6)
v_mfma_f32_16x16x32_bf16 v[56:59], v[24:27], v[128:131], v[56:59]
ds_read_b64_tr_b16 v[20:21], v7
v_mfma_f32_16x16x32_bf16 v[88:91], v[24:27], v[132:135], v[88:91]
ds_read_b64_tr_b16 v[22:23], v7 offset:1024
v_mfma_f32_16x16x32_bf16 v[120:123], v[24:27], v[136:139], v[120:123]
s_waitcnt lgkmcnt(5)
v_mfma_f32_16x16x32_bf16 v[60:63], v[28:31], v[128:131], v[60:63]
ds_read_b64_tr_b16 v[24:25], v6 offset:256
v_mfma_f32_16x16x32_bf16 v[92:95], v[28:31], v[132:135], v[92:95]
ds_read_b64_tr_b16 v[26:27], v6 offset:1280
v_mfma_f32_16x16x32_bf16 v[124:127], v[28:31], v[136:139], v[124:127]
s_waitcnt lgkmcnt(4)
v_mfma_f32_16x16x32_bf16 v[32:35], v[16:19], v[140:143], v[32:35]
ds_read_b64_tr_b16 v[28:29], v7 offset:256
v_mfma_f32_16x16x32_bf16 v[64:67], v[16:19], v[144:147], v[64:67]
ds_read_b64_tr_b16 v[30:31], v7 offset:1280
v_mfma_f32_16x16x32_bf16 v[96:99], v[16:19], v[148:151], v[96:99]
s_waitcnt vmcnt(9)
s_barrier
s_add_u32 m0, s56, 0x16000
s_lshl_b32 s66, s45, 12
s_add_u32 s66, s66, 0x200
buffer_load_dwordx4 v4, s[16:19], s66 offen lds
s_waitcnt lgkmcnt(4)
v_mfma_f32_16x16x32_bf16 v[36:39], v[20:23], v[140:143], v[36:39]
ds_read_b64_tr_b16 v[16:17], v6 offset:512
ds_write_b128 v10, v[164:167] offset:2560
s_add_u32 s67, s66, 0x7c00
buffer_load_dwordx4 v4, s[16:19], s67 offen offset:1024 lds
v_mfma_f32_16x16x32_bf16 v[68:71], v[20:23], v[144:147], v[68:71]
ds_read_b64_tr_b16 v[18:19], v6 offset:1536
v_mfma_f32_16x16x32_bf16 v[100:103], v[20:23], v[148:151], v[100:103]
ds_read_b128 v[128:131], v201 offset:1024
ds_read_b128 v[132:135], v201 offset:3072
s_add_u32 m0, s56, 0x6000
s_mov_b32 s58, 0x2e000
buffer_load_dwordx4 v2, s[8:11], s58 offen nt lds
s_waitcnt lgkmcnt(7)
v_mfma_f32_16x16x32_bf16 v[40:43], v[24:27], v[140:143], v[40:43]
ds_read_b64_tr_b16 v[20:21], v7 offset:512
v_mfma_f32_16x16x32_bf16 v[72:75], v[24:27], v[144:147], v[72:75]
ds_read_b64_tr_b16 v[22:23], v7 offset:1536
buffer_load_dwordx4 v[152:155], v5, s[20:23], s46 offen
v_mfma_f32_16x16x32_bf16 v[104:107], v[24:27], v[148:151], v[104:107]
buffer_load_dwordx4 v2, s[8:11], s58 offen offset:1024 nt lds
s_waitcnt lgkmcnt(7)
v_mfma_f32_16x16x32_bf16 v[44:47], v[28:31], v[140:143], v[44:47]
ds_read_b64_tr_b16 v[24:25], v6 offset:768
ds_write_b128 v202, v[168:171] offset:1024
v_mfma_f32_16x16x32_bf16 v[76:79], v[28:31], v[144:147], v[76:79]
ds_read_b64_tr_b16 v[26:27], v6 offset:1792
v_mfma_f32_16x16x32_bf16 v[108:111], v[28:31], v[148:151], v[108:111]
buffer_load_dwordx4 v[156:159], v200, s[20:23], s46 offen
s_add_u32 m0, s57, 0xa000
s_mov_b32 s59, 0x2a000
buffer_load_dwordx4 v3, s[12:15], s59 offen nt lds
s_waitcnt lgkmcnt(7)
v_mfma_f32_16x16x32_bf16 v[48:51], v[16:19], v[140:143], v[48:51]
ds_read_b64_tr_b16 v[28:29], v7 offset:768
v_mfma_f32_16x16x32_bf16 v[80:83], v[16:19], v[144:147], v[80:83]
ds_read_b64_tr_b16 v[30:31], v7 offset:1792
ds_write_b128 v202, v[172:175] offset:1536
buffer_load_dwordx4 v3, s[12:15], s59 offen offset:2048 nt lds
v_mfma_f32_16x16x32_bf16 v[112:115], v[16:19], v[148:151], v[112:115]
s_waitcnt lgkmcnt(6)
v_mfma_f32_16x16x32_bf16 v[52:55], v[20:23], v[140:143], v[52:55]
ds_read_b64_tr_b16 v[16:17], v6 offset:8192
ds_read_b128 v[136:139], v201 offset:3072
v_mfma_f32_16x16x32_bf16 v[84:87], v[20:23], v[144:147], v[84:87]
ds_read_b64_tr_b16 v[18:19], v6 offset:9216
s_add_u32 s75, s75, 0x480
buffer_load_dword v204, v203, s[28:31], s75 offen
v_mfma_f32_16x16x32_bf16 v[116:119], v[20:23], v[148:151], v[116:119]
s_waitcnt lgkmcnt(6)
v_mfma_f32_16x16x32_bf16 v[56:59], v[24:27], v[140:143], v[56:59]
ds_read_b64_tr_b16 v[20:21], v7 offset:8192
s_add_u32 s64, s46, 0x4800
buffer_load_dwordx4 v[160:163], v5, s[20:23], s64 offen
v_mfma_f32_16x16x32_bf16 v[88:91], v[24:27], v[144:147], v[88:91]
ds_read_b64_tr_b16 v[22:23], v7 offset:9216
v_mfma_f32_16x16x32_bf16 v[120:123], v[24:27], v[148:151], v[120:123]
s_waitcnt lgkmcnt(6)
v_mfma_f32_16x16x32_bf16 v[60:63], v[28:31], v[140:143], v[60:63]
ds_read_b64_tr_b16 v[24:25], v6 offset:8448
v_mfma_f32_16x16x32_bf16 v[92:95], v[28:31], v[144:147], v[92:95]
ds_read_b64_tr_b16 v[26:27], v6 offset:9472
v_mfma_f32_16x16x32_bf16 v[124:127], v[28:31], v[148:151], v[124:127]
s_waitcnt lgkmcnt(4)
v_mfma_f32_16x16x32_bf16 v[32:35], v[16:19], v[128:131], v[32:35]
ds_read_b64_tr_b16 v[28:29], v7 offset:8448
v_mfma_f32_16x16x32_bf16 v[64:67], v[16:19], v[132:135], v[64:67]
ds_read_b64_tr_b16 v[30:31], v7 offset:9472
v_mfma_f32_16x16x32_bf16 v[96:99], v[16:19], v[136:139], v[96:99]
s_waitcnt lgkmcnt(4)
v_mfma_f32_16x16x32_bf16 v[36:39], v[20:23], v[128:131], v[36:39]
ds_read_b64_tr_b16 v[16:17], v6 offset:8704
v_mfma_f32_16x16x32_bf16 v[68:71], v[20:23], v[132:135], v[68:71]
ds_read_b64_tr_b16 v[18:19], v6 offset:9728
v_mfma_f32_16x16x32_bf16 v[100:103], v[20:23], v[136:139], v[100:103]
s_waitcnt vmcnt(10)
s_barrier
s_add_u32 m0, s56, 0x10000
s_lshl_b32 s66, s45, 12
s_add_u32 s66, s66, 0x40200
buffer_load_dwordx4 v4, s[16:19], s66 offen lds
s_waitcnt lgkmcnt(4)
v_mfma_f32_16x16x32_bf16 v[40:43], v[24:27], v[128:131], v[40:43]
ds_read_b64_tr_b16 v[20:21], v7 offset:8704
ds_read_b128 v[140:143], v11
ds_read_b128 v[144:147], v11 offset:2048
ds_read_b128 v[148:151], v11 offset:1024
s_add_u32 s67, s66, 0x7c00
buffer_load_dwordx4 v4, s[16:19], s67 offen offset:1024 lds
v_mfma_f32_16x16x32_bf16 v[72:75], v[24:27], v[132:135], v[72:75]
ds_read_b64_tr_b16 v[22:23], v7 offset:9728
v_mfma_f32_16x16x32_bf16 v[104:107], v[24:27], v[136:139], v[104:107]
s_add_u32 s64, s46, 0x4800
buffer_load_dwordx4 v[164:167], v200, s[20:23], s64 offen
s_waitcnt lgkmcnt(7)
v_mfma_f32_16x16x32_bf16 v[44:47], v[28:31], v[128:131], v[44:47]
ds_read_b64_tr_b16 v[24:25], v6 offset:8960
s_add_u32 m0, s56, 0
s_mov_b32 s58, 0x30000
buffer_load_dwordx4 v2, s[8:11], s58 offen nt lds
v_mfma_f32_16x16x32_bf16 v[76:79], v[28:31], v[132:135], v[76:79]
ds_read_b64_tr_b16 v[26:27], v6 offset:9984
v_mfma_f32_16x16x32_bf16 v[108:111], v[28:31], v[136:139], v[108:111]
ds_write_b128 v10, v[176:179]
s_waitcnt lgkmcnt(8)
v_mfma_f32_16x16x32_bf16 v[48:51], v[16:19], v[128:131], v[48:51]
ds_read_b64_tr_b16 v[28:29], v7 offset:8960
buffer_load_dwordx4 v2, s[8:11], s58 offen offset:1024 nt lds
v_mfma_f32_16x16x32_bf16 v[80:83], v[16:19], v[132:135], v[80:83]
ds_read_b64_tr_b16 v[30:31], v7 offset:9984
s_add_u32 s64, s46, 0x9000
buffer_load_dwordx4 v[168:171], v5, s[20:23], s64 offen
v_mfma_f32_16x16x32_bf16 v[112:115], v[16:19], v[136:139], v[112:115]
s_waitcnt lgkmcnt(5)
v_mfma_f32_16x16x32_bf16 v[52:55], v[20:23], v[128:131], v[52:55]
ds_read_b64_tr_b16 v[16:17], v6 offset:16384
s_add_u32 m0, s57, 0xc000
s_mov_b32 s59, 0x2c000
buffer_load_dwordx4 v3, s[12:15], s59 offen nt lds
v_mfma_f32_16x16x32_bf16 v[84:87], v[20:23], v[132:135], v[84:87]
ds_read_b64_tr_b16 v[18:19], v6 offset:17408
ds_write_b128 v10, v[180:183] offset:512
v_mfma_f32_16x16x32_bf16 v[116:119], v[20:23], v[136:139], v[116:119]
s_waitcnt lgkmcnt(6)
v_mfma_f32_16x16x32_bf16 v[56:59], v[24:27], v[128:131], v[56:59]
ds_read_b64_tr_b16 v[20:21], v7 offset:16384
s_add_u32 s64, s46, 0x9000
buffer_load_dwordx4 v[172:175], v200, s[20:23], s64 offen
buffer_load_dwordx4 v3, s[12:15], s59 offen offset:2048 nt lds
v_mfma_f32_16x16x32_bf16 v[88:91], v[24:27], v[132:135], v[88:91]
ds_read_b64_tr_b16 v[22:23], v7 offset:17408
v_mfma_f32_16x16x32_bf16 v[120:123], v[24:27], v[136:139], v[120:123]
s_waitcnt lgkmcnt(5)
v_mfma_f32_16x16x32_bf16 v[60:63], v[28:31], v[128:131], v[60:63]
ds_read_b64_tr_b16 v[24:25], v6 offset:16640
ds_write_b128 v10, v[184:187] offset:2048
v_mfma_f32_16x16x32_bf16 v[92:95], v[28:31], v[132:135], v[92:95]
ds_read_b64_tr_b16 v[26:27], v6 offset:17664
v_mfma_f32_16x16x32_bf16 v[124:127], v[28:31], v[136:139], v[124:127]
s_waitcnt lgkmcnt(6)
v_mfma_f32_16x16x32_bf16 v[32:35], v[16:19], v[140:143], v[32:35]
ds_read_b64_tr_b16 v[28:29], v7 offset:16640
v_mfma_f32_16x16x32_bf16 v[64:67], v[16:19], v[144:147], v[64:67]
ds_read_b64_tr_b16 v[30:31], v7 offset:17664
v_mfma_f32_16x16x32_bf16 v[96:99], v[16:19], v[148:151], v[96:99]
s_waitcnt lgkmcnt(5)
v_mfma_f32_16x16x32_bf16 v[36:39], v[20:23], v[140:143], v[36:39]
ds_read_b64_tr_b16 v[16:17], v6 offset:16896
v_mfma_f32_16x16x32_bf16 v[68:71], v[20:23], v[144:147], v[68:71]
ds_read_b64_tr_b16 v[18:19], v6 offset:17920
v_mfma_f32_16x16x32_bf16 v[100:103], v[20:23], v[148:151], v[100:103]
s_waitcnt lgkmcnt(4)
v_mfma_f32_16x16x32_bf16 v[40:43], v[24:27], v[140:143], v[40:43]
ds_read_b64_tr_b16 v[20:21], v7 offset:16896
v_mfma_f32_16x16x32_bf16 v[72:75], v[24:27], v[144:147], v[72:75]
ds_read_b64_tr_b16 v[22:23], v7 offset:17920
v_mfma_f32_16x16x32_bf16 v[104:107], v[24:27], v[148:151], v[104:107]
s_waitcnt vmcnt(11)
s_barrier
s_add_u32 m0, s56, 0x12000
s_lshl_b32 s66, s46, 12
s_add_u32 s66, s66, 0x200
buffer_load_dwordx4 v4, s[16:19], s66 offen lds
s_waitcnt lgkmcnt(4)
v_mfma_f32_16x16x32_bf16 v[44:47], v[28:31], v[140:143], v[44:47]
ds_read_b64_tr_b16 v[24:25], v6 offset:17152
ds_write_b128 v10, v[188:191] offset:2560
s_add_u32 s67, s66, 0x7c00
buffer_load_dwordx4 v4, s[16:19], s67 offen offset:1024 lds
v_mfma_f32_16x16x32_bf16 v[76:79], v[28:31], v[144:147], v[76:79]
ds_read_b64_tr_b16 v[26:27], v6 offset:18176
ds_read_b128 v[128:131], v201 offset:1024
ds_read_b128 v[132:135], v201 offset:3072
v_mfma_f32_16x16x32_bf16 v[108:111], v[28:31], v[148:151], v[108:111]
s_waitcnt lgkmcnt(7)
v_mfma_f32_16x16x32_bf16 v[48:51], v[16:19], v[140:143], v[48:51]
ds_read_b64_tr_b16 v[28:29], v7 offset:17152
buffer_load_dwordx4 v[176:179], v5, s[20:23], s47 offen
s_add_u32 m0, s56, 0x2000
s_mov_b32 s58, 0x32000
buffer_load_dwordx4 v2, s[8:11], s58 offen nt lds
v_mfma_f32_16x16x32_bf16 v[80:83], v[16:19], v[144:147], v[80:83]
ds_read_b64_tr_b16 v[30:31], v7 offset:18176
v_mfma_f32_16x16x32_bf16 v[112:115], v[16:19], v[148:151], v[112:115]
ds_write_b128 v202, v[192:195] offset:1024
s_waitcnt lgkmcnt(8)
v_mfma_f32_16x16x32_bf16 v[52:55], v[20:23], v[140:143], v[52:55]
ds_read_b64_tr_b16 v[16:17], v6 offset:24576
buffer_load_dwordx4 v[180:183], v200, s[20:23], s47 offen
buffer_load_dwordx4 v2, s[8:11], s58 offen offset:1024 nt lds
v_mfma_f32_16x16x32_bf16 v[84:87], v[20:23], v[144:147], v[84:87]
ds_read_b64_tr_b16 v[18:19], v6 offset:25600
v_mfma_f32_16x16x32_bf16 v[116:119], v[20:23], v[148:151], v[116:119]
ds_write_b128 v202, v[196:199] offset:1536
s_waitcnt lgkmcnt(8)
v_mfma_f32_16x16x32_bf16 v[56:59], v[24:27], v[140:143], v[56:59]
ds_read_b64_tr_b16 v[20:21], v7 offset:24576
s_add_u32 m0, s57, 0xe000
s_mov_b32 s59, 0x2e000
buffer_load_dwordx4 v3, s[12:15], s59 offen nt lds
v_mfma_f32_16x16x32_bf16 v[88:91], v[24:27], v[144:147], v[88:91]
ds_read_b64_tr_b16 v[22:23], v7 offset:25600
ds_read_b128 v[136:139], v201 offset:3072
v_mfma_f32_16x16x32_bf16 v[120:123], v[24:27], v[148:151], v[120:123]
s_waitcnt lgkmcnt(7)
v_mfma_f32_16x16x32_bf16 v[60:63], v[28:31], v[140:143], v[60:63]
ds_read_b64_tr_b16 v[24:25], v6 offset:24832
s_add_u32 s64, s47, 0x4800
buffer_load_dwordx4 v[184:187], v5, s[20:23], s64 offen
buffer_load_dwordx4 v3, s[12:15], s59 offen offset:2048 nt lds
v_mfma_f32_16x16x32_bf16 v[92:95], v[28:31], v[144:147], v[92:95]
ds_read_b64_tr_b16 v[26:27], v6 offset:25856
v_mfma_f32_16x16x32_bf16 v[124:127], v[28:31], v[148:151], v[124:127]
s_waitcnt lgkmcnt(2)
v_mfma_f32_16x16x32_bf16 v[32:35], v[16:19], v[128:131], v[32:35]
ds_read_b64_tr_b16 v[28:29], v7 offset:24832
v_mfma_f32_16x16x32_bf16 v[64:67], v[16:19], v[132:135], v[64:67]
ds_read_b64_tr_b16 v[30:31], v7 offset:25856
v_mfma_f32_16x16x32_bf16 v[96:99], v[16:19], v[136:139], v[96:99]
v_mfma_f32_16x16x32_bf16 v[36:39], v[20:23], v[128:131], v[36:39]
ds_read_b64_tr_b16 v[16:17], v6 offset:25088
v_mfma_f32_16x16x32_bf16 v[68:71], v[20:23], v[132:135], v[68:71]
ds_read_b64_tr_b16 v[18:19], v6 offset:26112
v_mfma_f32_16x16x32_bf16 v[100:103], v[20:23], v[136:139], v[100:103]
s_waitcnt lgkmcnt(4)
v_mfma_f32_16x16x32_bf16 v[40:43], v[24:27], v[128:131], v[40:43]
ds_read_b64_tr_b16 v[20:21], v7 offset:25088
v_mfma_f32_16x16x32_bf16 v[72:75], v[24:27], v[132:135], v[72:75]
ds_read_b64_tr_b16 v[22:23], v7 offset:26112
v_mfma_f32_16x16x32_bf16 v[104:107], v[24:27], v[136:139], v[104:107]
s_waitcnt lgkmcnt(4)
v_mfma_f32_16x16x32_bf16 v[44:47], v[28:31], v[128:131], v[44:47]
ds_read_b64_tr_b16 v[24:25], v6 offset:25344
v_mfma_f32_16x16x32_bf16 v[76:79], v[28:31], v[132:135], v[76:79]
ds_read_b64_tr_b16 v[26:27], v6 offset:26368
v_mfma_f32_16x16x32_bf16 v[108:111], v[28:31], v[136:139], v[108:111]
s_waitcnt vmcnt(9)
s_barrier
s_add_u32 m0, s56, 0x14000
s_lshl_b32 s66, s46, 12
s_add_u32 s66, s66, 0x40200
buffer_load_dwordx4 v4, s[16:19], s66 offen lds
s_waitcnt lgkmcnt(4)
v_mfma_f32_16x16x32_bf16 v[48:51], v[16:19], v[128:131], v[48:51]
ds_read_b64_tr_b16 v[28:29], v7 offset:25344
ds_read_b128 v[140:143], v11
ds_read_b128 v[144:147], v11 offset:2048
ds_read_b128 v[148:151], v11 offset:1024
s_add_u32 s67, s66, 0x7c00
buffer_load_dwordx4 v4, s[16:19], s67 offen offset:1024 lds
v_mfma_f32_16x16x32_bf16 v[80:83], v[16:19], v[132:135], v[80:83]
ds_read_b64_tr_b16 v[30:31], v7 offset:26368
s_add_u32 s64, s47, 0x4800
buffer_load_dwordx4 v[188:191], v200, s[20:23], s64 offen
v_mfma_f32_16x16x32_bf16 v[112:115], v[16:19], v[136:139], v[112:115]
s_waitcnt lgkmcnt(7)
v_mfma_f32_16x16x32_bf16 v[52:55], v[20:23], v[128:131], v[52:55]
ds_read_b64_tr_b16 v[16:17], v6
ds_write_b128 v10, v[152:155]
s_add_u32 m0, s56, 0x4000
s_mov_b32 s58, 0x34000
buffer_load_dwordx4 v2, s[8:11], s58 offen nt lds
v_mfma_f32_16x16x32_bf16 v[84:87], v[20:23], v[132:135], v[84:87]
ds_read_b64_tr_b16 v[18:19], v6 offset:1024
s_add_u32 s64, s47, 0x9000
buffer_load_dwordx4 v[192:195], v5, s[20:23], s64 offen
v_mfma_f32_16x16x32_bf16 v[116:119], v[20:23], v[136:139], v[116:119]
s_waitcnt lgkmcnt(8)
v_mfma_f32_16x16x32_bf16 v[56:59], v[24:27], v[128:131], v[56:59]
ds_read_b64_tr_b16 v[20:21], v7
ds_write_b128 v10, v[156:159] offset:512
buffer_load_dwordx4 v2, s[8:11], s58 offen offset:1024 nt lds
v_mfma_f32_16x16x32_bf16 v[88:91], v[24:27], v[132:135], v[88:91]
ds_read_b64_tr_b16 v[22:23], v7 offset:1024
s_add_u32 s64, s47, 0x9000
buffer_load_dwordx4 v[196:199], v200, s[20:23], s64 offen
v_mfma_f32_16x16x32_bf16 v[120:123], v[24:27], v[136:139], v[120:123]
s_waitcnt lgkmcnt(6)
v_mfma_f32_16x16x32_bf16 v[60:63], v[28:31], v[128:131], v[60:63]
ds_read_b64_tr_b16 v[24:25], v6 offset:256
ds_write_b128 v10, v[160:163] offset:2048
s_add_u32 m0, s57, 0x8000
s_mov_b32 s59, 0x30000
buffer_load_dwordx4 v3, s[12:15], s59 offen nt lds
v_mfma_f32_16x16x32_bf16 v[92:95], v[28:31], v[132:135], v[92:95]
ds_read_b64_tr_b16 v[26:27], v6 offset:1280
v_mfma_f32_16x16x32_bf16 v[124:127], v[28:31], v[136:139], v[124:127]
s_waitcnt lgkmcnt(6)
v_mfma_f32_16x16x32_bf16 v[32:35], v[16:19], v[140:143], v[32:35]
ds_read_b64_tr_b16 v[28:29], v7 offset:256
buffer_load_dwordx4 v3, s[12:15], s59 offen offset:2048 nt lds
v_mfma_f32_16x16x32_bf16 v[64:67], v[16:19], v[144:147], v[64:67]
ds_read_b64_tr_b16 v[30:31], v7 offset:1280
ds_write_b128 v10, v[164:167] offset:2560
v_mfma_f32_16x16x32_bf16 v[96:99], v[16:19], v[148:151], v[96:99]
ds_read_b128 v[128:131], v201 offset:1024
ds_read_b128 v[132:135], v201 offset:3072
s_waitcnt lgkmcnt(8)
v_mfma_f32_16x16x32_bf16 v[36:39], v[20:23], v[140:143], v[36:39]
ds_read_b64_tr_b16 v[16:17], v6 offset:512
buffer_load_dwordx4 v[152:155], v5, s[20:23], s48 offen
v_mfma_f32_16x16x32_bf16 v[68:71], v[20:23], v[144:147], v[68:71]
ds_read_b64_tr_b16 v[18:19], v6 offset:1536
v_mfma_f32_16x16x32_bf16 v[100:103], v[20:23], v[148:151], v[100:103]
s_waitcnt lgkmcnt(7)
v_mfma_f32_16x16x32_bf16 v[40:43], v[24:27], v[140:143], v[40:43]
ds_read_b64_tr_b16 v[20:21], v7 offset:512
v_mfma_f32_16x16x32_bf16 v[72:75], v[24:27], v[144:147], v[72:75]
ds_read_b64_tr_b16 v[22:23], v7 offset:1536
v_mfma_f32_16x16x32_bf16 v[104:107], v[24:27], v[148:151], v[104:107]
s_waitcnt lgkmcnt(7)
v_mfma_f32_16x16x32_bf16 v[44:47], v[28:31], v[140:143], v[44:47]
ds_read_b64_tr_b16 v[24:25], v6 offset:768
v_mfma_f32_16x16x32_bf16 v[76:79], v[28:31], v[144:147], v[76:79]
ds_read_b64_tr_b16 v[26:27], v6 offset:1792
v_mfma_f32_16x16x32_bf16 v[108:111], v[28:31], v[148:151], v[108:111]
s_waitcnt lgkmcnt(4)
v_mfma_f32_16x16x32_bf16 v[48:51], v[16:19], v[140:143], v[48:51]
ds_read_b64_tr_b16 v[28:29], v7 offset:768
v_mfma_f32_16x16x32_bf16 v[80:83], v[16:19], v[144:147], v[80:83]
ds_read_b64_tr_b16 v[30:31], v7 offset:1792
v_mfma_f32_16x16x32_bf16 v[112:115], v[16:19], v[148:151], v[112:115]
s_waitcnt vmcnt(10)
s_barrier
s_add_u32 m0, s56, 0x16000
s_lshl_b32 s66, s47, 12
s_add_u32 s66, s66, 0x200
buffer_load_dwordx4 v4, s[16:19], s66 offen lds
s_waitcnt lgkmcnt(4)
v_mfma_f32_16x16x32_bf16 v[52:55], v[20:23], v[140:143], v[52:55]
ds_read_b64_tr_b16 v[16:17], v6 offset:8192
ds_write_b128 v202, v[168:171] offset:1024
s_add_u32 s67, s66, 0x7c00
buffer_load_dwordx4 v4, s[16:19], s67 offen offset:1024 lds
v_mfma_f32_16x16x32_bf16 v[84:87], v[20:23], v[144:147], v[84:87]
ds_read_b64_tr_b16 v[18:19], v6 offset:9216
v_mfma_f32_16x16x32_bf16 v[116:119], v[20:23], v[148:151], v[116:119]
buffer_load_dwordx4 v[156:159], v200, s[20:23], s48 offen
s_add_u32 m0, s56, 0x6000
s_mov_b32 s58, 0x36000
buffer_load_dwordx4 v2, s[8:11], s58 offen nt lds
s_waitcnt lgkmcnt(5)
v_mfma_f32_16x16x32_bf16 v[56:59], v[24:27], v[140:143], v[56:59]
ds_read_b64_tr_b16 v[20:21], v7 offset:8192
ds_write_b128 v202, v[172:175] offset:1536
v_mfma_f32_16x16x32_bf16 v[88:91], v[24:27], v[144:147], v[88:91]
ds_read_b64_tr_b16 v[22:23], v7 offset:9216
ds_read_b128 v[136:139], v201 offset:3072
v_mfma_f32_16x16x32_bf16 v[120:123], v[24:27], v[148:151], v[120:123]
buffer_load_dwordx4 v2, s[8:11], s58 offen offset:1024 nt lds
s_waitcnt lgkmcnt(7)
v_mfma_f32_16x16x32_bf16 v[60:63], v[28:31], v[140:143], v[60:63]
ds_read_b64_tr_b16 v[24:25], v6 offset:8448
s_add_u32 s64, s48, 0x4800
buffer_load_dwordx4 v[160:163], v5, s[20:23], s64 offen
v_mfma_f32_16x16x32_bf16 v[92:95], v[28:31], v[144:147], v[92:95]
ds_read_b64_tr_b16 v[26:27], v6 offset:9472
v_mfma_f32_16x16x32_bf16 v[124:127], v[28:31], v[148:151], v[124:127]
s_add_u32 m0, s57, 0xa000
s_mov_b32 s59, 0x32000
buffer_load_dwordx4 v3, s[12:15], s59 offen nt lds
s_waitcnt lgkmcnt(2)
v_mfma_f32_16x16x32_bf16 v[32:35], v[16:19], v[128:131], v[32:35]
ds_read_b64_tr_b16 v[28:29], v7 offset:8448
v_mfma_f32_16x16x32_bf16 v[64:67], v[16:19], v[132:135], v[64:67]
ds_read_b64_tr_b16 v[30:31], v7 offset:9472
ds_read_b128 v[140:143], v11
ds_read_b128 v[144:147], v11 offset:2048
ds_read_b128 v[148:151], v11 offset:1024
buffer_load_dwordx4 v3, s[12:15], s59 offen offset:2048 nt lds
v_mfma_f32_16x16x32_bf16 v[96:99], v[16:19], v[136:139], v[96:99]
s_add_u32 s64, s48, 0x4800
buffer_load_dwordx4 v[164:167], v200, s[20:23], s64 offen
v_mfma_f32_16x16x32_bf16 v[36:39], v[20:23], v[128:131], v[36:39]
ds_read_b64_tr_b16 v[16:17], v6 offset:8704
v_mfma_f32_16x16x32_bf16 v[68:71], v[20:23], v[132:135], v[68:71]
ds_read_b64_tr_b16 v[18:19], v6 offset:9728
ds_write_b128 v10, v[176:179]
s_add_u32 s75, s75, 0x480
buffer_load_dword v204, v203, s[28:31], s75 offen
v_mfma_f32_16x16x32_bf16 v[100:103], v[20:23], v[136:139], v[100:103]
s_add_u32 s64, s48, 0x9000
buffer_load_dwordx4 v[168:171], v5, s[20:23], s64 offen
s_waitcnt lgkmcnt(8)
v_mfma_f32_16x16x32_bf16 v[40:43], v[24:27], v[128:131], v[40:43]
ds_read_b64_tr_b16 v[20:21], v7 offset:8704
v_mfma_f32_16x16x32_bf16 v[72:75], v[24:27], v[132:135], v[72:75]
ds_read_b64_tr_b16 v[22:23], v7 offset:9728
v_mfma_f32_16x16x32_bf16 v[104:107], v[24:27], v[136:139], v[104:107]
s_waitcnt lgkmcnt(8)
v_mfma_f32_16x16x32_bf16 v[44:47], v[28:31], v[128:131], v[44:47]
ds_read_b64_tr_b16 v[24:25], v6 offset:8960
v_mfma_f32_16x16x32_bf16 v[76:79], v[28:31], v[132:135], v[76:79]
ds_read_b64_tr_b16 v[26:27], v6 offset:9984
v_mfma_f32_16x16x32_bf16 v[108:111], v[28:31], v[136:139], v[108:111]
s_waitcnt lgkmcnt(5)
v_mfma_f32_16x16x32_bf16 v[48:51], v[16:19], v[128:131], v[48:51]
ds_read_b64_tr_b16 v[28:29], v7 offset:8960
v_mfma_f32_16x16x32_bf16 v[80:83], v[16:19], v[132:135], v[80:83]
ds_read_b64_tr_b16 v[30:31], v7 offset:9984
v_mfma_f32_16x16x32_bf16 v[112:115], v[16:19], v[136:139], v[112:115]
s_waitcnt lgkmcnt(4)
v_mfma_f32_16x16x32_bf16 v[52:55], v[20:23], v[128:131], v[52:55]
v_mfma_f32_16x16x32_bf16 v[84:87], v[20:23], v[132:135], v[84:87]
v_mfma_f32_16x16x32_bf16 v[116:119], v[20:23], v[136:139], v[116:119]
s_waitcnt vmcnt(12)
s_barrier
ds_read_b64_tr_b16 v[16:17], v6 offset:16384
ds_read_b64_tr_b16 v[18:19], v6 offset:17408
s_add_u32 m0, s56, 0x10000
s_lshl_b32 s66, s47, 12
s_add_u32 s66, s66, 0x40200
buffer_load_dwordx4 v4, s[16:19], s66 offen lds
s_waitcnt lgkmcnt(4)
v_mfma_f32_16x16x32_bf16 v[56:59], v[24:27], v[128:131], v[56:59]
ds_read_b64_tr_b16 v[20:21], v7 offset:16384
ds_write_b128 v10, v[180:183] offset:512
s_add_u32 s67, s66, 0x7c00
buffer_load_dwordx4 v4, s[16:19], s67 offen offset:1024 lds
v_mfma_f32_16x16x32_bf16 v[88:91], v[24:27], v[132:135], v[88:91]
ds_read_b64_tr_b16 v[22:23], v7 offset:17408
s_add_u32 s64, s48, 0x9000
buffer_load_dwordx4 v[172:175], v200, s[20:23], s64 offen
v_mfma_f32_16x16x32_bf16 v[120:123], v[24:27], v[136:139], v[120:123]
s_waitcnt lgkmcnt(5)
v_mfma_f32_16x16x32_bf16 v[60:63], v[28:31], v[128:131], v[60:63]
ds_read_b64_tr_b16 v[24:25], v6 offset:16640
ds_write_b128 v10, v[184:187] offset:2048
s_add_u32 m0, s56, 0
s_mov_b32 s58, 0x38000
buffer_load_dwordx4 v2, s[8:11], s58 offen nt lds
v_mfma_f32_16x16x32_bf16 v[92:95], v[28:31], v[132:135], v[92:95]
ds_read_b64_tr_b16 v[26:27], v6 offset:17664
v_mfma_f32_16x16x32_bf16 v[124:127], v[28:31], v[136:139], v[124:127]
s_waitcnt lgkmcnt(6)
v_mfma_f32_16x16x32_bf16 v[32:35], v[16:19], v[140:143], v[32:35]
ds_read_b64_tr_b16 v[28:29], v7 offset:16640
buffer_load_dwordx4 v2, s[8:11], s58 offen offset:1024 nt lds
v_mfma_f32_16x16x32_bf16 v[64:67], v[16:19], v[144:147], v[64:67]
ds_read_b64_tr_b16 v[30:31], v7 offset:17664
ds_write_b128 v10, v[188:191] offset:2560
v_mfma_f32_16x16x32_bf16 v[96:99], v[16:19], v[148:151], v[96:99]
ds_read_b128 v[128:131], v201 offset:1024
ds_read_b128 v[132:135], v201 offset:3072
s_waitcnt lgkmcnt(8)
v_mfma_f32_16x16x32_bf16 v[36:39], v[20:23], v[140:143], v[36:39]
ds_read_b64_tr_b16 v[16:17], v6 offset:16896
buffer_load_dwordx4 v[176:179], v5, s[20:23], s40 offen
s_add_u32 m0, s57, 0xc000
s_mov_b32 s59, 0x34000
buffer_load_dwordx4 v3, s[12:15], s59 offen nt lds
v_mfma_f32_16x16x32_bf16 v[68:71], v[20:23], v[144:147], v[68:71]
ds_read_b64_tr_b16 v[18:19], v6 offset:17920
ds_write_b128 v202, v[192:195] offset:1024
v_mfma_f32_16x16x32_bf16 v[100:103], v[20:23], v[148:151], v[100:103]
s_waitcnt lgkmcnt(8)
v_mfma_f32_16x16x32_bf16 v[40:43], v[24:27], v[140:143], v[40:43]
ds_read_b64_tr_b16 v[20:21], v7 offset:16896
buffer_load_dwordx4 v[180:183], v200, s[20:23], s40 offen
buffer_load_dwordx4 v3, s[12:15], s59 offen offset:2048 nt lds
v_mfma_f32_16x16x32_bf16 v[72:75], v[24:27], v[144:147], v[72:75]
ds_read_b64_tr_b16 v[22:23], v7 offset:17920
ds_write_b128 v202, v[196:199] offset:1536
v_mfma_f32_16x16x32_bf16 v[104:107], v[24:27], v[148:151], v[104:107]
ds_read_b128 v[136:139], v201 offset:3072
s_waitcnt lgkmcnt(10)
v_mfma_f32_16x16x32_bf16 v[44:47], v[28:31], v[140:143], v[44:47]
ds_read_b64_tr_b16 v[24:25], v6 offset:17152
v_mfma_f32_16x16x32_bf16 v[76:79], v[28:31], v[144:147], v[76:79]
ds_read_b64_tr_b16 v[26:27], v6 offset:18176
v_mfma_f32_16x16x32_bf16 v[108:111], v[28:31], v[148:151], v[108:111]
s_waitcnt lgkmcnt(7)
v_mfma_f32_16x16x32_bf16 v[48:51], v[16:19], v[140:143], v[48:51]
ds_read_b64_tr_b16 v[28:29], v7 offset:17152
v_mfma_f32_16x16x32_bf16 v[80:83], v[16:19], v[144:147], v[80:83]
ds_read_b64_tr_b16 v[30:31], v7 offset:18176
v_mfma_f32_16x16x32_bf16 v[112:115], v[16:19], v[148:151], v[112:115]
s_waitcnt lgkmcnt(6)
v_mfma_f32_16x16x32_bf16 v[52:55], v[20:23], v[140:143], v[52:55]
v_mfma_f32_16x16x32_bf16 v[84:87], v[20:23], v[144:147], v[84:87]
v_mfma_f32_16x16x32_bf16 v[116:119], v[20:23], v[148:151], v[116:119]
s_waitcnt lgkmcnt(2)
v_mfma_f32_16x16x32_bf16 v[56:59], v[24:27], v[140:143], v[56:59]
v_mfma_f32_16x16x32_bf16 v[88:91], v[24:27], v[144:147], v[88:91]
v_mfma_f32_16x16x32_bf16 v[120:123], v[24:27], v[148:151], v[120:123]
s_waitcnt vmcnt(12)
s_barrier
ds_read_b64_tr_b16 v[16:17], v6 offset:24576
ds_read_b64_tr_b16 v[18:19], v6 offset:25600
ds_read_b64_tr_b16 v[20:21], v7 offset:24576
ds_read_b64_tr_b16 v[22:23], v7 offset:25600
s_add_u32 m0, s56, 0x12000
s_lshl_b32 s66, s48, 12
s_add_u32 s66, s66, 0x200
buffer_load_dwordx4 v4, s[16:19], s66 offen lds
s_waitcnt lgkmcnt(4)
v_mfma_f32_16x16x32_bf16 v[60:63], v[28:31], v[140:143], v[60:63]
ds_read_b64_tr_b16 v[24:25], v6 offset:24832
s_add_u32 s64, s40, 0x4800
buffer_load_dwordx4 v[184:187], v5, s[20:23], s64 offen
s_add_u32 s67, s66, 0x7c00
buffer_load_dwordx4 v4, s[16:19], s67 offen offset:1024 lds
v_mfma_f32_16x16x32_bf16 v[92:95], v[28:31], v[144:147], v[92:95]
ds_read_b64_tr_b16 v[26:27], v6 offset:25856
v_mfma_f32_16x16x32_bf16 v[124:127], v[28:31], v[148:151], v[124:127]
s_waitcnt lgkmcnt(4)
v_mfma_f32_16x16x32_bf16 v[32:35], v[16:19], v[128:131], v[32:35]
ds_read_b64_tr_b16 v[28:29], v7 offset:24832
s_add_u32 m0, s56, 0x2000
s_mov_b32 s58, 0x3a000
buffer_load_dwordx4 v2, s[8:11], s58 offen nt lds
v_mfma_f32_16x16x32_bf16 v[64:67], v[16:19], v[132:135], v[64:67]
ds_read_b64_tr_b16 v[30:31], v7 offset:25856
ds_read_b128 v[140:143], v11
ds_read_b128 v[144:147], v11 offset:2048
ds_read_b128 v[148:151], v11 offset:1024
v_mfma_f32_16x16x32_bf16 v[96:99], v[16:19], v[136:139], v[96:99]
s_add_u32 s64, s40, 0x4800
buffer_load_dwordx4 v[188:191], v200, s[20:23], s64 offen
s_waitcnt lgkmcnt(7)
v_mfma_f32_16x16x32_bf16 v[36:39], v[20:23], v[128:131], v[36:39]
ds_read_b64_tr_b16 v[16:17], v6 offset:25088
buffer_load_dwordx4 v2, s[8:11], s58 offen offset:1024 nt lds
v_mfma_f32_16x16x32_bf16 v[68:71], v[20:23], v[132:135], v[68:71]
ds_read_b64_tr_b16 v[18:19], v6 offset:26112
ds_write_b128 v10, v[152:155]
v_mfma_f32_16x16x32_bf16 v[100:103], v[20:23], v[136:139], v[100:103]
s_waitcnt lgkmcnt(8)
v_mfma_f32_16x16x32_bf16 v[40:43], v[24:27], v[128:131], v[40:43]
ds_read_b64_tr_b16 v[20:21], v7 offset:25088
s_add_u32 s64, s40, 0x9000
buffer_load_dwordx4 v[192:195], v5, s[20:23], s64 offen
s_add_u32 m0, s57, 0xe000
s_mov_b32 s59, 0x36000
buffer_load_dwordx4 v3, s[12:15], s59 offen nt lds
v_mfma_f32_16x16x32_bf16 v[72:75], v[24:27], v[132:135], v[72:75]
ds_read_b64_tr_b16 v[22:23], v7 offset:26112
v_mfma_f32_16x16x32_bf16 v[104:107], v[24:27], v[136:139], v[104:107]
ds_write_b128 v10, v[156:159] offset:512
s_waitcnt lgkmcnt(9)
v_mfma_f32_16x16x32_bf16 v[44:47], v[28:31], v[128:131], v[44:47]
ds_read_b64_tr_b16 v[24:25], v6 offset:25344
buffer_load_dwordx4 v3, s[12:15], s59 offen offset:2048 nt lds
v_mfma_f32_16x16x32_bf16 v[76:79], v[28:31], v[132:135], v[76:79]
ds_read_b64_tr_b16 v[26:27], v6 offset:26368
s_add_u32 s64, s40, 0x9000
buffer_load_dwordx4 v[196:199], v200, s[20:23], s64 offen
v_mfma_f32_16x16x32_bf16 v[108:111], v[28:31], v[136:139], v[108:111]
s_waitcnt lgkmcnt(6)
v_mfma_f32_16x16x32_bf16 v[48:51], v[16:19], v[128:131], v[48:51]
ds_read_b64_tr_b16 v[28:29], v7 offset:25344
ds_write_b128 v10, v[160:163] offset:2048
v_mfma_f32_16x16x32_bf16 v[80:83], v[16:19], v[132:135], v[80:83]
ds_read_b64_tr_b16 v[30:31], v7 offset:26368
v_mfma_f32_16x16x32_bf16 v[112:115], v[16:19], v[136:139], v[112:115]
s_waitcnt lgkmcnt(6)
v_mfma_f32_16x16x32_bf16 v[52:55], v[20:23], v[128:131], v[52:55]
v_mfma_f32_16x16x32_bf16 v[84:87], v[20:23], v[132:135], v[84:87]
v_mfma_f32_16x16x32_bf16 v[116:119], v[20:23], v[136:139], v[116:119]
s_waitcnt lgkmcnt(3)
v_mfma_f32_16x16x32_bf16 v[56:59], v[24:27], v[128:131], v[56:59]
v_mfma_f32_16x16x32_bf16 v[88:91], v[24:27], v[132:135], v[88:91]
v_mfma_f32_16x16x32_bf16 v[120:123], v[24:27], v[136:139], v[120:123]
s_waitcnt lgkmcnt(0)
v_mfma_f32_16x16x32_bf16 v[60:63], v[28:31], v[128:131], v[60:63]
v_mfma_f32_16x16x32_bf16 v[92:95], v[28:31], v[132:135], v[92:95]
v_mfma_f32_16x16x32_bf16 v[124:127], v[28:31], v[136:139], v[124:127]
s_waitcnt vmcnt(7)
s_barrier
ds_read_b64_tr_b16 v[16:17], v6
ds_read_b64_tr_b16 v[18:19], v6 offset:1024
ds_read_b64_tr_b16 v[20:21], v7
ds_read_b64_tr_b16 v[22:23], v7 offset:1024
ds_read_b64_tr_b16 v[24:25], v6 offset:256
ds_read_b64_tr_b16 v[26:27], v6 offset:1280
s_add_u32 m0, s56, 0x14000
s_lshl_b32 s66, s48, 12
s_add_u32 s66, s66, 0x40200
buffer_load_dwordx4 v4, s[16:19], s66 offen lds
s_waitcnt lgkmcnt(4)
v_mfma_f32_16x16x32_bf16 v[32:35], v[16:19], v[140:143], v[32:35]
ds_read_b64_tr_b16 v[28:29], v7 offset:256
s_add_u32 s67, s66, 0x7c00
buffer_load_dwordx4 v4, s[16:19], s67 offen offset:1024 lds
v_mfma_f32_16x16x32_bf16 v[64:67], v[16:19], v[144:147], v[64:67]
ds_read_b64_tr_b16 v[30:31], v7 offset:1280
ds_write_b128 v10, v[164:167] offset:2560
v_mfma_f32_16x16x32_bf16 v[96:99], v[16:19], v[148:151], v[96:99]
s_add_u32 m0, s56, 0x16000
s_lshl_b32 s66, s40, 12
s_add_u32 s66, s66, 0x300
buffer_load_dwordx4 v4, s[16:19], s66 offen lds
s_waitcnt lgkmcnt(5)
v_mfma_f32_16x16x32_bf16 v[36:39], v[20:23], v[140:143], v[36:39]
ds_read_b64_tr_b16 v[16:17], v6 offset:512
ds_read_b128 v[128:131], v201 offset:1024
ds_read_b128 v[132:135], v201 offset:3072
v_mfma_f32_16x16x32_bf16 v[68:71], v[20:23], v[144:147], v[68:71]
ds_read_b64_tr_b16 v[18:19], v6 offset:1536
s_add_u32 s67, s66, 0x7c00
buffer_load_dwordx4 v4, s[16:19], s67 offen offset:1024 lds
v_mfma_f32_16x16x32_bf16 v[100:103], v[20:23], v[148:151], v[100:103]
buffer_load_dwordx4 v[152:155], v5, s[20:23], s41 offen
s_waitcnt lgkmcnt(7)
v_mfma_f32_16x16x32_bf16 v[40:43], v[24:27], v[140:143], v[40:43]
ds_read_b64_tr_b16 v[20:21], v7 offset:512
s_add_u32 m0, s56, 0x4000
s_mov_b32 s58, 0x3c000
buffer_load_dwordx4 v2, s[8:11], s58 offen nt lds
v_mfma_f32_16x16x32_bf16 v[72:75], v[24:27], v[144:147], v[72:75]
ds_read_b64_tr_b16 v[22:23], v7 offset:1536
ds_write_b128 v202, v[168:171] offset:1024
v_mfma_f32_16x16x32_bf16 v[104:107], v[24:27], v[148:151], v[104:107]
s_waitcnt lgkmcnt(8)
v_mfma_f32_16x16x32_bf16 v[44:47], v[28:31], v[140:143], v[44:47]
ds_read_b64_tr_b16 v[24:25], v6 offset:768
buffer_load_dwordx4 v[156:159], v200, s[20:23], s41 offen
buffer_load_dwordx4 v2, s[8:11], s58 offen offset:1024 nt lds
v_mfma_f32_16x16x32_bf16 v[76:79], v[28:31], v[144:147], v[76:79]
ds_read_b64_tr_b16 v[26:27], v6 offset:1792
v_mfma_f32_16x16x32_bf16 v[108:111], v[28:31], v[148:151], v[108:111]
ds_write_b128 v202, v[172:175] offset:1536
s_add_u32 m0, s57, 0x8000
s_mov_b32 s59, 0x38000
buffer_load_dwordx4 v3, s[12:15], s59 offen nt lds
s_waitcnt lgkmcnt(6)
v_mfma_f32_16x16x32_bf16 v[48:51], v[16:19], v[140:143], v[48:51]
ds_read_b64_tr_b16 v[28:29], v7 offset:768
v_mfma_f32_16x16x32_bf16 v[80:83], v[16:19], v[144:147], v[80:83]
ds_read_b64_tr_b16 v[30:31], v7 offset:1792
ds_read_b128 v[136:139], v201 offset:3072
buffer_load_dwordx4 v3, s[12:15], s59 offen offset:2048 nt lds
v_mfma_f32_16x16x32_bf16 v[112:115], v[16:19], v[148:151], v[112:115]
s_waitcnt lgkmcnt(7)
v_mfma_f32_16x16x32_bf16 v[52:55], v[20:23], v[140:143], v[52:55]
ds_read_b64_tr_b16 v[16:17], v6 offset:8192
s_add_u32 s64, s41, 0x4800
buffer_load_dwordx4 v[160:163], v5, s[20:23], s64 offen
v_mfma_f32_16x16x32_bf16 v[84:87], v[20:23], v[144:147], v[84:87]
ds_read_b64_tr_b16 v[18:19], v6 offset:9216
v_mfma_f32_16x16x32_bf16 v[116:119], v[20:23], v[148:151], v[116:119]
s_waitcnt lgkmcnt(6)
v_mfma_f32_16x16x32_bf16 v[56:59], v[24:27], v[140:143], v[56:59]
ds_read_b64_tr_b16 v[20:21], v7 offset:8192
v_mfma_f32_16x16x32_bf16 v[88:91], v[24:27], v[144:147], v[88:91]
ds_read_b64_tr_b16 v[22:23], v7 offset:9216
v_mfma_f32_16x16x32_bf16 v[120:123], v[24:27], v[148:151], v[120:123]
s_waitcnt lgkmcnt(5)
v_mfma_f32_16x16x32_bf16 v[60:63], v[28:31], v[140:143], v[60:63]
ds_read_b64_tr_b16 v[24:25], v6 offset:8448
v_mfma_f32_16x16x32_bf16 v[92:95], v[28:31], v[144:147], v[92:95]
ds_read_b64_tr_b16 v[26:27], v6 offset:9472
v_mfma_f32_16x16x32_bf16 v[124:127], v[28:31], v[148:151], v[124:127]
s_waitcnt lgkmcnt(4)
v_mfma_f32_16x16x32_bf16 v[32:35], v[16:19], v[128:131], v[32:35]
ds_read_b64_tr_b16 v[28:29], v7 offset:8448
v_mfma_f32_16x16x32_bf16 v[64:67], v[16:19], v[132:135], v[64:67]
ds_read_b64_tr_b16 v[30:31], v7 offset:9472
v_mfma_f32_16x16x32_bf16 v[96:99], v[16:19], v[136:139], v[96:99]
s_waitcnt vmcnt(9)
s_barrier
s_add_u32 m0, s56, 0x10000
s_lshl_b32 s66, s40, 12
s_add_u32 s66, s66, 0x40300
buffer_load_dwordx4 v4, s[16:19], s66 offen lds
s_waitcnt lgkmcnt(4)
v_mfma_f32_16x16x32_bf16 v[36:39], v[20:23], v[128:131], v[36:39]
ds_read_b64_tr_b16 v[16:17], v6 offset:8704
ds_read_b128 v[140:143], v11
ds_read_b128 v[144:147], v11 offset:2048
ds_read_b128 v[148:151], v11 offset:1024
s_add_u32 s67, s66, 0x7c00
buffer_load_dwordx4 v4, s[16:19], s67 offen offset:1024 lds
v_mfma_f32_16x16x32_bf16 v[68:71], v[20:23], v[132:135], v[68:71]
ds_read_b64_tr_b16 v[18:19], v6 offset:9728
v_mfma_f32_16x16x32_bf16 v[100:103], v[20:23], v[136:139], v[100:103]
s_add_u32 s64, s41, 0x4800
buffer_load_dwordx4 v[164:167], v200, s[20:23], s64 offen
s_add_u32 m0, s56, 0x6000
s_mov_b32 s58, 0x3e000
buffer_load_dwordx4 v2, s[8:11], s58 offen nt lds
s_waitcnt lgkmcnt(7)
v_mfma_f32_16x16x32_bf16 v[40:43], v[24:27], v[128:131], v[40:43]
ds_read_b64_tr_b16 v[20:21], v7 offset:8704
v_mfma_f32_16x16x32_bf16 v[72:75], v[24:27], v[132:135], v[72:75]
ds_read_b64_tr_b16 v[22:23], v7 offset:9728
v_mfma_f32_16x16x32_bf16 v[104:107], v[24:27], v[136:139], v[104:107]
ds_write_b128 v10, v[176:179]
v_and_b32 v1, -16, v8
ds_read_b128 v[208:211], v1
ds_read_b128 v[224:227], v1 offset:4096
ds_read_b128 v[240:243], v1 offset:8192
buffer_load_dwordx4 v2, s[8:11], s58 offen offset:1024 nt lds
s_waitcnt lgkmcnt(11)
v_mfma_f32_16x16x32_bf16 v[44:47], v[28:31], v[128:131], v[44:47]
ds_read_b64_tr_b16 v[24:25], v6 offset:8960
v_mfma_f32_16x16x32_bf16 v[76:79], v[28:31], v[132:135], v[76:79]
ds_read_b64_tr_b16 v[26:27], v6 offset:9984
s_add_u32 s64, s41, 0x9000
buffer_load_dwordx4 v[168:171], v5, s[20:23], s64 offen
v_mfma_f32_16x16x32_bf16 v[108:111], v[28:31], v[136:139], v[108:111]
ds_read_b128 v[212:215], v1 offset:1024
ds_read_b128 v[228:231], v1 offset:5120
ds_read_b128 v[244:247], v1 offset:9216
s_add_u32 m0, s57, 0xa000
s_mov_b32 s59, 0x3a000
buffer_load_dwordx4 v3, s[12:15], s59 offen nt lds
s_waitcnt lgkmcnt(11)
v_mfma_f32_16x16x32_bf16 v[48:51], v[16:19], v[128:131], v[48:51]
ds_read_b64_tr_b16 v[28:29], v7 offset:8960
v_mfma_f32_16x16x32_bf16 v[80:83], v[16:19], v[132:135], v[80:83]
ds_read_b64_tr_b16 v[30:31], v7 offset:9984
ds_write_b128 v10, v[180:183] offset:512
buffer_load_dwordx4 v3, s[12:15], s59 offen offset:2048 nt lds
v_mfma_f32_16x16x32_bf16 v[112:115], v[16:19], v[136:139], v[112:115]
ds_read_b128 v[216:219], v1 offset:2048
ds_read_b128 v[232:235], v1 offset:6144
ds_read_b128 v[248:251], v1 offset:10240
s_waitcnt lgkmcnt(15)
v_mfma_f32_16x16x32_bf16 v[52:55], v[20:23], v[128:131], v[52:55]
ds_read_b64_tr_b16 v[16:17], v6 offset:16384
s_add_u32 s64, s41, 0x9000
buffer_load_dwordx4 v[172:175], v200, s[20:23], s64 offen
v_mfma_f32_16x16x32_bf16 v[84:87], v[20:23], v[132:135], v[84:87]
ds_read_b64_tr_b16 v[18:19], v6 offset:17408
s_add_u32 s75, s75, 0x480
buffer_load_dword v204, v203, s[28:31], s75 offen
v_mfma_f32_16x16x32_bf16 v[116:119], v[20:23], v[136:139], v[116:119]
s_waitcnt lgkmcnt(11)
v_mfma_f32_16x16x32_bf16 v[56:59], v[24:27], v[128:131], v[56:59]
ds_read_b64_tr_b16 v[20:21], v7 offset:16384
ds_write_b128 v10, v[184:187] offset:2048
ds_read_b128 v[220:223], v1 offset:3072
ds_read_b128 v[236:239], v1 offset:7168
ds_read_b128 v[252:255], v1 offset:11264
v_mfma_f32_16x16x32_bf16 v[88:91], v[24:27], v[132:135], v[88:91]
ds_read_b64_tr_b16 v[22:23], v7 offset:17408
v_mfma_f32_16x16x32_bf16 v[120:123], v[24:27], v[136:139], v[120:123]
s_waitcnt lgkmcnt(12)
v_mfma_f32_16x16x32_bf16 v[60:63], v[28:31], v[128:131], v[60:63]
ds_read_b64_tr_b16 v[24:25], v6 offset:16640
v_mfma_f32_16x16x32_bf16 v[92:95], v[28:31], v[132:135], v[92:95]
ds_read_b64_tr_b16 v[26:27], v6 offset:17664
v_mfma_f32_16x16x32_bf16 v[124:127], v[28:31], v[136:139], v[124:127]
s_waitcnt lgkmcnt(8)
v_mfma_f32_16x16x32_bf16 v[32:35], v[16:19], v[140:143], v[32:35]
ds_read_b64_tr_b16 v[28:29], v7 offset:16640
v_mfma_f32_16x16x32_bf16 v[64:67], v[16:19], v[144:147], v[64:67]
ds_read_b64_tr_b16 v[30:31], v7 offset:17664
v_mfma_f32_16x16x32_bf16 v[96:99], v[16:19], v[148:151], v[96:99]
s_waitcnt lgkmcnt(4)
v_mfma_f32_16x16x32_bf16 v[36:39], v[20:23], v[140:143], v[36:39]
ds_read_b64_tr_b16 v[16:17], v6 offset:16896
v_mfma_f32_16x16x32_bf16 v[68:71], v[20:23], v[144:147], v[68:71]
ds_read_b64_tr_b16 v[18:19], v6 offset:17920
v_mfma_f32_16x16x32_bf16 v[100:103], v[20:23], v[148:151], v[100:103]
s_waitcnt vmcnt(11)
s_barrier
s_add_u32 m0, s56, 0x12000
s_lshl_b32 s66, s41, 12
s_add_u32 s66, s66, 0x300
buffer_load_dwordx4 v4, s[16:19], s66 offen lds
s_waitcnt lgkmcnt(4)
v_mfma_f32_16x16x32_bf16 v[40:43], v[24:27], v[140:143], v[40:43]
ds_read_b64_tr_b16 v[20:21], v7 offset:16896
ds_write_b128 v10, v[188:191] offset:2560
v_mul_f32 v32, s61, v32
v_mul_f32 v33, s61, v33
v_mul_f32 v34, s61, v34
v_mul_f32 v35, s61, v35
v_cvt_pk_bf16_f32 v12, v32, v33
v_cvt_pk_bf16_f32 v13, v34, v35
ds_write_b64 v8, v[12:13]
s_add_u32 s67, s66, 0x7c00
buffer_load_dwordx4 v4, s[16:19], s67 offen offset:1024 lds
v_mfma_f32_16x16x32_bf16 v[72:75], v[24:27], v[144:147], v[72:75]
ds_read_b64_tr_b16 v[22:23], v7 offset:17920
ds_read_b128 v[128:131], v201 offset:1024
ds_read_b128 v[132:135], v201 offset:3072
v_mul_f32 v64, s61, v64
v_mul_f32 v65, s61, v65
v_mul_f32 v66, s61, v66
v_mul_f32 v67, s61, v67
v_mfma_f32_16x16x32_bf16 v[104:107], v[24:27], v[148:151], v[104:107]
buffer_load_dwordx4 v[176:179], v5, s[20:23], s42 offen
v_cvt_pk_bf16_f32 v14, v64, v65
v_cvt_pk_bf16_f32 v15, v66, v67
ds_write_b64 v8, v[14:15] offset:4096
v_mul_f32 v96, s61, v96
v_mul_f32 v97, s61, v97
v_mul_f32 v98, s61, v98
v_mul_f32 v99, s61, v99
s_add_u32 m0, s56, 0
s_mov_b32 s58, 0x40000
buffer_load_dwordx4 v2, s[8:11], s58 offen nt lds
s_waitcnt lgkmcnt(9)
v_mfma_f32_16x16x32_bf16 v[44:47], v[28:31], v[140:143], v[44:47]
ds_read_b64_tr_b16 v[24:25], v6 offset:17152
v_cvt_pk_bf16_f32 v12, v96, v97
v_cvt_pk_bf16_f32 v13, v98, v99
ds_write_b64 v8, v[12:13] offset:8192
v_mfma_f32_16x16x32_bf16 v[76:79], v[28:31], v[144:147], v[76:79]
ds_read_b64_tr_b16 v[26:27], v6 offset:18176
ds_write_b128 v202, v[192:195] offset:1024
v_mul_f32 v36, s61, v36
v_mul_f32 v37, s61, v37
v_mul_f32 v38, s61, v38
v_mul_f32 v39, s61, v39
v_cvt_pk_bf16_f32 v14, v36, v37
v_cvt_pk_bf16_f32 v15, v38, v39
ds_write_b64 v9, v[14:15]
buffer_load_dwordx4 v2, s[8:11], s58 offen offset:1024 nt lds
v_mfma_f32_16x16x32_bf16 v[108:111], v[28:31], v[148:151], v[108:111]
buffer_load_dwordx4 v[180:183], v200, s[20:23], s42 offen
v_mul_f32 v68, s61, v68
v_mul_f32 v69, s61, v69
v_mul_f32 v70, s61, v70
v_mul_f32 v71, s61, v71
s_waitcnt lgkmcnt(12)
v_mfma_f32_16x16x32_bf16 v[48:51], v[16:19], v[140:143], v[48:51]
ds_read_b64_tr_b16 v[28:29], v7 offset:17152
v_cvt_pk_bf16_f32 v12, v68, v69
v_cvt_pk_bf16_f32 v13, v70, v71
ds_write_b64 v9, v[12:13] offset:4096
s_add_u32 m0, s57, 0xc000
s_mov_b32 s59, 0x3c000
buffer_load_dwordx4 v3, s[12:15], s59 offen nt lds
v_mfma_f32_16x16x32_bf16 v[80:83], v[16:19], v[144:147], v[80:83]
ds_read_b64_tr_b16 v[30:31], v7 offset:18176
ds_write_b128 v202, v[196:199] offset:1536
v_mul_f32 v100, s61, v100
v_mul_f32 v101, s61, v101
v_mul_f32 v102, s61, v102
v_mul_f32 v103, s61, v103
v_cvt_pk_bf16_f32 v14, v100, v101
v_cvt_pk_bf16_f32 v15, v102, v103
ds_write_b64 v9, v[14:15] offset:8192
v_mfma_f32_16x16x32_bf16 v[112:115], v[16:19], v[148:151], v[112:115]
ds_read_b128 v[136:139], v201 offset:3072
v_mul_f32 v40, s61, v40
v_mul_f32 v41, s61, v41
v_mul_f32 v42, s61, v42
v_mul_f32 v43, s61, v43
buffer_load_dwordx4 v3, s[12:15], s59 offen offset:2048 nt lds
s_waitcnt lgkmcnt(14)
v_mfma_f32_16x16x32_bf16 v[52:55], v[20:23], v[140:143], v[52:55]
v_cvt_pk_bf16_f32 v12, v40, v41
v_cvt_pk_bf16_f32 v13, v42, v43
ds_write_b64 v8, v[12:13] offset:1024
v_mul_f32 v72, s61, v72
v_mul_f32 v73, s61, v73
v_mul_f32 v74, s61, v74
v_mul_f32 v75, s61, v75
v_mfma_f32_16x16x32_bf16 v[84:87], v[20:23], v[144:147], v[84:87]
s_add_u32 s64, s42, 0x4800
buffer_load_dwordx4 v[184:187], v5, s[20:23], s64 offen
v_cvt_pk_bf16_f32 v14, v72, v73
v_cvt_pk_bf16_f32 v15, v74, v75
ds_write_b64 v8, v[14:15] offset:5120
v_mfma_f32_16x16x32_bf16 v[116:119], v[20:23], v[148:151], v[116:119]
v_mul_f32 v104, s61, v104
v_mul_f32 v105, s61, v105
v_mul_f32 v106, s61, v106
v_mul_f32 v107, s61, v107
v_cvt_pk_bf16_f32 v12, v104, v105
v_cvt_pk_bf16_f32 v13, v106, v107
ds_write_b64 v8, v[12:13] offset:9216
s_waitcnt lgkmcnt(11)
v_mfma_f32_16x16x32_bf16 v[56:59], v[24:27], v[140:143], v[56:59]
v_mul_f32 v44, s61, v44
v_mul_f32 v45, s61, v45
v_mul_f32 v46, s61, v46
v_mul_f32 v47, s61, v47
v_mfma_f32_16x16x32_bf16 v[88:91], v[24:27], v[144:147], v[88:91]
v_cvt_pk_bf16_f32 v14, v44, v45
v_cvt_pk_bf16_f32 v15, v46, v47
ds_write_b64 v9, v[14:15] offset:1024
v_mfma_f32_16x16x32_bf16 v[120:123], v[24:27], v[148:151], v[120:123]
v_mul_f32 v76, s61, v76
v_mul_f32 v77, s61, v77
v_mul_f32 v78, s61, v78
v_mul_f32 v79, s61, v79
v_cvt_pk_bf16_f32 v12, v76, v77
v_cvt_pk_bf16_f32 v13, v78, v79
ds_write_b64 v9, v[12:13] offset:5120
s_waitcnt lgkmcnt(8)
v_mfma_f32_16x16x32_bf16 v[60:63], v[28:31], v[140:143], v[60:63]
v_mul_f32 v108, s61, v108
v_mul_f32 v109, s61, v109
v_mul_f32 v110, s61, v110
v_mul_f32 v111, s61, v111
v_mfma_f32_16x16x32_bf16 v[92:95], v[28:31], v[144:147], v[92:95]
v_cvt_pk_bf16_f32 v14, v108, v109
v_cvt_pk_bf16_f32 v15, v110, v111
ds_write_b64 v9, v[14:15] offset:9216
v_mul_f32 v48, s61, v48
v_mul_f32 v49, s61, v49
v_mul_f32 v50, s61, v50
v_mul_f32 v51, s61, v51
v_mfma_f32_16x16x32_bf16 v[124:127], v[28:31], v[148:151], v[124:127]
v_cvt_pk_bf16_f32 v12, v48, v49
v_cvt_pk_bf16_f32 v13, v50, v51
ds_write_b64 v8, v[12:13] offset:2048
s_waitcnt vmcnt(11)
s_barrier
ds_read_b64_tr_b16 v[16:17], v6 offset:24576
ds_read_b64_tr_b16 v[18:19], v6 offset:25600
ds_read_b64_tr_b16 v[20:21], v7 offset:24576
ds_read_b64_tr_b16 v[22:23], v7 offset:25600
ds_read_b64_tr_b16 v[24:25], v6 offset:24832
ds_read_b64_tr_b16 v[26:27], v6 offset:25856
s_add_u32 m0, s56, 0x14000
s_lshl_b32 s66, s41, 12
s_add_u32 s66, s66, 0x40300
buffer_load_dwordx4 v4, s[16:19], s66 offen lds
s_waitcnt lgkmcnt(4)
v_mfma_f32_16x16x32_bf16 v[32:35], v[16:19], v[128:131], 0
ds_read_b64_tr_b16 v[28:29], v7 offset:24832
v_mul_f32 v80, s61, v80
v_mul_f32 v81, s61, v81
v_mul_f32 v82, s61, v82
v_mul_f32 v83, s61, v83
v_cvt_pk_bf16_f32 v14, v80, v81
v_cvt_pk_bf16_f32 v15, v82, v83
ds_write_b64 v8, v[14:15] offset:6144
s_add_u32 s67, s66, 0x7c00
buffer_load_dwordx4 v4, s[16:19], s67 offen offset:1024 lds
v_mfma_f32_16x16x32_bf16 v[64:67], v[16:19], v[132:135], 0
ds_read_b64_tr_b16 v[30:31], v7 offset:25856
v_mul_f32 v112, s61, v112
v_mul_f32 v113, s61, v113
v_mul_f32 v114, s61, v114
v_mul_f32 v115, s61, v115
ds_read_b128 v[140:143], v11
ds_read_b128 v[144:147], v11 offset:2048
ds_read_b128 v[148:151], v11 offset:1024
v_mfma_f32_16x16x32_bf16 v[96:99], v[16:19], v[136:139], 0
v_cvt_pk_bf16_f32 v12, v112, v113
v_cvt_pk_bf16_f32 v13, v114, v115
ds_write_b64 v8, v[12:13] offset:10240
s_add_u32 m0, s56, 0x2000
s_mov_b32 s58, 0x42000
buffer_load_dwordx4 v2, s[8:11], s58 offen nt lds
s_waitcnt lgkmcnt(9)
v_mfma_f32_16x16x32_bf16 v[36:39], v[20:23], v[128:131], 0
ds_read_b64_tr_b16 v[16:17], v6 offset:25088
v_mul_f32 v52, s61, v52
v_mul_f32 v53, s61, v53
v_mul_f32 v54, s61, v54
v_mul_f32 v55, s61, v55
v_cvt_pk_bf16_f32 v14, v52, v53
v_cvt_pk_bf16_f32 v15, v54, v55
ds_write_b64 v9, v[14:15] offset:2048
s_add_u32 s64, s42, 0x4800
buffer_load_dwordx4 v[188:191], v200, s[20:23], s64 offen
v_mfma_f32_16x16x32_bf16 v[68:71], v[20:23], v[132:135], 0
ds_read_b64_tr_b16 v[18:19], v6 offset:26112
v_mul_f32 v84, s61, v84
v_mul_f32 v85, s61, v85
v_mul_f32 v86, s61, v86
v_mul_f32 v87, s61, v87
buffer_load_dwordx4 v2, s[8:11], s58 offen offset:1024 nt lds
v_mfma_f32_16x16x32_bf16 v[100:103], v[20:23], v[136:139], 0
v_cvt_pk_bf16_f32 v12, v84, v85
v_cvt_pk_bf16_f32 v13, v86, v87
ds_write_b64 v9, v[12:13] offset:6144
v_mul_f32 v116, s61, v116
v_mul_f32 v117, s61, v117
v_mul_f32 v118, s61, v118
v_mul_f32 v119, s61, v119
ds_write_b128 v10, v[152:155]
s_waitcnt lgkmcnt(12)
v_mfma_f32_16x16x32_bf16 v[40:43], v[24:27], v[128:131], 0
ds_read_b64_tr_b16 v[20:21], v7 offset:25088
v_cvt_pk_bf16_f32 v14, v116, v117
v_cvt_pk_bf16_f32 v15, v118, v119
ds_write_b64 v9, v[14:15] offset:10240
s_add_u32 m0, s57, 0xe000
s_mov_b32 s59, 0x3e000
buffer_load_dwordx4 v3, s[12:15], s59 offen nt lds
v_mfma_f32_16x16x32_bf16 v[72:75], v[24:27], v[132:135], 0
ds_read_b64_tr_b16 v[22:23], v7 offset:26112
v_mul_f32 v56, s61, v56
v_mul_f32 v57, s61, v57
v_mul_f32 v58, s61, v58
v_mul_f32 v59, s61, v59
v_cvt_pk_bf16_f32 v12, v56, v57
v_cvt_pk_bf16_f32 v13, v58, v59
ds_write_b64 v8, v[12:13] offset:3072
s_add_u32 s64, s42, 0x9000
buffer_load_dwordx4 v[192:195], v5, s[20:23], s64 offen
v_mfma_f32_16x16x32_bf16 v[104:107], v[24:27], v[136:139], 0
v_mul_f32 v88, s61, v88
v_mul_f32 v89, s61, v89
v_mul_f32 v90, s61, v90
v_mul_f32 v91, s61, v91
buffer_load_dwordx4 v3, s[12:15], s59 offen offset:2048 nt lds
s_waitcnt lgkmcnt(13)
v_mfma_f32_16x16x32_bf16 v[44:47], v[28:31], v[128:131], 0
ds_read_b64_tr_b16 v[24:25], v6 offset:25344
v_cvt_pk_bf16_f32 v14, v88, v89
v_cvt_pk_bf16_f32 v15, v90, v91
ds_write_b64 v8, v[14:15] offset:7168
ds_write_b128 v10, v[156:159] offset:512
v_mfma_f32_16x16x32_bf16 v[76:79], v[28:31], v[132:135], 0
ds_read_b64_tr_b16 v[26:27], v6 offset:26368
v_mul_f32 v120, s61, v120
v_mul_f32 v121, s61, v121
v_mul_f32 v122, s61, v122
v_mul_f32 v123, s61, v123
v_cvt_pk_bf16_f32 v12, v120, v121
v_cvt_pk_bf16_f32 v13, v122, v123
ds_write_b64 v8, v[12:13] offset:11264
v_mfma_f32_16x16x32_bf16 v[108:111], v[28:31], v[136:139], 0
v_mul_f32 v60, s61, v60
v_mul_f32 v61, s61, v61
v_mul_f32 v62, s61, v62
v_mul_f32 v63, s61, v63
s_waitcnt lgkmcnt(11)
v_mfma_f32_16x16x32_bf16 v[48:51], v[16:19], v[128:131], 0
ds_read_b64_tr_b16 v[28:29], v7 offset:25344
v_cvt_pk_bf16_f32 v14, v60, v61
v_cvt_pk_bf16_f32 v15, v62, v63
ds_write_b64 v9, v[14:15] offset:3072
v_mul_f32 v92, s61, v92
v_mul_f32 v93, s61, v93
v_mul_f32 v94, s61, v94
v_mul_f32 v95, s61, v95
v_mfma_f32_16x16x32_bf16 v[80:83], v[16:19], v[132:135], 0
ds_read_b64_tr_b16 v[30:31], v7 offset:26368
v_cvt_pk_bf16_f32 v12, v92, v93
v_cvt_pk_bf16_f32 v13, v94, v95
ds_write_b64 v9, v[12:13] offset:7168
v_mfma_f32_16x16x32_bf16 v[112:115], v[16:19], v[136:139], 0
v_mul_f32 v124, s61, v124
v_mul_f32 v125, s61, v125
v_mul_f32 v126, s61, v126
v_mul_f32 v127, s61, v127
s_waitcnt lgkmcnt(10)
v_mfma_f32_16x16x32_bf16 v[52:55], v[20:23], v[128:131], 0
v_cvt_pk_bf16_f32 v14, v124, v125
v_cvt_pk_bf16_f32 v15, v126, v127
ds_write_b64 v9, v[14:15] offset:11264
v_mfma_f32_16x16x32_bf16 v[84:87], v[20:23], v[132:135], 0
v_mfma_f32_16x16x32_bf16 v[116:119], v[20:23], v[136:139], 0
s_waitcnt vmcnt(9) lgkmcnt(0)
s_barrier
ds_read_b64_tr_b16 v[16:17], v6
ds_read_b64_tr_b16 v[18:19], v6 offset:1024
s_add_u32 m0, s56, 0x4000
s_mov_b32 s58, 0x44000
buffer_load_dwordx4 v2, s[8:11], s58 offen nt lds
v_mfma_f32_16x16x32_bf16 v[56:59], v[24:27], v[128:131], 0
ds_read_b64_tr_b16 v[20:21], v7
s_add_u32 s64, s42, 0x9000
buffer_load_dwordx4 v[196:199], v200, s[20:23], s64 offen
buffer_load_dwordx4 v2, s[8:11], s58 offen offset:1024 nt lds
v_mfma_f32_16x16x32_bf16 v[88:91], v[24:27], v[132:135], 0
ds_read_b64_tr_b16 v[22:23], v7 offset:1024
v_mfma_f32_16x16x32_bf16 v[120:123], v[24:27], v[136:139], 0
v_mfma_f32_16x16x32_bf16 v[60:63], v[28:31], v[128:131], 0
ds_read_b64_tr_b16 v[24:25], v6 offset:256
ds_write_b128 v10, v[160:163] offset:2048
v_mfma_f32_16x16x32_bf16 v[92:95], v[28:31], v[132:135], 0
ds_read_b64_tr_b16 v[26:27], v6 offset:1280
s_add_u32 m0, s57, 0x8000
s_mov_b32 s59, 0x40000
buffer_load_dwordx4 v3, s[12:15], s59 offen nt lds
v_mfma_f32_16x16x32_bf16 v[124:127], v[28:31], v[136:139], 0
s_waitcnt lgkmcnt(5)
v_mfma_f32_16x16x32_bf16 v[32:35], v[16:19], v[140:143], v[32:35]
ds_read_b64_tr_b16 v[28:29], v7 offset:256
v_mfma_f32_16x16x32_bf16 v[64:67], v[16:19], v[144:147], v[64:67]
ds_read_b64_tr_b16 v[30:31], v7 offset:1280
ds_write_b128 v10, v[164:167] offset:2560
v_mfma_f32_16x16x32_bf16 v[96:99], v[16:19], v[148:151], v[96:99]
ds_read_b128 v[128:131], v201 offset:1024
ds_read_b128 v[132:135], v201 offset:3072
s_waitcnt lgkmcnt(8)
v_mfma_f32_16x16x32_bf16 v[36:39], v[20:23], v[140:143], v[36:39]
ds_read_b64_tr_b16 v[16:17], v6 offset:512
buffer_load_dwordx4 v[152:155], v5, s[20:23], s43 offen
buffer_load_dwordx4 v3, s[12:15], s59 offen offset:2048 nt lds
v_mfma_f32_16x16x32_bf16 v[68:71], v[20:23], v[144:147], v[68:71]
ds_read_b64_tr_b16 v[18:19], v6 offset:1536
v_mfma_f32_16x16x32_bf16 v[100:103], v[20:23], v[148:151], v[100:103]
ds_write_b128 v202, v[168:171] offset:1024
s_waitcnt lgkmcnt(8)
v_mfma_f32_16x16x32_bf16 v[40:43], v[24:27], v[140:143], v[40:43]
ds_read_b64_tr_b16 v[20:21], v7 offset:512
buffer_load_dwordx4 v[156:159], v200, s[20:23], s43 offen
v_mfma_f32_16x16x32_bf16 v[72:75], v[24:27], v[144:147], v[72:75]
ds_read_b64_tr_b16 v[22:23], v7 offset:1536
v_mfma_f32_16x16x32_bf16 v[104:107], v[24:27], v[148:151], v[104:107]
s_waitcnt lgkmcnt(8)
v_mfma_f32_16x16x32_bf16 v[44:47], v[28:31], v[140:143], v[44:47]
ds_read_b64_tr_b16 v[24:25], v6 offset:768
v_mfma_f32_16x16x32_bf16 v[76:79], v[28:31], v[144:147], v[76:79]
ds_read_b64_tr_b16 v[26:27], v6 offset:1792
v_mfma_f32_16x16x32_bf16 v[108:111], v[28:31], v[148:151], v[108:111]
s_waitcnt lgkmcnt(5)
v_mfma_f32_16x16x32_bf16 v[48:51], v[16:19], v[140:143], v[48:51]
ds_read_b64_tr_b16 v[28:29], v7 offset:768
v_mfma_f32_16x16x32_bf16 v[80:83], v[16:19], v[144:147], v[80:83]
ds_read_b64_tr_b16 v[30:31], v7 offset:1792
v_mfma_f32_16x16x32_bf16 v[112:115], v[16:19], v[148:151], v[112:115]
s_waitcnt lgkmcnt(4)
v_mfma_f32_16x16x32_bf16 v[52:55], v[20:23], v[140:143], v[52:55]
v_mfma_f32_16x16x32_bf16 v[84:87], v[20:23], v[144:147], v[84:87]
v_mfma_f32_16x16x32_bf16 v[116:119], v[20:23], v[148:151], v[116:119]
s_waitcnt vmcnt(7)
s_barrier
ds_read_b64_tr_b16 v[16:17], v6 offset:8192
ds_read_b64_tr_b16 v[18:19], v6 offset:9216
s_add_u32 m0, s56, 0x16000
s_lshl_b32 s66, s42, 12
s_add_u32 s66, s66, 0x300
buffer_load_dwordx4 v4, s[16:19], s66 offen lds
s_waitcnt lgkmcnt(4)
v_mfma_f32_16x16x32_bf16 v[56:59], v[24:27], v[140:143], v[56:59]
ds_read_b64_tr_b16 v[20:21], v7 offset:8192
ds_write_b128 v202, v[172:175] offset:1536
s_add_u32 s67, s66, 0x7c00
buffer_load_dwordx4 v4, s[16:19], s67 offen offset:1024 lds
v_mfma_f32_16x16x32_bf16 v[88:91], v[24:27], v[144:147], v[88:91]
ds_read_b64_tr_b16 v[22:23], v7 offset:9216
ds_read_b128 v[136:139], v201 offset:3072
v_mfma_f32_16x16x32_bf16 v[120:123], v[24:27], v[148:151], v[120:123]
s_waitcnt lgkmcnt(6)
v_mfma_f32_16x16x32_bf16 v[60:63], v[28:31], v[140:143], v[60:63]
ds_read_b64_tr_b16 v[24:25], v6 offset:8448
s_add_u32 s64, s43, 0x4800
buffer_load_dwordx4 v[160:163], v5, s[20:23], s64 offen
s_add_u32 m0, s56, 0x6000
s_mov_b32 s58, 0x46000
buffer_load_dwordx4 v2, s[8:11], s58 offen nt lds
v_mfma_f32_16x16x32_bf16 v[92:95], v[28:31], v[144:147], v[92:95]
ds_read_b64_tr_b16 v[26:27], v6 offset:9472
v_mfma_f32_16x16x32_bf16 v[124:127], v[28:31], v[148:151], v[124:127]
s_waitcnt lgkmcnt(2)
v_mfma_f32_16x16x32_bf16 v[32:35], v[16:19], v[128:131], v[32:35]
ds_read_b64_tr_b16 v[28:29], v7 offset:8448
buffer_load_dwordx4 v2, s[8:11], s58 offen offset:1024 nt lds
v_mfma_f32_16x16x32_bf16 v[64:67], v[16:19], v[132:135], v[64:67]
ds_read_b64_tr_b16 v[30:31], v7 offset:9472
ds_read_b128 v[140:143], v11
ds_read_b128 v[144:147], v11 offset:2048
ds_read_b128 v[148:151], v11 offset:1024
v_mfma_f32_16x16x32_bf16 v[96:99], v[16:19], v[136:139], v[96:99]
v_mfma_f32_16x16x32_bf16 v[36:39], v[20:23], v[128:131], v[36:39]
ds_read_b64_tr_b16 v[16:17], v6 offset:8704
s_add_u32 s64, s43, 0x4800
buffer_load_dwordx4 v[164:167], v200, s[20:23], s64 offen
v_mfma_f32_16x16x32_bf16 v[68:71], v[20:23], v[132:135], v[68:71]
ds_read_b64_tr_b16 v[18:19], v6 offset:9728
s_add_u32 m0, s57, 0xa000
s_mov_b32 s59, 0x42000
buffer_load_dwordx4 v3, s[12:15], s59 offen nt lds
v_mfma_f32_16x16x32_bf16 v[100:103], v[20:23], v[136:139], v[100:103]
ds_write_b128 v10, v[176:179]
s_waitcnt lgkmcnt(8)
v_mfma_f32_16x16x32_bf16 v[40:43], v[24:27], v[128:131], v[40:43]
ds_read_b64_tr_b16 v[20:21], v7 offset:8704
v_mfma_f32_16x16x32_bf16 v[72:75], v[24:27], v[132:135], v[72:75]
ds_read_b64_tr_b16 v[22:23], v7 offset:9728
s_add_u32 s64, s43, 0x9000
buffer_load_dwordx4 v[168:171], v5, s[20:23], s64 offen
buffer_load_dwordx4 v3, s[12:15], s59 offen offset:2048 nt lds
v_mfma_f32_16x16x32_bf16 v[104:107], v[24:27], v[136:139], v[104:107]
s_waitcnt lgkmcnt(8)
v_mfma_f32_16x16x32_bf16 v[44:47], v[28:31], v[128:131], v[44:47]
ds_read_b64_tr_b16 v[24:25], v6 offset:8960
ds_write_b128 v10, v[180:183] offset:512
v_mfma_f32_16x16x32_bf16 v[76:79], v[28:31], v[132:135], v[76:79]
ds_read_b64_tr_b16 v[26:27], v6 offset:9984
s_add_u32 s75, s75, 0x480
buffer_load_dword v204, v203, s[28:31], s75 offen
v_mfma_f32_16x16x32_bf16 v[108:111], v[28:31], v[136:139], v[108:111]
s_add_u32 s64, s43, 0x9000
buffer_load_dwordx4 v[172:175], v200, s[20:23], s64 offen
s_waitcnt lgkmcnt(6)
v_mfma_f32_16x16x32_bf16 v[48:51], v[16:19], v[128:131], v[48:51]
ds_read_b64_tr_b16 v[28:29], v7 offset:8960
v_mfma_f32_16x16x32_bf16 v[80:83], v[16:19], v[132:135], v[80:83]
ds_read_b64_tr_b16 v[30:31], v7 offset:9984
ds_write_b128 v10, v[184:187] offset:2048
v_mfma_f32_16x16x32_bf16 v[112:115], v[16:19], v[136:139], v[112:115]
s_waitcnt lgkmcnt(6)
v_mfma_f32_16x16x32_bf16 v[52:55], v[20:23], v[128:131], v[52:55]
ds_read_b64_tr_b16 v[16:17], v6 offset:16384
v_mfma_f32_16x16x32_bf16 v[84:87], v[20:23], v[132:135], v[84:87]
ds_read_b64_tr_b16 v[18:19], v6 offset:17408
v_mfma_f32_16x16x32_bf16 v[116:119], v[20:23], v[136:139], v[116:119]
s_waitcnt lgkmcnt(5)
v_mfma_f32_16x16x32_bf16 v[56:59], v[24:27], v[128:131], v[56:59]
ds_read_b64_tr_b16 v[20:21], v7 offset:16384
v_mfma_f32_16x16x32_bf16 v[88:91], v[24:27], v[132:135], v[88:91]
ds_read_b64_tr_b16 v[22:23], v7 offset:17408
v_mfma_f32_16x16x32_bf16 v[120:123], v[24:27], v[136:139], v[120:123]
s_waitcnt lgkmcnt(5)
v_mfma_f32_16x16x32_bf16 v[60:63], v[28:31], v[128:131], v[60:63]
ds_read_b64_tr_b16 v[24:25], v6 offset:16640
v_mfma_f32_16x16x32_bf16 v[92:95], v[28:31], v[132:135], v[92:95]
ds_read_b64_tr_b16 v[26:27], v6 offset:17664
v_mfma_f32_16x16x32_bf16 v[124:127], v[28:31], v[136:139], v[124:127]
s_waitcnt lgkmcnt(4)
v_mfma_f32_16x16x32_bf16 v[32:35], v[16:19], v[140:143], v[32:35]
ds_read_b64_tr_b16 v[28:29], v7 offset:16640
v_mfma_f32_16x16x32_bf16 v[64:67], v[16:19], v[144:147], v[64:67]
ds_read_b64_tr_b16 v[30:31], v7 offset:17664
v_mfma_f32_16x16x32_bf16 v[96:99], v[16:19], v[148:151], v[96:99]
s_waitcnt vmcnt(9)
s_barrier
s_add_u32 m0, s56, 0x10000
s_lshl_b32 s66, s42, 12
s_add_u32 s66, s66, 0x40300
buffer_load_dwordx4 v4, s[16:19], s66 offen lds
s_waitcnt lgkmcnt(4)
v_mfma_f32_16x16x32_bf16 v[36:39], v[20:23], v[140:143], v[36:39]
ds_read_b64_tr_b16 v[16:17], v6 offset:16896
ds_write_b128 v10, v[188:191] offset:2560
s_add_u32 s67, s66, 0x7c00
buffer_load_dwordx4 v4, s[16:19], s67 offen offset:1024 lds
v_mfma_f32_16x16x32_bf16 v[68:71], v[20:23], v[144:147], v[68:71]
ds_read_b64_tr_b16 v[18:19], v6 offset:17920
v_mfma_f32_16x16x32_bf16 v[100:103], v[20:23], v[148:151], v[100:103]
ds_read_b128 v[128:131], v201 offset:1024
ds_read_b128 v[132:135], v201 offset:3072
s_waitcnt lgkmcnt(7)
v_mfma_f32_16x16x32_bf16 v[40:43], v[24:27], v[140:143], v[40:43]
ds_read_b64_tr_b16 v[20:21], v7 offset:16896
s_add_u32 m0, s56, 0x12000
s_lshl_b32 s66, s43, 12
s_add_u32 s66, s66, 0x300
buffer_load_dwordx4 v4, s[16:19], s66 offen lds
v_mfma_f32_16x16x32_bf16 v[72:75], v[24:27], v[144:147], v[72:75]
ds_read_b64_tr_b16 v[22:23], v7 offset:17920
v_mfma_f32_16x16x32_bf16 v[104:107], v[24:27], v[148:151], v[104:107]
buffer_load_dwordx4 v[176:179], v5, s[20:23], s44 offen
s_waitcnt lgkmcnt(7)
v_mfma_f32_16x16x32_bf16 v[44:47], v[28:31], v[140:143], v[44:47]
ds_read_b64_tr_b16 v[24:25], v6 offset:17152
v_mfma_f32_16x16x32_bf16 v[76:79], v[28:31], v[144:147], v[76:79]
ds_read_b64_tr_b16 v[26:27], v6 offset:18176
ds_write_b128 v202, v[192:195] offset:1024
s_add_u32 s67, s66, 0x7c00
buffer_load_dwordx4 v4, s[16:19], s67 offen offset:1024 lds
v_mfma_f32_16x16x32_bf16 v[108:111], v[28:31], v[148:151], v[108:111]
s_waitcnt lgkmcnt(7)
v_mfma_f32_16x16x32_bf16 v[48:51], v[16:19], v[140:143], v[48:51]
ds_read_b64_tr_b16 v[28:29], v7 offset:17152
v_mfma_f32_16x16x32_bf16 v[80:83], v[16:19], v[144:147], v[80:83]
ds_read_b64_tr_b16 v[30:31], v7 offset:18176
buffer_load_dwordx4 v[180:183], v200, s[20:23], s44 offen
v_mfma_f32_16x16x32_bf16 v[112:115], v[16:19], v[148:151], v[112:115]
s_add_u32 m0, s56, 0
s_mov_b32 s58, 0x48000
buffer_load_dwordx4 v2, s[8:11], s58 offen nt lds
s_waitcnt lgkmcnt(5)
v_mfma_f32_16x16x32_bf16 v[52:55], v[20:23], v[140:143], v[52:55]
ds_read_b64_tr_b16 v[16:17], v6 offset:24576
ds_write_b128 v202, v[196:199] offset:1536
v_mfma_f32_16x16x32_bf16 v[84:87], v[20:23], v[144:147], v[84:87]
ds_read_b64_tr_b16 v[18:19], v6 offset:25600
v_mfma_f32_16x16x32_bf16 v[116:119], v[20:23], v[148:151], v[116:119]
buffer_load_dwordx4 v2, s[8:11], s58 offen offset:1024 nt lds
s_waitcnt lgkmcnt(6)
v_mfma_f32_16x16x32_bf16 v[56:59], v[24:27], v[140:143], v[56:59]
ds_read_b64_tr_b16 v[20:21], v7 offset:24576
ds_read_b128 v[136:139], v201 offset:3072
v_mfma_f32_16x16x32_bf16 v[88:91], v[24:27], v[144:147], v[88:91]
ds_read_b64_tr_b16 v[22:23], v7 offset:25600
v_mfma_f32_16x16x32_bf16 v[120:123], v[24:27], v[148:151], v[120:123]
s_waitcnt lgkmcnt(6)
v_mfma_f32_16x16x32_bf16 v[60:63], v[28:31], v[140:143], v[60:63]
ds_read_b64_tr_b16 v[24:25], v6 offset:24832
s_add_u32 s64, s44, 0x4800
buffer_load_dwordx4 v[184:187], v5, s[20:23], s64 offen
s_add_u32 m0, s57, 0xc000
s_mov_b32 s59, 0x44000
buffer_load_dwordx4 v3, s[12:15], s59 offen nt lds
v_mfma_f32_16x16x32_bf16 v[92:95], v[28:31], v[144:147], v[92:95]
ds_read_b64_tr_b16 v[26:27], v6 offset:25856
v_mfma_f32_16x16x32_bf16 v[124:127], v[28:31], v[148:151], v[124:127]
s_waitcnt lgkmcnt(3)
v_mfma_f32_16x16x32_bf16 v[32:35], v[16:19], v[128:131], v[32:35]
ds_read_b64_tr_b16 v[28:29], v7 offset:24832
v_mfma_f32_16x16x32_bf16 v[64:67], v[16:19], v[132:135], v[64:67]
ds_read_b64_tr_b16 v[30:31], v7 offset:25856
ds_read_b128 v[140:143], v11
ds_read_b128 v[144:147], v11 offset:2048
ds_read_b128 v[148:151], v11 offset:1024
s_add_u32 s64, s44, 0x4800
buffer_load_dwordx4 v[188:191], v200, s[20:23], s64 offen
buffer_load_dwordx4 v3, s[12:15], s59 offen offset:2048 nt lds
v_mfma_f32_16x16x32_bf16 v[96:99], v[16:19], v[136:139], v[96:99]
ds_write_b128 v10, v[152:155]
s_waitcnt lgkmcnt(8)
v_mfma_f32_16x16x32_bf16 v[36:39], v[20:23], v[128:131], v[36:39]
ds_read_b64_tr_b16 v[16:17], v6 offset:25088
s_add_u32 s64, s44, 0x9000
buffer_load_dwordx4 v[192:195], v5, s[20:23], s64 offen
ds_write_b128 v10, v[156:159] offset:512
v_mfma_f32_16x16x32_bf16 v[68:71], v[20:23], v[132:135], v[68:71]
ds_read_b64_tr_b16 v[18:19], v6 offset:26112
s_add_u32 s64, s44, 0x9000
buffer_load_dwordx4 v[196:199], v200, s[20:23], s64 offen
v_mfma_f32_16x16x32_bf16 v[100:103], v[20:23], v[136:139], v[100:103]
s_waitcnt lgkmcnt(9)
v_mfma_f32_16x16x32_bf16 v[40:43], v[24:27], v[128:131], v[40:43]
ds_read_b64_tr_b16 v[20:21], v7 offset:25088
v_mfma_f32_16x16x32_bf16 v[72:75], v[24:27], v[132:135], v[72:75]
ds_read_b64_tr_b16 v[22:23], v7 offset:26112
v_mfma_f32_16x16x32_bf16 v[104:107], v[24:27], v[136:139], v[104:107]
s_waitcnt lgkmcnt(9)
v_mfma_f32_16x16x32_bf16 v[44:47], v[28:31], v[128:131], v[44:47]
ds_read_b64_tr_b16 v[24:25], v6 offset:25344
v_mfma_f32_16x16x32_bf16 v[76:79], v[28:31], v[132:135], v[76:79]
ds_read_b64_tr_b16 v[26:27], v6 offset:26368
v_mfma_f32_16x16x32_bf16 v[108:111], v[28:31], v[136:139], v[108:111]
s_waitcnt lgkmcnt(4)
v_mfma_f32_16x16x32_bf16 v[48:51], v[16:19], v[128:131], v[48:51]
ds_read_b64_tr_b16 v[28:29], v7 offset:25344
v_mfma_f32_16x16x32_bf16 v[80:83], v[16:19], v[132:135], v[80:83]
ds_read_b64_tr_b16 v[30:31], v7 offset:26368
v_mfma_f32_16x16x32_bf16 v[112:115], v[16:19], v[136:139], v[112:115]
s_waitcnt lgkmcnt(4)
v_mfma_f32_16x16x32_bf16 v[52:55], v[20:23], v[128:131], v[52:55]
v_mfma_f32_16x16x32_bf16 v[84:87], v[20:23], v[132:135], v[84:87]
v_mfma_f32_16x16x32_bf16 v[116:119], v[20:23], v[136:139], v[116:119]
s_waitcnt lgkmcnt(2)
v_mfma_f32_16x16x32_bf16 v[56:59], v[24:27], v[128:131], v[56:59]
v_mfma_f32_16x16x32_bf16 v[88:91], v[24:27], v[132:135], v[88:91]
v_mfma_f32_16x16x32_bf16 v[120:123], v[24:27], v[136:139], v[120:123]
s_waitcnt vmcnt(12)
s_barrier
ds_read_b64_tr_b16 v[16:17], v6
ds_read_b64_tr_b16 v[18:19], v6 offset:1024
ds_read_b64_tr_b16 v[20:21], v7
ds_read_b64_tr_b16 v[22:23], v7 offset:1024
s_add_u32 m0, s56, 0x14000
s_lshl_b32 s66, s43, 12
s_add_u32 s66, s66, 0x40300
buffer_load_dwordx4 v4, s[16:19], s66 offen lds
s_waitcnt lgkmcnt(4)
v_mfma_f32_16x16x32_bf16 v[60:63], v[28:31], v[128:131], v[60:63]
ds_read_b64_tr_b16 v[24:25], v6 offset:256
ds_write_b128 v10, v[160:163] offset:2048
s_add_u32 s67, s66, 0x7c00
buffer_load_dwordx4 v4, s[16:19], s67 offen offset:1024 lds
v_mfma_f32_16x16x32_bf16 v[92:95], v[28:31], v[132:135], v[92:95]
ds_read_b64_tr_b16 v[26:27], v6 offset:1280
v_mfma_f32_16x16x32_bf16 v[124:127], v[28:31], v[136:139], v[124:127]
s_waitcnt lgkmcnt(5)
v_mfma_f32_16x16x32_bf16 v[32:35], v[16:19], v[140:143], v[32:35]
ds_read_b64_tr_b16 v[28:29], v7 offset:256
s_add_u32 m0, s56, 0x2000
s_mov_b32 s58, 0x4a000
buffer_load_dwordx4 v2, s[8:11], s58 offen nt lds
v_mfma_f32_16x16x32_bf16 v[64:67], v[16:19], v[144:147], v[64:67]
ds_read_b64_tr_b16 v[30:31], v7 offset:1280
ds_write_b128 v10, v[164:167] offset:2560
v_mfma_f32_16x16x32_bf16 v[96:99], v[16:19], v[148:151], v[96:99]
ds_read_b128 v[128:131], v201 offset:1024
ds_read_b128 v[132:135], v201 offset:3072
s_waitcnt lgkmcnt(8)
v_mfma_f32_16x16x32_bf16 v[36:39], v[20:23], v[140:143], v[36:39]
ds_read_b64_tr_b16 v[16:17], v6 offset:512
buffer_load_dwordx4 v2, s[8:11], s58 offen offset:1024 nt lds
v_mfma_f32_16x16x32_bf16 v[68:71], v[20:23], v[144:147], v[68:71]
ds_read_b64_tr_b16 v[18:19], v6 offset:1536
buffer_load_dwordx4 v[152:155], v5, s[20:23], s45 offen
v_mfma_f32_16x16x32_bf16 v[100:103], v[20:23], v[148:151], v[100:103]
ds_write_b128 v202, v[168:171] offset:1024
s_waitcnt lgkmcnt(8)
v_mfma_f32_16x16x32_bf16 v[40:43], v[24:27], v[140:143], v[40:43]
ds_read_b64_tr_b16 v[20:21], v7 offset:512
s_add_u32 m0, s57, 0xe000
s_mov_b32 s59, 0x46000
buffer_load_dwordx4 v3, s[12:15], s59 offen nt lds
v_mfma_f32_16x16x32_bf16 v[72:75], v[24:27], v[144:147], v[72:75]
ds_read_b64_tr_b16 v[22:23], v7 offset:1536
buffer_load_dwordx4 v[156:159], v200, s[20:23], s45 offen
v_mfma_f32_16x16x32_bf16 v[104:107], v[24:27], v[148:151], v[104:107]
ds_write_b128 v202, v[172:175] offset:1536
s_waitcnt lgkmcnt(9)
v_mfma_f32_16x16x32_bf16 v[44:47], v[28:31], v[140:143], v[44:47]
ds_read_b64_tr_b16 v[24:25], v6 offset:768
buffer_load_dwordx4 v3, s[12:15], s59 offen offset:2048 nt lds
v_mfma_f32_16x16x32_bf16 v[76:79], v[28:31], v[144:147], v[76:79]
ds_read_b64_tr_b16 v[26:27], v6 offset:1792
ds_read_b128 v[136:139], v201 offset:3072
v_mfma_f32_16x16x32_bf16 v[108:111], v[28:31], v[148:151], v[108:111]
s_waitcnt lgkmcnt(7)
v_mfma_f32_16x16x32_bf16 v[48:51], v[16:19], v[140:143], v[48:51]
ds_read_b64_tr_b16 v[28:29], v7 offset:768
s_add_u32 s64, s45, 0x4800
buffer_load_dwordx4 v[160:163], v5, s[20:23], s64 offen
v_mfma_f32_16x16x32_bf16 v[80:83], v[16:19], v[144:147], v[80:83]
ds_read_b64_tr_b16 v[30:31], v7 offset:1792
v_mfma_f32_16x16x32_bf16 v[112:115], v[16:19], v[148:151], v[112:115]
s_waitcnt lgkmcnt(6)
v_mfma_f32_16x16x32_bf16 v[52:55], v[20:23], v[140:143], v[52:55]
v_mfma_f32_16x16x32_bf16 v[84:87], v[20:23], v[144:147], v[84:87]
v_mfma_f32_16x16x32_bf16 v[116:119], v[20:23], v[148:151], v[116:119]
s_waitcnt lgkmcnt(3)
v_mfma_f32_16x16x32_bf16 v[56:59], v[24:27], v[140:143], v[56:59]
v_mfma_f32_16x16x32_bf16 v[88:91], v[24:27], v[144:147], v[88:91]
v_mfma_f32_16x16x32_bf16 v[120:123], v[24:27], v[148:151], v[120:123]
s_waitcnt lgkmcnt(0)
v_mfma_f32_16x16x32_bf16 v[60:63], v[28:31], v[140:143], v[60:63]
v_mfma_f32_16x16x32_bf16 v[92:95], v[28:31], v[144:147], v[92:95]
v_mfma_f32_16x16x32_bf16 v[124:127], v[28:31], v[148:151], v[124:127]
s_waitcnt vmcnt(7)
s_barrier
ds_read_b64_tr_b16 v[16:17], v6 offset:8192
ds_read_b64_tr_b16 v[18:19], v6 offset:9216
ds_read_b64_tr_b16 v[20:21], v7 offset:8192
ds_read_b64_tr_b16 v[22:23], v7 offset:9216
ds_read_b64_tr_b16 v[24:25], v6 offset:8448
ds_read_b64_tr_b16 v[26:27], v6 offset:9472
s_add_u32 m0, s56, 0x16000
s_lshl_b32 s66, s44, 12
s_add_u32 s66, s66, 0x300
buffer_load_dwordx4 v4, s[16:19], s66 offen lds
s_waitcnt lgkmcnt(4)
v_mfma_f32_16x16x32_bf16 v[32:35], v[16:19], v[128:131], v[32:35]
ds_read_b64_tr_b16 v[28:29], v7 offset:8448
s_add_u32 s67, s66, 0x7c00
buffer_load_dwordx4 v4, s[16:19], s67 offen offset:1024 lds
v_mfma_f32_16x16x32_bf16 v[64:67], v[16:19], v[132:135], v[64:67]
ds_read_b64_tr_b16 v[30:31], v7 offset:9472
ds_read_b128 v[140:143], v11
ds_read_b128 v[144:147], v11 offset:2048
ds_read_b128 v[148:151], v11 offset:1024
v_mfma_f32_16x16x32_bf16 v[96:99], v[16:19], v[136:139], v[96:99]
s_add_u32 m0, s56, 0x10000
s_lshl_b32 s66, s44, 12
s_add_u32 s66, s66, 0x40300
buffer_load_dwordx4 v4, s[16:19], s66 offen lds
s_waitcnt lgkmcnt(7)
v_mfma_f32_16x16x32_bf16 v[36:39], v[20:23], v[128:131], v[36:39]
ds_read_b64_tr_b16 v[16:17], v6 offset:8704
s_add_u32 s64, s45, 0x4800
buffer_load_dwordx4 v[164:167], v200, s[20:23], s64 offen
v_mfma_f32_16x16x32_bf16 v[68:71], v[20:23], v[132:135], v[68:71]
ds_read_b64_tr_b16 v[18:19], v6 offset:9728
s_add_u32 s67, s66, 0x7c00
buffer_load_dwordx4 v4, s[16:19], s67 offen offset:1024 lds
v_mfma_f32_16x16x32_bf16 v[100:103], v[20:23], v[136:139], v[100:103]
ds_write_b128 v10, v[176:179]
s_waitcnt lgkmcnt(8)
v_mfma_f32_16x16x32_bf16 v[40:43], v[24:27], v[128:131], v[40:43]
ds_read_b64_tr_b16 v[20:21], v7 offset:8704
s_add_u32 m0, s56, 0x4000
s_mov_b32 s58, 0x4c000
buffer_load_dwordx4 v2, s[8:11], s58 offen nt lds
v_mfma_f32_16x16x32_bf16 v[72:75], v[24:27], v[132:135], v[72:75]
ds_read_b64_tr_b16 v[22:23], v7 offset:9728
v_mfma_f32_16x16x32_bf16 v[104:107], v[24:27], v[136:139], v[104:107]
s_add_u32 s64, s45, 0x9000
buffer_load_dwordx4 v[168:171], v5, s[20:23], s64 offen
s_waitcnt lgkmcnt(8)
v_mfma_f32_16x16x32_bf16 v[44:47], v[28:31], v[128:131], v[44:47]
ds_read_b64_tr_b16 v[24:25], v6 offset:8960
buffer_load_dwordx4 v2, s[8:11], s58 offen offset:1024 nt lds
v_mfma_f32_16x16x32_bf16 v[76:79], v[28:31], v[132:135], v[76:79]
ds_read_b64_tr_b16 v[26:27], v6 offset:9984
ds_write_b128 v10, v[180:183] offset:512
v_mfma_f32_16x16x32_bf16 v[108:111], v[28:31], v[136:139], v[108:111]
s_add_u32 m0, s57, 0x8000
s_mov_b32 s59, 0x48000
buffer_load_dwordx4 v3, s[12:15], s59 offen nt lds
s_waitcnt lgkmcnt(6)
v_mfma_f32_16x16x32_bf16 v[48:51], v[16:19], v[128:131], v[48:51]
ds_read_b64_tr_b16 v[28:29], v7 offset:8960
s_add_u32 s64, s45, 0x9000
buffer_load_dwordx4 v[172:175], v200, s[20:23], s64 offen
v_mfma_f32_16x16x32_bf16 v[80:83], v[16:19], v[132:135], v[80:83]
ds_read_b64_tr_b16 v[30:31], v7 offset:9984
buffer_load_dwordx4 v3, s[12:15], s59 offen offset:2048 nt lds
v_mfma_f32_16x16x32_bf16 v[112:115], v[16:19], v[136:139], v[112:115]
s_waitcnt lgkmcnt(5)
v_mfma_f32_16x16x32_bf16 v[52:55], v[20:23], v[128:131], v[52:55]
ds_read_b64_tr_b16 v[16:17], v6 offset:16384
ds_write_b128 v10, v[184:187] offset:2048
v_mfma_f32_16x16x32_bf16 v[84:87], v[20:23], v[132:135], v[84:87]
ds_read_b64_tr_b16 v[18:19], v6 offset:17408
v_mfma_f32_16x16x32_bf16 v[116:119], v[20:23], v[136:139], v[116:119]
s_waitcnt lgkmcnt(6)
v_mfma_f32_16x16x32_bf16 v[56:59], v[24:27], v[128:131], v[56:59]
ds_read_b64_tr_b16 v[20:21], v7 offset:16384
v_mfma_f32_16x16x32_bf16 v[88:91], v[24:27], v[132:135], v[88:91]
ds_read_b64_tr_b16 v[22:23], v7 offset:17408
v_mfma_f32_16x16x32_bf16 v[120:123], v[24:27], v[136:139], v[120:123]
s_waitcnt lgkmcnt(5)
v_mfma_f32_16x16x32_bf16 v[60:63], v[28:31], v[128:131], v[60:63]
ds_read_b64_tr_b16 v[24:25], v6 offset:16640
v_mfma_f32_16x16x32_bf16 v[92:95], v[28:31], v[132:135], v[92:95]
ds_read_b64_tr_b16 v[26:27], v6 offset:17664
v_mfma_f32_16x16x32_bf16 v[124:127], v[28:31], v[136:139], v[124:127]
s_waitcnt lgkmcnt(4)
v_mfma_f32_16x16x32_bf16 v[32:35], v[16:19], v[140:143], v[32:35]
ds_read_b64_tr_b16 v[28:29], v7 offset:16640
v_mfma_f32_16x16x32_bf16 v[64:67], v[16:19], v[144:147], v[64:67]
ds_read_b64_tr_b16 v[30:31], v7 offset:17664
v_mfma_f32_16x16x32_bf16 v[96:99], v[16:19], v[148:151], v[96:99]
s_waitcnt vmcnt(9)
s_barrier
s_add_u32 m0, s56, 0x12000
s_lshl_b32 s66, s45, 12
s_add_u32 s66, s66, 0x300
buffer_load_dwordx4 v4, s[16:19], s66 offen lds
s_waitcnt lgkmcnt(4)
v_mfma_f32_16x16x32_bf16 v[36:39], v[20:23], v[140:143], v[36:39]
ds_read_b64_tr_b16 v[16:17], v6 offset:16896
ds_write_b128 v10, v[188:191] offset:2560
s_add_u32 s67, s66, 0x7c00
buffer_load_dwordx4 v4, s[16:19], s67 offen offset:1024 lds
v_mfma_f32_16x16x32_bf16 v[68:71], v[20:23], v[144:147], v[68:71]
ds_read_b64_tr_b16 v[18:19], v6 offset:17920
v_mfma_f32_16x16x32_bf16 v[100:103], v[20:23], v[148:151], v[100:103]
ds_read_b128 v[128:131], v201 offset:1024
ds_read_b128 v[132:135], v201 offset:3072
s_waitcnt lgkmcnt(7)
v_mfma_f32_16x16x32_bf16 v[40:43], v[24:27], v[140:143], v[40:43]
ds_read_b64_tr_b16 v[20:21], v7 offset:16896
s_add_u32 m0, s56, 0x6000
s_mov_b32 s58, 0x4e000
buffer_load_dwordx4 v2, s[8:11], s58 offen nt lds
v_mfma_f32_16x16x32_bf16 v[72:75], v[24:27], v[144:147], v[72:75]
ds_read_b64_tr_b16 v[22:23], v7 offset:17920
buffer_load_dwordx4 v[176:179], v5, s[20:23], s46 offen
v_mfma_f32_16x16x32_bf16 v[104:107], v[24:27], v[148:151], v[104:107]
s_waitcnt lgkmcnt(7)
v_mfma_f32_16x16x32_bf16 v[44:47], v[28:31], v[140:143], v[44:47]
ds_read_b64_tr_b16 v[24:25], v6 offset:17152
ds_write_b128 v202, v[192:195] offset:1024
buffer_load_dwordx4 v2, s[8:11], s58 offen offset:1024 nt lds
v_mfma_f32_16x16x32_bf16 v[76:79], v[28:31], v[144:147], v[76:79]
ds_read_b64_tr_b16 v[26:27], v6 offset:18176
v_mfma_f32_16x16x32_bf16 v[108:111], v[28:31], v[148:151], v[108:111]
buffer_load_dwordx4 v[180:183], v200, s[20:23], s46 offen
s_waitcnt lgkmcnt(7)
v_mfma_f32_16x16x32_bf16 v[48:51], v[16:19], v[140:143], v[48:51]
ds_read_b64_tr_b16 v[28:29], v7 offset:17152
s_add_u32 m0, s57, 0xa000
s_mov_b32 s59, 0x4a000
buffer_load_dwordx4 v3, s[12:15], s59 offen nt lds
v_mfma_f32_16x16x32_bf16 v[80:83], v[16:19], v[144:147], v[80:83]
ds_read_b64_tr_b16 v[30:31], v7 offset:18176
ds_write_b128 v202, v[196:199] offset:1536
v_mfma_f32_16x16x32_bf16 v[112:115], v[16:19], v[148:151], v[112:115]
s_waitcnt lgkmcnt(6)
v_mfma_f32_16x16x32_bf16 v[52:55], v[20:23], v[140:143], v[52:55]
ds_read_b64_tr_b16 v[16:17], v6 offset:24576
ds_read_b128 v[136:139], v201 offset:3072
buffer_load_dwordx4 v3, s[12:15], s59 offen offset:2048 nt lds
v_mfma_f32_16x16x32_bf16 v[84:87], v[20:23], v[144:147], v[84:87]
ds_read_b64_tr_b16 v[18:19], v6 offset:25600
v_mfma_f32_16x16x32_bf16 v[116:119], v[20:23], v[148:151], v[116:119]
s_waitcnt lgkmcnt(6)
v_mfma_f32_16x16x32_bf16 v[56:59], v[24:27], v[140:143], v[56:59]
ds_read_b64_tr_b16 v[20:21], v7 offset:24576
s_add_u32 s64, s46, 0x4800
buffer_load_dwordx4 v[184:187], v5, s[20:23], s64 offen
v_mfma_f32_16x16x32_bf16 v[88:91], v[24:27], v[144:147], v[88:91]
ds_read_b64_tr_b16 v[22:23], v7 offset:25600
v_mfma_f32_16x16x32_bf16 v[120:123], v[24:27], v[148:151], v[120:123]
s_waitcnt lgkmcnt(6)
v_mfma_f32_16x16x32_bf16 v[60:63], v[28:31], v[140:143], v[60:63]
ds_read_b64_tr_b16 v[24:25], v6 offset:24832
v_mfma_f32_16x16x32_bf16 v[92:95], v[28:31], v[144:147], v[92:95]
ds_read_b64_tr_b16 v[26:27], v6 offset:25856
v_mfma_f32_16x16x32_bf16 v[124:127], v[28:31], v[148:151], v[124:127]
s_waitcnt lgkmcnt(4)
v_mfma_f32_16x16x32_bf16 v[32:35], v[16:19], v[128:131], v[32:35]
ds_read_b64_tr_b16 v[28:29], v7 offset:24832
v_mfma_f32_16x16x32_bf16 v[64:67], v[16:19], v[132:135], v[64:67]
ds_read_b64_tr_b16 v[30:31], v7 offset:25856
v_mfma_f32_16x16x32_bf16 v[96:99], v[16:19], v[136:139], v[96:99]
s_waitcnt lgkmcnt(4)
v_mfma_f32_16x16x32_bf16 v[36:39], v[20:23], v[128:131], v[36:39]
ds_read_b64_tr_b16 v[16:17], v6 offset:25088
v_mfma_f32_16x16x32_bf16 v[68:71], v[20:23], v[132:135], v[68:71]
ds_read_b64_tr_b16 v[18:19], v6 offset:26112
v_mfma_f32_16x16x32_bf16 v[100:103], v[20:23], v[136:139], v[100:103]
s_waitcnt vmcnt(9)
s_barrier
s_add_u32 m0, s56, 0x14000
s_lshl_b32 s66, s45, 12
s_add_u32 s66, s66, 0x40300
buffer_load_dwordx4 v4, s[16:19], s66 offen lds
s_waitcnt lgkmcnt(4)
v_mfma_f32_16x16x32_bf16 v[40:43], v[24:27], v[128:131], v[40:43]
ds_read_b64_tr_b16 v[20:21], v7 offset:25088
ds_read_b128 v[140:143], v11
ds_read_b128 v[144:147], v11 offset:2048
ds_read_b128 v[148:151], v11 offset:1024
s_add_u32 s67, s66, 0x7c00
buffer_load_dwordx4 v4, s[16:19], s67 offen offset:1024 lds
v_mfma_f32_16x16x32_bf16 v[72:75], v[24:27], v[132:135], v[72:75]
ds_read_b64_tr_b16 v[22:23], v7 offset:26112
v_mfma_f32_16x16x32_bf16 v[104:107], v[24:27], v[136:139], v[104:107]
s_add_u32 s64, s46, 0x4800
buffer_load_dwordx4 v[188:191], v200, s[20:23], s64 offen
s_waitcnt lgkmcnt(7)
v_mfma_f32_16x16x32_bf16 v[44:47], v[28:31], v[128:131], v[44:47]
ds_read_b64_tr_b16 v[24:25], v6 offset:25344
s_add_u32 m0, s56, 0
s_mov_b32 s58, 0x50000
buffer_load_dwordx4 v2, s[8:11], s58 offen nt lds
v_mfma_f32_16x16x32_bf16 v[76:79], v[28:31], v[132:135], v[76:79]
ds_read_b64_tr_b16 v[26:27], v6 offset:26368
v_mfma_f32_16x16x32_bf16 v[108:111], v[28:31], v[136:139], v[108:111]
ds_write_b128 v10, v[152:155]
s_waitcnt lgkmcnt(8)
v_mfma_f32_16x16x32_bf16 v[48:51], v[16:19], v[128:131], v[48:51]
ds_read_b64_tr_b16 v[28:29], v7 offset:25344
buffer_load_dwordx4 v2, s[8:11], s58 offen offset:1024 nt lds
v_mfma_f32_16x16x32_bf16 v[80:83], v[16:19], v[132:135], v[80:83]
ds_read_b64_tr_b16 v[30:31], v7 offset:26368
s_add_u32 s64, s46, 0x9000
buffer_load_dwordx4 v[192:195], v5, s[20:23], s64 offen
v_mfma_f32_16x16x32_bf16 v[112:115], v[16:19], v[136:139], v[112:115]
s_waitcnt lgkmcnt(5)
v_mfma_f32_16x16x32_bf16 v[52:55], v[20:23], v[128:131], v[52:55]
ds_read_b64_tr_b16 v[16:17], v6
s_add_u32 m0, s57, 0xc000
s_mov_b32 s59, 0x4c000
buffer_load_dwordx4 v3, s[12:15], s59 offen nt lds
v_mfma_f32_16x16x32_bf16 v[84:87], v[20:23], v[132:135], v[84:87]
ds_read_b64_tr_b16 v[18:19], v6 offset:1024
ds_write_b128 v10, v[156:159] offset:512
v_mfma_f32_16x16x32_bf16 v[116:119], v[20:23], v[136:139], v[116:119]
s_waitcnt lgkmcnt(6)
v_mfma_f32_16x16x32_bf16 v[56:59], v[24:27], v[128:131], v[56:59]
ds_read_b64_tr_b16 v[20:21], v7
s_add_u32 s64, s46, 0x9000
buffer_load_dwordx4 v[196:199], v200, s[20:23], s64 offen
buffer_load_dwordx4 v3, s[12:15], s59 offen offset:2048 nt lds
v_mfma_f32_16x16x32_bf16 v[88:91], v[24:27], v[132:135], v[88:91]
ds_read_b64_tr_b16 v[22:23], v7 offset:1024
v_mfma_f32_16x16x32_bf16 v[120:123], v[24:27], v[136:139], v[120:123]
s_waitcnt lgkmcnt(5)
v_mfma_f32_16x16x32_bf16 v[60:63], v[28:31], v[128:131], v[60:63]
ds_read_b64_tr_b16 v[24:25], v6 offset:256
ds_write_b128 v10, v[160:163] offset:2048
v_mfma_f32_16x16x32_bf16 v[92:95], v[28:31], v[132:135], v[92:95]
ds_read_b64_tr_b16 v[26:27], v6 offset:1280
v_mfma_f32_16x16x32_bf16 v[124:127], v[28:31], v[136:139], v[124:127]
s_waitcnt lgkmcnt(6)
v_mfma_f32_16x16x32_bf16 v[32:35], v[16:19], v[140:143], v[32:35]
ds_read_b64_tr_b16 v[28:29], v7 offset:256
v_mfma_f32_16x16x32_bf16 v[64:67], v[16:19], v[144:147], v[64:67]
ds_read_b64_tr_b16 v[30:31], v7 offset:1280
v_mfma_f32_16x16x32_bf16 v[96:99], v[16:19], v[148:151], v[96:99]
s_waitcnt lgkmcnt(5)
v_mfma_f32_16x16x32_bf16 v[36:39], v[20:23], v[140:143], v[36:39]
ds_read_b64_tr_b16 v[16:17], v6 offset:512
v_mfma_f32_16x16x32_bf16 v[68:71], v[20:23], v[144:147], v[68:71]
ds_read_b64_tr_b16 v[18:19], v6 offset:1536
v_mfma_f32_16x16x32_bf16 v[100:103], v[20:23], v[148:151], v[100:103]
s_waitcnt lgkmcnt(4)
v_mfma_f32_16x16x32_bf16 v[40:43], v[24:27], v[140:143], v[40:43]
ds_read_b64_tr_b16 v[20:21], v7 offset:512
v_mfma_f32_16x16x32_bf16 v[72:75], v[24:27], v[144:147], v[72:75]
ds_read_b64_tr_b16 v[22:23], v7 offset:1536
v_mfma_f32_16x16x32_bf16 v[104:107], v[24:27], v[148:151], v[104:107]
s_waitcnt vmcnt(10)
s_barrier
s_add_u32 m0, s56, 0x16000
s_lshl_b32 s66, s46, 12
s_add_u32 s66, s66, 0x300
buffer_load_dwordx4 v4, s[16:19], s66 offen lds
s_waitcnt lgkmcnt(4)
v_mfma_f32_16x16x32_bf16 v[44:47], v[28:31], v[140:143], v[44:47]
ds_read_b64_tr_b16 v[24:25], v6 offset:768
ds_write_b128 v10, v[164:167] offset:2560
s_add_u32 s67, s66, 0x7c00
buffer_load_dwordx4 v4, s[16:19], s67 offen offset:1024 lds
v_mfma_f32_16x16x32_bf16 v[76:79], v[28:31], v[144:147], v[76:79]
ds_read_b64_tr_b16 v[26:27], v6 offset:1792
ds_read_b128 v[128:131], v201 offset:1024
ds_read_b128 v[132:135], v201 offset:3072
v_mfma_f32_16x16x32_bf16 v[108:111], v[28:31], v[148:151], v[108:111]
s_waitcnt lgkmcnt(7)
v_mfma_f32_16x16x32_bf16 v[48:51], v[16:19], v[140:143], v[48:51]
ds_read_b64_tr_b16 v[28:29], v7 offset:768
buffer_load_dwordx4 v[152:155], v5, s[20:23], s47 offen
s_add_u32 m0, s56, 0x2000
s_mov_b32 s58, 0x52000
buffer_load_dwordx4 v2, s[8:11], s58 offen nt lds
v_mfma_f32_16x16x32_bf16 v[80:83], v[16:19], v[144:147], v[80:83]
ds_read_b64_tr_b16 v[30:31], v7 offset:1792
v_mfma_f32_16x16x32_bf16 v[112:115], v[16:19], v[148:151], v[112:115]
ds_write_b128 v202, v[168:171] offset:1024
s_waitcnt lgkmcnt(8)
v_mfma_f32_16x16x32_bf16 v[52:55], v[20:23], v[140:143], v[52:55]
ds_read_b64_tr_b16 v[16:17], v6 offset:8192
buffer_load_dwordx4 v[156:159], v200, s[20:23], s47 offen
buffer_load_dwordx4 v2, s[8:11], s58 offen offset:1024 nt lds
v_mfma_f32_16x16x32_bf16 v[84:87], v[20:23], v[144:147], v[84:87]
ds_read_b64_tr_b16 v[18:19], v6 offset:9216
v_mfma_f32_16x16x32_bf16 v[116:119], v[20:23], v[148:151], v[116:119]
ds_write_b128 v202, v[172:175] offset:1536
s_waitcnt lgkmcnt(8)
v_mfma_f32_16x16x32_bf16 v[56:59], v[24:27], v[140:143], v[56:59]
ds_read_b64_tr_b16 v[20:21], v7 offset:8192
s_add_u32 m0, s57, 0xe000
s_mov_b32 s59, 0x4e000
buffer_load_dwordx4 v3, s[12:15], s59 offen nt lds
v_mfma_f32_16x16x32_bf16 v[88:91], v[24:27], v[144:147], v[88:91]
ds_read_b64_tr_b16 v[22:23], v7 offset:9216
ds_read_b128 v[136:139], v201 offset:3072
v_mfma_f32_16x16x32_bf16 v[120:123], v[24:27], v[148:151], v[120:123]
s_waitcnt lgkmcnt(7)
v_mfma_f32_16x16x32_bf16 v[60:63], v[28:31], v[140:143], v[60:63]
ds_read_b64_tr_b16 v[24:25], v6 offset:8448
s_add_u32 s64, s47, 0x4800
buffer_load_dwordx4 v[160:163], v5, s[20:23], s64 offen
buffer_load_dwordx4 v3, s[12:15], s59 offen offset:2048 nt lds
v_mfma_f32_16x16x32_bf16 v[92:95], v[28:31], v[144:147], v[92:95]
ds_read_b64_tr_b16 v[26:27], v6 offset:9472
v_mfma_f32_16x16x32_bf16 v[124:127], v[28:31], v[148:151], v[124:127]
s_waitcnt lgkmcnt(2)
v_mfma_f32_16x16x32_bf16 v[32:35], v[16:19], v[128:131], v[32:35]
ds_read_b64_tr_b16 v[28:29], v7 offset:8448
v_mfma_f32_16x16x32_bf16 v[64:67], v[16:19], v[132:135], v[64:67]
ds_read_b64_tr_b16 v[30:31], v7 offset:9472
v_mfma_f32_16x16x32_bf16 v[96:99], v[16:19], v[136:139], v[96:99]
v_mfma_f32_16x16x32_bf16 v[36:39], v[20:23], v[128:131], v[36:39]
ds_read_b64_tr_b16 v[16:17], v6 offset:8704
v_mfma_f32_16x16x32_bf16 v[68:71], v[20:23], v[132:135], v[68:71]
ds_read_b64_tr_b16 v[18:19], v6 offset:9728
v_mfma_f32_16x16x32_bf16 v[100:103], v[20:23], v[136:139], v[100:103]
s_waitcnt lgkmcnt(4)
v_mfma_f32_16x16x32_bf16 v[40:43], v[24:27], v[128:131], v[40:43]
ds_read_b64_tr_b16 v[20:21], v7 offset:8704
v_mfma_f32_16x16x32_bf16 v[72:75], v[24:27], v[132:135], v[72:75]
ds_read_b64_tr_b16 v[22:23], v7 offset:9728
v_mfma_f32_16x16x32_bf16 v[104:107], v[24:27], v[136:139], v[104:107]
s_waitcnt lgkmcnt(4)
v_mfma_f32_16x16x32_bf16 v[44:47], v[28:31], v[128:131], v[44:47]
ds_read_b64_tr_b16 v[24:25], v6 offset:8960
v_mfma_f32_16x16x32_bf16 v[76:79], v[28:31], v[132:135], v[76:79]
ds_read_b64_tr_b16 v[26:27], v6 offset:9984
v_mfma_f32_16x16x32_bf16 v[108:111], v[28:31], v[136:139], v[108:111]
s_waitcnt vmcnt(9)
s_barrier
s_add_u32 m0, s56, 0x10000
s_lshl_b32 s66, s46, 12
s_add_u32 s66, s66, 0x40300
buffer_load_dwordx4 v4, s[16:19], s66 offen lds
s_waitcnt lgkmcnt(4)
v_mfma_f32_16x16x32_bf16 v[48:51], v[16:19], v[128:131], v[48:51]
ds_read_b64_tr_b16 v[28:29], v7 offset:8960
ds_read_b128 v[140:143], v11
ds_read_b128 v[144:147], v11 offset:2048
ds_read_b128 v[148:151], v11 offset:1024
s_add_u32 s67, s66, 0x7c00
buffer_load_dwordx4 v4, s[16:19], s67 offen offset:1024 lds
v_mfma_f32_16x16x32_bf16 v[80:83], v[16:19], v[132:135], v[80:83]
ds_read_b64_tr_b16 v[30:31], v7 offset:9984
s_add_u32 s64, s47, 0x4800
buffer_load_dwordx4 v[164:167], v200, s[20:23], s64 offen
v_mfma_f32_16x16x32_bf16 v[112:115], v[16:19], v[136:139], v[112:115]
s_waitcnt lgkmcnt(7)
v_mfma_f32_16x16x32_bf16 v[52:55], v[20:23], v[128:131], v[52:55]
ds_read_b64_tr_b16 v[16:17], v6 offset:16384
ds_write_b128 v10, v[176:179]
s_add_u32 m0, s56, 0x4000
s_mov_b32 s58, 0x54000
buffer_load_dwordx4 v2, s[8:11], s58 offen nt lds
v_mfma_f32_16x16x32_bf16 v[84:87], v[20:23], v[132:135], v[84:87]
ds_read_b64_tr_b16 v[18:19], v6 offset:17408
s_add_u32 s64, s47, 0x9000
buffer_load_dwordx4 v[168:171], v5, s[20:23], s64 offen
v_mfma_f32_16x16x32_bf16 v[116:119], v[20:23], v[136:139], v[116:119]
s_waitcnt lgkmcnt(8)
v_mfma_f32_16x16x32_bf16 v[56:59], v[24:27], v[128:131], v[56:59]
ds_read_b64_tr_b16 v[20:21], v7 offset:16384
ds_write_b128 v10, v[180:183] offset:512
buffer_load_dwordx4 v2, s[8:11], s58 offen offset:1024 nt lds
v_mfma_f32_16x16x32_bf16 v[88:91], v[24:27], v[132:135], v[88:91]
ds_read_b64_tr_b16 v[22:23], v7 offset:17408
s_add_u32 s64, s47, 0x9000
buffer_load_dwordx4 v[172:175], v200, s[20:23], s64 offen
v_mfma_f32_16x16x32_bf16 v[120:123], v[24:27], v[136:139], v[120:123]
s_waitcnt lgkmcnt(6)
v_mfma_f32_16x16x32_bf16 v[60:63], v[28:31], v[128:131], v[60:63]
ds_read_b64_tr_b16 v[24:25], v6 offset:16640
ds_write_b128 v10, v[184:187] offset:2048
s_add_u32 m0, s57, 0x8000
s_mov_b32 s59, 0x50000
buffer_load_dwordx4 v3, s[12:15], s59 offen nt lds
v_mfma_f32_16x16x32_bf16 v[92:95], v[28:31], v[132:135], v[92:95]
ds_read_b64_tr_b16 v[26:27], v6 offset:17664
v_mfma_f32_16x16x32_bf16 v[124:127], v[28:31], v[136:139], v[124:127]
s_waitcnt lgkmcnt(6)
v_mfma_f32_16x16x32_bf16 v[32:35], v[16:19], v[140:143], v[32:35]
ds_read_b64_tr_b16 v[28:29], v7 offset:16640
buffer_load_dwordx4 v3, s[12:15], s59 offen offset:2048 nt lds
v_mfma_f32_16x16x32_bf16 v[64:67], v[16:19], v[144:147], v[64:67]
ds_read_b64_tr_b16 v[30:31], v7 offset:17664
ds_write_b128 v10, v[188:191] offset:2560
v_mfma_f32_16x16x32_bf16 v[96:99], v[16:19], v[148:151], v[96:99]
ds_read_b128 v[128:131], v201 offset:1024
ds_read_b128 v[132:135], v201 offset:3072
s_waitcnt lgkmcnt(8)
v_mfma_f32_16x16x32_bf16 v[36:39], v[20:23], v[140:143], v[36:39]
ds_read_b64_tr_b16 v[16:17], v6 offset:16896
buffer_load_dwordx4 v[176:179], v5, s[20:23], s48 offen
v_mfma_f32_16x16x32_bf16 v[68:71], v[20:23], v[144:147], v[68:71]
ds_read_b64_tr_b16 v[18:19], v6 offset:17920
v_mfma_f32_16x16x32_bf16 v[100:103], v[20:23], v[148:151], v[100:103]
s_waitcnt lgkmcnt(7)
v_mfma_f32_16x16x32_bf16 v[40:43], v[24:27], v[140:143], v[40:43]
ds_read_b64_tr_b16 v[20:21], v7 offset:16896
v_mfma_f32_16x16x32_bf16 v[72:75], v[24:27], v[144:147], v[72:75]
ds_read_b64_tr_b16 v[22:23], v7 offset:17920
v_mfma_f32_16x16x32_bf16 v[104:107], v[24:27], v[148:151], v[104:107]
s_waitcnt lgkmcnt(7)
v_mfma_f32_16x16x32_bf16 v[44:47], v[28:31], v[140:143], v[44:47]
ds_read_b64_tr_b16 v[24:25], v6 offset:17152
v_mfma_f32_16x16x32_bf16 v[76:79], v[28:31], v[144:147], v[76:79]
ds_read_b64_tr_b16 v[26:27], v6 offset:18176
v_mfma_f32_16x16x32_bf16 v[108:111], v[28:31], v[148:151], v[108:111]
s_waitcnt lgkmcnt(4)
v_mfma_f32_16x16x32_bf16 v[48:51], v[16:19], v[140:143], v[48:51]
ds_read_b64_tr_b16 v[28:29], v7 offset:17152
v_mfma_f32_16x16x32_bf16 v[80:83], v[16:19], v[144:147], v[80:83]
ds_read_b64_tr_b16 v[30:31], v7 offset:18176
v_mfma_f32_16x16x32_bf16 v[112:115], v[16:19], v[148:151], v[112:115]
s_waitcnt vmcnt(10)
s_barrier
s_add_u32 m0, s56, 0x12000
s_lshl_b32 s66, s47, 12
s_add_u32 s66, s66, 0x300
buffer_load_dwordx4 v4, s[16:19], s66 offen lds
s_waitcnt lgkmcnt(4)
v_mfma_f32_16x16x32_bf16 v[52:55], v[20:23], v[140:143], v[52:55]
ds_read_b64_tr_b16 v[16:17], v6 offset:24576
ds_write_b128 v202, v[192:195] offset:1024
s_add_u32 s67, s66, 0x7c00
buffer_load_dwordx4 v4, s[16:19], s67 offen offset:1024 lds
v_mfma_f32_16x16x32_bf16 v[84:87], v[20:23], v[144:147], v[84:87]
ds_read_b64_tr_b16 v[18:19], v6 offset:25600
v_mfma_f32_16x16x32_bf16 v[116:119], v[20:23], v[148:151], v[116:119]
buffer_load_dwordx4 v[180:183], v200, s[20:23], s48 offen
s_waitcnt lgkmcnt(5)
v_mfma_f32_16x16x32_bf16 v[56:59], v[24:27], v[140:143], v[56:59]
ds_read_b64_tr_b16 v[20:21], v7 offset:24576
ds_write_b128 v202, v[196:199] offset:1536
s_add_u32 m0, s56, 0x6000
s_mov_b32 s58, 0x56000
buffer_load_dwordx4 v2, s[8:11], s58 offen nt lds
v_mfma_f32_16x16x32_bf16 v[88:91], v[24:27], v[144:147], v[88:91]
ds_read_b64_tr_b16 v[22:23], v7 offset:25600
ds_read_b128 v[136:139], v201 offset:3072
v_mfma_f32_16x16x32_bf16 v[120:123], v[24:27], v[148:151], v[120:123]
s_waitcnt lgkmcnt(7)
v_mfma_f32_16x16x32_bf16 v[60:63], v[28:31], v[140:143], v[60:63]
ds_read_b64_tr_b16 v[24:25], v6 offset:24832
s_add_u32 s64, s48, 0x4800
buffer_load_dwordx4 v[184:187], v5, s[20:23], s64 offen
buffer_load_dwordx4 v2, s[8:11], s58 offen offset:1024 nt lds
v_mfma_f32_16x16x32_bf16 v[92:95], v[28:31], v[144:147], v[92:95]
ds_read_b64_tr_b16 v[26:27], v6 offset:25856
v_mfma_f32_16x16x32_bf16 v[124:127], v[28:31], v[148:151], v[124:127]
s_waitcnt lgkmcnt(2)
v_mfma_f32_16x16x32_bf16 v[32:35], v[16:19], v[128:131], v[32:35]
ds_read_b64_tr_b16 v[28:29], v7 offset:24832
s_add_u32 m0, s57, 0xa000
s_mov_b32 s59, 0x52000
buffer_load_dwordx4 v3, s[12:15], s59 offen nt lds
v_mfma_f32_16x16x32_bf16 v[64:67], v[16:19], v[132:135], v[64:67]
ds_read_b64_tr_b16 v[30:31], v7 offset:25856
ds_read_b128 v[140:143], v11
ds_read_b128 v[144:147], v11 offset:2048
ds_read_b128 v[148:151], v11 offset:1024
v_mfma_f32_16x16x32_bf16 v[96:99], v[16:19], v[136:139], v[96:99]
s_add_u32 s64, s48, 0x4800
buffer_load_dwordx4 v[188:191], v200, s[20:23], s64 offen
v_mfma_f32_16x16x32_bf16 v[36:39], v[20:23], v[128:131], v[36:39]
ds_read_b64_tr_b16 v[16:17], v6 offset:25088
buffer_load_dwordx4 v3, s[12:15], s59 offen offset:2048 nt lds
v_mfma_f32_16x16x32_bf16 v[68:71], v[20:23], v[132:135], v[68:71]
ds_read_b64_tr_b16 v[18:19], v6 offset:26112
ds_write_b128 v10, v[152:155]
v_mfma_f32_16x16x32_bf16 v[100:103], v[20:23], v[136:139], v[100:103]
s_add_u32 s64, s48, 0x9000
buffer_load_dwordx4 v[192:195], v5, s[20:23], s64 offen
s_waitcnt lgkmcnt(8)
v_mfma_f32_16x16x32_bf16 v[40:43], v[24:27], v[128:131], v[40:43]
ds_read_b64_tr_b16 v[20:21], v7 offset:25088
v_mfma_f32_16x16x32_bf16 v[72:75], v[24:27], v[132:135], v[72:75]
ds_read_b64_tr_b16 v[22:23], v7 offset:26112
v_mfma_f32_16x16x32_bf16 v[104:107], v[24:27], v[136:139], v[104:107]
s_waitcnt lgkmcnt(8)
v_mfma_f32_16x16x32_bf16 v[44:47], v[28:31], v[128:131], v[44:47]
ds_read_b64_tr_b16 v[24:25], v6 offset:25344
v_mfma_f32_16x16x32_bf16 v[76:79], v[28:31], v[132:135], v[76:79]
ds_read_b64_tr_b16 v[26:27], v6 offset:26368
v_mfma_f32_16x16x32_bf16 v[108:111], v[28:31], v[136:139], v[108:111]
s_waitcnt lgkmcnt(5)
v_mfma_f32_16x16x32_bf16 v[48:51], v[16:19], v[128:131], v[48:51]
ds_read_b64_tr_b16 v[28:29], v7 offset:25344
v_mfma_f32_16x16x32_bf16 v[80:83], v[16:19], v[132:135], v[80:83]
ds_read_b64_tr_b16 v[30:31], v7 offset:26368
v_mfma_f32_16x16x32_bf16 v[112:115], v[16:19], v[136:139], v[112:115]
s_waitcnt lgkmcnt(4)
v_mfma_f32_16x16x32_bf16 v[52:55], v[20:23], v[128:131], v[52:55]
v_mfma_f32_16x16x32_bf16 v[84:87], v[20:23], v[132:135], v[84:87]
v_mfma_f32_16x16x32_bf16 v[116:119], v[20:23], v[136:139], v[116:119]
s_waitcnt vmcnt(11)
s_barrier
ds_read_b64_tr_b16 v[16:17], v6
ds_read_b64_tr_b16 v[18:19], v6 offset:1024
s_add_u32 m0, s56, 0x14000
s_lshl_b32 s66, s47, 12
s_add_u32 s66, s66, 0x40300
buffer_load_dwordx4 v4, s[16:19], s66 offen lds
s_waitcnt lgkmcnt(4)
v_mfma_f32_16x16x32_bf16 v[56:59], v[24:27], v[128:131], v[56:59]
ds_read_b64_tr_b16 v[20:21], v7
ds_write_b128 v10, v[156:159] offset:512
s_add_u32 s67, s66, 0x7c00
buffer_load_dwordx4 v4, s[16:19], s67 offen offset:1024 lds
v_mfma_f32_16x16x32_bf16 v[88:91], v[24:27], v[132:135], v[88:91]
ds_read_b64_tr_b16 v[22:23], v7 offset:1024
s_add_u32 s64, s48, 0x9000
buffer_load_dwordx4 v[196:199], v200, s[20:23], s64 offen
v_mfma_f32_16x16x32_bf16 v[120:123], v[24:27], v[136:139], v[120:123]
s_waitcnt lgkmcnt(5)
v_mfma_f32_16x16x32_bf16 v[60:63], v[28:31], v[128:131], v[60:63]
ds_read_b64_tr_b16 v[24:25], v6 offset:256
ds_write_b128 v10, v[160:163] offset:2048
s_add_u32 m0, s56, 0
s_mov_b32 s58, 0x58000
buffer_load_dwordx4 v2, s[8:11], s58 offen nt lds
v_mfma_f32_16x16x32_bf16 v[92:95], v[28:31], v[132:135], v[92:95]
ds_read_b64_tr_b16 v[26:27], v6 offset:1280
v_mfma_f32_16x16x32_bf16 v[124:127], v[28:31], v[136:139], v[124:127]
s_waitcnt lgkmcnt(6)
v_mfma_f32_16x16x32_bf16 v[32:35], v[16:19], v[140:143], v[32:35]
ds_read_b64_tr_b16 v[28:29], v7 offset:256
buffer_load_dwordx4 v2, s[8:11], s58 offen offset:1024 nt lds
v_mfma_f32_16x16x32_bf16 v[64:67], v[16:19], v[144:147], v[64:67]
ds_read_b64_tr_b16 v[30:31], v7 offset:1280
ds_write_b128 v10, v[164:167] offset:2560
v_mfma_f32_16x16x32_bf16 v[96:99], v[16:19], v[148:151], v[96:99]
ds_read_b128 v[128:131], v201 offset:1024
ds_read_b128 v[132:135], v201 offset:3072
s_waitcnt lgkmcnt(8)
v_mfma_f32_16x16x32_bf16 v[36:39], v[20:23], v[140:143], v[36:39]
ds_read_b64_tr_b16 v[16:17], v6 offset:512
s_add_u32 m0, s57, 0xc000
s_mov_b32 s59, 0x54000
buffer_load_dwordx4 v3, s[12:15], s59 offen nt lds
v_mfma_f32_16x16x32_bf16 v[68:71], v[20:23], v[144:147], v[68:71]
ds_read_b64_tr_b16 v[18:19], v6 offset:1536
ds_write_b128 v202, v[168:171] offset:1024
v_mfma_f32_16x16x32_bf16 v[100:103], v[20:23], v[148:151], v[100:103]
s_waitcnt lgkmcnt(8)
v_mfma_f32_16x16x32_bf16 v[40:43], v[24:27], v[140:143], v[40:43]
ds_read_b64_tr_b16 v[20:21], v7 offset:512
buffer_load_dwordx4 v3, s[12:15], s59 offen offset:2048 nt lds
v_mfma_f32_16x16x32_bf16 v[72:75], v[24:27], v[144:147], v[72:75]
ds_read_b64_tr_b16 v[22:23], v7 offset:1536
ds_write_b128 v202, v[172:175] offset:1536
v_mfma_f32_16x16x32_bf16 v[104:107], v[24:27], v[148:151], v[104:107]
ds_read_b128 v[136:139], v201 offset:3072
s_waitcnt lgkmcnt(10)
v_mfma_f32_16x16x32_bf16 v[44:47], v[28:31], v[140:143], v[44:47]
ds_read_b64_tr_b16 v[24:25], v6 offset:768
v_mfma_f32_16x16x32_bf16 v[76:79], v[28:31], v[144:147], v[76:79]
ds_read_b64_tr_b16 v[26:27], v6 offset:1792
v_mfma_f32_16x16x32_bf16 v[108:111], v[28:31], v[148:151], v[108:111]
s_waitcnt lgkmcnt(7)
v_mfma_f32_16x16x32_bf16 v[48:51], v[16:19], v[140:143], v[48:51]
ds_read_b64_tr_b16 v[28:29], v7 offset:768
v_mfma_f32_16x16x32_bf16 v[80:83], v[16:19], v[144:147], v[80:83]
ds_read_b64_tr_b16 v[30:31], v7 offset:1792
v_mfma_f32_16x16x32_bf16 v[112:115], v[16:19], v[148:151], v[112:115]
s_waitcnt lgkmcnt(6)
v_mfma_f32_16x16x32_bf16 v[52:55], v[20:23], v[140:143], v[52:55]
v_mfma_f32_16x16x32_bf16 v[84:87], v[20:23], v[144:147], v[84:87]
v_mfma_f32_16x16x32_bf16 v[116:119], v[20:23], v[148:151], v[116:119]
s_waitcnt lgkmcnt(2)
v_mfma_f32_16x16x32_bf16 v[56:59], v[24:27], v[140:143], v[56:59]
v_mfma_f32_16x16x32_bf16 v[88:91], v[24:27], v[144:147], v[88:91]
v_mfma_f32_16x16x32_bf16 v[120:123], v[24:27], v[148:151], v[120:123]
s_waitcnt vmcnt(8)
s_barrier
ds_read_b64_tr_b16 v[16:17], v6 offset:8192
ds_read_b64_tr_b16 v[18:19], v6 offset:9216
ds_read_b64_tr_b16 v[20:21], v7 offset:8192
ds_read_b64_tr_b16 v[22:23], v7 offset:9216
s_add_u32 m0, s56, 0x16000
s_lshl_b32 s66, s48, 12
s_add_u32 s66, s66, 0x300
buffer_load_dwordx4 v4, s[16:19], s66 offen lds
s_waitcnt lgkmcnt(4)
v_mfma_f32_16x16x32_bf16 v[60:63], v[28:31], v[140:143], v[60:63]
ds_read_b64_tr_b16 v[24:25], v6 offset:8448
s_add_u32 s67, s66, 0x7c00
buffer_load_dwordx4 v4, s[16:19], s67 offen offset:1024 lds
v_mfma_f32_16x16x32_bf16 v[92:95], v[28:31], v[144:147], v[92:95]
ds_read_b64_tr_b16 v[26:27], v6 offset:9472
v_mfma_f32_16x16x32_bf16 v[124:127], v[28:31], v[148:151], v[124:127]
s_waitcnt lgkmcnt(4)
v_mfma_f32_16x16x32_bf16 v[32:35], v[16:19], v[128:131], v[32:35]
ds_read_b64_tr_b16 v[28:29], v7 offset:8448
s_add_u32 m0, s56, 0x2000
s_mov_b32 s58, 0x5a000
buffer_load_dwordx4 v2, s[8:11], s58 offen nt lds
v_mfma_f32_16x16x32_bf16 v[64:67], v[16:19], v[132:135], v[64:67]
ds_read_b64_tr_b16 v[30:31], v7 offset:9472
ds_read_b128 v[140:143], v11
ds_read_b128 v[144:147], v11 offset:2048
ds_read_b128 v[148:151], v11 offset:1024
v_mfma_f32_16x16x32_bf16 v[96:99], v[16:19], v[136:139], v[96:99]
s_waitcnt lgkmcnt(7)
v_mfma_f32_16x16x32_bf16 v[36:39], v[20:23], v[128:131], v[36:39]
ds_read_b64_tr_b16 v[16:17], v6 offset:8704
buffer_load_dwordx4 v2, s[8:11], s58 offen offset:1024 nt lds
v_mfma_f32_16x16x32_bf16 v[68:71], v[20:23], v[132:135], v[68:71]
ds_read_b64_tr_b16 v[18:19], v6 offset:9728
ds_write_b128 v10, v[176:179]
v_mfma_f32_16x16x32_bf16 v[100:103], v[20:23], v[136:139], v[100:103]
s_waitcnt lgkmcnt(8)
v_mfma_f32_16x16x32_bf16 v[40:43], v[24:27], v[128:131], v[40:43]
ds_read_b64_tr_b16 v[20:21], v7 offset:8704
s_add_u32 m0, s57, 0xe000
s_mov_b32 s59, 0x56000
buffer_load_dwordx4 v3, s[12:15], s59 offen nt lds
v_mfma_f32_16x16x32_bf16 v[72:75], v[24:27], v[132:135], v[72:75]
ds_read_b64_tr_b16 v[22:23], v7 offset:9728
v_mfma_f32_16x16x32_bf16 v[104:107], v[24:27], v[136:139], v[104:107]
ds_write_b128 v10, v[180:183] offset:512
s_waitcnt lgkmcnt(9)
v_mfma_f32_16x16x32_bf16 v[44:47], v[28:31], v[128:131], v[44:47]
ds_read_b64_tr_b16 v[24:25], v6 offset:8960
buffer_load_dwordx4 v3, s[12:15], s59 offen offset:2048 nt lds
v_mfma_f32_16x16x32_bf16 v[76:79], v[28:31], v[132:135], v[76:79]
ds_read_b64_tr_b16 v[26:27], v6 offset:9984
v_mfma_f32_16x16x32_bf16 v[108:111], v[28:31], v[136:139], v[108:111]
s_waitcnt lgkmcnt(6)
v_mfma_f32_16x16x32_bf16 v[48:51], v[16:19], v[128:131], v[48:51]
ds_read_b64_tr_b16 v[28:29], v7 offset:8960
ds_write_b128 v10, v[184:187] offset:2048
v_mfma_f32_16x16x32_bf16 v[80:83], v[16:19], v[132:135], v[80:83]
ds_read_b64_tr_b16 v[30:31], v7 offset:9984
v_mfma_f32_16x16x32_bf16 v[112:115], v[16:19], v[136:139], v[112:115]
s_waitcnt lgkmcnt(6)
v_mfma_f32_16x16x32_bf16 v[52:55], v[20:23], v[128:131], v[52:55]
v_mfma_f32_16x16x32_bf16 v[84:87], v[20:23], v[132:135], v[84:87]
v_mfma_f32_16x16x32_bf16 v[116:119], v[20:23], v[136:139], v[116:119]
s_waitcnt lgkmcnt(3)
v_mfma_f32_16x16x32_bf16 v[56:59], v[24:27], v[128:131], v[56:59]
v_mfma_f32_16x16x32_bf16 v[88:91], v[24:27], v[132:135], v[88:91]
v_mfma_f32_16x16x32_bf16 v[120:123], v[24:27], v[136:139], v[120:123]
s_waitcnt lgkmcnt(0)
v_mfma_f32_16x16x32_bf16 v[60:63], v[28:31], v[128:131], v[60:63]
v_mfma_f32_16x16x32_bf16 v[92:95], v[28:31], v[132:135], v[92:95]
v_mfma_f32_16x16x32_bf16 v[124:127], v[28:31], v[136:139], v[124:127]
s_waitcnt vmcnt(4)
s_barrier
ds_read_b64_tr_b16 v[16:17], v6 offset:16384
ds_read_b64_tr_b16 v[18:19], v6 offset:17408
ds_read_b64_tr_b16 v[20:21], v7 offset:16384
ds_read_b64_tr_b16 v[22:23], v7 offset:17408
ds_read_b64_tr_b16 v[24:25], v6 offset:16640
ds_read_b64_tr_b16 v[26:27], v6 offset:17664
s_add_u32 m0, s56, 0x10000
s_lshl_b32 s66, s48, 12
s_add_u32 s66, s66, 0x40300
buffer_load_dwordx4 v4, s[16:19], s66 offen lds
s_waitcnt lgkmcnt(4)
v_mfma_f32_16x16x32_bf16 v[32:35], v[16:19], v[140:143], v[32:35]
ds_read_b64_tr_b16 v[28:29], v7 offset:16640
s_add_u32 s67, s66, 0x7c00
buffer_load_dwordx4 v4, s[16:19], s67 offen offset:1024 lds
v_mfma_f32_16x16x32_bf16 v[64:67], v[16:19], v[144:147], v[64:67]
ds_read_b64_tr_b16 v[30:31], v7 offset:17664
ds_write_b128 v10, v[188:191] offset:2560
v_mfma_f32_16x16x32_bf16 v[96:99], v[16:19], v[148:151], v[96:99]
s_waitcnt lgkmcnt(5)
v_mfma_f32_16x16x32_bf16 v[36:39], v[20:23], v[140:143], v[36:39]
ds_read_b64_tr_b16 v[16:17], v6 offset:16896
ds_read_b128 v[128:131], v201 offset:1024
ds_read_b128 v[132:135], v201 offset:3072
s_add_u32 m0, s56, 0x4000
s_mov_b32 s58, 0x5c000
buffer_load_dwordx4 v2, s[8:11], s58 offen nt lds
v_mfma_f32_16x16x32_bf16 v[68:71], v[20:23], v[144:147], v[68:71]
ds_read_b64_tr_b16 v[18:19], v6 offset:17920
v_mfma_f32_16x16x32_bf16 v[100:103], v[20:23], v[148:151], v[100:103]
s_waitcnt lgkmcnt(7)
v_mfma_f32_16x16x32_bf16 v[40:43], v[24:27], v[140:143], v[40:43]
ds_read_b64_tr_b16 v[20:21], v7 offset:16896
buffer_load_dwordx4 v2, s[8:11], s58 offen offset:1024 nt lds
v_mfma_f32_16x16x32_bf16 v[72:75], v[24:27], v[144:147], v[72:75]
ds_read_b64_tr_b16 v[22:23], v7 offset:17920
ds_write_b128 v202, v[192:195] offset:1024
v_mfma_f32_16x16x32_bf16 v[104:107], v[24:27], v[148:151], v[104:107]
s_waitcnt lgkmcnt(8)
v_mfma_f32_16x16x32_bf16 v[44:47], v[28:31], v[140:143], v[44:47]
ds_read_b64_tr_b16 v[24:25], v6 offset:17152
s_add_u32 m0, s57, 0x8000
s_mov_b32 s59, 0x58000
buffer_load_dwordx4 v3, s[12:15], s59 offen nt lds
v_mfma_f32_16x16x32_bf16 v[76:79], v[28:31], v[144:147], v[76:79]
ds_read_b64_tr_b16 v[26:27], v6 offset:18176
v_mfma_f32_16x16x32_bf16 v[108:111], v[28:31], v[148:151], v[108:111]
ds_write_b128 v202, v[196:199] offset:1536
s_waitcnt lgkmcnt(6)
v_mfma_f32_16x16x32_bf16 v[48:51], v[16:19], v[140:143], v[48:51]
ds_read_b64_tr_b16 v[28:29], v7 offset:17152
buffer_load_dwordx4 v3, s[12:15], s59 offen offset:2048 nt lds
v_mfma_f32_16x16x32_bf16 v[80:83], v[16:19], v[144:147], v[80:83]
ds_read_b64_tr_b16 v[30:31], v7 offset:18176
ds_read_b128 v[136:139], v201 offset:3072
v_mfma_f32_16x16x32_bf16 v[112:115], v[16:19], v[148:151], v[112:115]
s_waitcnt lgkmcnt(7)
v_mfma_f32_16x16x32_bf16 v[52:55], v[20:23], v[140:143], v[52:55]
ds_read_b64_tr_b16 v[16:17], v6 offset:24576
v_mfma_f32_16x16x32_bf16 v[84:87], v[20:23], v[144:147], v[84:87]
ds_read_b64_tr_b16 v[18:19], v6 offset:25600
v_mfma_f32_16x16x32_bf16 v[116:119], v[20:23], v[148:151], v[116:119]
s_waitcnt lgkmcnt(6)
v_mfma_f32_16x16x32_bf16 v[56:59], v[24:27], v[140:143], v[56:59]
ds_read_b64_tr_b16 v[20:21], v7 offset:24576
v_mfma_f32_16x16x32_bf16 v[88:91], v[24:27], v[144:147], v[88:91]
ds_read_b64_tr_b16 v[22:23], v7 offset:25600
v_mfma_f32_16x16x32_bf16 v[120:123], v[24:27], v[148:151], v[120:123]
s_waitcnt lgkmcnt(5)
v_mfma_f32_16x16x32_bf16 v[60:63], v[28:31], v[140:143], v[60:63]
ds_read_b64_tr_b16 v[24:25], v6 offset:24832
v_mfma_f32_16x16x32_bf16 v[92:95], v[28:31], v[144:147], v[92:95]
ds_read_b64_tr_b16 v[26:27], v6 offset:25856
v_mfma_f32_16x16x32_bf16 v[124:127], v[28:31], v[148:151], v[124:127]
s_waitcnt lgkmcnt(4)
v_mfma_f32_16x16x32_bf16 v[32:35], v[16:19], v[128:131], v[32:35]
ds_read_b64_tr_b16 v[28:29], v7 offset:24832
v_mfma_f32_16x16x32_bf16 v[64:67], v[16:19], v[132:135], v[64:67]
ds_read_b64_tr_b16 v[30:31], v7 offset:25856
v_mfma_f32_16x16x32_bf16 v[96:99], v[16:19], v[136:139], v[96:99]
s_waitcnt vmcnt(4)
s_barrier
s_add_u32 m0, s56, 0x6000
s_mov_b32 s58, 0x5e000
buffer_load_dwordx4 v2, s[8:11], s58 offen nt lds
s_waitcnt lgkmcnt(4)
v_mfma_f32_16x16x32_bf16 v[36:39], v[20:23], v[128:131], v[36:39]
ds_read_b64_tr_b16 v[16:17], v6 offset:25088
ds_read_b128 v[140:143], v11
ds_read_b128 v[144:147], v11 offset:2048
ds_read_b128 v[148:151], v11 offset:1024
buffer_load_dwordx4 v2, s[8:11], s58 offen offset:1024 nt lds
v_mfma_f32_16x16x32_bf16 v[68:71], v[20:23], v[132:135], v[68:71]
ds_read_b64_tr_b16 v[18:19], v6 offset:26112
v_mfma_f32_16x16x32_bf16 v[100:103], v[20:23], v[136:139], v[100:103]
s_waitcnt lgkmcnt(7)
v_mfma_f32_16x16x32_bf16 v[40:43], v[24:27], v[128:131], v[40:43]
ds_read_b64_tr_b16 v[20:21], v7 offset:25088
v_mfma_f32_16x16x32_bf16 v[72:75], v[24:27], v[132:135], v[72:75]
ds_read_b64_tr_b16 v[22:23], v7 offset:26112
v_mfma_f32_16x16x32_bf16 v[104:107], v[24:27], v[136:139], v[104:107]
v_and_b32 v1, -16, v8
ds_read_b128 v[160:163], v1
ds_read_b128 v[176:179], v1 offset:4096
ds_read_b128 v[192:195], v1 offset:8192
s_add_u32 m0, s57, 0xa000
s_mov_b32 s59, 0x5a000
buffer_load_dwordx4 v3, s[12:15], s59 offen nt lds
s_waitcnt lgkmcnt(10)
v_mfma_f32_16x16x32_bf16 v[44:47], v[28:31], v[128:131], v[44:47]
ds_read_b64_tr_b16 v[24:25], v6 offset:25344
v_mfma_f32_16x16x32_bf16 v[76:79], v[28:31], v[132:135], v[76:79]
ds_read_b64_tr_b16 v[26:27], v6 offset:26368
v_mfma_f32_16x16x32_bf16 v[108:111], v[28:31], v[136:139], v[108:111]
ds_read_b128 v[164:167], v1 offset:1024
ds_read_b128 v[180:183], v1 offset:5120
ds_read_b128 v[196:199], v1 offset:9216
s_waitcnt lgkmcnt(10)
v_mfma_f32_16x16x32_bf16 v[48:51], v[16:19], v[128:131], v[48:51]
ds_read_b64_tr_b16 v[28:29], v7 offset:25344
v_mfma_f32_16x16x32_bf16 v[80:83], v[16:19], v[132:135], v[80:83]
ds_read_b64_tr_b16 v[30:31], v7 offset:26368
buffer_load_dwordx4 v3, s[12:15], s59 offen offset:2048 nt lds
v_mfma_f32_16x16x32_bf16 v[112:115], v[16:19], v[136:139], v[112:115]
ds_read_b128 v[168:171], v1 offset:2048
ds_read_b128 v[184:187], v1 offset:6144
ds_read_b128 v[200:203], v1 offset:10240
s_waitcnt lgkmcnt(13)
v_mfma_f32_16x16x32_bf16 v[52:55], v[20:23], v[128:131], v[52:55]
ds_read_b64_tr_b16 v[16:17], v6
v_mfma_f32_16x16x32_bf16 v[84:87], v[20:23], v[132:135], v[84:87]
ds_read_b64_tr_b16 v[18:19], v6 offset:1024
v_mfma_f32_16x16x32_bf16 v[116:119], v[20:23], v[136:139], v[116:119]
s_waitcnt lgkmcnt(10)
v_mfma_f32_16x16x32_bf16 v[56:59], v[24:27], v[128:131], v[56:59]
ds_read_b64_tr_b16 v[20:21], v7
ds_read_b128 v[172:175], v1 offset:3072
ds_read_b128 v[188:191], v1 offset:7168
ds_read_b128 v[204:207], v1 offset:11264
v_mfma_f32_16x16x32_bf16 v[88:91], v[24:27], v[132:135], v[88:91]
ds_read_b64_tr_b16 v[22:23], v7 offset:1024
v_mfma_f32_16x16x32_bf16 v[120:123], v[24:27], v[136:139], v[120:123]
s_waitcnt lgkmcnt(10)
v_mfma_f32_16x16x32_bf16 v[60:63], v[28:31], v[128:131], v[60:63]
ds_read_b64_tr_b16 v[24:25], v6 offset:256
v_mfma_f32_16x16x32_bf16 v[92:95], v[28:31], v[132:135], v[92:95]
ds_read_b64_tr_b16 v[26:27], v6 offset:1280
v_mfma_f32_16x16x32_bf16 v[124:127], v[28:31], v[136:139], v[124:127]
s_waitcnt lgkmcnt(7)
v_mfma_f32_16x16x32_bf16 v[32:35], v[16:19], v[140:143], v[32:35]
ds_read_b64_tr_b16 v[28:29], v7 offset:256
v_mfma_f32_16x16x32_bf16 v[64:67], v[16:19], v[144:147], v[64:67]
ds_read_b64_tr_b16 v[30:31], v7 offset:1280
v_mfma_f32_16x16x32_bf16 v[96:99], v[16:19], v[148:151], v[96:99]
s_waitcnt lgkmcnt(4)
v_mfma_f32_16x16x32_bf16 v[36:39], v[20:23], v[140:143], v[36:39]
ds_read_b64_tr_b16 v[16:17], v6 offset:512
v_mfma_f32_16x16x32_bf16 v[68:71], v[20:23], v[144:147], v[68:71]
ds_read_b64_tr_b16 v[18:19], v6 offset:1536
v_mfma_f32_16x16x32_bf16 v[100:103], v[20:23], v[148:151], v[100:103]
s_waitcnt vmcnt(4)
s_barrier
s_add_u32 m0, s56, 0
s_mov_b32 s58, 0x60000
buffer_load_dwordx4 v2, s[8:11], s58 offen nt lds
s_waitcnt lgkmcnt(4)
v_mfma_f32_16x16x32_bf16 v[40:43], v[24:27], v[140:143], v[40:43]
ds_read_b64_tr_b16 v[20:21], v7 offset:512
v_mul_f32 v32, s61, v32
v_mul_f32 v33, s61, v33
v_mul_f32 v34, s61, v34
v_mul_f32 v35, s61, v35
v_cvt_pk_bf16_f32 v12, v32, v33
v_cvt_pk_bf16_f32 v13, v34, v35
ds_write_b64 v8, v[12:13]
buffer_load_dwordx4 v2, s[8:11], s58 offen offset:1024 nt lds
v_mfma_f32_16x16x32_bf16 v[72:75], v[24:27], v[144:147], v[72:75]
ds_read_b64_tr_b16 v[22:23], v7 offset:1536
v_mul_f32 v64, s61, v64
v_mul_f32 v65, s61, v65
v_mul_f32 v66, s61, v66
v_mul_f32 v67, s61, v67
v_mfma_f32_16x16x32_bf16 v[104:107], v[24:27], v[148:151], v[104:107]
v_cvt_pk_bf16_f32 v14, v64, v65
v_cvt_pk_bf16_f32 v15, v66, v67
ds_write_b64 v8, v[14:15] offset:4096
v_mul_f32 v96, s61, v96
v_mul_f32 v97, s61, v97
v_mul_f32 v98, s61, v98
v_mul_f32 v99, s61, v99
s_waitcnt lgkmcnt(6)
v_mfma_f32_16x16x32_bf16 v[44:47], v[28:31], v[140:143], v[44:47]
ds_read_b64_tr_b16 v[24:25], v6 offset:768
v_cvt_pk_bf16_f32 v12, v96, v97
v_cvt_pk_bf16_f32 v13, v98, v99
ds_write_b64 v8, v[12:13] offset:8192
s_add_u32 m0, s57, 0xc000
s_mov_b32 s59, 0x5c000
buffer_load_dwordx4 v3, s[12:15], s59 offen nt lds
v_mfma_f32_16x16x32_bf16 v[76:79], v[28:31], v[144:147], v[76:79]
ds_read_b64_tr_b16 v[26:27], v6 offset:1792
v_mul_f32 v36, s61, v36
v_mul_f32 v37, s61, v37
v_mul_f32 v38, s61, v38
v_mul_f32 v39, s61, v39
v_cvt_pk_bf16_f32 v14, v36, v37
v_cvt_pk_bf16_f32 v15, v38, v39
ds_write_b64 v9, v[14:15]
v_mfma_f32_16x16x32_bf16 v[108:111], v[28:31], v[148:151], v[108:111]
v_mul_f32 v68, s61, v68
v_mul_f32 v69, s61, v69
v_mul_f32 v70, s61, v70
v_mul_f32 v71, s61, v71
s_waitcnt lgkmcnt(8)
v_mfma_f32_16x16x32_bf16 v[48:51], v[16:19], v[140:143], v[48:51]
ds_read_b64_tr_b16 v[28:29], v7 offset:768
v_cvt_pk_bf16_f32 v12, v68, v69
v_cvt_pk_bf16_f32 v13, v70, v71
ds_write_b64 v9, v[12:13] offset:4096
v_mfma_f32_16x16x32_bf16 v[80:83], v[16:19], v[144:147], v[80:83]
ds_read_b64_tr_b16 v[30:31], v7 offset:1792
v_mul_f32 v100, s61, v100
v_mul_f32 v101, s61, v101
v_mul_f32 v102, s61, v102
v_mul_f32 v103, s61, v103
v_cvt_pk_bf16_f32 v14, v100, v101
v_cvt_pk_bf16_f32 v15, v102, v103
ds_write_b64 v9, v[14:15] offset:8192
buffer_load_dwordx4 v3, s[12:15], s59 offen offset:2048 nt lds
v_mfma_f32_16x16x32_bf16 v[112:115], v[16:19], v[148:151], v[112:115]
v_mul_f32 v40, s61, v40
v_mul_f32 v41, s61, v41
v_mul_f32 v42, s61, v42
v_mul_f32 v43, s61, v43
s_waitcnt lgkmcnt(9)
v_mfma_f32_16x16x32_bf16 v[52:55], v[20:23], v[140:143], v[52:55]
v_cvt_pk_bf16_f32 v12, v40, v41
v_cvt_pk_bf16_f32 v13, v42, v43
ds_write_b64 v8, v[12:13] offset:1024
v_mul_f32 v72, s61, v72
v_mul_f32 v73, s61, v73
v_mul_f32 v74, s61, v74
v_mul_f32 v75, s61, v75
v_mfma_f32_16x16x32_bf16 v[84:87], v[20:23], v[144:147], v[84:87]
v_cvt_pk_bf16_f32 v14, v72, v73
v_cvt_pk_bf16_f32 v15, v74, v75
ds_write_b64 v8, v[14:15] offset:5120
v_mfma_f32_16x16x32_bf16 v[116:119], v[20:23], v[148:151], v[116:119]
v_mul_f32 v104, s61, v104
v_mul_f32 v105, s61, v105
v_mul_f32 v106, s61, v106
v_mul_f32 v107, s61, v107
v_cvt_pk_bf16_f32 v12, v104, v105
v_cvt_pk_bf16_f32 v13, v106, v107
ds_write_b64 v8, v[12:13] offset:9216
s_waitcnt lgkmcnt(8)
v_mfma_f32_16x16x32_bf16 v[56:59], v[24:27], v[140:143], v[56:59]
v_mul_f32 v44, s61, v44
v_mul_f32 v45, s61, v45
v_mul_f32 v46, s61, v46
v_mul_f32 v47, s61, v47
v_mfma_f32_16x16x32_bf16 v[88:91], v[24:27], v[144:147], v[88:91]
v_cvt_pk_bf16_f32 v14, v44, v45
v_cvt_pk_bf16_f32 v15, v46, v47
ds_write_b64 v9, v[14:15] offset:1024
v_mfma_f32_16x16x32_bf16 v[120:123], v[24:27], v[148:151], v[120:123]
v_mul_f32 v76, s61, v76
v_mul_f32 v77, s61, v77
v_mul_f32 v78, s61, v78
v_mul_f32 v79, s61, v79
v_cvt_pk_bf16_f32 v12, v76, v77
v_cvt_pk_bf16_f32 v13, v78, v79
ds_write_b64 v9, v[12:13] offset:5120
s_waitcnt lgkmcnt(6)
v_mfma_f32_16x16x32_bf16 v[60:63], v[28:31], v[140:143], v[60:63]
v_mul_f32 v108, s61, v108
v_mul_f32 v109, s61, v109
v_mul_f32 v110, s61, v110
v_mul_f32 v111, s61, v111
v_mfma_f32_16x16x32_bf16 v[92:95], v[28:31], v[144:147], v[92:95]
v_cvt_pk_bf16_f32 v14, v108, v109
v_cvt_pk_bf16_f32 v15, v110, v111
ds_write_b64 v9, v[14:15] offset:9216
v_mul_f32 v48, s61, v48
v_mul_f32 v49, s61, v49
v_mul_f32 v50, s61, v50
v_mul_f32 v51, s61, v51
v_mfma_f32_16x16x32_bf16 v[124:127], v[28:31], v[148:151], v[124:127]
v_cvt_pk_bf16_f32 v12, v48, v49
v_cvt_pk_bf16_f32 v13, v50, v51
ds_write_b64 v8, v[12:13] offset:2048
s_waitcnt vmcnt(4)
s_barrier
s_add_u32 m0, s56, 0x2000
s_mov_b32 s58, 0x62000
buffer_load_dwordx4 v2, s[8:11], s58 offen nt lds
buffer_load_dwordx4 v2, s[8:11], s58 offen offset:1024 nt lds
s_add_u32 m0, s57, 0xe000
s_mov_b32 s59, 0x5e000
buffer_load_dwordx4 v3, s[12:15], s59 offen nt lds
buffer_load_dwordx4 v3, s[12:15], s59 offen offset:2048 nt lds
v_mul_f32 v80, s61, v80
v_mul_f32 v81, s61, v81
v_mul_f32 v82, s61, v82
v_mul_f32 v83, s61, v83
v_cvt_pk_bf16_f32 v14, v80, v81
v_cvt_pk_bf16_f32 v15, v82, v83
ds_write_b64 v8, v[14:15] offset:6144
v_mul_f32 v112, s61, v112
v_mul_f32 v113, s61, v113
v_mul_f32 v114, s61, v114
v_mul_f32 v115, s61, v115
v_cvt_pk_bf16_f32 v12, v112, v113
v_cvt_pk_bf16_f32 v13, v114, v115
ds_write_b64 v8, v[12:13] offset:10240
v_mul_f32 v52, s61, v52
v_mul_f32 v53, s61, v53
v_mul_f32 v54, s61, v54
v_mul_f32 v55, s61, v55
v_cvt_pk_bf16_f32 v14, v52, v53
v_cvt_pk_bf16_f32 v15, v54, v55
ds_write_b64 v9, v[14:15] offset:2048
v_mul_f32 v84, s61, v84
v_mul_f32 v85, s61, v85
v_mul_f32 v86, s61, v86
v_mul_f32 v87, s61, v87
v_cvt_pk_bf16_f32 v12, v84, v85
v_cvt_pk_bf16_f32 v13, v86, v87
ds_write_b64 v9, v[12:13] offset:6144
v_mul_f32 v116, s61, v116
v_mul_f32 v117, s61, v117
v_mul_f32 v118, s61, v118
v_mul_f32 v119, s61, v119
v_cvt_pk_bf16_f32 v14, v116, v117
v_cvt_pk_bf16_f32 v15, v118, v119
ds_write_b64 v9, v[14:15] offset:10240
v_mul_f32 v56, s61, v56
v_mul_f32 v57, s61, v57
v_mul_f32 v58, s61, v58
v_mul_f32 v59, s61, v59
v_cvt_pk_bf16_f32 v12, v56, v57
v_cvt_pk_bf16_f32 v13, v58, v59
ds_write_b64 v8, v[12:13] offset:3072
v_mul_f32 v88, s61, v88
v_mul_f32 v89, s61, v89
v_mul_f32 v90, s61, v90
v_mul_f32 v91, s61, v91
v_cvt_pk_bf16_f32 v14, v88, v89
v_cvt_pk_bf16_f32 v15, v90, v91
ds_write_b64 v8, v[14:15] offset:7168
v_mul_f32 v120, s61, v120
v_mul_f32 v121, s61, v121
v_mul_f32 v122, s61, v122
v_mul_f32 v123, s61, v123
v_cvt_pk_bf16_f32 v12, v120, v121
v_cvt_pk_bf16_f32 v13, v122, v123
ds_write_b64 v8, v[12:13] offset:11264
v_mul_f32 v60, s61, v60
v_mul_f32 v61, s61, v61
v_mul_f32 v62, s61, v62
v_mul_f32 v63, s61, v63
v_cvt_pk_bf16_f32 v14, v60, v61
v_cvt_pk_bf16_f32 v15, v62, v63
ds_write_b64 v9, v[14:15] offset:3072
v_mul_f32 v92, s61, v92
v_mul_f32 v93, s61, v93
v_mul_f32 v94, s61, v94
v_mul_f32 v95, s61, v95
v_cvt_pk_bf16_f32 v12, v92, v93
v_cvt_pk_bf16_f32 v13, v94, v95
ds_write_b64 v9, v[12:13] offset:7168
v_mul_f32 v124, s61, v124
v_mul_f32 v125, s61, v125
v_mul_f32 v126, s61, v126
v_mul_f32 v127, s61, v127
v_cvt_pk_bf16_f32 v14, v124, v125
v_cvt_pk_bf16_f32 v15, v126, v127
ds_write_b64 v9, v[14:15] offset:11264
s_waitcnt vmcnt(4) lgkmcnt(0)
s_barrier
s_add_u32 m0, s56, 0x4000
s_mov_b32 s58, 0x64000
buffer_load_dwordx4 v2, s[8:11], s58 offen nt lds
buffer_load_dwordx4 v2, s[8:11], s58 offen offset:1024 nt lds
s_add_u32 m0, s57, 0x8000
s_mov_b32 s59, 0x60000
buffer_load_dwordx4 v3, s[12:15], s59 offen nt lds
buffer_load_dwordx4 v3, s[12:15], s59 offen offset:2048 nt lds
s_waitcnt vmcnt(4)
s_barrier
s_add_u32 m0, s56, 0x6000
s_mov_b32 s58, 0x66000
buffer_load_dwordx4 v2, s[8:11], s58 offen nt lds
buffer_load_dwordx4 v2, s[8:11], s58 offen offset:1024 nt lds
s_add_u32 m0, s57, 0xa000
s_mov_b32 s59, 0x62000
buffer_load_dwordx4 v3, s[12:15], s59 offen nt lds
buffer_load_dwordx4 v3, s[12:15], s59 offen offset:2048 nt lds
v_bfe_u32 v12, v0, 4, 1
v_lshlrev_b32 v12, 1, v12
v_and_b32 v1, 3, v0
v_xor_b32 v1, v1, v12
v_lshlrev_b32 v1, 4, v1
v_lshrrev_b32 v12, 2, v0
v_mul_u32_u24 v12, 0x480, v12
v_add_u32 v1, v1, v12
s_mul_i32 s54, s50, 0x9000
v_add_u32 v4, s54, v1
v_bfe_u32 v1, v0, 1, 1
v_bfe_u32 v12, v0, 4, 1
v_lshl_add_u32 v1, v12, 1, v1
v_lshrrev_b32 v12, 2, v0
v_lshl_add_u32 v1, v12, 2, v1
v_lshlrev_b32 v1, 4, v1
v_and_b32 v12, 1, v0
v_lshl_add_u32 v1, v12, 3, v1
v_add_u32 v6, 0x10000, v1
v_xor_b32 v7, 32, v6
v_lshlrev_b32 v5, 4, v0
s_mul_i32 s74, s51, 0x36000
s_mul_i32 s54, s50, 0xd800
s_add_u32 s74, s74, s54
s_add_u32 s74, s74, 0x6c00
s_add_u32 s75, s74, 0x6c00
s_and_b32 s54, s34, 0
s_mul_i32 s55, s54, 0x1800
s_add_u32 s74, s74, s55
s_lshl_b32 s54, s54, 7
s_sub_u32 s55, s54, 0x240
s_cmp_ge_u32 s54, 0x240
s_cselect_b32 s40, s55, s54
s_add_u32 s54, s40, 64
s_sub_u32 s55, s54, 0x240
s_cmp_ge_u32 s54, 0x240
s_cselect_b32 s41, s55, s54
s_add_u32 s54, s41, 64
s_sub_u32 s55, s54, 0x240
s_cmp_ge_u32 s54, 0x240
s_cselect_b32 s42, s55, s54
s_add_u32 s54, s42, 64
s_sub_u32 s55, s54, 0x240
s_cmp_ge_u32 s54, 0x240
s_cselect_b32 s43, s55, s54
s_add_u32 s54, s43, 64
s_sub_u32 s55, s54, 0x240
s_cmp_ge_u32 s54, 0x240
s_cselect_b32 s44, s55, s54
s_add_u32 s54, s44, 64
s_sub_u32 s55, s54, 0x240
s_cmp_ge_u32 s54, 0x240
s_cselect_b32 s45, s55, s54
s_add_u32 s54, s45, 64
s_sub_u32 s55, s54, 0x240
s_cmp_ge_u32 s54, 0x240
s_cselect_b32 s46, s55, s54
s_add_u32 s54, s46, 64
s_sub_u32 s55, s54, 0x240
s_cmp_ge_u32 s54, 0x240
s_cselect_b32 s47, s55, s54
s_add_u32 s54, s47, 64
s_sub_u32 s55, s54, 0x240
s_cmp_ge_u32 s54, 0x240
s_cselect_b32 s48, s55, s54
s_add_u32 s54, s48, 64
v_and_b32 v8, -16, v8
s_waitcnt vmcnt(4)
s_barrier
s_add_u32 m0, s56, 0
s_mov_b32 s58, 0x68000
buffer_load_dwordx4 v2, s[8:11], s58 offen nt lds
buffer_load_dwordx4 v2, s[8:11], s58 offen offset:1024 nt lds
s_add_u32 m0, s57, 0xc000
s_mov_b32 s59, 0x64000
buffer_load_dwordx4 v3, s[12:15], s59 offen nt lds
buffer_load_dwordx4 v3, s[12:15], s59 offen offset:2048 nt lds
s_waitcnt vmcnt(4)
s_barrier
s_add_u32 m0, s56, 0x2000
s_mov_b32 s58, 0x6a000
buffer_load_dwordx4 v2, s[8:11], s58 offen nt lds
buffer_load_dwordx4 v2, s[8:11], s58 offen offset:1024 nt lds
s_add_u32 m0, s57, 0xe000
s_mov_b32 s59, 0x66000
buffer_load_dwordx4 v3, s[12:15], s59 offen nt lds
buffer_load_dwordx4 v3, s[12:15], s59 offen offset:2048 nt lds
s_waitcnt vmcnt(4)
s_barrier
s_add_u32 m0, s56, 0x4000
s_mov_b32 s58, 0x6c000
buffer_load_dwordx4 v2, s[8:11], s58 offen nt lds
buffer_load_dwordx4 v2, s[8:11], s58 offen offset:1024 nt lds
s_add_u32 m0, s57, 0x8000
s_mov_b32 s59, 0x68000
buffer_load_dwordx4 v3, s[12:15], s59 offen nt lds
buffer_load_dwordx4 v3, s[12:15], s59 offen offset:2048 nt lds
ds_read_b128 v[112:115], v8
ds_read_b128 v[128:131], v8 offset:4096
ds_read_b128 v[144:147], v8 offset:8192
ds_read_b128 v[116:119], v8 offset:1024
ds_read_b128 v[132:135], v8 offset:5120
ds_read_b128 v[148:151], v8 offset:9216
ds_read_b128 v[120:123], v8 offset:2048
ds_read_b128 v[136:139], v8 offset:6144
ds_read_b128 v[152:155], v8 offset:10240
ds_read_b128 v[124:127], v8 offset:3072
ds_read_b128 v[140:143], v8 offset:7168
ds_read_b128 v[156:159], v8 offset:11264
s_waitcnt vmcnt(4) lgkmcnt(0)
s_barrier
s_add_u32 m0, s56, 0x6000
s_mov_b32 s58, 0x6e000
buffer_load_dwordx4 v2, s[8:11], s58 offen nt lds
buffer_load_dwordx4 v2, s[8:11], s58 offen offset:1024 nt lds
s_add_u32 m0, s57, 0xa000
s_mov_b32 s59, 0x6a000
buffer_load_dwordx4 v3, s[12:15], s59 offen nt lds
buffer_load_dwordx4 v3, s[12:15], s59 offen offset:2048 nt lds
s_waitcnt vmcnt(4)
s_barrier
s_add_u32 m0, s56, 0
s_mov_b32 s58, 0x70000
buffer_load_dwordx4 v2, s[8:11], s58 offen nt lds
buffer_load_dwordx4 v2, s[8:11], s58 offen offset:1024 nt lds
s_add_u32 m0, s57, 0xc000
s_mov_b32 s59, 0x6c000
buffer_load_dwordx4 v3, s[12:15], s59 offen nt lds
buffer_load_dwordx4 v3, s[12:15], s59 offen offset:2048 nt lds
s_waitcnt vmcnt(4)
s_barrier
s_add_u32 m0, s56, 0x2000
s_mov_b32 s58, 0x72000
buffer_load_dwordx4 v2, s[8:11], s58 offen nt lds
buffer_load_dwordx4 v2, s[8:11], s58 offen offset:1024 nt lds
s_add_u32 m0, s57, 0xe000
s_mov_b32 s59, 0x6e000
buffer_load_dwordx4 v3, s[12:15], s59 offen nt lds
buffer_load_dwordx4 v3, s[12:15], s59 offen offset:2048 nt lds
s_waitcnt vmcnt(4)
s_barrier
s_add_u32 m0, s56, 0x4000
s_mov_b32 s58, 0x74000
buffer_load_dwordx4 v2, s[8:11], s58 offen nt lds
buffer_load_dwordx4 v2, s[8:11], s58 offen offset:1024 nt lds
s_add_u32 m0, s57, 0x8000
s_mov_b32 s59, 0x70000
buffer_load_dwordx4 v3, s[12:15], s59 offen nt lds
buffer_load_dwordx4 v3, s[12:15], s59 offen offset:2048 nt lds
s_add_u32 m0, s56, 0x10000
s_add_u32 s66, s40, 0x240
buffer_load_dwordx4 v4, s[28:31], s66 offen lds
s_add_u32 s67, s66, 0x4400
buffer_load_dwordx4 v4, s[28:31], s67 offen offset:1024 lds
s_waitcnt vmcnt(6)
s_barrier
s_add_u32 m0, s56, 0x6000
s_mov_b32 s58, 0x76000
buffer_load_dwordx4 v2, s[8:11], s58 offen nt lds
buffer_load_dwordx4 v2, s[8:11], s58 offen offset:1024 nt lds
s_add_u32 m0, s57, 0xa000
s_mov_b32 s59, 0x72000
buffer_load_dwordx4 v3, s[12:15], s59 offen nt lds
buffer_load_dwordx4 v3, s[12:15], s59 offen offset:2048 nt lds
s_add_u32 m0, s56, 0x12000
s_add_u32 s66, s40, 0x24240
buffer_load_dwordx4 v4, s[28:31], s66 offen lds
s_add_u32 s67, s66, 0x4400
buffer_load_dwordx4 v4, s[28:31], s67 offen offset:1024 lds
s_waitcnt vmcnt(8)
s_barrier
s_add_u32 m0, s56, 0
s_mov_b32 s58, 0x78000
buffer_load_dwordx4 v2, s[8:11], s58 offen nt lds
buffer_load_dwordx4 v2, s[8:11], s58 offen offset:1024 nt lds
s_add_u32 m0, s57, 0xc000
s_mov_b32 s59, 0x74000
buffer_load_dwordx4 v3, s[12:15], s59 offen nt lds
buffer_load_dwordx4 v3, s[12:15], s59 offen offset:2048 nt lds
s_add_u32 m0, s56, 0x14000
s_add_u32 s66, s40, 0x48240
buffer_load_dwordx4 v4, s[28:31], s66 offen lds
s_add_u32 s67, s66, 0x4400
buffer_load_dwordx4 v4, s[28:31], s67 offen offset:1024 lds
s_waitcnt vmcnt(8)
s_barrier
s_add_u32 m0, s56, 0x2000
s_mov_b32 s58, 0x7a000
buffer_load_dwordx4 v2, s[8:11], s58 offen nt lds
buffer_load_dwordx4 v2, s[8:11], s58 offen offset:1024 nt lds
s_add_u32 m0, s57, 0xe000
s_mov_b32 s59, 0x76000
buffer_load_dwordx4 v3, s[12:15], s59 offen nt lds
buffer_load_dwordx4 v3, s[12:15], s59 offen offset:2048 nt lds
s_add_u32 m0, s56, 0x16000
s_add_u32 s66, s40, 0x6c240
buffer_load_dwordx4 v4, s[28:31], s66 offen lds
s_add_u32 s67, s66, 0x4400
buffer_load_dwordx4 v4, s[28:31], s67 offen offset:1024 lds
s_waitcnt vmcnt(8)
s_barrier
s_add_u32 m0, s56, 0x4000
s_mov_b32 s58, 0x7c000
buffer_load_dwordx4 v2, s[8:11], s58 offen nt lds
buffer_load_dwordx4 v2, s[8:11], s58 offen offset:1024 nt lds
s_add_u32 m0, s57, 0x8000
s_mov_b32 s59, 0x78000
buffer_load_dwordx4 v3, s[12:15], s59 offen nt lds
buffer_load_dwordx4 v3, s[12:15], s59 offen offset:2048 nt lds
s_add_u32 m0, s56, 0x18000
s_add_u32 s66, s41, 0x240
buffer_load_dwordx4 v4, s[28:31], s66 offen lds
s_add_u32 s67, s66, 0x4400
buffer_load_dwordx4 v4, s[28:31], s67 offen offset:1024 lds
s_waitcnt vmcnt(8)
s_barrier
s_add_u32 m0, s56, 0x6000
s_mov_b32 s58, 0x7e000
buffer_load_dwordx4 v2, s[8:11], s58 offen nt lds
buffer_load_dwordx4 v2, s[8:11], s58 offen offset:1024 nt lds
s_add_u32 m0, s57, 0xa000
s_mov_b32 s59, 0x7a000
buffer_load_dwordx4 v3, s[12:15], s59 offen nt lds
buffer_load_dwordx4 v3, s[12:15], s59 offen offset:2048 nt lds
s_waitcnt vmcnt(6)
s_barrier
s_add_u32 m0, s57, 0xc000
s_mov_b32 s59, 0x7c000
buffer_load_dwordx4 v3, s[12:15], s59 offen nt lds
buffer_load_dwordx4 v3, s[12:15], s59 offen offset:2048 nt lds
s_add_u32 m0, s56, 0
s_add_u32 s66, s40, 0x6c000
buffer_load_dwordx4 v4, s[28:31], s66 offen lds
s_add_u32 s67, s66, 0x4400
buffer_load_dwordx4 v4, s[28:31], s67 offen offset:1024 lds
s_waitcnt vmcnt(4)
s_barrier
s_add_u32 m0, s57, 0xe000
s_mov_b32 s59, 0x7e000
buffer_load_dwordx4 v3, s[12:15], s59 offen nt lds
buffer_load_dwordx4 v3, s[12:15], s59 offen offset:2048 nt lds
ds_read_b64_tr_b16 v[16:17], v6
ds_read_b64_tr_b16 v[18:19], v6 offset:1024
ds_read_b64_tr_b16 v[20:21], v7
ds_read_b64_tr_b16 v[22:23], v7 offset:1024
ds_read_b64_tr_b16 v[24:25], v6 offset:2048
ds_read_b64_tr_b16 v[26:27], v6 offset:3072
s_waitcnt lgkmcnt(4)
v_mfma_f32_16x16x32_bf16 v[32:35], v[16:19], v[208:211], 0
ds_read_b64_tr_b16 v[28:29], v7 offset:2048
ds_read_b64_tr_b16 v[30:31], v7 offset:3072
v_mfma_f32_16x16x32_bf16 v[40:43], v[16:19], v[224:227], 0
s_add_u32 m0, s56, 0x1a000
s_add_u32 s66, s41, 0x24240
buffer_load_dwordx4 v4, s[28:31], s66 offen lds
v_mfma_f32_16x16x32_bf16 v[48:51], v[16:19], v[240:243], 0
s_add_u32 s67, s66, 0x4400
buffer_load_dwordx4 v4, s[28:31], s67 offen offset:1024 lds
s_waitcnt lgkmcnt(4)
v_mfma_f32_16x16x32_bf16 v[36:39], v[20:23], v[208:211], 0
ds_read_b64_tr_b16 v[16:17], v6 offset:4096
ds_read_b64_tr_b16 v[18:19], v6 offset:5120
v_mfma_f32_16x16x32_bf16 v[44:47], v[20:23], v[224:227], 0
s_add_u32 m0, s56, 0x2000
s_add_u32 s66, s40, 0x48000
buffer_load_dwordx4 v4, s[28:31], s66 offen lds
v_mfma_f32_16x16x32_bf16 v[52:55], v[20:23], v[240:243], 0
s_add_u32 s67, s66, 0x4400
buffer_load_dwordx4 v4, s[28:31], s67 offen offset:1024 lds
s_waitcnt lgkmcnt(4)
v_mfma_f32_16x16x32_bf16 v[32:35], v[24:27], v[212:215], v[32:35]
ds_read_b64_tr_b16 v[20:21], v7 offset:4096
ds_read_b64_tr_b16 v[22:23], v7 offset:5120
v_mfma_f32_16x16x32_bf16 v[40:43], v[24:27], v[228:231], v[40:43]
v_mfma_f32_16x16x32_bf16 v[48:51], v[24:27], v[244:247], v[48:51]
s_waitcnt lgkmcnt(4)
v_mfma_f32_16x16x32_bf16 v[36:39], v[28:31], v[212:215], v[36:39]
ds_read_b64_tr_b16 v[24:25], v6 offset:6144
ds_read_b64_tr_b16 v[26:27], v6 offset:7168
v_mfma_f32_16x16x32_bf16 v[44:47], v[28:31], v[228:231], v[44:47]
v_mfma_f32_16x16x32_bf16 v[52:55], v[28:31], v[244:247], v[52:55]
s_waitcnt lgkmcnt(4)
v_mfma_f32_16x16x32_bf16 v[32:35], v[16:19], v[216:219], v[32:35]
ds_read_b64_tr_b16 v[28:29], v7 offset:6144
ds_read_b64_tr_b16 v[30:31], v7 offset:7168
v_mfma_f32_16x16x32_bf16 v[40:43], v[16:19], v[232:235], v[40:43]
v_mfma_f32_16x16x32_bf16 v[48:51], v[16:19], v[248:251], v[48:51]
s_waitcnt lgkmcnt(4)
v_mfma_f32_16x16x32_bf16 v[36:39], v[20:23], v[216:219], v[36:39]
ds_read_b64_tr_b16 v[16:17], v6 offset:8192
ds_read_b64_tr_b16 v[18:19], v6 offset:9216
v_mfma_f32_16x16x32_bf16 v[44:47], v[20:23], v[232:235], v[44:47]
v_mfma_f32_16x16x32_bf16 v[52:55], v[20:23], v[248:251], v[52:55]
s_waitcnt lgkmcnt(4)
v_mfma_f32_16x16x32_bf16 v[32:35], v[24:27], v[220:223], v[32:35]
ds_read_b64_tr_b16 v[20:21], v7 offset:8192
ds_read_b64_tr_b16 v[22:23], v7 offset:9216
v_mfma_f32_16x16x32_bf16 v[40:43], v[24:27], v[236:239], v[40:43]
v_mfma_f32_16x16x32_bf16 v[48:51], v[24:27], v[252:255], v[48:51]
s_waitcnt lgkmcnt(4)
v_mfma_f32_16x16x32_bf16 v[36:39], v[28:31], v[220:223], v[36:39]
ds_read_b64_tr_b16 v[24:25], v6 offset:10240
ds_read_b64_tr_b16 v[26:27], v6 offset:11264
v_mfma_f32_16x16x32_bf16 v[44:47], v[28:31], v[236:239], v[44:47]
v_mfma_f32_16x16x32_bf16 v[52:55], v[28:31], v[252:255], v[52:55]
s_waitcnt vmcnt(8)
s_barrier
s_waitcnt lgkmcnt(4)
v_mfma_f32_16x16x32_bf16 v[32:35], v[16:19], v[160:163], v[32:35]
ds_read_b64_tr_b16 v[28:29], v7 offset:10240
ds_read_b64_tr_b16 v[30:31], v7 offset:11264
v_mfma_f32_16x16x32_bf16 v[40:43], v[16:19], v[176:179], v[40:43]
s_add_u32 m0, s56, 0x10000
s_add_u32 s66, s41, 0x48240
buffer_load_dwordx4 v4, s[28:31], s66 offen lds
v_mfma_f32_16x16x32_bf16 v[48:51], v[16:19], v[192:195], v[48:51]
s_add_u32 s67, s66, 0x4400
buffer_load_dwordx4 v4, s[28:31], s67 offen offset:1024 lds
s_waitcnt lgkmcnt(4)
v_mfma_f32_16x16x32_bf16 v[36:39], v[20:23], v[160:163], v[36:39]
ds_read_b64_tr_b16 v[16:17], v6 offset:12288
ds_read_b64_tr_b16 v[18:19], v6 offset:13312
v_mfma_f32_16x16x32_bf16 v[44:47], v[20:23], v[176:179], v[44:47]
s_add_u32 m0, s56, 0x4000
s_add_u32 s66, s40, 0
buffer_load_dwordx4 v4, s[28:31], s66 offen lds
v_mfma_f32_16x16x32_bf16 v[52:55], v[20:23], v[192:195], v[52:55]
s_add_u32 s67, s66, 0x4400
buffer_load_dwordx4 v4, s[28:31], s67 offen offset:1024 lds
s_waitcnt lgkmcnt(4)
v_mfma_f32_16x16x32_bf16 v[32:35], v[24:27], v[164:167], v[32:35]
ds_read_b64_tr_b16 v[20:21], v7 offset:12288
ds_read_b64_tr_b16 v[22:23], v7 offset:13312
v_mfma_f32_16x16x32_bf16 v[40:43], v[24:27], v[180:183], v[40:43]
s_add_u32 m0, s56, 0x8000
s_add_u32 s66, s40, 0x24000
buffer_load_dwordx4 v4, s[28:31], s66 offen lds
v_mfma_f32_16x16x32_bf16 v[48:51], v[24:27], v[196:199], v[48:51]
s_add_u32 s67, s66, 0x4400
buffer_load_dwordx4 v4, s[28:31], s67 offen offset:1024 lds
s_waitcnt lgkmcnt(4)
v_mfma_f32_16x16x32_bf16 v[36:39], v[28:31], v[164:167], v[36:39]
ds_read_b64_tr_b16 v[24:25], v6 offset:14336
ds_read_b64_tr_b16 v[26:27], v6 offset:15360
v_mfma_f32_16x16x32_bf16 v[44:47], v[28:31], v[180:183], v[44:47]
v_mfma_f32_16x16x32_bf16 v[52:55], v[28:31], v[196:199], v[52:55]
s_waitcnt lgkmcnt(4)
v_mfma_f32_16x16x32_bf16 v[32:35], v[16:19], v[168:171], v[32:35]
ds_read_b64_tr_b16 v[28:29], v7 offset:14336
ds_read_b64_tr_b16 v[30:31], v7 offset:15360
v_mfma_f32_16x16x32_bf16 v[40:43], v[16:19], v[184:187], v[40:43]
v_mfma_f32_16x16x32_bf16 v[48:51], v[16:19], v[200:203], v[48:51]
s_waitcnt lgkmcnt(4)
v_mfma_f32_16x16x32_bf16 v[36:39], v[20:23], v[168:171], v[36:39]
ds_read_b64_tr_b16 v[16:17], v6 offset:16384
ds_read_b64_tr_b16 v[18:19], v6 offset:17408
v_mfma_f32_16x16x32_bf16 v[44:47], v[20:23], v[184:187], v[44:47]
v_mfma_f32_16x16x32_bf16 v[52:55], v[20:23], v[200:203], v[52:55]
s_waitcnt lgkmcnt(4)
v_mfma_f32_16x16x32_bf16 v[32:35], v[24:27], v[172:175], v[32:35]
ds_read_b64_tr_b16 v[20:21], v7 offset:16384
ds_read_b64_tr_b16 v[22:23], v7 offset:17408
v_mfma_f32_16x16x32_bf16 v[40:43], v[24:27], v[188:191], v[40:43]
v_mfma_f32_16x16x32_bf16 v[48:51], v[24:27], v[204:207], v[48:51]
s_waitcnt lgkmcnt(4)
v_mfma_f32_16x16x32_bf16 v[36:39], v[28:31], v[172:175], v[36:39]
ds_read_b64_tr_b16 v[24:25], v6 offset:18432
ds_read_b64_tr_b16 v[26:27], v6 offset:19456
v_mfma_f32_16x16x32_bf16 v[44:47], v[28:31], v[188:191], v[44:47]
v_mfma_f32_16x16x32_bf16 v[52:55], v[28:31], v[204:207], v[52:55]
s_waitcnt vmcnt(10)
s_barrier
s_waitcnt lgkmcnt(4)
v_mfma_f32_16x16x32_bf16 v[32:35], v[16:19], v[112:115], v[32:35]
ds_read_b64_tr_b16 v[28:29], v7 offset:18432
ds_read_b64_tr_b16 v[30:31], v7 offset:19456
v_mfma_f32_16x16x32_bf16 v[40:43], v[16:19], v[128:131], v[40:43]
s_add_u32 m0, s56, 0x12000
s_add_u32 s66, s41, 0x6c240
buffer_load_dwordx4 v4, s[28:31], s66 offen lds
v_mfma_f32_16x16x32_bf16 v[48:51], v[16:19], v[144:147], v[48:51]
s_add_u32 s67, s66, 0x4400
buffer_load_dwordx4 v4, s[28:31], s67 offen offset:1024 lds
s_waitcnt lgkmcnt(4)
v_mfma_f32_16x16x32_bf16 v[36:39], v[20:23], v[112:115], v[36:39]
ds_read_b64_tr_b16 v[16:17], v6 offset:20480
ds_read_b64_tr_b16 v[18:19], v6 offset:21504
v_mfma_f32_16x16x32_bf16 v[44:47], v[20:23], v[128:131], v[44:47]
s_add_u32 m0, s56, 0x6000
s_add_u32 s66, s41, 0x6c000
buffer_load_dwordx4 v4, s[28:31], s66 offen lds
v_mfma_f32_16x16x32_bf16 v[52:55], v[20:23], v[144:147], v[52:55]
s_add_u32 s67, s66, 0x4400
buffer_load_dwordx4 v4, s[28:31], s67 offen offset:1024 lds
s_waitcnt lgkmcnt(4)
v_mfma_f32_16x16x32_bf16 v[32:35], v[24:27], v[116:119], v[32:35]
ds_read_b64_tr_b16 v[20:21], v7 offset:20480
ds_read_b64_tr_b16 v[22:23], v7 offset:21504
v_mfma_f32_16x16x32_bf16 v[40:43], v[24:27], v[132:135], v[40:43]
s_add_u32 m0, s56, 0xa000
s_add_u32 s66, s41, 0x48000
buffer_load_dwordx4 v4, s[28:31], s66 offen lds
v_mfma_f32_16x16x32_bf16 v[48:51], v[24:27], v[148:151], v[48:51]
s_add_u32 s67, s66, 0x4400
buffer_load_dwordx4 v4, s[28:31], s67 offen offset:1024 lds
s_waitcnt lgkmcnt(4)
v_mfma_f32_16x16x32_bf16 v[36:39], v[28:31], v[116:119], v[36:39]
ds_read_b64_tr_b16 v[24:25], v6 offset:22528
ds_read_b64_tr_b16 v[26:27], v6 offset:23552
v_mfma_f32_16x16x32_bf16 v[44:47], v[28:31], v[132:135], v[44:47]
v_mfma_f32_16x16x32_bf16 v[52:55], v[28:31], v[148:151], v[52:55]
s_waitcnt lgkmcnt(4)
v_mfma_f32_16x16x32_bf16 v[32:35], v[16:19], v[120:123], v[32:35]
ds_read_b64_tr_b16 v[28:29], v7 offset:22528
ds_read_b64_tr_b16 v[30:31], v7 offset:23552
v_mfma_f32_16x16x32_bf16 v[40:43], v[16:19], v[136:139], v[40:43]
v_mfma_f32_16x16x32_bf16 v[48:51], v[16:19], v[152:155], v[48:51]
s_waitcnt lgkmcnt(4)
v_mfma_f32_16x16x32_bf16 v[36:39], v[20:23], v[120:123], v[36:39]
ds_read_b64_tr_b16 v[16:17], v6 offset:24576
ds_read_b64_tr_b16 v[18:19], v6 offset:25600
v_mfma_f32_16x16x32_bf16 v[44:47], v[20:23], v[136:139], v[44:47]
v_mfma_f32_16x16x32_bf16 v[52:55], v[20:23], v[152:155], v[52:55]
s_waitcnt lgkmcnt(4)
v_mfma_f32_16x16x32_bf16 v[32:35], v[24:27], v[124:127], v[32:35]
ds_read_b64_tr_b16 v[20:21], v7 offset:24576
ds_read_b64_tr_b16 v[22:23], v7 offset:25600
v_mfma_f32_16x16x32_bf16 v[40:43], v[24:27], v[140:143], v[40:43]
v_mfma_f32_16x16x32_bf16 v[48:51], v[24:27], v[156:159], v[48:51]
s_waitcnt lgkmcnt(4)
v_mfma_f32_16x16x32_bf16 v[36:39], v[28:31], v[124:127], v[36:39]
ds_read_b64_tr_b16 v[24:25], v6 offset:26624
ds_read_b64_tr_b16 v[26:27], v6 offset:27648
v_mfma_f32_16x16x32_bf16 v[44:47], v[28:31], v[140:143], v[44:47]
v_mfma_f32_16x16x32_bf16 v[52:55], v[28:31], v[156:159], v[52:55]
s_waitcnt vmcnt(12)
s_barrier
ds_read_b128 v[64:67], v8
ds_read_b128 v[80:83], v8 offset:4096
ds_read_b128 v[96:99], v8 offset:8192
ds_read_b128 v[68:71], v8 offset:1024
ds_read_b128 v[84:87], v8 offset:5120
ds_read_b128 v[100:103], v8 offset:9216
ds_read_b128 v[72:75], v8 offset:2048
ds_read_b128 v[88:91], v8 offset:6144
ds_read_b128 v[104:107], v8 offset:10240
ds_read_b128 v[76:79], v8 offset:3072
ds_read_b128 v[92:95], v8 offset:7168
ds_read_b128 v[108:111], v8 offset:11264
s_waitcnt lgkmcnt(9)
v_mfma_f32_16x16x32_bf16 v[32:35], v[16:19], v[64:67], v[32:35]
ds_read_b64_tr_b16 v[28:29], v7 offset:26624
ds_read_b64_tr_b16 v[30:31], v7 offset:27648
v_mfma_f32_16x16x32_bf16 v[40:43], v[16:19], v[80:83], v[40:43]
ds_write_b128 v8, v[208:211]
v_mfma_f32_16x16x32_bf16 v[48:51], v[16:19], v[96:99], v[48:51]
ds_write_b128 v8, v[224:227] offset:4096
v_mfma_f32_16x16x32_bf16 v[36:39], v[20:23], v[64:67], v[36:39]
ds_read_b64_tr_b16 v[16:17], v6 offset:28672
ds_read_b64_tr_b16 v[18:19], v6 offset:29696
v_mfma_f32_16x16x32_bf16 v[44:47], v[20:23], v[80:83], v[44:47]
ds_write_b128 v8, v[240:243] offset:8192
v_mfma_f32_16x16x32_bf16 v[52:55], v[20:23], v[96:99], v[52:55]
ds_write_b128 v8, v[212:215] offset:1024
s_waitcnt lgkmcnt(14)
v_mfma_f32_16x16x32_bf16 v[32:35], v[24:27], v[68:71], v[32:35]
ds_read_b64_tr_b16 v[20:21], v7 offset:28672
ds_read_b64_tr_b16 v[22:23], v7 offset:29696
v_mfma_f32_16x16x32_bf16 v[40:43], v[24:27], v[84:87], v[40:43]
ds_write_b128 v8, v[228:231] offset:5120
v_mfma_f32_16x16x32_bf16 v[48:51], v[24:27], v[100:103], v[48:51]
ds_write_b128 v8, v[244:247] offset:9216
s_waitcnt lgkmcnt(10)
v_mfma_f32_16x16x32_bf16 v[36:39], v[28:31], v[68:71], v[36:39]
ds_read_b64_tr_b16 v[24:25], v6 offset:30720
ds_read_b64_tr_b16 v[26:27], v6 offset:31744
v_mfma_f32_16x16x32_bf16 v[44:47], v[28:31], v[84:87], v[44:47]
ds_write_b128 v8, v[216:219] offset:2048
v_mfma_f32_16x16x32_bf16 v[52:55], v[28:31], v[100:103], v[52:55]
ds_write_b128 v8, v[232:235] offset:6144
s_waitcnt lgkmcnt(10)
v_mfma_f32_16x16x32_bf16 v[32:35], v[16:19], v[72:75], v[32:35]
ds_read_b64_tr_b16 v[28:29], v7 offset:30720
ds_read_b64_tr_b16 v[30:31], v7 offset:31744
v_mfma_f32_16x16x32_bf16 v[40:43], v[16:19], v[88:91], v[40:43]
ds_write_b128 v8, v[248:251] offset:10240
v_mfma_f32_16x16x32_bf16 v[48:51], v[16:19], v[104:107], v[48:51]
ds_write_b128 v8, v[220:223] offset:3072
s_waitcnt lgkmcnt(10)
v_mfma_f32_16x16x32_bf16 v[36:39], v[20:23], v[72:75], v[36:39]
ds_read_b64_tr_b16 v[16:17], v6 offset:32768
ds_read_b64_tr_b16 v[18:19], v6 offset:33792
v_mfma_f32_16x16x32_bf16 v[44:47], v[20:23], v[88:91], v[44:47]
ds_write_b128 v8, v[236:239] offset:7168
v_mfma_f32_16x16x32_bf16 v[52:55], v[20:23], v[104:107], v[52:55]
ds_write_b128 v8, v[252:255] offset:11264
s_waitcnt lgkmcnt(10)
v_mfma_f32_16x16x32_bf16 v[32:35], v[24:27], v[76:79], v[32:35]
ds_read_b64_tr_b16 v[20:21], v7 offset:32768
ds_read_b64_tr_b16 v[22:23], v7 offset:33792
v_mfma_f32_16x16x32_bf16 v[40:43], v[24:27], v[92:95], v[40:43]
s_add_u32 m0, s56, 0x14000
s_add_u32 s66, s42, 0x240
buffer_load_dwordx4 v4, s[28:31], s66 offen lds
v_mfma_f32_16x16x32_bf16 v[48:51], v[24:27], v[108:111], v[48:51]
s_add_u32 s67, s66, 0x4400
buffer_load_dwordx4 v4, s[28:31], s67 offen offset:1024 lds
s_waitcnt lgkmcnt(8)
v_mfma_f32_16x16x32_bf16 v[36:39], v[28:31], v[76:79], v[36:39]
ds_read_b64_tr_b16 v[24:25], v6 offset:34816
ds_read_b64_tr_b16 v[26:27], v6 offset:35840
v_mfma_f32_16x16x32_bf16 v[44:47], v[28:31], v[92:95], v[44:47]
s_add_u32 m0, s56, 0xc000
s_add_u32 s66, s41, 0
buffer_load_dwordx4 v4, s[28:31], s66 offen lds
v_mfma_f32_16x16x32_bf16 v[52:55], v[28:31], v[108:111], v[52:55]
s_add_u32 s67, s66, 0x4400
buffer_load_dwordx4 v4, s[28:31], s67 offen offset:1024 lds
s_add_u32 m0, s56, 0xe000
s_add_u32 s66, s41, 0x24000
buffer_load_dwordx4 v4, s[28:31], s66 offen lds
s_add_u32 s67, s66, 0x4400
buffer_load_dwordx4 v4, s[28:31], s67 offen offset:1024 lds
v_cvt_pk_bf16_f32 v56, v32, v33
v_cvt_pk_bf16_f32 v57, v34, v35
v_cvt_pk_bf16_f32 v58, v36, v37
v_cvt_pk_bf16_f32 v59, v38, v39
v_cvt_pk_bf16_f32 v60, v40, v41
v_cvt_pk_bf16_f32 v61, v42, v43
v_cvt_pk_bf16_f32 v62, v44, v45
v_cvt_pk_bf16_f32 v63, v46, v47
v_cvt_pk_bf16_f32 v12, v48, v49
v_cvt_pk_bf16_f32 v13, v50, v51
v_cvt_pk_bf16_f32 v14, v52, v53
v_cvt_pk_bf16_f32 v15, v54, v55
s_waitcnt vmcnt(14) lgkmcnt(4)
s_barrier
v_mfma_f32_16x16x32_bf16 v[32:35], v[16:19], v[208:211], 0
ds_read_b64_tr_b16 v[28:29], v7 offset:34816
ds_read_b64_tr_b16 v[30:31], v7 offset:35840
v_mfma_f32_16x16x32_bf16 v[40:43], v[16:19], v[224:227], 0
s_add_u32 m0, s56, 0x16000
s_add_u32 s66, s42, 0x24240
buffer_load_dwordx4 v4, s[28:31], s66 offen lds
v_mfma_f32_16x16x32_bf16 v[48:51], v[16:19], v[240:243], 0
s_add_u32 s67, s66, 0x4400
buffer_load_dwordx4 v4, s[28:31], s67 offen offset:1024 lds
s_waitcnt lgkmcnt(4)
v_mfma_f32_16x16x32_bf16 v[36:39], v[20:23], v[208:211], 0
ds_read_b64_tr_b16 v[16:17], v6 offset:36864
ds_read_b64_tr_b16 v[18:19], v6 offset:37888
v_mfma_f32_16x16x32_bf16 v[44:47], v[20:23], v[224:227], 0
buffer_store_dwordx4 v[56:59], v5, s[24:27], s74 offen sc1
v_mfma_f32_16x16x32_bf16 v[52:55], v[20:23], v[240:243], 0
s_add_u32 m0, s56, 0
s_add_u32 s66, s42, 0x6c000
buffer_load_dwordx4 v4, s[28:31], s66 offen lds
s_waitcnt lgkmcnt(4)
v_mfma_f32_16x16x32_bf16 v[32:35], v[24:27], v[212:215], v[32:35]
ds_read_b64_tr_b16 v[20:21], v7 offset:36864
ds_read_b64_tr_b16 v[22:23], v7 offset:37888
v_mfma_f32_16x16x32_bf16 v[40:43], v[24:27], v[228:231], v[40:43]
s_add_u32 s67, s66, 0x4400
buffer_load_dwordx4 v4, s[28:31], s67 offen offset:1024 lds
v_mfma_f32_16x16x32_bf16 v[48:51], v[24:27], v[244:247], v[48:51]
s_waitcnt lgkmcnt(4)
v_mfma_f32_16x16x32_bf16 v[36:39], v[28:31], v[212:215], v[36:39]
ds_read_b64_tr_b16 v[24:25], v6 offset:38912
ds_read_b64_tr_b16 v[26:27], v6 offset:39936
v_mfma_f32_16x16x32_bf16 v[44:47], v[28:31], v[228:231], v[44:47]
v_mfma_f32_16x16x32_bf16 v[52:55], v[28:31], v[244:247], v[52:55]
s_waitcnt lgkmcnt(4)
v_mfma_f32_16x16x32_bf16 v[32:35], v[16:19], v[216:219], v[32:35]
ds_read_b64_tr_b16 v[28:29], v7 offset:38912
ds_read_b64_tr_b16 v[30:31], v7 offset:39936
v_mfma_f32_16x16x32_bf16 v[40:43], v[16:19], v[232:235], v[40:43]
v_mfma_f32_16x16x32_bf16 v[48:51], v[16:19], v[248:251], v[48:51]
s_waitcnt lgkmcnt(4)
v_mfma_f32_16x16x32_bf16 v[36:39], v[20:23], v[216:219], v[36:39]
ds_read_b64_tr_b16 v[16:17], v6 offset:40960
ds_read_b64_tr_b16 v[18:19], v6 offset:41984
v_mfma_f32_16x16x32_bf16 v[44:47], v[20:23], v[232:235], v[44:47]
v_mfma_f32_16x16x32_bf16 v[52:55], v[20:23], v[248:251], v[52:55]
s_waitcnt lgkmcnt(4)
v_mfma_f32_16x16x32_bf16 v[32:35], v[24:27], v[220:223], v[32:35]
ds_read_b64_tr_b16 v[20:21], v7 offset:40960
ds_read_b64_tr_b16 v[22:23], v7 offset:41984
v_mfma_f32_16x16x32_bf16 v[40:43], v[24:27], v[236:239], v[40:43]
v_mfma_f32_16x16x32_bf16 v[48:51], v[24:27], v[252:255], v[48:51]
s_waitcnt lgkmcnt(4)
v_mfma_f32_16x16x32_bf16 v[36:39], v[28:31], v[220:223], v[36:39]
ds_read_b64_tr_b16 v[24:25], v6 offset:43008
ds_read_b64_tr_b16 v[26:27], v6 offset:44032
v_mfma_f32_16x16x32_bf16 v[44:47], v[28:31], v[236:239], v[44:47]
v_mfma_f32_16x16x32_bf16 v[52:55], v[28:31], v[252:255], v[52:55]
s_waitcnt vmcnt(17)
s_barrier
s_waitcnt lgkmcnt(4)
v_mfma_f32_16x16x32_bf16 v[32:35], v[16:19], v[160:163], v[32:35]
ds_read_b64_tr_b16 v[28:29], v7 offset:43008
ds_read_b64_tr_b16 v[30:31], v7 offset:44032
v_mfma_f32_16x16x32_bf16 v[40:43], v[16:19], v[176:179], v[40:43]
ds_write_b128 v8, v[160:163]
v_mfma_f32_16x16x32_bf16 v[48:51], v[16:19], v[192:195], v[48:51]
ds_write_b128 v8, v[176:179] offset:4096
s_waitcnt lgkmcnt(6)
v_mfma_f32_16x16x32_bf16 v[36:39], v[20:23], v[160:163], v[36:39]
ds_read_b64_tr_b16 v[16:17], v6 offset:45056
ds_read_b64_tr_b16 v[18:19], v6 offset:46080
v_mfma_f32_16x16x32_bf16 v[44:47], v[20:23], v[176:179], v[44:47]
ds_write_b128 v8, v[192:195] offset:8192
v_mfma_f32_16x16x32_bf16 v[52:55], v[20:23], v[192:195], v[52:55]
ds_write_b128 v8, v[164:167] offset:1024
s_waitcnt lgkmcnt(8)
v_mfma_f32_16x16x32_bf16 v[32:35], v[24:27], v[164:167], v[32:35]
ds_read_b64_tr_b16 v[20:21], v7 offset:45056
ds_read_b64_tr_b16 v[22:23], v7 offset:46080
v_mfma_f32_16x16x32_bf16 v[40:43], v[24:27], v[180:183], v[40:43]
ds_write_b128 v8, v[180:183] offset:5120
v_mfma_f32_16x16x32_bf16 v[48:51], v[24:27], v[196:199], v[48:51]
ds_write_b128 v8, v[196:199] offset:9216
s_waitcnt lgkmcnt(10)
v_mfma_f32_16x16x32_bf16 v[36:39], v[28:31], v[164:167], v[36:39]
ds_read_b64_tr_b16 v[24:25], v6 offset:47104
ds_read_b64_tr_b16 v[26:27], v6 offset:48128
v_mfma_f32_16x16x32_bf16 v[44:47], v[28:31], v[180:183], v[44:47]
ds_write_b128 v8, v[168:171] offset:2048
v_mfma_f32_16x16x32_bf16 v[52:55], v[28:31], v[196:199], v[52:55]
ds_write_b128 v8, v[184:187] offset:6144
s_waitcnt lgkmcnt(10)
v_mfma_f32_16x16x32_bf16 v[32:35], v[16:19], v[168:171], v[32:35]
ds_read_b64_tr_b16 v[28:29], v7 offset:47104
ds_read_b64_tr_b16 v[30:31], v7 offset:48128
v_mfma_f32_16x16x32_bf16 v[40:43], v[16:19], v[184:187], v[40:43]
buffer_store_dwordx4 v[60:63], v5, s[24:27], s74 offen offset:1024 sc1
v_mfma_f32_16x16x32_bf16 v[48:51], v[16:19], v[200:203], v[48:51]
ds_write_b128 v8, v[200:203] offset:10240
s_waitcnt lgkmcnt(9)
v_mfma_f32_16x16x32_bf16 v[36:39], v[20:23], v[168:171], v[36:39]
ds_read_b64_tr_b16 v[16:17], v6
ds_read_b64_tr_b16 v[18:19], v6 offset:1024
v_mfma_f32_16x16x32_bf16 v[44:47], v[20:23], v[184:187], v[44:47]
ds_write_b128 v8, v[172:175] offset:3072
v_mfma_f32_16x16x32_bf16 v[52:55], v[20:23], v[200:203], v[52:55]
ds_write_b128 v8, v[188:191] offset:7168
s_waitcnt lgkmcnt(9)
v_mfma_f32_16x16x32_bf16 v[32:35], v[24:27], v[172:175], v[32:35]
ds_read_b64_tr_b16 v[20:21], v7
ds_read_b64_tr_b16 v[22:23], v7 offset:1024
v_mfma_f32_16x16x32_bf16 v[40:43], v[24:27], v[188:191], v[40:43]
ds_write_b128 v8, v[204:207] offset:11264
v_mfma_f32_16x16x32_bf16 v[48:51], v[24:27], v[204:207], v[48:51]
s_add_u32 m0, s56, 0x18000
s_add_u32 s66, s42, 0x48240
buffer_load_dwordx4 v4, s[28:31], s66 offen lds
s_waitcnt lgkmcnt(8)
v_mfma_f32_16x16x32_bf16 v[36:39], v[28:31], v[172:175], v[36:39]
ds_read_b64_tr_b16 v[24:25], v6 offset:2048
ds_read_b64_tr_b16 v[26:27], v6 offset:3072
v_mfma_f32_16x16x32_bf16 v[44:47], v[28:31], v[188:191], v[44:47]
s_add_u32 s67, s66, 0x4400
buffer_load_dwordx4 v4, s[28:31], s67 offen offset:1024 lds
v_mfma_f32_16x16x32_bf16 v[52:55], v[28:31], v[204:207], v[52:55]
s_add_u32 m0, s56, 0x2000
s_add_u32 s66, s42, 0x48000
buffer_load_dwordx4 v4, s[28:31], s66 offen lds
s_add_u32 s67, s66, 0x4400
buffer_load_dwordx4 v4, s[28:31], s67 offen offset:1024 lds
s_waitcnt vmcnt(18) lgkmcnt(2)
s_barrier
v_mfma_f32_16x16x32_bf16 v[32:35], v[16:19], v[112:115], v[32:35]
ds_read_b64_tr_b16 v[28:29], v7 offset:2048
ds_read_b64_tr_b16 v[30:31], v7 offset:3072
v_mfma_f32_16x16x32_bf16 v[40:43], v[16:19], v[128:131], v[40:43]
s_add_u32 m0, s56, 0x1a000
s_add_u32 s66, s42, 0x6c240
buffer_load_dwordx4 v4, s[28:31], s66 offen lds
v_mfma_f32_16x16x32_bf16 v[48:51], v[16:19], v[144:147], v[48:51]
s_add_u32 s67, s66, 0x4400
buffer_load_dwordx4 v4, s[28:31], s67 offen offset:1024 lds
v_mfma_f32_16x16x32_bf16 v[36:39], v[20:23], v[112:115], v[36:39]
ds_read_b64_tr_b16 v[16:17], v6 offset:4096
ds_read_b64_tr_b16 v[18:19], v6 offset:5120
v_mfma_f32_16x16x32_bf16 v[44:47], v[20:23], v[128:131], v[44:47]
buffer_store_dwordx4 v[12:15], v5, s[24:27], s74 offen offset:2048 sc1
s_add_u32 s74, s74, 0xc00
s_sub_u32 s55, s74, 0x6c00
s_cmp_ge_u32 s74, s75
s_cselect_b32 s74, s55, s74
v_mfma_f32_16x16x32_bf16 v[52:55], v[20:23], v[144:147], v[52:55]
s_add_u32 m0, s56, 0x4000
s_add_u32 s66, s42, 0
buffer_load_dwordx4 v4, s[28:31], s66 offen lds
s_waitcnt lgkmcnt(4)
v_mfma_f32_16x16x32_bf16 v[32:35], v[24:27], v[116:119], v[32:35]
ds_read_b64_tr_b16 v[20:21], v7 offset:4096
ds_read_b64_tr_b16 v[22:23], v7 offset:5120
v_mfma_f32_16x16x32_bf16 v[40:43], v[24:27], v[132:135], v[40:43]
s_add_u32 s67, s66, 0x4400
buffer_load_dwordx4 v4, s[28:31], s67 offen offset:1024 lds
v_mfma_f32_16x16x32_bf16 v[48:51], v[24:27], v[148:151], v[48:51]
s_waitcnt lgkmcnt(4)
v_mfma_f32_16x16x32_bf16 v[36:39], v[28:31], v[116:119], v[36:39]
ds_read_b64_tr_b16 v[24:25], v6 offset:6144
ds_read_b64_tr_b16 v[26:27], v6 offset:7168
v_mfma_f32_16x16x32_bf16 v[44:47], v[28:31], v[132:135], v[44:47]
v_mfma_f32_16x16x32_bf16 v[52:55], v[28:31], v[148:151], v[52:55]
s_waitcnt lgkmcnt(4)
v_mfma_f32_16x16x32_bf16 v[32:35], v[16:19], v[120:123], v[32:35]
ds_read_b64_tr_b16 v[28:29], v7 offset:6144
ds_read_b64_tr_b16 v[30:31], v7 offset:7168
v_mfma_f32_16x16x32_bf16 v[40:43], v[16:19], v[136:139], v[40:43]
v_mfma_f32_16x16x32_bf16 v[48:51], v[16:19], v[152:155], v[48:51]
s_waitcnt lgkmcnt(4)
v_mfma_f32_16x16x32_bf16 v[36:39], v[20:23], v[120:123], v[36:39]
ds_read_b64_tr_b16 v[16:17], v6 offset:8192
ds_read_b64_tr_b16 v[18:19], v6 offset:9216
v_mfma_f32_16x16x32_bf16 v[44:47], v[20:23], v[136:139], v[44:47]
v_mfma_f32_16x16x32_bf16 v[52:55], v[20:23], v[152:155], v[52:55]
s_waitcnt lgkmcnt(4)
v_mfma_f32_16x16x32_bf16 v[32:35], v[24:27], v[124:127], v[32:35]
ds_read_b64_tr_b16 v[20:21], v7 offset:8192
ds_read_b64_tr_b16 v[22:23], v7 offset:9216
v_mfma_f32_16x16x32_bf16 v[40:43], v[24:27], v[140:143], v[40:43]
v_mfma_f32_16x16x32_bf16 v[48:51], v[24:27], v[156:159], v[48:51]
s_waitcnt lgkmcnt(4)
v_mfma_f32_16x16x32_bf16 v[36:39], v[28:31], v[124:127], v[36:39]
ds_read_b64_tr_b16 v[24:25], v6 offset:10240
ds_read_b64_tr_b16 v[26:27], v6 offset:11264
v_mfma_f32_16x16x32_bf16 v[44:47], v[28:31], v[140:143], v[44:47]
v_mfma_f32_16x16x32_bf16 v[52:55], v[28:31], v[156:159], v[52:55]
s_waitcnt vmcnt(19)
s_barrier
s_waitcnt lgkmcnt(4)
v_mfma_f32_16x16x32_bf16 v[32:35], v[16:19], v[64:67], v[32:35]
ds_read_b64_tr_b16 v[28:29], v7 offset:10240
ds_read_b64_tr_b16 v[30:31], v7 offset:11264
v_mfma_f32_16x16x32_bf16 v[40:43], v[16:19], v[80:83], v[40:43]
s_add_u32 m0, s56, 0x10000
s_add_u32 s66, s43, 0x240
buffer_load_dwordx4 v4, s[28:31], s66 offen lds
v_mfma_f32_16x16x32_bf16 v[48:51], v[16:19], v[96:99], v[48:51]
s_add_u32 s67, s66, 0x4400
buffer_load_dwordx4 v4, s[28:31], s67 offen offset:1024 lds
s_waitcnt lgkmcnt(4)
v_mfma_f32_16x16x32_bf16 v[36:39], v[20:23], v[64:67], v[36:39]
ds_read_b64_tr_b16 v[16:17], v6 offset:12288
ds_read_b64_tr_b16 v[18:19], v6 offset:13312
v_mfma_f32_16x16x32_bf16 v[44:47], v[20:23], v[80:83], v[44:47]
s_add_u32 m0, s56, 0x1c000
s_add_u32 s66, s43, 0x24240
buffer_load_dwordx4 v4, s[28:31], s66 offen lds
v_mfma_f32_16x16x32_bf16 v[52:55], v[20:23], v[96:99], v[52:55]
s_add_u32 s67, s66, 0x4400
buffer_load_dwordx4 v4, s[28:31], s67 offen offset:1024 lds
s_waitcnt lgkmcnt(4)
v_mfma_f32_16x16x32_bf16 v[32:35], v[24:27], v[68:71], v[32:35]
ds_read_b64_tr_b16 v[20:21], v7 offset:12288
ds_read_b64_tr_b16 v[22:23], v7 offset:13312
v_mfma_f32_16x16x32_bf16 v[40:43], v[24:27], v[84:87], v[40:43]
s_add_u32 m0, s56, 0x8000
s_add_u32 s66, s42, 0x24000
buffer_load_dwordx4 v4, s[28:31], s66 offen lds
v_mfma_f32_16x16x32_bf16 v[48:51], v[24:27], v[100:103], v[48:51]
s_add_u32 s67, s66, 0x4400
buffer_load_dwordx4 v4, s[28:31], s67 offen offset:1024 lds
s_waitcnt lgkmcnt(4)
v_mfma_f32_16x16x32_bf16 v[36:39], v[28:31], v[68:71], v[36:39]
ds_read_b64_tr_b16 v[24:25], v6 offset:14336
ds_read_b64_tr_b16 v[26:27], v6 offset:15360
v_mfma_f32_16x16x32_bf16 v[44:47], v[28:31], v[84:87], v[44:47]
v_mfma_f32_16x16x32_bf16 v[52:55], v[28:31], v[100:103], v[52:55]
s_waitcnt lgkmcnt(4)
v_mfma_f32_16x16x32_bf16 v[32:35], v[16:19], v[72:75], v[32:35]
ds_read_b64_tr_b16 v[28:29], v7 offset:14336
ds_read_b64_tr_b16 v[30:31], v7 offset:15360
v_mfma_f32_16x16x32_bf16 v[40:43], v[16:19], v[88:91], v[40:43]
v_mfma_f32_16x16x32_bf16 v[48:51], v[16:19], v[104:107], v[48:51]
s_waitcnt lgkmcnt(4)
v_mfma_f32_16x16x32_bf16 v[36:39], v[20:23], v[72:75], v[36:39]
ds_read_b64_tr_b16 v[16:17], v6 offset:16384
ds_read_b64_tr_b16 v[18:19], v6 offset:17408
v_mfma_f32_16x16x32_bf16 v[44:47], v[20:23], v[88:91], v[44:47]
v_mfma_f32_16x16x32_bf16 v[52:55], v[20:23], v[104:107], v[52:55]
s_waitcnt lgkmcnt(4)
v_mfma_f32_16x16x32_bf16 v[32:35], v[24:27], v[76:79], v[32:35]
ds_read_b64_tr_b16 v[20:21], v7 offset:16384
ds_read_b64_tr_b16 v[22:23], v7 offset:17408
v_mfma_f32_16x16x32_bf16 v[40:43], v[24:27], v[92:95], v[40:43]
v_mfma_f32_16x16x32_bf16 v[48:51], v[24:27], v[108:111], v[48:51]
s_waitcnt lgkmcnt(4)
v_mfma_f32_16x16x32_bf16 v[36:39], v[28:31], v[76:79], v[36:39]
ds_read_b64_tr_b16 v[24:25], v6 offset:18432
ds_read_b64_tr_b16 v[26:27], v6 offset:19456
v_mfma_f32_16x16x32_bf16 v[44:47], v[28:31], v[92:95], v[44:47]
v_mfma_f32_16x16x32_bf16 v[52:55], v[28:31], v[108:111], v[52:55]
v_cvt_pk_bf16_f32 v56, v32, v33
v_cvt_pk_bf16_f32 v57, v34, v35
s_nop 1
v_cvt_pk_bf16_f32 v58, v36, v37
v_cvt_pk_bf16_f32 v59, v38, v39
v_cvt_pk_bf16_f32 v60, v40, v41
v_cvt_pk_bf16_f32 v61, v42, v43
v_cvt_pk_bf16_f32 v62, v44, v45
v_cvt_pk_bf16_f32 v63, v46, v47
v_cvt_pk_bf16_f32 v12, v48, v49
v_cvt_pk_bf16_f32 v13, v50, v51
v_cvt_pk_bf16_f32 v14, v52, v53
v_cvt_pk_bf16_f32 v15, v54, v55
s_waitcnt vmcnt(19)
s_barrier
s_waitcnt lgkmcnt(4)
v_mfma_f32_16x16x32_bf16 v[32:35], v[16:19], v[208:211], 0
ds_read_b64_tr_b16 v[28:29], v7 offset:18432
ds_read_b64_tr_b16 v[30:31], v7 offset:19456
v_mfma_f32_16x16x32_bf16 v[40:43], v[16:19], v[224:227], 0
s_add_u32 m0, s56, 0x1e000
s_add_u32 s66, s43, 0x48240
buffer_load_dwordx4 v4, s[28:31], s66 offen lds
v_mfma_f32_16x16x32_bf16 v[48:51], v[16:19], v[240:243], 0
s_add_u32 s67, s66, 0x4400
buffer_load_dwordx4 v4, s[28:31], s67 offen offset:1024 lds
s_waitcnt lgkmcnt(4)
v_mfma_f32_16x16x32_bf16 v[36:39], v[20:23], v[208:211], 0
ds_read_b64_tr_b16 v[16:17], v6 offset:20480
ds_read_b64_tr_b16 v[18:19], v6 offset:21504
v_mfma_f32_16x16x32_bf16 v[44:47], v[20:23], v[224:227], 0
s_add_u32 m0, s56, 0x12000
s_add_u32 s66, s43, 0x6c240
buffer_load_dwordx4 v4, s[28:31], s66 offen lds
v_mfma_f32_16x16x32_bf16 v[52:55], v[20:23], v[240:243], 0
buffer_store_dwordx4 v[56:59], v5, s[24:27], s74 offen sc1
s_waitcnt lgkmcnt(4)
v_mfma_f32_16x16x32_bf16 v[32:35], v[24:27], v[212:215], v[32:35]
ds_read_b64_tr_b16 v[20:21], v7 offset:20480
ds_read_b64_tr_b16 v[22:23], v7 offset:21504
v_mfma_f32_16x16x32_bf16 v[40:43], v[24:27], v[228:231], v[40:43]
s_add_u32 s67, s66, 0x4400
buffer_load_dwordx4 v4, s[28:31], s67 offen offset:1024 lds
v_mfma_f32_16x16x32_bf16 v[48:51], v[24:27], v[244:247], v[48:51]
s_add_u32 m0, s56, 0x6000
s_add_u32 s66, s43, 0x6c000
buffer_load_dwordx4 v4, s[28:31], s66 offen lds
s_waitcnt lgkmcnt(4)
v_mfma_f32_16x16x32_bf16 v[36:39], v[28:31], v[212:215], v[36:39]
ds_read_b64_tr_b16 v[24:25], v6 offset:22528
ds_read_b64_tr_b16 v[26:27], v6 offset:23552
v_mfma_f32_16x16x32_bf16 v[44:47], v[28:31], v[228:231], v[44:47]
s_add_u32 s67, s66, 0x4400
buffer_load_dwordx4 v4, s[28:31], s67 offen offset:1024 lds
v_mfma_f32_16x16x32_bf16 v[52:55], v[28:31], v[244:247], v[52:55]
s_waitcnt lgkmcnt(4)
v_mfma_f32_16x16x32_bf16 v[32:35], v[16:19], v[216:219], v[32:35]
ds_read_b64_tr_b16 v[28:29], v7 offset:22528
ds_read_b64_tr_b16 v[30:31], v7 offset:23552
v_mfma_f32_16x16x32_bf16 v[40:43], v[16:19], v[232:235], v[40:43]
v_mfma_f32_16x16x32_bf16 v[48:51], v[16:19], v[248:251], v[48:51]
s_waitcnt lgkmcnt(4)
v_mfma_f32_16x16x32_bf16 v[36:39], v[20:23], v[216:219], v[36:39]
ds_read_b64_tr_b16 v[16:17], v6 offset:24576
ds_read_b64_tr_b16 v[18:19], v6 offset:25600
v_mfma_f32_16x16x32_bf16 v[44:47], v[20:23], v[232:235], v[44:47]
v_mfma_f32_16x16x32_bf16 v[52:55], v[20:23], v[248:251], v[52:55]
s_waitcnt lgkmcnt(4)
v_mfma_f32_16x16x32_bf16 v[32:35], v[24:27], v[220:223], v[32:35]
ds_read_b64_tr_b16 v[20:21], v7 offset:24576
ds_read_b64_tr_b16 v[22:23], v7 offset:25600
v_mfma_f32_16x16x32_bf16 v[40:43], v[24:27], v[236:239], v[40:43]
v_mfma_f32_16x16x32_bf16 v[48:51], v[24:27], v[252:255], v[48:51]
s_waitcnt lgkmcnt(4)
v_mfma_f32_16x16x32_bf16 v[36:39], v[28:31], v[220:223], v[36:39]
ds_read_b64_tr_b16 v[24:25], v6 offset:26624
ds_read_b64_tr_b16 v[26:27], v6 offset:27648
v_mfma_f32_16x16x32_bf16 v[44:47], v[28:31], v[236:239], v[44:47]
v_mfma_f32_16x16x32_bf16 v[52:55], v[28:31], v[252:255], v[52:55]
s_waitcnt vmcnt(20)
s_barrier
s_waitcnt lgkmcnt(4)
v_mfma_f32_16x16x32_bf16 v[32:35], v[16:19], v[160:163], v[32:35]
ds_read_b64_tr_b16 v[28:29], v7 offset:26624
ds_read_b64_tr_b16 v[30:31], v7 offset:27648
v_mfma_f32_16x16x32_bf16 v[40:43], v[16:19], v[176:179], v[40:43]
s_add_u32 m0, s56, 0x14000
s_add_u32 s66, s44, 0x240
buffer_load_dwordx4 v4, s[28:31], s66 offen lds
v_mfma_f32_16x16x32_bf16 v[48:51], v[16:19], v[192:195], v[48:51]
s_add_u32 s67, s66, 0x4400
buffer_load_dwordx4 v4, s[28:31], s67 offen offset:1024 lds
s_waitcnt lgkmcnt(4)
v_mfma_f32_16x16x32_bf16 v[36:39], v[20:23], v[160:163], v[36:39]
ds_read_b64_tr_b16 v[16:17], v6 offset:28672
ds_read_b64_tr_b16 v[18:19], v6 offset:29696
v_mfma_f32_16x16x32_bf16 v[44:47], v[20:23], v[176:179], v[44:47]
buffer_store_dwordx4 v[60:63], v5, s[24:27], s74 offen offset:1024 sc1
v_mfma_f32_16x16x32_bf16 v[52:55], v[20:23], v[192:195], v[52:55]
s_add_u32 m0, s56, 0xa000
s_add_u32 s66, s43, 0x48000
buffer_load_dwordx4 v4, s[28:31], s66 offen lds
s_waitcnt lgkmcnt(4)
v_mfma_f32_16x16x32_bf16 v[32:35], v[24:27], v[164:167], v[32:35]
ds_read_b64_tr_b16 v[20:21], v7 offset:28672
ds_read_b64_tr_b16 v[22:23], v7 offset:29696
v_mfma_f32_16x16x32_bf16 v[40:43], v[24:27], v[180:183], v[40:43]
s_add_u32 s67, s66, 0x4400
buffer_load_dwordx4 v4, s[28:31], s67 offen offset:1024 lds
v_mfma_f32_16x16x32_bf16 v[48:51], v[24:27], v[196:199], v[48:51]
s_waitcnt lgkmcnt(4)
v_mfma_f32_16x16x32_bf16 v[36:39], v[28:31], v[164:167], v[36:39]
ds_read_b64_tr_b16 v[24:25], v6 offset:30720
ds_read_b64_tr_b16 v[26:27], v6 offset:31744
v_mfma_f32_16x16x32_bf16 v[44:47], v[28:31], v[180:183], v[44:47]
v_mfma_f32_16x16x32_bf16 v[52:55], v[28:31], v[196:199], v[52:55]
s_waitcnt lgkmcnt(4)
v_mfma_f32_16x16x32_bf16 v[32:35], v[16:19], v[168:171], v[32:35]
ds_read_b64_tr_b16 v[28:29], v7 offset:30720
ds_read_b64_tr_b16 v[30:31], v7 offset:31744
v_mfma_f32_16x16x32_bf16 v[40:43], v[16:19], v[184:187], v[40:43]
v_mfma_f32_16x16x32_bf16 v[48:51], v[16:19], v[200:203], v[48:51]
s_waitcnt lgkmcnt(4)
v_mfma_f32_16x16x32_bf16 v[36:39], v[20:23], v[168:171], v[36:39]
ds_read_b64_tr_b16 v[16:17], v6 offset:32768
ds_read_b64_tr_b16 v[18:19], v6 offset:33792
v_mfma_f32_16x16x32_bf16 v[44:47], v[20:23], v[184:187], v[44:47]
v_mfma_f32_16x16x32_bf16 v[52:55], v[20:23], v[200:203], v[52:55]
s_waitcnt lgkmcnt(4)
v_mfma_f32_16x16x32_bf16 v[32:35], v[24:27], v[172:175], v[32:35]
ds_read_b64_tr_b16 v[20:21], v7 offset:32768
ds_read_b64_tr_b16 v[22:23], v7 offset:33792
v_mfma_f32_16x16x32_bf16 v[40:43], v[24:27], v[188:191], v[40:43]
v_mfma_f32_16x16x32_bf16 v[48:51], v[24:27], v[204:207], v[48:51]
s_waitcnt lgkmcnt(4)
v_mfma_f32_16x16x32_bf16 v[36:39], v[28:31], v[172:175], v[36:39]
ds_read_b64_tr_b16 v[24:25], v6 offset:34816
ds_read_b64_tr_b16 v[26:27], v6 offset:35840
v_mfma_f32_16x16x32_bf16 v[44:47], v[28:31], v[188:191], v[44:47]
v_mfma_f32_16x16x32_bf16 v[52:55], v[28:31], v[204:207], v[52:55]
s_waitcnt vmcnt(21)
s_barrier
s_waitcnt lgkmcnt(4)
v_mfma_f32_16x16x32_bf16 v[32:35], v[16:19], v[112:115], v[32:35]
ds_read_b64_tr_b16 v[28:29], v7 offset:34816
ds_read_b64_tr_b16 v[30:31], v7 offset:35840
v_mfma_f32_16x16x32_bf16 v[40:43], v[16:19], v[128:131], v[40:43]
s_add_u32 m0, s56, 0x16000
s_add_u32 s66, s44, 0x24240
buffer_load_dwordx4 v4, s[28:31], s66 offen lds
v_mfma_f32_16x16x32_bf16 v[48:51], v[16:19], v[144:147], v[48:51]
s_add_u32 s67, s66, 0x4400
buffer_load_dwordx4 v4, s[28:31], s67 offen offset:1024 lds
s_waitcnt lgkmcnt(4)
v_mfma_f32_16x16x32_bf16 v[36:39], v[20:23], v[112:115], v[36:39]
ds_read_b64_tr_b16 v[16:17], v6 offset:36864
ds_read_b64_tr_b16 v[18:19], v6 offset:37888
v_mfma_f32_16x16x32_bf16 v[44:47], v[20:23], v[128:131], v[44:47]
buffer_store_dwordx4 v[12:15], v5, s[24:27], s74 offen offset:2048 sc1
s_add_u32 s74, s74, 0xc00
s_sub_u32 s55, s74, 0x6c00
s_cmp_ge_u32 s74, s75
s_cselect_b32 s74, s55, s74
v_mfma_f32_16x16x32_bf16 v[52:55], v[20:23], v[144:147], v[52:55]
s_add_u32 m0, s56, 0xc000
s_add_u32 s66, s43, 0
buffer_load_dwordx4 v4, s[28:31], s66 offen lds
s_waitcnt lgkmcnt(4)
v_mfma_f32_16x16x32_bf16 v[32:35], v[24:27], v[116:119], v[32:35]
ds_read_b64_tr_b16 v[20:21], v7 offset:36864
ds_read_b64_tr_b16 v[22:23], v7 offset:37888
v_mfma_f32_16x16x32_bf16 v[40:43], v[24:27], v[132:135], v[40:43]
s_add_u32 s67, s66, 0x4400
buffer_load_dwordx4 v4, s[28:31], s67 offen offset:1024 lds
v_mfma_f32_16x16x32_bf16 v[48:51], v[24:27], v[148:151], v[48:51]
s_waitcnt lgkmcnt(4)
v_mfma_f32_16x16x32_bf16 v[36:39], v[28:31], v[116:119], v[36:39]
ds_read_b64_tr_b16 v[24:25], v6 offset:38912
ds_read_b64_tr_b16 v[26:27], v6 offset:39936
v_mfma_f32_16x16x32_bf16 v[44:47], v[28:31], v[132:135], v[44:47]
v_mfma_f32_16x16x32_bf16 v[52:55], v[28:31], v[148:151], v[52:55]
s_waitcnt lgkmcnt(4)
v_mfma_f32_16x16x32_bf16 v[32:35], v[16:19], v[120:123], v[32:35]
ds_read_b64_tr_b16 v[28:29], v7 offset:38912
ds_read_b64_tr_b16 v[30:31], v7 offset:39936
v_mfma_f32_16x16x32_bf16 v[40:43], v[16:19], v[136:139], v[40:43]
v_mfma_f32_16x16x32_bf16 v[48:51], v[16:19], v[152:155], v[48:51]
s_waitcnt lgkmcnt(4)
v_mfma_f32_16x16x32_bf16 v[36:39], v[20:23], v[120:123], v[36:39]
ds_read_b64_tr_b16 v[16:17], v6 offset:40960
ds_read_b64_tr_b16 v[18:19], v6 offset:41984
v_mfma_f32_16x16x32_bf16 v[44:47], v[20:23], v[136:139], v[44:47]
v_mfma_f32_16x16x32_bf16 v[52:55], v[20:23], v[152:155], v[52:55]
s_waitcnt lgkmcnt(4)
v_mfma_f32_16x16x32_bf16 v[32:35], v[24:27], v[124:127], v[32:35]
ds_read_b64_tr_b16 v[20:21], v7 offset:40960
ds_read_b64_tr_b16 v[22:23], v7 offset:41984
v_mfma_f32_16x16x32_bf16 v[40:43], v[24:27], v[140:143], v[40:43]
v_mfma_f32_16x16x32_bf16 v[48:51], v[24:27], v[156:159], v[48:51]
s_waitcnt lgkmcnt(4)
v_mfma_f32_16x16x32_bf16 v[36:39], v[28:31], v[124:127], v[36:39]
ds_read_b64_tr_b16 v[24:25], v6 offset:43008
ds_read_b64_tr_b16 v[26:27], v6 offset:44032
v_mfma_f32_16x16x32_bf16 v[44:47], v[28:31], v[140:143], v[44:47]
v_mfma_f32_16x16x32_bf16 v[52:55], v[28:31], v[156:159], v[52:55]
s_waitcnt vmcnt(21)
s_barrier
s_waitcnt lgkmcnt(4)
v_mfma_f32_16x16x32_bf16 v[32:35], v[16:19], v[64:67], v[32:35]
ds_read_b64_tr_b16 v[28:29], v7 offset:43008
ds_read_b64_tr_b16 v[30:31], v7 offset:44032
v_mfma_f32_16x16x32_bf16 v[40:43], v[16:19], v[80:83], v[40:43]
s_add_u32 m0, s56, 0x18000
s_add_u32 s66, s44, 0x48240
buffer_load_dwordx4 v4, s[28:31], s66 offen lds
v_mfma_f32_16x16x32_bf16 v[48:51], v[16:19], v[96:99], v[48:51]
s_add_u32 s67, s66, 0x4400
buffer_load_dwordx4 v4, s[28:31], s67 offen offset:1024 lds
s_waitcnt lgkmcnt(4)
v_mfma_f32_16x16x32_bf16 v[36:39], v[20:23], v[64:67], v[36:39]
ds_read_b64_tr_b16 v[16:17], v6 offset:45056
ds_read_b64_tr_b16 v[18:19], v6 offset:46080
v_mfma_f32_16x16x32_bf16 v[44:47], v[20:23], v[80:83], v[44:47]
s_add_u32 m0, s56, 0xe000
s_add_u32 s66, s43, 0x24000
buffer_load_dwordx4 v4, s[28:31], s66 offen lds
v_mfma_f32_16x16x32_bf16 v[52:55], v[20:23], v[96:99], v[52:55]
s_add_u32 s67, s66, 0x4400
buffer_load_dwordx4 v4, s[28:31], s67 offen offset:1024 lds
s_waitcnt lgkmcnt(4)
v_mfma_f32_16x16x32_bf16 v[32:35], v[24:27], v[68:71], v[32:35]
ds_read_b64_tr_b16 v[20:21], v7 offset:45056
ds_read_b64_tr_b16 v[22:23], v7 offset:46080
v_mfma_f32_16x16x32_bf16 v[40:43], v[24:27], v[84:87], v[40:43]
v_mfma_f32_16x16x32_bf16 v[48:51], v[24:27], v[100:103], v[48:51]
s_waitcnt lgkmcnt(4)
v_mfma_f32_16x16x32_bf16 v[36:39], v[28:31], v[68:71], v[36:39]
ds_read_b64_tr_b16 v[24:25], v6 offset:47104
ds_read_b64_tr_b16 v[26:27], v6 offset:48128
v_mfma_f32_16x16x32_bf16 v[44:47], v[28:31], v[84:87], v[44:47]
v_mfma_f32_16x16x32_bf16 v[52:55], v[28:31], v[100:103], v[52:55]
s_waitcnt lgkmcnt(4)
v_mfma_f32_16x16x32_bf16 v[32:35], v[16:19], v[72:75], v[32:35]
ds_read_b64_tr_b16 v[28:29], v7 offset:47104
ds_read_b64_tr_b16 v[30:31], v7 offset:48128
v_mfma_f32_16x16x32_bf16 v[40:43], v[16:19], v[88:91], v[40:43]
v_mfma_f32_16x16x32_bf16 v[48:51], v[16:19], v[104:107], v[48:51]
s_waitcnt lgkmcnt(4)
v_mfma_f32_16x16x32_bf16 v[36:39], v[20:23], v[72:75], v[36:39]
ds_read_b64_tr_b16 v[16:17], v6
ds_read_b64_tr_b16 v[18:19], v6 offset:1024
v_mfma_f32_16x16x32_bf16 v[44:47], v[20:23], v[88:91], v[44:47]
v_mfma_f32_16x16x32_bf16 v[52:55], v[20:23], v[104:107], v[52:55]
s_waitcnt lgkmcnt(4)
v_mfma_f32_16x16x32_bf16 v[32:35], v[24:27], v[76:79], v[32:35]
ds_read_b64_tr_b16 v[20:21], v7
ds_read_b64_tr_b16 v[22:23], v7 offset:1024
v_mfma_f32_16x16x32_bf16 v[40:43], v[24:27], v[92:95], v[40:43]
v_mfma_f32_16x16x32_bf16 v[48:51], v[24:27], v[108:111], v[48:51]
s_waitcnt lgkmcnt(4)
v_mfma_f32_16x16x32_bf16 v[36:39], v[28:31], v[76:79], v[36:39]
ds_read_b64_tr_b16 v[24:25], v6 offset:2048
ds_read_b64_tr_b16 v[26:27], v6 offset:3072
v_mfma_f32_16x16x32_bf16 v[44:47], v[28:31], v[92:95], v[44:47]
v_mfma_f32_16x16x32_bf16 v[52:55], v[28:31], v[108:111], v[52:55]
v_cvt_pk_bf16_f32 v56, v32, v33
v_cvt_pk_bf16_f32 v57, v34, v35
s_nop 1
v_cvt_pk_bf16_f32 v58, v36, v37
v_cvt_pk_bf16_f32 v59, v38, v39
v_cvt_pk_bf16_f32 v60, v40, v41
v_cvt_pk_bf16_f32 v61, v42, v43
v_cvt_pk_bf16_f32 v62, v44, v45
v_cvt_pk_bf16_f32 v63, v46, v47
v_cvt_pk_bf16_f32 v12, v48, v49
v_cvt_pk_bf16_f32 v13, v50, v51
v_cvt_pk_bf16_f32 v14, v52, v53
v_cvt_pk_bf16_f32 v15, v54, v55
s_waitcnt vmcnt(23)
s_barrier
s_waitcnt lgkmcnt(4)
v_mfma_f32_16x16x32_bf16 v[32:35], v[16:19], v[208:211], 0
ds_read_b64_tr_b16 v[28:29], v7 offset:2048
ds_read_b64_tr_b16 v[30:31], v7 offset:3072
v_mfma_f32_16x16x32_bf16 v[40:43], v[16:19], v[224:227], 0
s_add_u32 m0, s56, 0x1a000
s_add_u32 s66, s44, 0x6c240
buffer_load_dwordx4 v4, s[28:31], s66 offen lds
v_mfma_f32_16x16x32_bf16 v[48:51], v[16:19], v[240:243], 0
s_add_u32 s67, s66, 0x4400
buffer_load_dwordx4 v4, s[28:31], s67 offen offset:1024 lds
s_waitcnt lgkmcnt(4)
v_mfma_f32_16x16x32_bf16 v[36:39], v[20:23], v[208:211], 0
ds_read_b64_tr_b16 v[16:17], v6 offset:4096
ds_read_b64_tr_b16 v[18:19], v6 offset:5120
v_mfma_f32_16x16x32_bf16 v[44:47], v[20:23], v[224:227], 0
buffer_store_dwordx4 v[56:59], v5, s[24:27], s74 offen sc1
v_mfma_f32_16x16x32_bf16 v[52:55], v[20:23], v[240:243], 0
s_add_u32 m0, s56, 0
s_add_u32 s66, s44, 0x6c000
buffer_load_dwordx4 v4, s[28:31], s66 offen lds
s_waitcnt lgkmcnt(4)
v_mfma_f32_16x16x32_bf16 v[32:35], v[24:27], v[212:215], v[32:35]
ds_read_b64_tr_b16 v[20:21], v7 offset:4096
ds_read_b64_tr_b16 v[22:23], v7 offset:5120
v_mfma_f32_16x16x32_bf16 v[40:43], v[24:27], v[228:231], v[40:43]
s_add_u32 s67, s66, 0x4400
buffer_load_dwordx4 v4, s[28:31], s67 offen offset:1024 lds
v_mfma_f32_16x16x32_bf16 v[48:51], v[24:27], v[244:247], v[48:51]
s_waitcnt lgkmcnt(4)
v_mfma_f32_16x16x32_bf16 v[36:39], v[28:31], v[212:215], v[36:39]
ds_read_b64_tr_b16 v[24:25], v6 offset:6144
ds_read_b64_tr_b16 v[26:27], v6 offset:7168
v_mfma_f32_16x16x32_bf16 v[44:47], v[28:31], v[228:231], v[44:47]
v_mfma_f32_16x16x32_bf16 v[52:55], v[28:31], v[244:247], v[52:55]
s_waitcnt lgkmcnt(4)
v_mfma_f32_16x16x32_bf16 v[32:35], v[16:19], v[216:219], v[32:35]
ds_read_b64_tr_b16 v[28:29], v7 offset:6144
ds_read_b64_tr_b16 v[30:31], v7 offset:7168
v_mfma_f32_16x16x32_bf16 v[40:43], v[16:19], v[232:235], v[40:43]
v_mfma_f32_16x16x32_bf16 v[48:51], v[16:19], v[248:251], v[48:51]
s_waitcnt lgkmcnt(4)
v_mfma_f32_16x16x32_bf16 v[36:39], v[20:23], v[216:219], v[36:39]
ds_read_b64_tr_b16 v[16:17], v6 offset:49152
ds_read_b64_tr_b16 v[18:19], v6 offset:50176
v_mfma_f32_16x16x32_bf16 v[44:47], v[20:23], v[232:235], v[44:47]
v_mfma_f32_16x16x32_bf16 v[52:55], v[20:23], v[248:251], v[52:55]
s_waitcnt lgkmcnt(4)
v_mfma_f32_16x16x32_bf16 v[32:35], v[24:27], v[220:223], v[32:35]
ds_read_b64_tr_b16 v[20:21], v7 offset:49152
ds_read_b64_tr_b16 v[22:23], v7 offset:50176
v_mfma_f32_16x16x32_bf16 v[40:43], v[24:27], v[236:239], v[40:43]
v_mfma_f32_16x16x32_bf16 v[48:51], v[24:27], v[252:255], v[48:51]
s_waitcnt lgkmcnt(4)
v_mfma_f32_16x16x32_bf16 v[36:39], v[28:31], v[220:223], v[36:39]
ds_read_b64_tr_b16 v[24:25], v6 offset:51200
ds_read_b64_tr_b16 v[26:27], v6 offset:52224
v_mfma_f32_16x16x32_bf16 v[44:47], v[28:31], v[236:239], v[44:47]
v_mfma_f32_16x16x32_bf16 v[52:55], v[28:31], v[252:255], v[52:55]
s_waitcnt vmcnt(24)
s_barrier
s_waitcnt lgkmcnt(4)
v_mfma_f32_16x16x32_bf16 v[32:35], v[16:19], v[160:163], v[32:35]
ds_read_b64_tr_b16 v[28:29], v7 offset:51200
ds_read_b64_tr_b16 v[30:31], v7 offset:52224
v_mfma_f32_16x16x32_bf16 v[40:43], v[16:19], v[176:179], v[40:43]
s_add_u32 m0, s56, 0x10000
s_add_u32 s66, s45, 0x240
buffer_load_dwordx4 v4, s[28:31], s66 offen lds
v_mfma_f32_16x16x32_bf16 v[48:51], v[16:19], v[192:195], v[48:51]
s_add_u32 s67, s66, 0x4400
buffer_load_dwordx4 v4, s[28:31], s67 offen offset:1024 lds
s_waitcnt lgkmcnt(4)
v_mfma_f32_16x16x32_bf16 v[36:39], v[20:23], v[160:163], v[36:39]
ds_read_b64_tr_b16 v[16:17], v6 offset:53248
ds_read_b64_tr_b16 v[18:19], v6 offset:54272
v_mfma_f32_16x16x32_bf16 v[44:47], v[20:23], v[176:179], v[44:47]
buffer_store_dwordx4 v[60:63], v5, s[24:27], s74 offen offset:1024 sc1
v_mfma_f32_16x16x32_bf16 v[52:55], v[20:23], v[192:195], v[52:55]
s_add_u32 m0, s56, 0x2000
s_add_u32 s66, s44, 0x48000
buffer_load_dwordx4 v4, s[28:31], s66 offen lds
s_waitcnt lgkmcnt(4)
v_mfma_f32_16x16x32_bf16 v[32:35], v[24:27], v[164:167], v[32:35]
ds_read_b64_tr_b16 v[20:21], v7 offset:53248
ds_read_b64_tr_b16 v[22:23], v7 offset:54272
v_mfma_f32_16x16x32_bf16 v[40:43], v[24:27], v[180:183], v[40:43]
s_add_u32 s67, s66, 0x4400
buffer_load_dwordx4 v4, s[28:31], s67 offen offset:1024 lds
v_mfma_f32_16x16x32_bf16 v[48:51], v[24:27], v[196:199], v[48:51]
s_waitcnt lgkmcnt(4)
v_mfma_f32_16x16x32_bf16 v[36:39], v[28:31], v[164:167], v[36:39]
ds_read_b64_tr_b16 v[24:25], v6 offset:55296
ds_read_b64_tr_b16 v[26:27], v6 offset:56320
v_mfma_f32_16x16x32_bf16 v[44:47], v[28:31], v[180:183], v[44:47]
v_mfma_f32_16x16x32_bf16 v[52:55], v[28:31], v[196:199], v[52:55]
s_waitcnt lgkmcnt(4)
v_mfma_f32_16x16x32_bf16 v[32:35], v[16:19], v[168:171], v[32:35]
ds_read_b64_tr_b16 v[28:29], v7 offset:55296
ds_read_b64_tr_b16 v[30:31], v7 offset:56320
v_mfma_f32_16x16x32_bf16 v[40:43], v[16:19], v[184:187], v[40:43]
v_mfma_f32_16x16x32_bf16 v[48:51], v[16:19], v[200:203], v[48:51]
s_waitcnt lgkmcnt(4)
v_mfma_f32_16x16x32_bf16 v[36:39], v[20:23], v[168:171], v[36:39]
ds_read_b64_tr_b16 v[16:17], v6 offset:57344
ds_read_b64_tr_b16 v[18:19], v6 offset:58368
v_mfma_f32_16x16x32_bf16 v[44:47], v[20:23], v[184:187], v[44:47]
v_mfma_f32_16x16x32_bf16 v[52:55], v[20:23], v[200:203], v[52:55]
s_waitcnt lgkmcnt(4)
v_mfma_f32_16x16x32_bf16 v[32:35], v[24:27], v[172:175], v[32:35]
ds_read_b64_tr_b16 v[20:21], v7 offset:57344
ds_read_b64_tr_b16 v[22:23], v7 offset:58368
v_mfma_f32_16x16x32_bf16 v[40:43], v[24:27], v[188:191], v[40:43]
v_mfma_f32_16x16x32_bf16 v[48:51], v[24:27], v[204:207], v[48:51]
s_waitcnt lgkmcnt(4)
v_mfma_f32_16x16x32_bf16 v[36:39], v[28:31], v[172:175], v[36:39]
ds_read_b64_tr_b16 v[24:25], v6 offset:59392
ds_read_b64_tr_b16 v[26:27], v6 offset:60416
v_mfma_f32_16x16x32_bf16 v[44:47], v[28:31], v[188:191], v[44:47]
v_mfma_f32_16x16x32_bf16 v[52:55], v[28:31], v[204:207], v[52:55]
s_waitcnt vmcnt(24)
s_barrier
s_waitcnt lgkmcnt(4)
v_mfma_f32_16x16x32_bf16 v[32:35], v[16:19], v[112:115], v[32:35]
ds_read_b64_tr_b16 v[28:29], v7 offset:59392
ds_read_b64_tr_b16 v[30:31], v7 offset:60416
v_mfma_f32_16x16x32_bf16 v[40:43], v[16:19], v[128:131], v[40:43]
s_add_u32 m0, s56, 0x1c000
s_add_u32 s66, s45, 0x24240
buffer_load_dwordx4 v4, s[28:31], s66 offen lds
v_mfma_f32_16x16x32_bf16 v[48:51], v[16:19], v[144:147], v[48:51]
s_add_u32 s67, s66, 0x4400
buffer_load_dwordx4 v4, s[28:31], s67 offen offset:1024 lds
s_waitcnt lgkmcnt(4)
v_mfma_f32_16x16x32_bf16 v[36:39], v[20:23], v[112:115], v[36:39]
ds_read_b64_tr_b16 v[16:17], v6 offset:61440
ds_read_b64_tr_b16 v[18:19], v6 offset:62464
v_mfma_f32_16x16x32_bf16 v[44:47], v[20:23], v[128:131], v[44:47]
buffer_store_dwordx4 v[12:15], v5, s[24:27], s74 offen offset:2048 sc1
s_add_u32 s74, s74, 0xc00
s_sub_u32 s55, s74, 0x6c00
s_cmp_ge_u32 s74, s75
s_cselect_b32 s74, s55, s74
v_mfma_f32_16x16x32_bf16 v[52:55], v[20:23], v[144:147], v[52:55]
s_add_u32 m0, s56, 0x4000
s_add_u32 s66, s44, 0
buffer_load_dwordx4 v4, s[28:31], s66 offen lds
s_waitcnt lgkmcnt(4)
v_mfma_f32_16x16x32_bf16 v[32:35], v[24:27], v[116:119], v[32:35]
ds_read_b64_tr_b16 v[20:21], v7 offset:61440
ds_read_b64_tr_b16 v[22:23], v7 offset:62464
v_mfma_f32_16x16x32_bf16 v[40:43], v[24:27], v[132:135], v[40:43]
s_add_u32 s67, s66, 0x4400
buffer_load_dwordx4 v4, s[28:31], s67 offen offset:1024 lds
v_mfma_f32_16x16x32_bf16 v[48:51], v[24:27], v[148:151], v[48:51]
s_waitcnt lgkmcnt(4)
v_mfma_f32_16x16x32_bf16 v[36:39], v[28:31], v[116:119], v[36:39]
ds_read_b64_tr_b16 v[24:25], v6 offset:63488
ds_read_b64_tr_b16 v[26:27], v6 offset:64512
v_mfma_f32_16x16x32_bf16 v[44:47], v[28:31], v[132:135], v[44:47]
v_mfma_f32_16x16x32_bf16 v[52:55], v[28:31], v[148:151], v[52:55]
s_waitcnt lgkmcnt(4)
v_mfma_f32_16x16x32_bf16 v[32:35], v[16:19], v[120:123], v[32:35]
ds_read_b64_tr_b16 v[28:29], v7 offset:63488
ds_read_b64_tr_b16 v[30:31], v7 offset:64512
v_mfma_f32_16x16x32_bf16 v[40:43], v[16:19], v[136:139], v[40:43]
v_mfma_f32_16x16x32_bf16 v[48:51], v[16:19], v[152:155], v[48:51]
s_waitcnt lgkmcnt(4)
v_mfma_f32_16x16x32_bf16 v[36:39], v[20:23], v[120:123], v[36:39]
ds_read_b64_tr_b16 v[16:17], v6 offset:8192
ds_read_b64_tr_b16 v[18:19], v6 offset:9216
v_mfma_f32_16x16x32_bf16 v[44:47], v[20:23], v[136:139], v[44:47]
v_mfma_f32_16x16x32_bf16 v[52:55], v[20:23], v[152:155], v[52:55]
s_waitcnt lgkmcnt(4)
v_mfma_f32_16x16x32_bf16 v[32:35], v[24:27], v[124:127], v[32:35]
ds_read_b64_tr_b16 v[20:21], v7 offset:8192
ds_read_b64_tr_b16 v[22:23], v7 offset:9216
v_mfma_f32_16x16x32_bf16 v[40:43], v[24:27], v[140:143], v[40:43]
v_mfma_f32_16x16x32_bf16 v[48:51], v[24:27], v[156:159], v[48:51]
s_waitcnt lgkmcnt(4)
v_mfma_f32_16x16x32_bf16 v[36:39], v[28:31], v[124:127], v[36:39]
ds_read_b64_tr_b16 v[24:25], v6 offset:10240
ds_read_b64_tr_b16 v[26:27], v6 offset:11264
v_mfma_f32_16x16x32_bf16 v[44:47], v[28:31], v[140:143], v[44:47]
v_mfma_f32_16x16x32_bf16 v[52:55], v[28:31], v[156:159], v[52:55]
s_waitcnt vmcnt(24)
s_barrier
s_waitcnt lgkmcnt(4)
v_mfma_f32_16x16x32_bf16 v[32:35], v[16:19], v[64:67], v[32:35]
ds_read_b64_tr_b16 v[28:29], v7 offset:10240
ds_read_b64_tr_b16 v[30:31], v7 offset:11264
v_mfma_f32_16x16x32_bf16 v[40:43], v[16:19], v[80:83], v[40:43]
s_add_u32 m0, s56, 0x1e000
s_add_u32 s66, s45, 0x48240
buffer_load_dwordx4 v4, s[28:31], s66 offen lds
v_mfma_f32_16x16x32_bf16 v[48:51], v[16:19], v[96:99], v[48:51]
s_add_u32 s67, s66, 0x4400
buffer_load_dwordx4 v4, s[28:31], s67 offen offset:1024 lds
s_waitcnt lgkmcnt(4)
v_mfma_f32_16x16x32_bf16 v[36:39], v[20:23], v[64:67], v[36:39]
ds_read_b64_tr_b16 v[16:17], v6 offset:12288
ds_read_b64_tr_b16 v[18:19], v6 offset:13312
v_mfma_f32_16x16x32_bf16 v[44:47], v[20:23], v[80:83], v[44:47]
s_add_u32 m0, s56, 0x8000
s_add_u32 s66, s44, 0x24000
buffer_load_dwordx4 v4, s[28:31], s66 offen lds
v_mfma_f32_16x16x32_bf16 v[52:55], v[20:23], v[96:99], v[52:55]
s_add_u32 s67, s66, 0x4400
buffer_load_dwordx4 v4, s[28:31], s67 offen offset:1024 lds
s_waitcnt lgkmcnt(4)
v_mfma_f32_16x16x32_bf16 v[32:35], v[24:27], v[68:71], v[32:35]
ds_read_b64_tr_b16 v[20:21], v7 offset:12288
ds_read_b64_tr_b16 v[22:23], v7 offset:13312
v_mfma_f32_16x16x32_bf16 v[40:43], v[24:27], v[84:87], v[40:43]
v_mfma_f32_16x16x32_bf16 v[48:51], v[24:27], v[100:103], v[48:51]
s_waitcnt lgkmcnt(4)
v_mfma_f32_16x16x32_bf16 v[36:39], v[28:31], v[68:71], v[36:39]
ds_read_b64_tr_b16 v[24:25], v6 offset:14336
ds_read_b64_tr_b16 v[26:27], v6 offset:15360
v_mfma_f32_16x16x32_bf16 v[44:47], v[28:31], v[84:87], v[44:47]
v_mfma_f32_16x16x32_bf16 v[52:55], v[28:31], v[100:103], v[52:55]
s_waitcnt lgkmcnt(4)
v_mfma_f32_16x16x32_bf16 v[32:35], v[16:19], v[72:75], v[32:35]
ds_read_b64_tr_b16 v[28:29], v7 offset:14336
ds_read_b64_tr_b16 v[30:31], v7 offset:15360
v_mfma_f32_16x16x32_bf16 v[40:43], v[16:19], v[88:91], v[40:43]
v_mfma_f32_16x16x32_bf16 v[48:51], v[16:19], v[104:107], v[48:51]
s_waitcnt lgkmcnt(4)
v_mfma_f32_16x16x32_bf16 v[36:39], v[20:23], v[72:75], v[36:39]
ds_read_b64_tr_b16 v[16:17], v6 offset:16384
ds_read_b64_tr_b16 v[18:19], v6 offset:17408
v_mfma_f32_16x16x32_bf16 v[44:47], v[20:23], v[88:91], v[44:47]
v_mfma_f32_16x16x32_bf16 v[52:55], v[20:23], v[104:107], v[52:55]
s_waitcnt lgkmcnt(4)
v_mfma_f32_16x16x32_bf16 v[32:35], v[24:27], v[76:79], v[32:35]
ds_read_b64_tr_b16 v[20:21], v7 offset:16384
ds_read_b64_tr_b16 v[22:23], v7 offset:17408
v_mfma_f32_16x16x32_bf16 v[40:43], v[24:27], v[92:95], v[40:43]
v_mfma_f32_16x16x32_bf16 v[48:51], v[24:27], v[108:111], v[48:51]
s_waitcnt lgkmcnt(4)
v_mfma_f32_16x16x32_bf16 v[36:39], v[28:31], v[76:79], v[36:39]
ds_read_b64_tr_b16 v[24:25], v6 offset:18432
ds_read_b64_tr_b16 v[26:27], v6 offset:19456
v_mfma_f32_16x16x32_bf16 v[44:47], v[28:31], v[92:95], v[44:47]
v_mfma_f32_16x16x32_bf16 v[52:55], v[28:31], v[108:111], v[52:55]
v_cvt_pk_bf16_f32 v56, v32, v33
v_cvt_pk_bf16_f32 v57, v34, v35
s_nop 1
v_cvt_pk_bf16_f32 v58, v36, v37
v_cvt_pk_bf16_f32 v59, v38, v39
v_cvt_pk_bf16_f32 v60, v40, v41
v_cvt_pk_bf16_f32 v61, v42, v43
v_cvt_pk_bf16_f32 v62, v44, v45
v_cvt_pk_bf16_f32 v63, v46, v47
v_cvt_pk_bf16_f32 v12, v48, v49
v_cvt_pk_bf16_f32 v13, v50, v51
v_cvt_pk_bf16_f32 v14, v52, v53
v_cvt_pk_bf16_f32 v15, v54, v55
s_waitcnt vmcnt(23)
s_barrier
s_waitcnt lgkmcnt(4)
v_mfma_f32_16x16x32_bf16 v[32:35], v[16:19], v[208:211], 0
ds_read_b64_tr_b16 v[28:29], v7 offset:18432
ds_read_b64_tr_b16 v[30:31], v7 offset:19456
v_mfma_f32_16x16x32_bf16 v[40:43], v[16:19], v[224:227], 0
s_add_u32 m0, s56, 0x12000
s_add_u32 s66, s45, 0x6c240
buffer_load_dwordx4 v4, s[28:31], s66 offen lds
v_mfma_f32_16x16x32_bf16 v[48:51], v[16:19], v[240:243], 0
s_add_u32 s67, s66, 0x4400
buffer_load_dwordx4 v4, s[28:31], s67 offen offset:1024 lds
s_waitcnt lgkmcnt(4)
v_mfma_f32_16x16x32_bf16 v[36:39], v[20:23], v[208:211], 0
ds_read_b64_tr_b16 v[16:17], v6 offset:20480
ds_read_b64_tr_b16 v[18:19], v6 offset:21504
v_mfma_f32_16x16x32_bf16 v[44:47], v[20:23], v[224:227], 0
buffer_store_dwordx4 v[56:59], v5, s[24:27], s74 offen sc1
v_mfma_f32_16x16x32_bf16 v[52:55], v[20:23], v[240:243], 0
s_add_u32 m0, s56, 0x6000
s_add_u32 s66, s45, 0x6c000
buffer_load_dwordx4 v4, s[28:31], s66 offen lds
s_waitcnt lgkmcnt(4)
v_mfma_f32_16x16x32_bf16 v[32:35], v[24:27], v[212:215], v[32:35]
ds_read_b64_tr_b16 v[20:21], v7 offset:20480
ds_read_b64_tr_b16 v[22:23], v7 offset:21504
v_mfma_f32_16x16x32_bf16 v[40:43], v[24:27], v[228:231], v[40:43]
s_add_u32 s67, s66, 0x4400
buffer_load_dwordx4 v4, s[28:31], s67 offen offset:1024 lds
v_mfma_f32_16x16x32_bf16 v[48:51], v[24:27], v[244:247], v[48:51]
s_waitcnt lgkmcnt(4)
v_mfma_f32_16x16x32_bf16 v[36:39], v[28:31], v[212:215], v[36:39]
ds_read_b64_tr_b16 v[24:25], v6 offset:22528
ds_read_b64_tr_b16 v[26:27], v6 offset:23552
v_mfma_f32_16x16x32_bf16 v[44:47], v[28:31], v[228:231], v[44:47]
v_mfma_f32_16x16x32_bf16 v[52:55], v[28:31], v[244:247], v[52:55]
s_waitcnt lgkmcnt(4)
v_mfma_f32_16x16x32_bf16 v[32:35], v[16:19], v[216:219], v[32:35]
ds_read_b64_tr_b16 v[28:29], v7 offset:22528
ds_read_b64_tr_b16 v[30:31], v7 offset:23552
v_mfma_f32_16x16x32_bf16 v[40:43], v[16:19], v[232:235], v[40:43]
v_mfma_f32_16x16x32_bf16 v[48:51], v[16:19], v[248:251], v[48:51]
s_waitcnt lgkmcnt(4)
v_mfma_f32_16x16x32_bf16 v[36:39], v[20:23], v[216:219], v[36:39]
ds_read_b64_tr_b16 v[16:17], v6 offset:24576
ds_read_b64_tr_b16 v[18:19], v6 offset:25600
v_mfma_f32_16x16x32_bf16 v[44:47], v[20:23], v[232:235], v[44:47]
v_mfma_f32_16x16x32_bf16 v[52:55], v[20:23], v[248:251], v[52:55]
s_waitcnt lgkmcnt(4)
v_mfma_f32_16x16x32_bf16 v[32:35], v[24:27], v[220:223], v[32:35]
ds_read_b64_tr_b16 v[20:21], v7 offset:24576
ds_read_b64_tr_b16 v[22:23], v7 offset:25600
v_mfma_f32_16x16x32_bf16 v[40:43], v[24:27], v[236:239], v[40:43]
v_mfma_f32_16x16x32_bf16 v[48:51], v[24:27], v[252:255], v[48:51]
s_waitcnt lgkmcnt(4)
v_mfma_f32_16x16x32_bf16 v[36:39], v[28:31], v[220:223], v[36:39]
ds_read_b64_tr_b16 v[24:25], v6 offset:26624
ds_read_b64_tr_b16 v[26:27], v6 offset:27648
v_mfma_f32_16x16x32_bf16 v[44:47], v[28:31], v[236:239], v[44:47]
v_mfma_f32_16x16x32_bf16 v[52:55], v[28:31], v[252:255], v[52:55]
s_waitcnt vmcnt(24)
s_barrier
s_waitcnt lgkmcnt(4)
v_mfma_f32_16x16x32_bf16 v[32:35], v[16:19], v[160:163], v[32:35]
ds_read_b64_tr_b16 v[28:29], v7 offset:26624
ds_read_b64_tr_b16 v[30:31], v7 offset:27648
v_mfma_f32_16x16x32_bf16 v[40:43], v[16:19], v[176:179], v[40:43]
s_add_u32 m0, s56, 0x14000
s_add_u32 s66, s46, 0x240
buffer_load_dwordx4 v4, s[28:31], s66 offen lds
v_mfma_f32_16x16x32_bf16 v[48:51], v[16:19], v[192:195], v[48:51]
s_add_u32 s67, s66, 0x4400
buffer_load_dwordx4 v4, s[28:31], s67 offen offset:1024 lds
s_waitcnt lgkmcnt(4)
v_mfma_f32_16x16x32_bf16 v[36:39], v[20:23], v[160:163], v[36:39]
ds_read_b64_tr_b16 v[16:17], v6 offset:28672
ds_read_b64_tr_b16 v[18:19], v6 offset:29696
v_mfma_f32_16x16x32_bf16 v[44:47], v[20:23], v[176:179], v[44:47]
buffer_store_dwordx4 v[60:63], v5, s[24:27], s74 offen offset:1024 sc1
v_mfma_f32_16x16x32_bf16 v[52:55], v[20:23], v[192:195], v[52:55]
s_add_u32 m0, s56, 0xa000
s_add_u32 s66, s45, 0x48000
buffer_load_dwordx4 v4, s[28:31], s66 offen lds
s_waitcnt lgkmcnt(4)
v_mfma_f32_16x16x32_bf16 v[32:35], v[24:27], v[164:167], v[32:35]
ds_read_b64_tr_b16 v[20:21], v7 offset:28672
ds_read_b64_tr_b16 v[22:23], v7 offset:29696
v_mfma_f32_16x16x32_bf16 v[40:43], v[24:27], v[180:183], v[40:43]
s_add_u32 s67, s66, 0x4400
buffer_load_dwordx4 v4, s[28:31], s67 offen offset:1024 lds
v_mfma_f32_16x16x32_bf16 v[48:51], v[24:27], v[196:199], v[48:51]
s_waitcnt lgkmcnt(4)
v_mfma_f32_16x16x32_bf16 v[36:39], v[28:31], v[164:167], v[36:39]
ds_read_b64_tr_b16 v[24:25], v6 offset:30720
ds_read_b64_tr_b16 v[26:27], v6 offset:31744
v_mfma_f32_16x16x32_bf16 v[44:47], v[28:31], v[180:183], v[44:47]
v_mfma_f32_16x16x32_bf16 v[52:55], v[28:31], v[196:199], v[52:55]
s_waitcnt lgkmcnt(4)
v_mfma_f32_16x16x32_bf16 v[32:35], v[16:19], v[168:171], v[32:35]
ds_read_b64_tr_b16 v[28:29], v7 offset:30720
ds_read_b64_tr_b16 v[30:31], v7 offset:31744
v_mfma_f32_16x16x32_bf16 v[40:43], v[16:19], v[184:187], v[40:43]
v_mfma_f32_16x16x32_bf16 v[48:51], v[16:19], v[200:203], v[48:51]
s_waitcnt lgkmcnt(4)
v_mfma_f32_16x16x32_bf16 v[36:39], v[20:23], v[168:171], v[36:39]
ds_read_b64_tr_b16 v[16:17], v6 offset:32768
ds_read_b64_tr_b16 v[18:19], v6 offset:33792
v_mfma_f32_16x16x32_bf16 v[44:47], v[20:23], v[184:187], v[44:47]
v_mfma_f32_16x16x32_bf16 v[52:55], v[20:23], v[200:203], v[52:55]
s_waitcnt lgkmcnt(4)
v_mfma_f32_16x16x32_bf16 v[32:35], v[24:27], v[172:175], v[32:35]
ds_read_b64_tr_b16 v[20:21], v7 offset:32768
ds_read_b64_tr_b16 v[22:23], v7 offset:33792
v_mfma_f32_16x16x32_bf16 v[40:43], v[24:27], v[188:191], v[40:43]
v_mfma_f32_16x16x32_bf16 v[48:51], v[24:27], v[204:207], v[48:51]
s_waitcnt lgkmcnt(4)
v_mfma_f32_16x16x32_bf16 v[36:39], v[28:31], v[172:175], v[36:39]
ds_read_b64_tr_b16 v[24:25], v6 offset:34816
ds_read_b64_tr_b16 v[26:27], v6 offset:35840
v_mfma_f32_16x16x32_bf16 v[44:47], v[28:31], v[188:191], v[44:47]
v_mfma_f32_16x16x32_bf16 v[52:55], v[28:31], v[204:207], v[52:55]
s_waitcnt vmcnt(24)
s_barrier
s_waitcnt lgkmcnt(4)
v_mfma_f32_16x16x32_bf16 v[32:35], v[16:19], v[112:115], v[32:35]
ds_read_b64_tr_b16 v[28:29], v7 offset:34816
ds_read_b64_tr_b16 v[30:31], v7 offset:35840
v_mfma_f32_16x16x32_bf16 v[40:43], v[16:19], v[128:131], v[40:43]
s_add_u32 m0, s56, 0x16000
s_add_u32 s66, s46, 0x24240
buffer_load_dwordx4 v4, s[28:31], s66 offen lds
v_mfma_f32_16x16x32_bf16 v[48:51], v[16:19], v[144:147], v[48:51]
s_add_u32 s67, s66, 0x4400
buffer_load_dwordx4 v4, s[28:31], s67 offen offset:1024 lds
s_waitcnt lgkmcnt(4)
v_mfma_f32_16x16x32_bf16 v[36:39], v[20:23], v[112:115], v[36:39]
ds_read_b64_tr_b16 v[16:17], v6 offset:36864
ds_read_b64_tr_b16 v[18:19], v6 offset:37888
v_mfma_f32_16x16x32_bf16 v[44:47], v[20:23], v[128:131], v[44:47]
buffer_store_dwordx4 v[12:15], v5, s[24:27], s74 offen offset:2048 sc1
s_add_u32 s74, s74, 0xc00
s_sub_u32 s55, s74, 0x6c00
s_cmp_ge_u32 s74, s75
s_cselect_b32 s74, s55, s74
v_mfma_f32_16x16x32_bf16 v[52:55], v[20:23], v[144:147], v[52:55]
s_add_u32 m0, s56, 0xc000
s_add_u32 s66, s45, 0
buffer_load_dwordx4 v4, s[28:31], s66 offen lds
s_waitcnt lgkmcnt(4)
v_mfma_f32_16x16x32_bf16 v[32:35], v[24:27], v[116:119], v[32:35]
ds_read_b64_tr_b16 v[20:21], v7 offset:36864
ds_read_b64_tr_b16 v[22:23], v7 offset:37888
v_mfma_f32_16x16x32_bf16 v[40:43], v[24:27], v[132:135], v[40:43]
s_add_u32 s67, s66, 0x4400
buffer_load_dwordx4 v4, s[28:31], s67 offen offset:1024 lds
v_mfma_f32_16x16x32_bf16 v[48:51], v[24:27], v[148:151], v[48:51]
s_waitcnt lgkmcnt(4)
v_mfma_f32_16x16x32_bf16 v[36:39], v[28:31], v[116:119], v[36:39]
ds_read_b64_tr_b16 v[24:25], v6 offset:38912
ds_read_b64_tr_b16 v[26:27], v6 offset:39936
v_mfma_f32_16x16x32_bf16 v[44:47], v[28:31], v[132:135], v[44:47]
v_mfma_f32_16x16x32_bf16 v[52:55], v[28:31], v[148:151], v[52:55]
s_waitcnt lgkmcnt(4)
v_mfma_f32_16x16x32_bf16 v[32:35], v[16:19], v[120:123], v[32:35]
ds_read_b64_tr_b16 v[28:29], v7 offset:38912
ds_read_b64_tr_b16 v[30:31], v7 offset:39936
v_mfma_f32_16x16x32_bf16 v[40:43], v[16:19], v[136:139], v[40:43]
v_mfma_f32_16x16x32_bf16 v[48:51], v[16:19], v[152:155], v[48:51]
s_waitcnt lgkmcnt(4)
v_mfma_f32_16x16x32_bf16 v[36:39], v[20:23], v[120:123], v[36:39]
ds_read_b64_tr_b16 v[16:17], v6 offset:40960
ds_read_b64_tr_b16 v[18:19], v6 offset:41984
v_mfma_f32_16x16x32_bf16 v[44:47], v[20:23], v[136:139], v[44:47]
v_mfma_f32_16x16x32_bf16 v[52:55], v[20:23], v[152:155], v[52:55]
s_waitcnt lgkmcnt(4)
v_mfma_f32_16x16x32_bf16 v[32:35], v[24:27], v[124:127], v[32:35]
ds_read_b64_tr_b16 v[20:21], v7 offset:40960
ds_read_b64_tr_b16 v[22:23], v7 offset:41984
v_mfma_f32_16x16x32_bf16 v[40:43], v[24:27], v[140:143], v[40:43]
v_mfma_f32_16x16x32_bf16 v[48:51], v[24:27], v[156:159], v[48:51]
s_waitcnt lgkmcnt(4)
v_mfma_f32_16x16x32_bf16 v[36:39], v[28:31], v[124:127], v[36:39]
ds_read_b64_tr_b16 v[24:25], v6 offset:43008
ds_read_b64_tr_b16 v[26:27], v6 offset:44032
v_mfma_f32_16x16x32_bf16 v[44:47], v[28:31], v[140:143], v[44:47]
v_mfma_f32_16x16x32_bf16 v[52:55], v[28:31], v[156:159], v[52:55]
s_waitcnt vmcnt(24)
s_barrier
s_waitcnt lgkmcnt(4)
v_mfma_f32_16x16x32_bf16 v[32:35], v[16:19], v[64:67], v[32:35]
ds_read_b64_tr_b16 v[28:29], v7 offset:43008
ds_read_b64_tr_b16 v[30:31], v7 offset:44032
v_mfma_f32_16x16x32_bf16 v[40:43], v[16:19], v[80:83], v[40:43]
s_add_u32 m0, s56, 0x18000
s_add_u32 s66, s46, 0x48240
buffer_load_dwordx4 v4, s[28:31], s66 offen lds
v_mfma_f32_16x16x32_bf16 v[48:51], v[16:19], v[96:99], v[48:51]
s_add_u32 s67, s66, 0x4400
buffer_load_dwordx4 v4, s[28:31], s67 offen offset:1024 lds
s_waitcnt lgkmcnt(4)
v_mfma_f32_16x16x32_bf16 v[36:39], v[20:23], v[64:67], v[36:39]
ds_read_b64_tr_b16 v[16:17], v6 offset:45056
ds_read_b64_tr_b16 v[18:19], v6 offset:46080
v_mfma_f32_16x16x32_bf16 v[44:47], v[20:23], v[80:83], v[44:47]
s_add_u32 m0, s56, 0xe000
s_add_u32 s66, s45, 0x24000
buffer_load_dwordx4 v4, s[28:31], s66 offen lds
v_mfma_f32_16x16x32_bf16 v[52:55], v[20:23], v[96:99], v[52:55]
s_add_u32 s67, s66, 0x4400
buffer_load_dwordx4 v4, s[28:31], s67 offen offset:1024 lds
s_waitcnt lgkmcnt(4)
v_mfma_f32_16x16x32_bf16 v[32:35], v[24:27], v[68:71], v[32:35]
ds_read_b64_tr_b16 v[20:21], v7 offset:45056
ds_read_b64_tr_b16 v[22:23], v7 offset:46080
v_mfma_f32_16x16x32_bf16 v[40:43], v[24:27], v[84:87], v[40:43]
v_mfma_f32_16x16x32_bf16 v[48:51], v[24:27], v[100:103], v[48:51]
s_waitcnt lgkmcnt(4)
v_mfma_f32_16x16x32_bf16 v[36:39], v[28:31], v[68:71], v[36:39]
ds_read_b64_tr_b16 v[24:25], v6 offset:47104
ds_read_b64_tr_b16 v[26:27], v6 offset:48128
v_mfma_f32_16x16x32_bf16 v[44:47], v[28:31], v[84:87], v[44:47]
v_mfma_f32_16x16x32_bf16 v[52:55], v[28:31], v[100:103], v[52:55]
s_waitcnt lgkmcnt(4)
v_mfma_f32_16x16x32_bf16 v[32:35], v[16:19], v[72:75], v[32:35]
ds_read_b64_tr_b16 v[28:29], v7 offset:47104
ds_read_b64_tr_b16 v[30:31], v7 offset:48128
v_mfma_f32_16x16x32_bf16 v[40:43], v[16:19], v[88:91], v[40:43]
v_mfma_f32_16x16x32_bf16 v[48:51], v[16:19], v[104:107], v[48:51]
s_waitcnt lgkmcnt(4)
v_mfma_f32_16x16x32_bf16 v[36:39], v[20:23], v[72:75], v[36:39]
ds_read_b64_tr_b16 v[16:17], v6
ds_read_b64_tr_b16 v[18:19], v6 offset:1024
v_mfma_f32_16x16x32_bf16 v[44:47], v[20:23], v[88:91], v[44:47]
v_mfma_f32_16x16x32_bf16 v[52:55], v[20:23], v[104:107], v[52:55]
s_waitcnt lgkmcnt(4)
v_mfma_f32_16x16x32_bf16 v[32:35], v[24:27], v[76:79], v[32:35]
ds_read_b64_tr_b16 v[20:21], v7
ds_read_b64_tr_b16 v[22:23], v7 offset:1024
v_mfma_f32_16x16x32_bf16 v[40:43], v[24:27], v[92:95], v[40:43]
v_mfma_f32_16x16x32_bf16 v[48:51], v[24:27], v[108:111], v[48:51]
s_waitcnt lgkmcnt(4)
v_mfma_f32_16x16x32_bf16 v[36:39], v[28:31], v[76:79], v[36:39]
ds_read_b64_tr_b16 v[24:25], v6 offset:2048
ds_read_b64_tr_b16 v[26:27], v6 offset:3072
v_mfma_f32_16x16x32_bf16 v[44:47], v[28:31], v[92:95], v[44:47]
v_mfma_f32_16x16x32_bf16 v[52:55], v[28:31], v[108:111], v[52:55]
v_cvt_pk_bf16_f32 v56, v32, v33
v_cvt_pk_bf16_f32 v57, v34, v35
s_nop 1
v_cvt_pk_bf16_f32 v58, v36, v37
v_cvt_pk_bf16_f32 v59, v38, v39
v_cvt_pk_bf16_f32 v60, v40, v41
v_cvt_pk_bf16_f32 v61, v42, v43
v_cvt_pk_bf16_f32 v62, v44, v45
v_cvt_pk_bf16_f32 v63, v46, v47
v_cvt_pk_bf16_f32 v12, v48, v49
v_cvt_pk_bf16_f32 v13, v50, v51
v_cvt_pk_bf16_f32 v14, v52, v53
v_cvt_pk_bf16_f32 v15, v54, v55
s_waitcnt vmcnt(23)
s_barrier
s_waitcnt lgkmcnt(4)
v_mfma_f32_16x16x32_bf16 v[32:35], v[16:19], v[208:211], 0
ds_read_b64_tr_b16 v[28:29], v7 offset:2048
ds_read_b64_tr_b16 v[30:31], v7 offset:3072
v_mfma_f32_16x16x32_bf16 v[40:43], v[16:19], v[224:227], 0
s_add_u32 m0, s56, 0x1a000
s_add_u32 s66, s46, 0x6c240
buffer_load_dwordx4 v4, s[28:31], s66 offen lds
v_mfma_f32_16x16x32_bf16 v[48:51], v[16:19], v[240:243], 0
s_add_u32 s67, s66, 0x4400
buffer_load_dwordx4 v4, s[28:31], s67 offen offset:1024 lds
s_waitcnt lgkmcnt(4)
v_mfma_f32_16x16x32_bf16 v[36:39], v[20:23], v[208:211], 0
ds_read_b64_tr_b16 v[16:17], v6 offset:4096
ds_read_b64_tr_b16 v[18:19], v6 offset:5120
v_mfma_f32_16x16x32_bf16 v[44:47], v[20:23], v[224:227], 0
buffer_store_dwordx4 v[56:59], v5, s[24:27], s74 offen sc1
v_mfma_f32_16x16x32_bf16 v[52:55], v[20:23], v[240:243], 0
s_add_u32 m0, s56, 0
s_add_u32 s66, s46, 0x6c000
buffer_load_dwordx4 v4, s[28:31], s66 offen lds
s_waitcnt lgkmcnt(4)
v_mfma_f32_16x16x32_bf16 v[32:35], v[24:27], v[212:215], v[32:35]
ds_read_b64_tr_b16 v[20:21], v7 offset:4096
ds_read_b64_tr_b16 v[22:23], v7 offset:5120
v_mfma_f32_16x16x32_bf16 v[40:43], v[24:27], v[228:231], v[40:43]
s_add_u32 s67, s66, 0x4400
buffer_load_dwordx4 v4, s[28:31], s67 offen offset:1024 lds
v_mfma_f32_16x16x32_bf16 v[48:51], v[24:27], v[244:247], v[48:51]
s_waitcnt lgkmcnt(4)
v_mfma_f32_16x16x32_bf16 v[36:39], v[28:31], v[212:215], v[36:39]
ds_read_b64_tr_b16 v[24:25], v6 offset:6144
ds_read_b64_tr_b16 v[26:27], v6 offset:7168
v_mfma_f32_16x16x32_bf16 v[44:47], v[28:31], v[228:231], v[44:47]
v_mfma_f32_16x16x32_bf16 v[52:55], v[28:31], v[244:247], v[52:55]
s_waitcnt lgkmcnt(4)
v_mfma_f32_16x16x32_bf16 v[32:35], v[16:19], v[216:219], v[32:35]
ds_read_b64_tr_b16 v[28:29], v7 offset:6144
ds_read_b64_tr_b16 v[30:31], v7 offset:7168
v_mfma_f32_16x16x32_bf16 v[40:43], v[16:19], v[232:235], v[40:43]
v_mfma_f32_16x16x32_bf16 v[48:51], v[16:19], v[248:251], v[48:51]
s_waitcnt lgkmcnt(4)
v_mfma_f32_16x16x32_bf16 v[36:39], v[20:23], v[216:219], v[36:39]
ds_read_b64_tr_b16 v[16:17], v6 offset:49152
ds_read_b64_tr_b16 v[18:19], v6 offset:50176
v_mfma_f32_16x16x32_bf16 v[44:47], v[20:23], v[232:235], v[44:47]
v_mfma_f32_16x16x32_bf16 v[52:55], v[20:23], v[248:251], v[52:55]
s_waitcnt lgkmcnt(4)
v_mfma_f32_16x16x32_bf16 v[32:35], v[24:27], v[220:223], v[32:35]
ds_read_b64_tr_b16 v[20:21], v7 offset:49152
ds_read_b64_tr_b16 v[22:23], v7 offset:50176
v_mfma_f32_16x16x32_bf16 v[40:43], v[24:27], v[236:239], v[40:43]
v_mfma_f32_16x16x32_bf16 v[48:51], v[24:27], v[252:255], v[48:51]
s_waitcnt lgkmcnt(4)
v_mfma_f32_16x16x32_bf16 v[36:39], v[28:31], v[220:223], v[36:39]
ds_read_b64_tr_b16 v[24:25], v6 offset:51200
ds_read_b64_tr_b16 v[26:27], v6 offset:52224
v_mfma_f32_16x16x32_bf16 v[44:47], v[28:31], v[236:239], v[44:47]
v_mfma_f32_16x16x32_bf16 v[52:55], v[28:31], v[252:255], v[52:55]
s_waitcnt vmcnt(24)
s_barrier
s_waitcnt lgkmcnt(4)
v_mfma_f32_16x16x32_bf16 v[32:35], v[16:19], v[160:163], v[32:35]
ds_read_b64_tr_b16 v[28:29], v7 offset:51200
ds_read_b64_tr_b16 v[30:31], v7 offset:52224
v_mfma_f32_16x16x32_bf16 v[40:43], v[16:19], v[176:179], v[40:43]
s_add_u32 m0, s56, 0x10000
s_add_u32 s66, s47, 0x240
buffer_load_dwordx4 v4, s[28:31], s66 offen lds
v_mfma_f32_16x16x32_bf16 v[48:51], v[16:19], v[192:195], v[48:51]
s_add_u32 s67, s66, 0x4400
buffer_load_dwordx4 v4, s[28:31], s67 offen offset:1024 lds
s_waitcnt lgkmcnt(4)
v_mfma_f32_16x16x32_bf16 v[36:39], v[20:23], v[160:163], v[36:39]
ds_read_b64_tr_b16 v[16:17], v6 offset:53248
ds_read_b64_tr_b16 v[18:19], v6 offset:54272
v_mfma_f32_16x16x32_bf16 v[44:47], v[20:23], v[176:179], v[44:47]
buffer_store_dwordx4 v[60:63], v5, s[24:27], s74 offen offset:1024 sc1
v_mfma_f32_16x16x32_bf16 v[52:55], v[20:23], v[192:195], v[52:55]
s_add_u32 m0, s56, 0x2000
s_add_u32 s66, s46, 0x48000
buffer_load_dwordx4 v4, s[28:31], s66 offen lds
s_waitcnt lgkmcnt(4)
v_mfma_f32_16x16x32_bf16 v[32:35], v[24:27], v[164:167], v[32:35]
ds_read_b64_tr_b16 v[20:21], v7 offset:53248
ds_read_b64_tr_b16 v[22:23], v7 offset:54272
v_mfma_f32_16x16x32_bf16 v[40:43], v[24:27], v[180:183], v[40:43]
s_add_u32 s67, s66, 0x4400
buffer_load_dwordx4 v4, s[28:31], s67 offen offset:1024 lds
v_mfma_f32_16x16x32_bf16 v[48:51], v[24:27], v[196:199], v[48:51]
s_waitcnt lgkmcnt(4)
v_mfma_f32_16x16x32_bf16 v[36:39], v[28:31], v[164:167], v[36:39]
ds_read_b64_tr_b16 v[24:25], v6 offset:55296
ds_read_b64_tr_b16 v[26:27], v6 offset:56320
v_mfma_f32_16x16x32_bf16 v[44:47], v[28:31], v[180:183], v[44:47]
v_mfma_f32_16x16x32_bf16 v[52:55], v[28:31], v[196:199], v[52:55]
s_waitcnt lgkmcnt(4)
v_mfma_f32_16x16x32_bf16 v[32:35], v[16:19], v[168:171], v[32:35]
ds_read_b64_tr_b16 v[28:29], v7 offset:55296
ds_read_b64_tr_b16 v[30:31], v7 offset:56320
v_mfma_f32_16x16x32_bf16 v[40:43], v[16:19], v[184:187], v[40:43]
v_mfma_f32_16x16x32_bf16 v[48:51], v[16:19], v[200:203], v[48:51]
s_waitcnt lgkmcnt(4)
v_mfma_f32_16x16x32_bf16 v[36:39], v[20:23], v[168:171], v[36:39]
ds_read_b64_tr_b16 v[16:17], v6 offset:57344
ds_read_b64_tr_b16 v[18:19], v6 offset:58368
v_mfma_f32_16x16x32_bf16 v[44:47], v[20:23], v[184:187], v[44:47]
v_mfma_f32_16x16x32_bf16 v[52:55], v[20:23], v[200:203], v[52:55]
s_waitcnt lgkmcnt(4)
v_mfma_f32_16x16x32_bf16 v[32:35], v[24:27], v[172:175], v[32:35]
ds_read_b64_tr_b16 v[20:21], v7 offset:57344
ds_read_b64_tr_b16 v[22:23], v7 offset:58368
v_mfma_f32_16x16x32_bf16 v[40:43], v[24:27], v[188:191], v[40:43]
v_mfma_f32_16x16x32_bf16 v[48:51], v[24:27], v[204:207], v[48:51]
s_waitcnt lgkmcnt(4)
v_mfma_f32_16x16x32_bf16 v[36:39], v[28:31], v[172:175], v[36:39]
ds_read_b64_tr_b16 v[24:25], v6 offset:59392
ds_read_b64_tr_b16 v[26:27], v6 offset:60416
v_mfma_f32_16x16x32_bf16 v[44:47], v[28:31], v[188:191], v[44:47]
v_mfma_f32_16x16x32_bf16 v[52:55], v[28:31], v[204:207], v[52:55]
s_waitcnt vmcnt(24)
s_barrier
s_waitcnt lgkmcnt(4)
v_mfma_f32_16x16x32_bf16 v[32:35], v[16:19], v[112:115], v[32:35]
ds_read_b64_tr_b16 v[28:29], v7 offset:59392
ds_read_b64_tr_b16 v[30:31], v7 offset:60416
v_mfma_f32_16x16x32_bf16 v[40:43], v[16:19], v[128:131], v[40:43]
s_add_u32 m0, s56, 0x1c000
s_add_u32 s66, s47, 0x24240
buffer_load_dwordx4 v4, s[28:31], s66 offen lds
v_mfma_f32_16x16x32_bf16 v[48:51], v[16:19], v[144:147], v[48:51]
s_add_u32 s67, s66, 0x4400
buffer_load_dwordx4 v4, s[28:31], s67 offen offset:1024 lds
s_waitcnt lgkmcnt(4)
v_mfma_f32_16x16x32_bf16 v[36:39], v[20:23], v[112:115], v[36:39]
ds_read_b64_tr_b16 v[16:17], v6 offset:61440
ds_read_b64_tr_b16 v[18:19], v6 offset:62464
v_mfma_f32_16x16x32_bf16 v[44:47], v[20:23], v[128:131], v[44:47]
buffer_store_dwordx4 v[12:15], v5, s[24:27], s74 offen offset:2048 sc1
s_add_u32 s74, s74, 0xc00
s_sub_u32 s55, s74, 0x6c00
s_cmp_ge_u32 s74, s75
s_cselect_b32 s74, s55, s74
v_mfma_f32_16x16x32_bf16 v[52:55], v[20:23], v[144:147], v[52:55]
s_add_u32 m0, s56, 0x4000
s_add_u32 s66, s46, 0
buffer_load_dwordx4 v4, s[28:31], s66 offen lds
s_waitcnt lgkmcnt(4)
v_mfma_f32_16x16x32_bf16 v[32:35], v[24:27], v[116:119], v[32:35]
ds_read_b64_tr_b16 v[20:21], v7 offset:61440
ds_read_b64_tr_b16 v[22:23], v7 offset:62464
v_mfma_f32_16x16x32_bf16 v[40:43], v[24:27], v[132:135], v[40:43]
s_add_u32 s67, s66, 0x4400
buffer_load_dwordx4 v4, s[28:31], s67 offen offset:1024 lds
v_mfma_f32_16x16x32_bf16 v[48:51], v[24:27], v[148:151], v[48:51]
s_waitcnt lgkmcnt(4)
v_mfma_f32_16x16x32_bf16 v[36:39], v[28:31], v[116:119], v[36:39]
ds_read_b64_tr_b16 v[24:25], v6 offset:63488
ds_read_b64_tr_b16 v[26:27], v6 offset:64512
v_mfma_f32_16x16x32_bf16 v[44:47], v[28:31], v[132:135], v[44:47]
v_mfma_f32_16x16x32_bf16 v[52:55], v[28:31], v[148:151], v[52:55]
s_waitcnt lgkmcnt(4)
v_mfma_f32_16x16x32_bf16 v[32:35], v[16:19], v[120:123], v[32:35]
ds_read_b64_tr_b16 v[28:29], v7 offset:63488
ds_read_b64_tr_b16 v[30:31], v7 offset:64512
v_mfma_f32_16x16x32_bf16 v[40:43], v[16:19], v[136:139], v[40:43]
v_mfma_f32_16x16x32_bf16 v[48:51], v[16:19], v[152:155], v[48:51]
s_waitcnt lgkmcnt(4)
v_mfma_f32_16x16x32_bf16 v[36:39], v[20:23], v[120:123], v[36:39]
ds_read_b64_tr_b16 v[16:17], v6 offset:8192
ds_read_b64_tr_b16 v[18:19], v6 offset:9216
v_mfma_f32_16x16x32_bf16 v[44:47], v[20:23], v[136:139], v[44:47]
v_mfma_f32_16x16x32_bf16 v[52:55], v[20:23], v[152:155], v[52:55]
s_waitcnt lgkmcnt(4)
v_mfma_f32_16x16x32_bf16 v[32:35], v[24:27], v[124:127], v[32:35]
ds_read_b64_tr_b16 v[20:21], v7 offset:8192
ds_read_b64_tr_b16 v[22:23], v7 offset:9216
v_mfma_f32_16x16x32_bf16 v[40:43], v[24:27], v[140:143], v[40:43]
v_mfma_f32_16x16x32_bf16 v[48:51], v[24:27], v[156:159], v[48:51]
s_waitcnt lgkmcnt(4)
v_mfma_f32_16x16x32_bf16 v[36:39], v[28:31], v[124:127], v[36:39]
ds_read_b64_tr_b16 v[24:25], v6 offset:10240
ds_read_b64_tr_b16 v[26:27], v6 offset:11264
v_mfma_f32_16x16x32_bf16 v[44:47], v[28:31], v[140:143], v[44:47]
v_mfma_f32_16x16x32_bf16 v[52:55], v[28:31], v[156:159], v[52:55]
s_waitcnt vmcnt(24)
s_barrier
s_waitcnt lgkmcnt(4)
v_mfma_f32_16x16x32_bf16 v[32:35], v[16:19], v[64:67], v[32:35]
ds_read_b64_tr_b16 v[28:29], v7 offset:10240
ds_read_b64_tr_b16 v[30:31], v7 offset:11264
v_mfma_f32_16x16x32_bf16 v[40:43], v[16:19], v[80:83], v[40:43]
s_add_u32 m0, s56, 0x1e000
s_add_u32 s66, s47, 0x48240
buffer_load_dwordx4 v4, s[28:31], s66 offen lds
v_mfma_f32_16x16x32_bf16 v[48:51], v[16:19], v[96:99], v[48:51]
s_add_u32 s67, s66, 0x4400
buffer_load_dwordx4 v4, s[28:31], s67 offen offset:1024 lds
s_waitcnt lgkmcnt(4)
v_mfma_f32_16x16x32_bf16 v[36:39], v[20:23], v[64:67], v[36:39]
ds_read_b64_tr_b16 v[16:17], v6 offset:12288
ds_read_b64_tr_b16 v[18:19], v6 offset:13312
v_mfma_f32_16x16x32_bf16 v[44:47], v[20:23], v[80:83], v[44:47]
s_add_u32 m0, s56, 0x8000
s_add_u32 s66, s46, 0x24000
buffer_load_dwordx4 v4, s[28:31], s66 offen lds
v_mfma_f32_16x16x32_bf16 v[52:55], v[20:23], v[96:99], v[52:55]
s_add_u32 s67, s66, 0x4400
buffer_load_dwordx4 v4, s[28:31], s67 offen offset:1024 lds
s_waitcnt lgkmcnt(4)
v_mfma_f32_16x16x32_bf16 v[32:35], v[24:27], v[68:71], v[32:35]
ds_read_b64_tr_b16 v[20:21], v7 offset:12288
ds_read_b64_tr_b16 v[22:23], v7 offset:13312
v_mfma_f32_16x16x32_bf16 v[40:43], v[24:27], v[84:87], v[40:43]
v_mfma_f32_16x16x32_bf16 v[48:51], v[24:27], v[100:103], v[48:51]
s_waitcnt lgkmcnt(4)
v_mfma_f32_16x16x32_bf16 v[36:39], v[28:31], v[68:71], v[36:39]
ds_read_b64_tr_b16 v[24:25], v6 offset:14336
ds_read_b64_tr_b16 v[26:27], v6 offset:15360
v_mfma_f32_16x16x32_bf16 v[44:47], v[28:31], v[84:87], v[44:47]
v_mfma_f32_16x16x32_bf16 v[52:55], v[28:31], v[100:103], v[52:55]
s_waitcnt lgkmcnt(4)
v_mfma_f32_16x16x32_bf16 v[32:35], v[16:19], v[72:75], v[32:35]
ds_read_b64_tr_b16 v[28:29], v7 offset:14336
ds_read_b64_tr_b16 v[30:31], v7 offset:15360
v_mfma_f32_16x16x32_bf16 v[40:43], v[16:19], v[88:91], v[40:43]
v_mfma_f32_16x16x32_bf16 v[48:51], v[16:19], v[104:107], v[48:51]
s_waitcnt lgkmcnt(4)
v_mfma_f32_16x16x32_bf16 v[36:39], v[20:23], v[72:75], v[36:39]
ds_read_b64_tr_b16 v[16:17], v6 offset:16384
ds_read_b64_tr_b16 v[18:19], v6 offset:17408
v_mfma_f32_16x16x32_bf16 v[44:47], v[20:23], v[88:91], v[44:47]
v_mfma_f32_16x16x32_bf16 v[52:55], v[20:23], v[104:107], v[52:55]
s_waitcnt lgkmcnt(4)
v_mfma_f32_16x16x32_bf16 v[32:35], v[24:27], v[76:79], v[32:35]
ds_read_b64_tr_b16 v[20:21], v7 offset:16384
ds_read_b64_tr_b16 v[22:23], v7 offset:17408
v_mfma_f32_16x16x32_bf16 v[40:43], v[24:27], v[92:95], v[40:43]
v_mfma_f32_16x16x32_bf16 v[48:51], v[24:27], v[108:111], v[48:51]
s_waitcnt lgkmcnt(4)
v_mfma_f32_16x16x32_bf16 v[36:39], v[28:31], v[76:79], v[36:39]
ds_read_b64_tr_b16 v[24:25], v6 offset:18432
ds_read_b64_tr_b16 v[26:27], v6 offset:19456
v_mfma_f32_16x16x32_bf16 v[44:47], v[28:31], v[92:95], v[44:47]
v_mfma_f32_16x16x32_bf16 v[52:55], v[28:31], v[108:111], v[52:55]
v_cvt_pk_bf16_f32 v56, v32, v33
v_cvt_pk_bf16_f32 v57, v34, v35
s_nop 1
v_cvt_pk_bf16_f32 v58, v36, v37
v_cvt_pk_bf16_f32 v59, v38, v39
v_cvt_pk_bf16_f32 v60, v40, v41
v_cvt_pk_bf16_f32 v61, v42, v43
v_cvt_pk_bf16_f32 v62, v44, v45
v_cvt_pk_bf16_f32 v63, v46, v47
v_cvt_pk_bf16_f32 v12, v48, v49
v_cvt_pk_bf16_f32 v13, v50, v51
v_cvt_pk_bf16_f32 v14, v52, v53
v_cvt_pk_bf16_f32 v15, v54, v55
s_waitcnt vmcnt(23)
s_barrier
s_waitcnt lgkmcnt(4)
v_mfma_f32_16x16x32_bf16 v[32:35], v[16:19], v[208:211], 0
ds_read_b64_tr_b16 v[28:29], v7 offset:18432
ds_read_b64_tr_b16 v[30:31], v7 offset:19456
v_mfma_f32_16x16x32_bf16 v[40:43], v[16:19], v[224:227], 0
s_add_u32 m0, s56, 0x12000
s_add_u32 s66, s47, 0x6c240
buffer_load_dwordx4 v4, s[28:31], s66 offen lds
v_mfma_f32_16x16x32_bf16 v[48:51], v[16:19], v[240:243], 0
s_add_u32 s67, s66, 0x4400
buffer_load_dwordx4 v4, s[28:31], s67 offen offset:1024 lds
s_waitcnt lgkmcnt(4)
v_mfma_f32_16x16x32_bf16 v[36:39], v[20:23], v[208:211], 0
ds_read_b64_tr_b16 v[16:17], v6 offset:20480
ds_read_b64_tr_b16 v[18:19], v6 offset:21504
v_mfma_f32_16x16x32_bf16 v[44:47], v[20:23], v[224:227], 0
buffer_store_dwordx4 v[56:59], v5, s[24:27], s74 offen sc1
v_mfma_f32_16x16x32_bf16 v[52:55], v[20:23], v[240:243], 0
s_add_u32 m0, s56, 0x6000
s_add_u32 s66, s47, 0x6c000
buffer_load_dwordx4 v4, s[28:31], s66 offen lds
s_waitcnt lgkmcnt(4)
v_mfma_f32_16x16x32_bf16 v[32:35], v[24:27], v[212:215], v[32:35]
ds_read_b64_tr_b16 v[20:21], v7 offset:20480
ds_read_b64_tr_b16 v[22:23], v7 offset:21504
v_mfma_f32_16x16x32_bf16 v[40:43], v[24:27], v[228:231], v[40:43]
s_add_u32 s67, s66, 0x4400
buffer_load_dwordx4 v4, s[28:31], s67 offen offset:1024 lds
v_mfma_f32_16x16x32_bf16 v[48:51], v[24:27], v[244:247], v[48:51]
s_waitcnt lgkmcnt(4)
v_mfma_f32_16x16x32_bf16 v[36:39], v[28:31], v[212:215], v[36:39]
ds_read_b64_tr_b16 v[24:25], v6 offset:22528
ds_read_b64_tr_b16 v[26:27], v6 offset:23552
v_mfma_f32_16x16x32_bf16 v[44:47], v[28:31], v[228:231], v[44:47]
v_mfma_f32_16x16x32_bf16 v[52:55], v[28:31], v[244:247], v[52:55]
s_waitcnt lgkmcnt(4)
v_mfma_f32_16x16x32_bf16 v[32:35], v[16:19], v[216:219], v[32:35]
ds_read_b64_tr_b16 v[28:29], v7 offset:22528
ds_read_b64_tr_b16 v[30:31], v7 offset:23552
v_mfma_f32_16x16x32_bf16 v[40:43], v[16:19], v[232:235], v[40:43]
v_mfma_f32_16x16x32_bf16 v[48:51], v[16:19], v[248:251], v[48:51]
s_waitcnt lgkmcnt(4)
v_mfma_f32_16x16x32_bf16 v[36:39], v[20:23], v[216:219], v[36:39]
ds_read_b64_tr_b16 v[16:17], v6 offset:24576
ds_read_b64_tr_b16 v[18:19], v6 offset:25600
v_mfma_f32_16x16x32_bf16 v[44:47], v[20:23], v[232:235], v[44:47]
v_mfma_f32_16x16x32_bf16 v[52:55], v[20:23], v[248:251], v[52:55]
s_waitcnt lgkmcnt(4)
v_mfma_f32_16x16x32_bf16 v[32:35], v[24:27], v[220:223], v[32:35]
ds_read_b64_tr_b16 v[20:21], v7 offset:24576
ds_read_b64_tr_b16 v[22:23], v7 offset:25600
v_mfma_f32_16x16x32_bf16 v[40:43], v[24:27], v[236:239], v[40:43]
v_mfma_f32_16x16x32_bf16 v[48:51], v[24:27], v[252:255], v[48:51]
s_waitcnt lgkmcnt(4)
v_mfma_f32_16x16x32_bf16 v[36:39], v[28:31], v[220:223], v[36:39]
ds_read_b64_tr_b16 v[24:25], v6 offset:26624
ds_read_b64_tr_b16 v[26:27], v6 offset:27648
v_mfma_f32_16x16x32_bf16 v[44:47], v[28:31], v[236:239], v[44:47]
v_mfma_f32_16x16x32_bf16 v[52:55], v[28:31], v[252:255], v[52:55]
s_waitcnt vmcnt(24)
s_barrier
s_waitcnt lgkmcnt(4)
v_mfma_f32_16x16x32_bf16 v[32:35], v[16:19], v[160:163], v[32:35]
ds_read_b64_tr_b16 v[28:29], v7 offset:26624
ds_read_b64_tr_b16 v[30:31], v7 offset:27648
v_mfma_f32_16x16x32_bf16 v[40:43], v[16:19], v[176:179], v[40:43]
s_add_u32 m0, s56, 0x14000
s_add_u32 s66, s48, 0x240
buffer_load_dwordx4 v4, s[28:31], s66 offen lds
v_mfma_f32_16x16x32_bf16 v[48:51], v[16:19], v[192:195], v[48:51]
s_add_u32 s67, s66, 0x4400
buffer_load_dwordx4 v4, s[28:31], s67 offen offset:1024 lds
s_waitcnt lgkmcnt(4)
v_mfma_f32_16x16x32_bf16 v[36:39], v[20:23], v[160:163], v[36:39]
ds_read_b64_tr_b16 v[16:17], v6 offset:28672
ds_read_b64_tr_b16 v[18:19], v6 offset:29696
v_mfma_f32_16x16x32_bf16 v[44:47], v[20:23], v[176:179], v[44:47]
buffer_store_dwordx4 v[60:63], v5, s[24:27], s74 offen offset:1024 sc1
v_mfma_f32_16x16x32_bf16 v[52:55], v[20:23], v[192:195], v[52:55]
s_add_u32 m0, s56, 0xa000
s_add_u32 s66, s47, 0x48000
buffer_load_dwordx4 v4, s[28:31], s66 offen lds
s_waitcnt lgkmcnt(4)
v_mfma_f32_16x16x32_bf16 v[32:35], v[24:27], v[164:167], v[32:35]
ds_read_b64_tr_b16 v[20:21], v7 offset:28672
ds_read_b64_tr_b16 v[22:23], v7 offset:29696
v_mfma_f32_16x16x32_bf16 v[40:43], v[24:27], v[180:183], v[40:43]
s_add_u32 s67, s66, 0x4400
buffer_load_dwordx4 v4, s[28:31], s67 offen offset:1024 lds
v_mfma_f32_16x16x32_bf16 v[48:51], v[24:27], v[196:199], v[48:51]
s_waitcnt lgkmcnt(4)
v_mfma_f32_16x16x32_bf16 v[36:39], v[28:31], v[164:167], v[36:39]
ds_read_b64_tr_b16 v[24:25], v6 offset:30720
ds_read_b64_tr_b16 v[26:27], v6 offset:31744
v_mfma_f32_16x16x32_bf16 v[44:47], v[28:31], v[180:183], v[44:47]
v_mfma_f32_16x16x32_bf16 v[52:55], v[28:31], v[196:199], v[52:55]
s_waitcnt lgkmcnt(4)
v_mfma_f32_16x16x32_bf16 v[32:35], v[16:19], v[168:171], v[32:35]
ds_read_b64_tr_b16 v[28:29], v7 offset:30720
ds_read_b64_tr_b16 v[30:31], v7 offset:31744
v_mfma_f32_16x16x32_bf16 v[40:43], v[16:19], v[184:187], v[40:43]
v_mfma_f32_16x16x32_bf16 v[48:51], v[16:19], v[200:203], v[48:51]
s_waitcnt lgkmcnt(4)
v_mfma_f32_16x16x32_bf16 v[36:39], v[20:23], v[168:171], v[36:39]
ds_read_b64_tr_b16 v[16:17], v6 offset:32768
ds_read_b64_tr_b16 v[18:19], v6 offset:33792
v_mfma_f32_16x16x32_bf16 v[44:47], v[20:23], v[184:187], v[44:47]
v_mfma_f32_16x16x32_bf16 v[52:55], v[20:23], v[200:203], v[52:55]
s_waitcnt lgkmcnt(4)
v_mfma_f32_16x16x32_bf16 v[32:35], v[24:27], v[172:175], v[32:35]
ds_read_b64_tr_b16 v[20:21], v7 offset:32768
ds_read_b64_tr_b16 v[22:23], v7 offset:33792
v_mfma_f32_16x16x32_bf16 v[40:43], v[24:27], v[188:191], v[40:43]
v_mfma_f32_16x16x32_bf16 v[48:51], v[24:27], v[204:207], v[48:51]
s_waitcnt lgkmcnt(4)
v_mfma_f32_16x16x32_bf16 v[36:39], v[28:31], v[172:175], v[36:39]
ds_read_b64_tr_b16 v[24:25], v6 offset:34816
ds_read_b64_tr_b16 v[26:27], v6 offset:35840
v_mfma_f32_16x16x32_bf16 v[44:47], v[28:31], v[188:191], v[44:47]
v_mfma_f32_16x16x32_bf16 v[52:55], v[28:31], v[204:207], v[52:55]
s_waitcnt vmcnt(24)
s_barrier
s_waitcnt lgkmcnt(4)
v_mfma_f32_16x16x32_bf16 v[32:35], v[16:19], v[112:115], v[32:35]
ds_read_b64_tr_b16 v[28:29], v7 offset:34816
ds_read_b64_tr_b16 v[30:31], v7 offset:35840
v_mfma_f32_16x16x32_bf16 v[40:43], v[16:19], v[128:131], v[40:43]
s_add_u32 m0, s56, 0x16000
s_add_u32 s66, s48, 0x24240
buffer_load_dwordx4 v4, s[28:31], s66 offen lds
v_mfma_f32_16x16x32_bf16 v[48:51], v[16:19], v[144:147], v[48:51]
s_add_u32 s67, s66, 0x4400
buffer_load_dwordx4 v4, s[28:31], s67 offen offset:1024 lds
s_waitcnt lgkmcnt(4)
v_mfma_f32_16x16x32_bf16 v[36:39], v[20:23], v[112:115], v[36:39]
ds_read_b64_tr_b16 v[16:17], v6 offset:36864
ds_read_b64_tr_b16 v[18:19], v6 offset:37888
v_mfma_f32_16x16x32_bf16 v[44:47], v[20:23], v[128:131], v[44:47]
buffer_store_dwordx4 v[12:15], v5, s[24:27], s74 offen offset:2048 sc1
s_add_u32 s74, s74, 0xc00
s_sub_u32 s55, s74, 0x6c00
s_cmp_ge_u32 s74, s75
s_cselect_b32 s74, s55, s74
v_mfma_f32_16x16x32_bf16 v[52:55], v[20:23], v[144:147], v[52:55]
s_add_u32 m0, s56, 0xc000
s_add_u32 s66, s47, 0
buffer_load_dwordx4 v4, s[28:31], s66 offen lds
s_waitcnt lgkmcnt(4)
v_mfma_f32_16x16x32_bf16 v[32:35], v[24:27], v[116:119], v[32:35]
ds_read_b64_tr_b16 v[20:21], v7 offset:36864
ds_read_b64_tr_b16 v[22:23], v7 offset:37888
v_mfma_f32_16x16x32_bf16 v[40:43], v[24:27], v[132:135], v[40:43]
s_add_u32 s67, s66, 0x4400
buffer_load_dwordx4 v4, s[28:31], s67 offen offset:1024 lds
v_mfma_f32_16x16x32_bf16 v[48:51], v[24:27], v[148:151], v[48:51]
s_waitcnt lgkmcnt(4)
v_mfma_f32_16x16x32_bf16 v[36:39], v[28:31], v[116:119], v[36:39]
ds_read_b64_tr_b16 v[24:25], v6 offset:38912
ds_read_b64_tr_b16 v[26:27], v6 offset:39936
v_mfma_f32_16x16x32_bf16 v[44:47], v[28:31], v[132:135], v[44:47]
v_mfma_f32_16x16x32_bf16 v[52:55], v[28:31], v[148:151], v[52:55]
s_waitcnt lgkmcnt(4)
v_mfma_f32_16x16x32_bf16 v[32:35], v[16:19], v[120:123], v[32:35]
ds_read_b64_tr_b16 v[28:29], v7 offset:38912
ds_read_b64_tr_b16 v[30:31], v7 offset:39936
v_mfma_f32_16x16x32_bf16 v[40:43], v[16:19], v[136:139], v[40:43]
v_mfma_f32_16x16x32_bf16 v[48:51], v[16:19], v[152:155], v[48:51]
s_waitcnt lgkmcnt(4)
v_mfma_f32_16x16x32_bf16 v[36:39], v[20:23], v[120:123], v[36:39]
ds_read_b64_tr_b16 v[16:17], v6 offset:40960
ds_read_b64_tr_b16 v[18:19], v6 offset:41984
v_mfma_f32_16x16x32_bf16 v[44:47], v[20:23], v[136:139], v[44:47]
v_mfma_f32_16x16x32_bf16 v[52:55], v[20:23], v[152:155], v[52:55]
s_waitcnt lgkmcnt(4)
v_mfma_f32_16x16x32_bf16 v[32:35], v[24:27], v[124:127], v[32:35]
ds_read_b64_tr_b16 v[20:21], v7 offset:40960
ds_read_b64_tr_b16 v[22:23], v7 offset:41984
v_mfma_f32_16x16x32_bf16 v[40:43], v[24:27], v[140:143], v[40:43]
v_mfma_f32_16x16x32_bf16 v[48:51], v[24:27], v[156:159], v[48:51]
s_waitcnt lgkmcnt(4)
v_mfma_f32_16x16x32_bf16 v[36:39], v[28:31], v[124:127], v[36:39]
ds_read_b64_tr_b16 v[24:25], v6 offset:43008
ds_read_b64_tr_b16 v[26:27], v6 offset:44032
v_mfma_f32_16x16x32_bf16 v[44:47], v[28:31], v[140:143], v[44:47]
v_mfma_f32_16x16x32_bf16 v[52:55], v[28:31], v[156:159], v[52:55]
s_waitcnt vmcnt(24)
s_barrier
s_waitcnt lgkmcnt(4)
v_mfma_f32_16x16x32_bf16 v[32:35], v[16:19], v[64:67], v[32:35]
ds_read_b64_tr_b16 v[28:29], v7 offset:43008
ds_read_b64_tr_b16 v[30:31], v7 offset:44032
v_mfma_f32_16x16x32_bf16 v[40:43], v[16:19], v[80:83], v[40:43]
s_add_u32 m0, s56, 0x18000
s_add_u32 s66, s48, 0x48240
buffer_load_dwordx4 v4, s[28:31], s66 offen lds
v_mfma_f32_16x16x32_bf16 v[48:51], v[16:19], v[96:99], v[48:51]
s_add_u32 s67, s66, 0x4400
buffer_load_dwordx4 v4, s[28:31], s67 offen offset:1024 lds
s_waitcnt lgkmcnt(4)
v_mfma_f32_16x16x32_bf16 v[36:39], v[20:23], v[64:67], v[36:39]
ds_read_b64_tr_b16 v[16:17], v6 offset:45056
ds_read_b64_tr_b16 v[18:19], v6 offset:46080
v_mfma_f32_16x16x32_bf16 v[44:47], v[20:23], v[80:83], v[44:47]
s_add_u32 m0, s56, 0xe000
s_add_u32 s66, s47, 0x24000
buffer_load_dwordx4 v4, s[28:31], s66 offen lds
v_mfma_f32_16x16x32_bf16 v[52:55], v[20:23], v[96:99], v[52:55]
s_add_u32 s67, s66, 0x4400
buffer_load_dwordx4 v4, s[28:31], s67 offen offset:1024 lds
s_waitcnt lgkmcnt(4)
v_mfma_f32_16x16x32_bf16 v[32:35], v[24:27], v[68:71], v[32:35]
ds_read_b64_tr_b16 v[20:21], v7 offset:45056
ds_read_b64_tr_b16 v[22:23], v7 offset:46080
v_mfma_f32_16x16x32_bf16 v[40:43], v[24:27], v[84:87], v[40:43]
v_mfma_f32_16x16x32_bf16 v[48:51], v[24:27], v[100:103], v[48:51]
s_waitcnt lgkmcnt(4)
v_mfma_f32_16x16x32_bf16 v[36:39], v[28:31], v[68:71], v[36:39]
ds_read_b64_tr_b16 v[24:25], v6 offset:47104
ds_read_b64_tr_b16 v[26:27], v6 offset:48128
v_mfma_f32_16x16x32_bf16 v[44:47], v[28:31], v[84:87], v[44:47]
v_mfma_f32_16x16x32_bf16 v[52:55], v[28:31], v[100:103], v[52:55]
s_waitcnt lgkmcnt(4)
v_mfma_f32_16x16x32_bf16 v[32:35], v[16:19], v[72:75], v[32:35]
ds_read_b64_tr_b16 v[28:29], v7 offset:47104
ds_read_b64_tr_b16 v[30:31], v7 offset:48128
v_mfma_f32_16x16x32_bf16 v[40:43], v[16:19], v[88:91], v[40:43]
v_mfma_f32_16x16x32_bf16 v[48:51], v[16:19], v[104:107], v[48:51]
s_waitcnt lgkmcnt(4)
v_mfma_f32_16x16x32_bf16 v[36:39], v[20:23], v[72:75], v[36:39]
ds_read_b64_tr_b16 v[16:17], v6
ds_read_b64_tr_b16 v[18:19], v6 offset:1024
v_mfma_f32_16x16x32_bf16 v[44:47], v[20:23], v[88:91], v[44:47]
v_mfma_f32_16x16x32_bf16 v[52:55], v[20:23], v[104:107], v[52:55]
s_waitcnt lgkmcnt(4)
v_mfma_f32_16x16x32_bf16 v[32:35], v[24:27], v[76:79], v[32:35]
ds_read_b64_tr_b16 v[20:21], v7
ds_read_b64_tr_b16 v[22:23], v7 offset:1024
v_mfma_f32_16x16x32_bf16 v[40:43], v[24:27], v[92:95], v[40:43]
v_mfma_f32_16x16x32_bf16 v[48:51], v[24:27], v[108:111], v[48:51]
s_waitcnt lgkmcnt(4)
v_mfma_f32_16x16x32_bf16 v[36:39], v[28:31], v[76:79], v[36:39]
ds_read_b64_tr_b16 v[24:25], v6 offset:2048
ds_read_b64_tr_b16 v[26:27], v6 offset:3072
v_mfma_f32_16x16x32_bf16 v[44:47], v[28:31], v[92:95], v[44:47]
v_mfma_f32_16x16x32_bf16 v[52:55], v[28:31], v[108:111], v[52:55]
v_cvt_pk_bf16_f32 v56, v32, v33
v_cvt_pk_bf16_f32 v57, v34, v35
s_nop 1
v_cvt_pk_bf16_f32 v58, v36, v37
v_cvt_pk_bf16_f32 v59, v38, v39
v_cvt_pk_bf16_f32 v60, v40, v41
v_cvt_pk_bf16_f32 v61, v42, v43
v_cvt_pk_bf16_f32 v62, v44, v45
v_cvt_pk_bf16_f32 v63, v46, v47
v_cvt_pk_bf16_f32 v12, v48, v49
v_cvt_pk_bf16_f32 v13, v50, v51
v_cvt_pk_bf16_f32 v14, v52, v53
v_cvt_pk_bf16_f32 v15, v54, v55
s_waitcnt vmcnt(23)
s_barrier
s_waitcnt lgkmcnt(4)
v_mfma_f32_16x16x32_bf16 v[32:35], v[16:19], v[208:211], 0
ds_read_b64_tr_b16 v[28:29], v7 offset:2048
ds_read_b64_tr_b16 v[30:31], v7 offset:3072
v_mfma_f32_16x16x32_bf16 v[40:43], v[16:19], v[224:227], 0
s_add_u32 m0, s56, 0x1a000
s_add_u32 s66, s48, 0x6c240
buffer_load_dwordx4 v4, s[28:31], s66 offen lds
v_mfma_f32_16x16x32_bf16 v[48:51], v[16:19], v[240:243], 0
s_add_u32 s67, s66, 0x4400
buffer_load_dwordx4 v4, s[28:31], s67 offen offset:1024 lds
s_waitcnt lgkmcnt(4)
v_mfma_f32_16x16x32_bf16 v[36:39], v[20:23], v[208:211], 0
ds_read_b64_tr_b16 v[16:17], v6 offset:4096
ds_read_b64_tr_b16 v[18:19], v6 offset:5120
v_mfma_f32_16x16x32_bf16 v[44:47], v[20:23], v[224:227], 0
buffer_store_dwordx4 v[56:59], v5, s[24:27], s74 offen sc1
v_mfma_f32_16x16x32_bf16 v[52:55], v[20:23], v[240:243], 0
s_add_u32 m0, s56, 0
s_add_u32 s66, s48, 0x6c000
buffer_load_dwordx4 v4, s[28:31], s66 offen lds
s_waitcnt lgkmcnt(4)
v_mfma_f32_16x16x32_bf16 v[32:35], v[24:27], v[212:215], v[32:35]
ds_read_b64_tr_b16 v[20:21], v7 offset:4096
ds_read_b64_tr_b16 v[22:23], v7 offset:5120
v_mfma_f32_16x16x32_bf16 v[40:43], v[24:27], v[228:231], v[40:43]
s_add_u32 s67, s66, 0x4400
buffer_load_dwordx4 v4, s[28:31], s67 offen offset:1024 lds
v_mfma_f32_16x16x32_bf16 v[48:51], v[24:27], v[244:247], v[48:51]
s_waitcnt lgkmcnt(4)
v_mfma_f32_16x16x32_bf16 v[36:39], v[28:31], v[212:215], v[36:39]
ds_read_b64_tr_b16 v[24:25], v6 offset:6144
ds_read_b64_tr_b16 v[26:27], v6 offset:7168
v_mfma_f32_16x16x32_bf16 v[44:47], v[28:31], v[228:231], v[44:47]
v_mfma_f32_16x16x32_bf16 v[52:55], v[28:31], v[244:247], v[52:55]
s_waitcnt lgkmcnt(4)
v_mfma_f32_16x16x32_bf16 v[32:35], v[16:19], v[216:219], v[32:35]
ds_read_b64_tr_b16 v[28:29], v7 offset:6144
ds_read_b64_tr_b16 v[30:31], v7 offset:7168
v_mfma_f32_16x16x32_bf16 v[40:43], v[16:19], v[232:235], v[40:43]
v_mfma_f32_16x16x32_bf16 v[48:51], v[16:19], v[248:251], v[48:51]
s_waitcnt lgkmcnt(4)
v_mfma_f32_16x16x32_bf16 v[36:39], v[20:23], v[216:219], v[36:39]
ds_read_b64_tr_b16 v[16:17], v6 offset:49152
ds_read_b64_tr_b16 v[18:19], v6 offset:50176
v_mfma_f32_16x16x32_bf16 v[44:47], v[20:23], v[232:235], v[44:47]
v_mfma_f32_16x16x32_bf16 v[52:55], v[20:23], v[248:251], v[52:55]
s_waitcnt lgkmcnt(4)
v_mfma_f32_16x16x32_bf16 v[32:35], v[24:27], v[220:223], v[32:35]
ds_read_b64_tr_b16 v[20:21], v7 offset:49152
ds_read_b64_tr_b16 v[22:23], v7 offset:50176
v_mfma_f32_16x16x32_bf16 v[40:43], v[24:27], v[236:239], v[40:43]
v_mfma_f32_16x16x32_bf16 v[48:51], v[24:27], v[252:255], v[48:51]
s_waitcnt lgkmcnt(4)
v_mfma_f32_16x16x32_bf16 v[36:39], v[28:31], v[220:223], v[36:39]
ds_read_b64_tr_b16 v[24:25], v6 offset:51200
ds_read_b64_tr_b16 v[26:27], v6 offset:52224
v_mfma_f32_16x16x32_bf16 v[44:47], v[28:31], v[236:239], v[44:47]
v_mfma_f32_16x16x32_bf16 v[52:55], v[28:31], v[252:255], v[52:55]
s_waitcnt vmcnt(24)
s_barrier
s_waitcnt lgkmcnt(4)
v_mfma_f32_16x16x32_bf16 v[32:35], v[16:19], v[160:163], v[32:35]
ds_read_b64_tr_b16 v[28:29], v7 offset:51200
ds_read_b64_tr_b16 v[30:31], v7 offset:52224
v_mfma_f32_16x16x32_bf16 v[40:43], v[16:19], v[176:179], v[40:43]
s_add_u32 m0, s56, 0x2000
s_add_u32 s66, s48, 0x48000
buffer_load_dwordx4 v4, s[28:31], s66 offen lds
v_mfma_f32_16x16x32_bf16 v[48:51], v[16:19], v[192:195], v[48:51]
buffer_store_dwordx4 v[60:63], v5, s[24:27], s74 offen offset:1024 sc1
s_waitcnt lgkmcnt(4)
v_mfma_f32_16x16x32_bf16 v[36:39], v[20:23], v[160:163], v[36:39]
ds_read_b64_tr_b16 v[16:17], v6 offset:53248
ds_read_b64_tr_b16 v[18:19], v6 offset:54272
v_mfma_f32_16x16x32_bf16 v[44:47], v[20:23], v[176:179], v[44:47]
s_add_u32 s67, s66, 0x4400
buffer_load_dwordx4 v4, s[28:31], s67 offen offset:1024 lds
v_mfma_f32_16x16x32_bf16 v[52:55], v[20:23], v[192:195], v[52:55]
s_waitcnt lgkmcnt(4)
v_mfma_f32_16x16x32_bf16 v[32:35], v[24:27], v[164:167], v[32:35]
ds_read_b64_tr_b16 v[20:21], v7 offset:53248
ds_read_b64_tr_b16 v[22:23], v7 offset:54272
v_mfma_f32_16x16x32_bf16 v[40:43], v[24:27], v[180:183], v[40:43]
v_mfma_f32_16x16x32_bf16 v[48:51], v[24:27], v[196:199], v[48:51]
s_waitcnt lgkmcnt(4)
v_mfma_f32_16x16x32_bf16 v[36:39], v[28:31], v[164:167], v[36:39]
ds_read_b64_tr_b16 v[24:25], v6 offset:55296
ds_read_b64_tr_b16 v[26:27], v6 offset:56320
v_mfma_f32_16x16x32_bf16 v[44:47], v[28:31], v[180:183], v[44:47]
v_mfma_f32_16x16x32_bf16 v[52:55], v[28:31], v[196:199], v[52:55]
s_waitcnt lgkmcnt(4)
v_mfma_f32_16x16x32_bf16 v[32:35], v[16:19], v[168:171], v[32:35]
ds_read_b64_tr_b16 v[28:29], v7 offset:55296
ds_read_b64_tr_b16 v[30:31], v7 offset:56320
v_mfma_f32_16x16x32_bf16 v[40:43], v[16:19], v[184:187], v[40:43]
v_mfma_f32_16x16x32_bf16 v[48:51], v[16:19], v[200:203], v[48:51]
s_waitcnt lgkmcnt(4)
v_mfma_f32_16x16x32_bf16 v[36:39], v[20:23], v[168:171], v[36:39]
ds_read_b64_tr_b16 v[16:17], v6 offset:57344
ds_read_b64_tr_b16 v[18:19], v6 offset:58368
v_mfma_f32_16x16x32_bf16 v[44:47], v[20:23], v[184:187], v[44:47]
v_mfma_f32_16x16x32_bf16 v[52:55], v[20:23], v[200:203], v[52:55]
s_waitcnt lgkmcnt(4)
v_mfma_f32_16x16x32_bf16 v[32:35], v[24:27], v[172:175], v[32:35]
ds_read_b64_tr_b16 v[20:21], v7 offset:57344
ds_read_b64_tr_b16 v[22:23], v7 offset:58368
v_mfma_f32_16x16x32_bf16 v[40:43], v[24:27], v[188:191], v[40:43]
v_mfma_f32_16x16x32_bf16 v[48:51], v[24:27], v[204:207], v[48:51]
s_waitcnt lgkmcnt(4)
v_mfma_f32_16x16x32_bf16 v[36:39], v[28:31], v[172:175], v[36:39]
ds_read_b64_tr_b16 v[24:25], v6 offset:59392
ds_read_b64_tr_b16 v[26:27], v6 offset:60416
v_mfma_f32_16x16x32_bf16 v[44:47], v[28:31], v[188:191], v[44:47]
v_mfma_f32_16x16x32_bf16 v[52:55], v[28:31], v[204:207], v[52:55]
s_waitcnt vmcnt(22)
s_barrier
s_waitcnt lgkmcnt(4)
v_mfma_f32_16x16x32_bf16 v[32:35], v[16:19], v[112:115], v[32:35]
ds_read_b64_tr_b16 v[28:29], v7 offset:59392
ds_read_b64_tr_b16 v[30:31], v7 offset:60416
v_mfma_f32_16x16x32_bf16 v[40:43], v[16:19], v[128:131], v[40:43]
s_add_u32 m0, s56, 0x4000
s_add_u32 s66, s48, 0
buffer_load_dwordx4 v4, s[28:31], s66 offen lds
v_mfma_f32_16x16x32_bf16 v[48:51], v[16:19], v[144:147], v[48:51]
buffer_store_dwordx4 v[12:15], v5, s[24:27], s74 offen offset:2048 sc1
s_add_u32 s74, s74, 0xc00
s_sub_u32 s55, s74, 0x6c00
s_cmp_ge_u32 s74, s75
s_cselect_b32 s74, s55, s74
s_waitcnt lgkmcnt(4)
v_mfma_f32_16x16x32_bf16 v[36:39], v[20:23], v[112:115], v[36:39]
ds_read_b64_tr_b16 v[16:17], v6 offset:61440
ds_read_b64_tr_b16 v[18:19], v6 offset:62464
v_mfma_f32_16x16x32_bf16 v[44:47], v[20:23], v[128:131], v[44:47]
s_add_u32 s67, s66, 0x4400
buffer_load_dwordx4 v4, s[28:31], s67 offen offset:1024 lds
v_mfma_f32_16x16x32_bf16 v[52:55], v[20:23], v[144:147], v[52:55]
s_waitcnt lgkmcnt(4)
v_mfma_f32_16x16x32_bf16 v[32:35], v[24:27], v[116:119], v[32:35]
ds_read_b64_tr_b16 v[20:21], v7 offset:61440
ds_read_b64_tr_b16 v[22:23], v7 offset:62464
v_mfma_f32_16x16x32_bf16 v[40:43], v[24:27], v[132:135], v[40:43]
v_mfma_f32_16x16x32_bf16 v[48:51], v[24:27], v[148:151], v[48:51]
s_waitcnt lgkmcnt(4)
v_mfma_f32_16x16x32_bf16 v[36:39], v[28:31], v[116:119], v[36:39]
ds_read_b64_tr_b16 v[24:25], v6 offset:63488
ds_read_b64_tr_b16 v[26:27], v6 offset:64512
v_mfma_f32_16x16x32_bf16 v[44:47], v[28:31], v[132:135], v[44:47]
v_mfma_f32_16x16x32_bf16 v[52:55], v[28:31], v[148:151], v[52:55]
s_waitcnt lgkmcnt(4)
v_mfma_f32_16x16x32_bf16 v[32:35], v[16:19], v[120:123], v[32:35]
ds_read_b64_tr_b16 v[28:29], v7 offset:63488
ds_read_b64_tr_b16 v[30:31], v7 offset:64512
v_mfma_f32_16x16x32_bf16 v[40:43], v[16:19], v[136:139], v[40:43]
v_mfma_f32_16x16x32_bf16 v[48:51], v[16:19], v[152:155], v[48:51]
s_waitcnt lgkmcnt(4)
v_mfma_f32_16x16x32_bf16 v[36:39], v[20:23], v[120:123], v[36:39]
ds_read_b64_tr_b16 v[16:17], v6 offset:8192
ds_read_b64_tr_b16 v[18:19], v6 offset:9216
v_mfma_f32_16x16x32_bf16 v[44:47], v[20:23], v[136:139], v[44:47]
v_mfma_f32_16x16x32_bf16 v[52:55], v[20:23], v[152:155], v[52:55]
s_waitcnt lgkmcnt(4)
v_mfma_f32_16x16x32_bf16 v[32:35], v[24:27], v[124:127], v[32:35]
ds_read_b64_tr_b16 v[20:21], v7 offset:8192
ds_read_b64_tr_b16 v[22:23], v7 offset:9216
v_mfma_f32_16x16x32_bf16 v[40:43], v[24:27], v[140:143], v[40:43]
v_mfma_f32_16x16x32_bf16 v[48:51], v[24:27], v[156:159], v[48:51]
s_waitcnt lgkmcnt(4)
v_mfma_f32_16x16x32_bf16 v[36:39], v[28:31], v[124:127], v[36:39]
ds_read_b64_tr_b16 v[24:25], v6 offset:10240
ds_read_b64_tr_b16 v[26:27], v6 offset:11264
v_mfma_f32_16x16x32_bf16 v[44:47], v[28:31], v[140:143], v[44:47]
v_mfma_f32_16x16x32_bf16 v[52:55], v[28:31], v[156:159], v[52:55]
s_waitcnt vmcnt(20)
s_barrier
s_waitcnt lgkmcnt(4)
v_mfma_f32_16x16x32_bf16 v[32:35], v[16:19], v[64:67], v[32:35]
ds_read_b64_tr_b16 v[28:29], v7 offset:10240
ds_read_b64_tr_b16 v[30:31], v7 offset:11264
v_mfma_f32_16x16x32_bf16 v[40:43], v[16:19], v[80:83], v[40:43]
s_add_u32 m0, s56, 0x8000
s_add_u32 s66, s48, 0x24000
buffer_load_dwordx4 v4, s[28:31], s66 offen lds
v_mfma_f32_16x16x32_bf16 v[48:51], v[16:19], v[96:99], v[48:51]
s_add_u32 s67, s66, 0x4400
buffer_load_dwordx4 v4, s[28:31], s67 offen offset:1024 lds
s_waitcnt lgkmcnt(4)
v_mfma_f32_16x16x32_bf16 v[36:39], v[20:23], v[64:67], v[36:39]
ds_read_b64_tr_b16 v[16:17], v6 offset:12288
ds_read_b64_tr_b16 v[18:19], v6 offset:13312
v_mfma_f32_16x16x32_bf16 v[44:47], v[20:23], v[80:83], v[44:47]
v_mfma_f32_16x16x32_bf16 v[52:55], v[20:23], v[96:99], v[52:55]
s_waitcnt lgkmcnt(4)
v_mfma_f32_16x16x32_bf16 v[32:35], v[24:27], v[68:71], v[32:35]
ds_read_b64_tr_b16 v[20:21], v7 offset:12288
ds_read_b64_tr_b16 v[22:23], v7 offset:13312
v_mfma_f32_16x16x32_bf16 v[40:43], v[24:27], v[84:87], v[40:43]
v_mfma_f32_16x16x32_bf16 v[48:51], v[24:27], v[100:103], v[48:51]
s_waitcnt lgkmcnt(4)
v_mfma_f32_16x16x32_bf16 v[36:39], v[28:31], v[68:71], v[36:39]
ds_read_b64_tr_b16 v[24:25], v6 offset:14336
ds_read_b64_tr_b16 v[26:27], v6 offset:15360
v_mfma_f32_16x16x32_bf16 v[44:47], v[28:31], v[84:87], v[44:47]
v_mfma_f32_16x16x32_bf16 v[52:55], v[28:31], v[100:103], v[52:55]
s_waitcnt lgkmcnt(4)
v_mfma_f32_16x16x32_bf16 v[32:35], v[16:19], v[72:75], v[32:35]
ds_read_b64_tr_b16 v[28:29], v7 offset:14336
ds_read_b64_tr_b16 v[30:31], v7 offset:15360
v_mfma_f32_16x16x32_bf16 v[40:43], v[16:19], v[88:91], v[40:43]
v_mfma_f32_16x16x32_bf16 v[48:51], v[16:19], v[104:107], v[48:51]
s_waitcnt lgkmcnt(4)
v_mfma_f32_16x16x32_bf16 v[36:39], v[20:23], v[72:75], v[36:39]
ds_read_b64_tr_b16 v[16:17], v6 offset:16384
ds_read_b64_tr_b16 v[18:19], v6 offset:17408
v_mfma_f32_16x16x32_bf16 v[44:47], v[20:23], v[88:91], v[44:47]
v_mfma_f32_16x16x32_bf16 v[52:55], v[20:23], v[104:107], v[52:55]
s_waitcnt lgkmcnt(4)
v_mfma_f32_16x16x32_bf16 v[32:35], v[24:27], v[76:79], v[32:35]
ds_read_b64_tr_b16 v[20:21], v7 offset:16384
ds_read_b64_tr_b16 v[22:23], v7 offset:17408
v_mfma_f32_16x16x32_bf16 v[40:43], v[24:27], v[92:95], v[40:43]
v_mfma_f32_16x16x32_bf16 v[48:51], v[24:27], v[108:111], v[48:51]
s_waitcnt lgkmcnt(4)
v_mfma_f32_16x16x32_bf16 v[36:39], v[28:31], v[76:79], v[36:39]
ds_read_b64_tr_b16 v[24:25], v6 offset:18432
ds_read_b64_tr_b16 v[26:27], v6 offset:19456
v_mfma_f32_16x16x32_bf16 v[44:47], v[28:31], v[92:95], v[44:47]
v_mfma_f32_16x16x32_bf16 v[52:55], v[28:31], v[108:111], v[52:55]
v_cvt_pk_bf16_f32 v56, v32, v33
v_cvt_pk_bf16_f32 v57, v34, v35
s_nop 1
v_cvt_pk_bf16_f32 v58, v36, v37
v_cvt_pk_bf16_f32 v59, v38, v39
v_cvt_pk_bf16_f32 v60, v40, v41
v_cvt_pk_bf16_f32 v61, v42, v43
v_cvt_pk_bf16_f32 v62, v44, v45
v_cvt_pk_bf16_f32 v63, v46, v47
v_cvt_pk_bf16_f32 v12, v48, v49
v_cvt_pk_bf16_f32 v13, v50, v51
v_cvt_pk_bf16_f32 v14, v52, v53
v_cvt_pk_bf16_f32 v15, v54, v55
s_waitcnt vmcnt(17)
s_barrier
s_waitcnt lgkmcnt(4)
v_mfma_f32_16x16x32_bf16 v[32:35], v[16:19], v[208:211], 0
ds_read_b64_tr_b16 v[28:29], v7 offset:18432
ds_read_b64_tr_b16 v[30:31], v7 offset:19456
v_mfma_f32_16x16x32_bf16 v[40:43], v[16:19], v[224:227], 0
buffer_store_dwordx4 v[56:59], v5, s[24:27], s74 offen sc1
v_mfma_f32_16x16x32_bf16 v[48:51], v[16:19], v[240:243], 0
s_waitcnt lgkmcnt(4)
v_mfma_f32_16x16x32_bf16 v[36:39], v[20:23], v[208:211], 0
ds_read_b64_tr_b16 v[16:17], v6 offset:20480
ds_read_b64_tr_b16 v[18:19], v6 offset:21504
v_mfma_f32_16x16x32_bf16 v[44:47], v[20:23], v[224:227], 0
v_mfma_f32_16x16x32_bf16 v[52:55], v[20:23], v[240:243], 0
s_waitcnt lgkmcnt(4)
v_mfma_f32_16x16x32_bf16 v[32:35], v[24:27], v[212:215], v[32:35]
ds_read_b64_tr_b16 v[20:21], v7 offset:20480
ds_read_b64_tr_b16 v[22:23], v7 offset:21504
v_mfma_f32_16x16x32_bf16 v[40:43], v[24:27], v[228:231], v[40:43]
v_mfma_f32_16x16x32_bf16 v[48:51], v[24:27], v[244:247], v[48:51]
s_waitcnt lgkmcnt(4)
v_mfma_f32_16x16x32_bf16 v[36:39], v[28:31], v[212:215], v[36:39]
ds_read_b64_tr_b16 v[24:25], v6 offset:22528
ds_read_b64_tr_b16 v[26:27], v6 offset:23552
v_mfma_f32_16x16x32_bf16 v[44:47], v[28:31], v[228:231], v[44:47]
v_mfma_f32_16x16x32_bf16 v[52:55], v[28:31], v[244:247], v[52:55]
s_waitcnt lgkmcnt(4)
v_mfma_f32_16x16x32_bf16 v[32:35], v[16:19], v[216:219], v[32:35]
ds_read_b64_tr_b16 v[28:29], v7 offset:22528
ds_read_b64_tr_b16 v[30:31], v7 offset:23552
v_mfma_f32_16x16x32_bf16 v[40:43], v[16:19], v[232:235], v[40:43]
v_mfma_f32_16x16x32_bf16 v[48:51], v[16:19], v[248:251], v[48:51]
s_waitcnt lgkmcnt(4)
v_mfma_f32_16x16x32_bf16 v[36:39], v[20:23], v[216:219], v[36:39]
ds_read_b64_tr_b16 v[16:17], v6 offset:24576
ds_read_b64_tr_b16 v[18:19], v6 offset:25600
v_mfma_f32_16x16x32_bf16 v[44:47], v[20:23], v[232:235], v[44:47]
v_mfma_f32_16x16x32_bf16 v[52:55], v[20:23], v[248:251], v[52:55]
s_waitcnt lgkmcnt(4)
v_mfma_f32_16x16x32_bf16 v[32:35], v[24:27], v[220:223], v[32:35]
ds_read_b64_tr_b16 v[20:21], v7 offset:24576
ds_read_b64_tr_b16 v[22:23], v7 offset:25600
v_mfma_f32_16x16x32_bf16 v[40:43], v[24:27], v[236:239], v[40:43]
v_mfma_f32_16x16x32_bf16 v[48:51], v[24:27], v[252:255], v[48:51]
s_waitcnt lgkmcnt(4)
v_mfma_f32_16x16x32_bf16 v[36:39], v[28:31], v[220:223], v[36:39]
ds_read_b64_tr_b16 v[24:25], v6 offset:26624
ds_read_b64_tr_b16 v[26:27], v6 offset:27648
v_mfma_f32_16x16x32_bf16 v[44:47], v[28:31], v[236:239], v[44:47]
v_mfma_f32_16x16x32_bf16 v[52:55], v[28:31], v[252:255], v[52:55]
s_waitcnt vmcnt(14)
s_barrier
s_waitcnt lgkmcnt(4)
v_mfma_f32_16x16x32_bf16 v[32:35], v[16:19], v[160:163], v[32:35]
ds_read_b64_tr_b16 v[28:29], v7 offset:26624
ds_read_b64_tr_b16 v[30:31], v7 offset:27648
v_mfma_f32_16x16x32_bf16 v[40:43], v[16:19], v[176:179], v[40:43]
buffer_store_dwordx4 v[60:63], v5, s[24:27], s74 offen offset:1024 sc1
v_mfma_f32_16x16x32_bf16 v[48:51], v[16:19], v[192:195], v[48:51]
s_waitcnt lgkmcnt(4)
v_mfma_f32_16x16x32_bf16 v[36:39], v[20:23], v[160:163], v[36:39]
ds_read_b64_tr_b16 v[16:17], v6 offset:28672
ds_read_b64_tr_b16 v[18:19], v6 offset:29696
v_mfma_f32_16x16x32_bf16 v[44:47], v[20:23], v[176:179], v[44:47]
v_mfma_f32_16x16x32_bf16 v[52:55], v[20:23], v[192:195], v[52:55]
s_waitcnt lgkmcnt(4)
v_mfma_f32_16x16x32_bf16 v[32:35], v[24:27], v[164:167], v[32:35]
ds_read_b64_tr_b16 v[20:21], v7 offset:28672
ds_read_b64_tr_b16 v[22:23], v7 offset:29696
v_mfma_f32_16x16x32_bf16 v[40:43], v[24:27], v[180:183], v[40:43]
v_mfma_f32_16x16x32_bf16 v[48:51], v[24:27], v[196:199], v[48:51]
s_waitcnt lgkmcnt(4)
v_mfma_f32_16x16x32_bf16 v[36:39], v[28:31], v[164:167], v[36:39]
ds_read_b64_tr_b16 v[24:25], v6 offset:30720
ds_read_b64_tr_b16 v[26:27], v6 offset:31744
v_mfma_f32_16x16x32_bf16 v[44:47], v[28:31], v[180:183], v[44:47]
v_mfma_f32_16x16x32_bf16 v[52:55], v[28:31], v[196:199], v[52:55]
s_waitcnt lgkmcnt(4)
v_mfma_f32_16x16x32_bf16 v[32:35], v[16:19], v[168:171], v[32:35]
ds_read_b64_tr_b16 v[28:29], v7 offset:30720
ds_read_b64_tr_b16 v[30:31], v7 offset:31744
v_mfma_f32_16x16x32_bf16 v[40:43], v[16:19], v[184:187], v[40:43]
v_mfma_f32_16x16x32_bf16 v[48:51], v[16:19], v[200:203], v[48:51]
s_waitcnt lgkmcnt(4)
v_mfma_f32_16x16x32_bf16 v[36:39], v[20:23], v[168:171], v[36:39]
ds_read_b64_tr_b16 v[16:17], v6 offset:32768
ds_read_b64_tr_b16 v[18:19], v6 offset:33792
v_mfma_f32_16x16x32_bf16 v[44:47], v[20:23], v[184:187], v[44:47]
v_mfma_f32_16x16x32_bf16 v[52:55], v[20:23], v[200:203], v[52:55]
s_waitcnt lgkmcnt(4)
v_mfma_f32_16x16x32_bf16 v[32:35], v[24:27], v[172:175], v[32:35]
ds_read_b64_tr_b16 v[20:21], v7 offset:32768
ds_read_b64_tr_b16 v[22:23], v7 offset:33792
v_mfma_f32_16x16x32_bf16 v[40:43], v[24:27], v[188:191], v[40:43]
v_mfma_f32_16x16x32_bf16 v[48:51], v[24:27], v[204:207], v[48:51]
s_waitcnt lgkmcnt(4)
v_mfma_f32_16x16x32_bf16 v[36:39], v[28:31], v[172:175], v[36:39]
ds_read_b64_tr_b16 v[24:25], v6 offset:34816
ds_read_b64_tr_b16 v[26:27], v6 offset:35840
v_mfma_f32_16x16x32_bf16 v[44:47], v[28:31], v[188:191], v[44:47]
v_mfma_f32_16x16x32_bf16 v[52:55], v[28:31], v[204:207], v[52:55]
s_waitcnt vmcnt(10)
s_barrier
s_waitcnt lgkmcnt(4)
v_mfma_f32_16x16x32_bf16 v[32:35], v[16:19], v[112:115], v[32:35]
ds_read_b64_tr_b16 v[28:29], v7 offset:34816
ds_read_b64_tr_b16 v[30:31], v7 offset:35840
v_mfma_f32_16x16x32_bf16 v[40:43], v[16:19], v[128:131], v[40:43]
buffer_store_dwordx4 v[12:15], v5, s[24:27], s74 offen offset:2048 sc1
s_add_u32 s74, s74, 0xc00
s_sub_u32 s55, s74, 0x6c00
s_cmp_ge_u32 s74, s75
s_cselect_b32 s74, s55, s74
v_mfma_f32_16x16x32_bf16 v[48:51], v[16:19], v[144:147], v[48:51]
s_waitcnt lgkmcnt(4)
v_mfma_f32_16x16x32_bf16 v[36:39], v[20:23], v[112:115], v[36:39]
ds_read_b64_tr_b16 v[16:17], v6 offset:36864
ds_read_b64_tr_b16 v[18:19], v6 offset:37888
v_mfma_f32_16x16x32_bf16 v[44:47], v[20:23], v[128:131], v[44:47]
v_mfma_f32_16x16x32_bf16 v[52:55], v[20:23], v[144:147], v[52:55]
s_waitcnt lgkmcnt(4)
v_mfma_f32_16x16x32_bf16 v[32:35], v[24:27], v[116:119], v[32:35]
ds_read_b64_tr_b16 v[20:21], v7 offset:36864
ds_read_b64_tr_b16 v[22:23], v7 offset:37888
v_mfma_f32_16x16x32_bf16 v[40:43], v[24:27], v[132:135], v[40:43]
v_mfma_f32_16x16x32_bf16 v[48:51], v[24:27], v[148:151], v[48:51]
s_waitcnt lgkmcnt(4)
v_mfma_f32_16x16x32_bf16 v[36:39], v[28:31], v[116:119], v[36:39]
ds_read_b64_tr_b16 v[24:25], v6 offset:38912
ds_read_b64_tr_b16 v[26:27], v6 offset:39936
v_mfma_f32_16x16x32_bf16 v[44:47], v[28:31], v[132:135], v[44:47]
v_mfma_f32_16x16x32_bf16 v[52:55], v[28:31], v[148:151], v[52:55]
s_waitcnt lgkmcnt(4)
v_mfma_f32_16x16x32_bf16 v[32:35], v[16:19], v[120:123], v[32:35]
ds_read_b64_tr_b16 v[28:29], v7 offset:38912
ds_read_b64_tr_b16 v[30:31], v7 offset:39936
v_mfma_f32_16x16x32_bf16 v[40:43], v[16:19], v[136:139], v[40:43]
v_mfma_f32_16x16x32_bf16 v[48:51], v[16:19], v[152:155], v[48:51]
s_waitcnt lgkmcnt(4)
v_mfma_f32_16x16x32_bf16 v[36:39], v[20:23], v[120:123], v[36:39]
ds_read_b64_tr_b16 v[16:17], v6 offset:40960
ds_read_b64_tr_b16 v[18:19], v6 offset:41984
v_mfma_f32_16x16x32_bf16 v[44:47], v[20:23], v[136:139], v[44:47]
v_mfma_f32_16x16x32_bf16 v[52:55], v[20:23], v[152:155], v[52:55]
s_waitcnt lgkmcnt(4)
v_mfma_f32_16x16x32_bf16 v[32:35], v[24:27], v[124:127], v[32:35]
ds_read_b64_tr_b16 v[20:21], v7 offset:40960
ds_read_b64_tr_b16 v[22:23], v7 offset:41984
v_mfma_f32_16x16x32_bf16 v[40:43], v[24:27], v[140:143], v[40:43]
v_mfma_f32_16x16x32_bf16 v[48:51], v[24:27], v[156:159], v[48:51]
s_waitcnt lgkmcnt(4)
v_mfma_f32_16x16x32_bf16 v[36:39], v[28:31], v[124:127], v[36:39]
ds_read_b64_tr_b16 v[24:25], v6 offset:43008
ds_read_b64_tr_b16 v[26:27], v6 offset:44032
v_mfma_f32_16x16x32_bf16 v[44:47], v[28:31], v[140:143], v[44:47]
v_mfma_f32_16x16x32_bf16 v[52:55], v[28:31], v[156:159], v[52:55]
s_waitcnt vmcnt(8)
s_barrier
s_waitcnt lgkmcnt(4)
v_mfma_f32_16x16x32_bf16 v[32:35], v[16:19], v[64:67], v[32:35]
ds_read_b64_tr_b16 v[28:29], v7 offset:43008
ds_read_b64_tr_b16 v[30:31], v7 offset:44032
v_mfma_f32_16x16x32_bf16 v[40:43], v[16:19], v[80:83], v[40:43]
v_mfma_f32_16x16x32_bf16 v[48:51], v[16:19], v[96:99], v[48:51]
s_waitcnt lgkmcnt(4)
v_mfma_f32_16x16x32_bf16 v[36:39], v[20:23], v[64:67], v[36:39]
ds_read_b64_tr_b16 v[16:17], v6 offset:45056
ds_read_b64_tr_b16 v[18:19], v6 offset:46080
v_mfma_f32_16x16x32_bf16 v[44:47], v[20:23], v[80:83], v[44:47]
v_mfma_f32_16x16x32_bf16 v[52:55], v[20:23], v[96:99], v[52:55]
s_waitcnt lgkmcnt(4)
v_mfma_f32_16x16x32_bf16 v[32:35], v[24:27], v[68:71], v[32:35]
ds_read_b64_tr_b16 v[20:21], v7 offset:45056
ds_read_b64_tr_b16 v[22:23], v7 offset:46080
v_mfma_f32_16x16x32_bf16 v[40:43], v[24:27], v[84:87], v[40:43]
v_mfma_f32_16x16x32_bf16 v[48:51], v[24:27], v[100:103], v[48:51]
s_waitcnt lgkmcnt(4)
v_mfma_f32_16x16x32_bf16 v[36:39], v[28:31], v[68:71], v[36:39]
ds_read_b64_tr_b16 v[24:25], v6 offset:47104
ds_read_b64_tr_b16 v[26:27], v6 offset:48128
v_mfma_f32_16x16x32_bf16 v[44:47], v[28:31], v[84:87], v[44:47]
v_mfma_f32_16x16x32_bf16 v[52:55], v[28:31], v[100:103], v[52:55]
s_waitcnt lgkmcnt(4)
v_mfma_f32_16x16x32_bf16 v[32:35], v[16:19], v[72:75], v[32:35]
ds_read_b64_tr_b16 v[28:29], v7 offset:47104
ds_read_b64_tr_b16 v[30:31], v7 offset:48128
v_mfma_f32_16x16x32_bf16 v[40:43], v[16:19], v[88:91], v[40:43]
v_mfma_f32_16x16x32_bf16 v[48:51], v[16:19], v[104:107], v[48:51]
s_waitcnt lgkmcnt(4)
v_mfma_f32_16x16x32_bf16 v[36:39], v[20:23], v[72:75], v[36:39]
v_mfma_f32_16x16x32_bf16 v[44:47], v[20:23], v[88:91], v[44:47]
v_mfma_f32_16x16x32_bf16 v[52:55], v[20:23], v[104:107], v[52:55]
s_waitcnt lgkmcnt(2)
v_mfma_f32_16x16x32_bf16 v[32:35], v[24:27], v[76:79], v[32:35]
v_mfma_f32_16x16x32_bf16 v[40:43], v[24:27], v[92:95], v[40:43]
v_mfma_f32_16x16x32_bf16 v[48:51], v[24:27], v[108:111], v[48:51]
s_waitcnt lgkmcnt(0)
v_mfma_f32_16x16x32_bf16 v[36:39], v[28:31], v[76:79], v[36:39]
v_mfma_f32_16x16x32_bf16 v[44:47], v[28:31], v[92:95], v[44:47]
v_mfma_f32_16x16x32_bf16 v[52:55], v[28:31], v[108:111], v[52:55]
s_nop 1
v_cvt_pk_bf16_f32 v56, v32, v33
v_cvt_pk_bf16_f32 v57, v34, v35
s_nop 1
v_cvt_pk_bf16_f32 v58, v36, v37
v_cvt_pk_bf16_f32 v59, v38, v39
v_cvt_pk_bf16_f32 v60, v40, v41
v_cvt_pk_bf16_f32 v61, v42, v43
v_cvt_pk_bf16_f32 v62, v44, v45
v_cvt_pk_bf16_f32 v63, v46, v47
v_cvt_pk_bf16_f32 v12, v48, v49
v_cvt_pk_bf16_f32 v13, v50, v51
v_cvt_pk_bf16_f32 v14, v52, v53
v_cvt_pk_bf16_f32 v15, v54, v55
buffer_store_dwordx4 v[56:59], v5, s[24:27], s74 offen sc1
buffer_store_dwordx4 v[60:63], v5, s[24:27], s74 offen offset:1024 sc1
buffer_store_dwordx4 v[12:15], v5, s[24:27], s74 offen offset:2048 sc1
s_add_u32 s74, s74, 0xc00
s_sub_u32 s55, s74, 0x6c00
s_cmp_ge_u32 s74, s75
s_cselect_b32 s74, s55, s74
s_waitcnt vmcnt(6)
s_barrier
s_endpgm
L_k1_end:
.globl k3_kernel
.p2align 8
.type k3_kernel,@function
k3_kernel:
s_cmp_ge_u32 s2, 1728
s_cbranch_scc0 L3_go
s_endpgm
L3_go:
s_load_dwordx2 s[4:5], s[0:1], 80
s_load_dwordx2 s[6:7], s[0:1], 96
v_lshrrev_b32 v1, 6, v0
s_nop 0
v_readfirstlane_b32 s16, v1
v_and_b32 v0, 63, v0
s_and_b32 s17, s2, 7
s_mul_i32 s17, s17, 0xd8
s_lshr_b32 s18, s2, 3
s_add_u32 s17, s17, s18
s_lshl_b32 s17, s17, 2
s_add_u32 s17, s17, s16
s_mul_hi_u32 s18, s17, 0x12f684c
s_mul_i32 s19, s18, 0xd8
s_sub_u32 s19, s17, s19
s_mul_hi_u32 s20, s19, 0x97b425f
s_mul_i32 s21, s20, 27
s_sub_u32 s21, s19, s21
s_mul_hi_u32 s22, s21, 0x55555556
s_mul_i32 s23, s22, 3
s_sub_u32 s23, s21, s23
s_waitcnt lgkmcnt(0)
s_mov_b32 s8, s6
s_mov_b32 s9, s7
s_mov_b32 s10, 0x3600000
s_mov_b32 s11, 0x20000
s_mov_b32 s12, s4
s_mov_b32 s13, s5
s_mov_b32 s14, 0x6c0000
s_mov_b32 s15, 0x20000
s_mul_i32 s24, s18, 0x1b0000
s_lshl_b32 s25, s19, 10
s_add_u32 s24, s24, s25
s_add_u32 s24, s24, 0
v_lshlrev_b32 v1, 4, v0
buffer_load_dwordx4 v[8:11], v1, s[8:11], s24 offen
s_add_u32 s24, s24, 0x36000
buffer_load_dwordx4 v[12:15], v1, s[8:11], s24 offen
s_add_u32 s24, s24, 0x36000
buffer_load_dwordx4 v[16:19], v1, s[8:11], s24 offen
s_add_u32 s24, s24, 0x36000
buffer_load_dwordx4 v[20:23], v1, s[8:11], s24 offen
s_add_u32 s24, s24, 0x36000
buffer_load_dwordx4 v[24:27], v1, s[8:11], s24 offen
s_add_u32 s24, s24, 0x36000
buffer_load_dwordx4 v[28:31], v1, s[8:11], s24 offen
s_add_u32 s24, s24, 0x36000
buffer_load_dwordx4 v[32:35], v1, s[8:11], s24 offen
s_add_u32 s24, s24, 0x36000
buffer_load_dwordx4 v[36:39], v1, s[8:11], s24 offen
s_add_u32 s24, s24, 0x36000
s_and_b32 s26, s18, 15
s_mul_i32 s26, s26, 0xc0
s_lshr_b32 s27, s20, 1
s_mul_i32 s27, s27, 48
s_add_u32 s26, s26, s27
s_lshl_b32 s27, s23, 4
s_add_u32 s26, s26, s27
s_mul_i32 s26, s26, 0x900
s_lshr_b32 s27, s18, 4
s_mul_i32 s27, s27, 0x480
s_add_u32 s26, s26, s27
s_and_b32 s27, s20, 1
s_mul_i32 s27, s27, 0x240
s_add_u32 s26, s26, s27
s_lshl_b32 s27, s22, 6
s_add_u32 s26, s26, s27
v_and_b32 v2, 15, v0
v_mul_u32_u24 v2, 0x900, v2
v_lshrrev_b32 v3, 4, v0
v_lshl_add_u32 v2, v3, 3, v2
s_waitcnt vmcnt(7)
v_lshlrev_b32 v40, 16, v8
v_and_b32 v41, 0xffff0000, v8
v_lshlrev_b32 v42, 16, v9
v_and_b32 v43, 0xffff0000, v9
v_lshlrev_b32 v44, 16, v10
v_and_b32 v45, 0xffff0000, v10
v_lshlrev_b32 v46, 16, v11
v_and_b32 v47, 0xffff0000, v11
s_waitcnt vmcnt(6)
v_lshlrev_b32 v4, 16, v12
v_and_b32 v5, 0xffff0000, v12
v_add_f32 v40, v40, v4
v_add_f32 v41, v41, v5
v_lshlrev_b32 v4, 16, v13
v_and_b32 v5, 0xffff0000, v13
v_add_f32 v42, v42, v4
v_add_f32 v43, v43, v5
v_lshlrev_b32 v4, 16, v14
v_and_b32 v5, 0xffff0000, v14
v_add_f32 v44, v44, v4
v_add_f32 v45, v45, v5
v_lshlrev_b32 v4, 16, v15
v_and_b32 v5, 0xffff0000, v15
v_add_f32 v46, v46, v4
v_add_f32 v47, v47, v5
s_waitcnt vmcnt(5)
v_lshlrev_b32 v4, 16, v16
v_and_b32 v5, 0xffff0000, v16
v_add_f32 v40, v40, v4
v_add_f32 v41, v41, v5
v_lshlrev_b32 v4, 16, v17
v_and_b32 v5, 0xffff0000, v17
v_add_f32 v42, v42, v4
v_add_f32 v43, v43, v5
v_lshlrev_b32 v4, 16, v18
v_and_b32 v5, 0xffff0000, v18
v_add_f32 v44, v44, v4
v_add_f32 v45, v45, v5
v_lshlrev_b32 v4, 16, v19
v_and_b32 v5, 0xffff0000, v19
v_add_f32 v46, v46, v4
v_add_f32 v47, v47, v5
s_waitcnt vmcnt(4)
v_lshlrev_b32 v4, 16, v20
v_and_b32 v5, 0xffff0000, v20
v_add_f32 v40, v40, v4
v_add_f32 v41, v41, v5
v_lshlrev_b32 v4, 16, v21
v_and_b32 v5, 0xffff0000, v21
v_add_f32 v42, v42, v4
v_add_f32 v43, v43, v5
v_lshlrev_b32 v4, 16, v22
v_and_b32 v5, 0xffff0000, v22
v_add_f32 v44, v44, v4
v_add_f32 v45, v45, v5
v_lshlrev_b32 v4, 16, v23
v_and_b32 v5, 0xffff0000, v23
v_add_f32 v46, v46, v4
v_add_f32 v47, v47, v5
s_waitcnt vmcnt(3)
v_lshlrev_b32 v4, 16, v24
v_and_b32 v5, 0xffff0000, v24
v_add_f32 v40, v40, v4
v_add_f32 v41, v41, v5
v_lshlrev_b32 v4, 16, v25
v_and_b32 v5, 0xffff0000, v25
v_add_f32 v42, v42, v4
v_add_f32 v43, v43, v5
v_lshlrev_b32 v4, 16, v26
v_and_b32 v5, 0xffff0000, v26
v_add_f32 v44, v44, v4
v_add_f32 v45, v45, v5
v_lshlrev_b32 v4, 16, v27
v_and_b32 v5, 0xffff0000, v27
v_add_f32 v46, v46, v4
v_add_f32 v47, v47, v5
s_waitcnt vmcnt(2)
v_lshlrev_b32 v4, 16, v28
v_and_b32 v5, 0xffff0000, v28
v_add_f32 v40, v40, v4
v_add_f32 v41, v41, v5
v_lshlrev_b32 v4, 16, v29
v_and_b32 v5, 0xffff0000, v29
v_add_f32 v42, v42, v4
v_add_f32 v43, v43, v5
v_lshlrev_b32 v4, 16, v30
v_and_b32 v5, 0xffff0000, v30
v_add_f32 v44, v44, v4
v_add_f32 v45, v45, v5
v_lshlrev_b32 v4, 16, v31
v_and_b32 v5, 0xffff0000, v31
v_add_f32 v46, v46, v4
v_add_f32 v47, v47, v5
s_waitcnt vmcnt(1)
v_lshlrev_b32 v4, 16, v32
v_and_b32 v5, 0xffff0000, v32
v_add_f32 v40, v40, v4
v_add_f32 v41, v41, v5
v_lshlrev_b32 v4, 16, v33
v_and_b32 v5, 0xffff0000, v33
v_add_f32 v42, v42, v4
v_add_f32 v43, v43, v5
v_lshlrev_b32 v4, 16, v34
v_and_b32 v5, 0xffff0000, v34
v_add_f32 v44, v44, v4
v_add_f32 v45, v45, v5
v_lshlrev_b32 v4, 16, v35
v_and_b32 v5, 0xffff0000, v35
v_add_f32 v46, v46, v4
v_add_f32 v47, v47, v5
s_waitcnt vmcnt(0)
v_lshlrev_b32 v4, 16, v36
v_and_b32 v5, 0xffff0000, v36
v_add_f32 v40, v40, v4
v_add_f32 v41, v41, v5
v_lshlrev_b32 v4, 16, v37
v_and_b32 v5, 0xffff0000, v37
v_add_f32 v42, v42, v4
v_add_f32 v43, v43, v5
v_lshlrev_b32 v4, 16, v38
v_and_b32 v5, 0xffff0000, v38
v_add_f32 v44, v44, v4
v_add_f32 v45, v45, v5
v_lshlrev_b32 v4, 16, v39
v_and_b32 v5, 0xffff0000, v39
v_add_f32 v46, v46, v4
v_add_f32 v47, v47, v5
v_cvt_pk_bf16_f32 v8, v40, v41
v_cvt_pk_bf16_f32 v9, v42, v43
v_cvt_pk_bf16_f32 v10, v44, v45
v_cvt_pk_bf16_f32 v11, v46, v47
buffer_store_dwordx2 v[8:9], v2, s[12:15], s26 offen
buffer_store_dwordx2 v[10:11], v2, s[12:15], s26 offen offset:32
s_endpgm
.section .rodata,"a"
.p2align 6
.amdhsa_kernel k1_kernel
  .amdhsa_next_free_vgpr 256
  .amdhsa_next_free_sgpr 102
  .amdhsa_accum_offset 256
  .amdhsa_group_segment_fixed_size 0
  .amdhsa_kernarg_size 104
  .amdhsa_user_sgpr_count 2
  .amdhsa_user_sgpr_kernarg_segment_ptr 1
  .amdhsa_system_sgpr_workgroup_id_x 1
.end_amdhsa_kernel
.p2align 6
.amdhsa_kernel k3_kernel
  .amdhsa_next_free_vgpr 48
  .amdhsa_next_free_sgpr 32
  .amdhsa_accum_offset 48
  .amdhsa_group_segment_fixed_size 0
  .amdhsa_kernarg_size 104
  .amdhsa_user_sgpr_count 2
  .amdhsa_user_sgpr_kernarg_segment_ptr 1
  .amdhsa_system_sgpr_workgroup_id_x 1
.end_amdhsa_kernel
```
